```python
import torch

def _softmax(x, axis=-1):
    return torch.softmax(x, dim=axis)
def _gelu(x):
    return torch.nn.functional.gelu(x, approximate="tanh")
def _silu(x):
    return torch.nn.functional.silu(x)
def _sigmoid(x):
    return torch.sigmoid(x)
def _layernorm(x, axis=-1, eps=1e-5):
    m = x.mean(dim=axis, keepdim=True)
    v = x.var(dim=axis, keepdim=True, unbiased=False)
    return (x - m) / torch.sqrt(v + eps)
def _scatter_add(tgt, idx, src, axis=0):
    return tgt.clone().index_add_(axis, idx, src)
def _segment_sum(src, seg, n):
    out = torch.zeros((n,) + src.shape[1:], dtype=src.dtype)
    return out.index_add_(0, seg, src)
def _pad(x, pw):
    flat = tuple(v for pair in reversed(pw) for v in pair)
    return torch.nn.functional.pad(x, flat)

kernel_name = 'interleave_layers__grouped_kv_mqa__dense_activation_silu__prompt'

def setup_inputs():

    _w = (lambda a: (lambda t: t.to(torch.bfloat16) if t.is_floating_point() else t)(torch.as_tensor(a)))
    def _A_setup():
        B, S, D, H = 1, 2048, 512, 32
        Dh = D // H
        return {
            "x": _w((lambda *s: torch.randn(*s, dtype=torch.bfloat16) * 0.05)(B, S, D)),
            "wq": _w((lambda *s: torch.randn(*s, dtype=torch.bfloat16) * 0.05)(D, H * Dh)),
            "wk": _w((lambda *s: torch.randn(*s, dtype=torch.bfloat16) * 0.05)(D, Dh)),
            "wv": _w((lambda *s: torch.randn(*s, dtype=torch.bfloat16) * 0.05)(D, Dh)),
            "wo": _w((lambda *s: torch.randn(*s, dtype=torch.bfloat16) * 0.05)(H * Dh, D)),
        }
    _A_in = _A_setup()

    def _B_setup():
        B, S, D, F = 1, 2048, 512, 1792
        return {
            "x": _w((lambda *s: torch.randn(*s, dtype=torch.bfloat16) * 0.05)(B, S, D)),
            "w1": _w((lambda *s: torch.randn(*s, dtype=torch.bfloat16) * 0.8)(D, F) * (D ** -0.5)),
            "w2": _w((lambda *s: torch.randn(*s, dtype=torch.bfloat16) * 0.8)(F, D) * (F ** -0.5)),
        }
    _B_in = _B_setup()

    return {
        "A_x": _A_in["x"],
        "A_wq": _A_in["wq"],
        "A_wk": _A_in["wk"],
        "A_wv": _A_in["wv"],
        "A_wo": _A_in["wo"],
        "B_x": _B_in["x"],
        "B_w1": _B_in["w1"],
        "B_w2": _B_in["w2"],
    }

def reference(A_x, A_wq, A_wk, A_wv, A_wo, B_x, B_w1, B_w2):
    def _A_ref(x, wq, wk, wv, wo):
        B, S, D = x.shape
        H = 32
        Dh = D // H
        q = (lambda x, *d: x.permute(*d))((x @ wq).reshape(B, S, H, Dh), 0, 2, 1, 3)
        k = x @ wk
        v = x @ wv
        scores = torch.einsum("bhqd,bkd->bhqk", q, k) * (Dh ** -0.5)
        p = _softmax(scores, axis=-1)
        o = torch.einsum("bhqk,bkd->bhqd", p, v)
        return (lambda x, *d: x.permute(*d))(o, 0, 2, 1, 3).reshape(B, S, H * Dh) @ wo

    def _B_ref(x, w1, w2):
        h = torch.einsum("bsd,df->bsf", x, w1)
        h = _silu(h)
        out = torch.einsum("bsf,fd->bsd", h, w2)
        return out

    x = A_x
    x = x + _A_ref(_layernorm(x, axis=-1), A_wq, A_wk, A_wv, A_wo)
    x = x + _B_ref(_layernorm(x, axis=-1), B_w1, B_w2)
    x = x + _A_ref(_layernorm(x, axis=-1), A_wq, A_wk, A_wv, A_wo)
    x = x + _B_ref(_layernorm(x, axis=-1), B_w1, B_w2)
    return x
```

```asm
; @launch grid=(256,1,1) block=(256,1,1) lds=163840
.amdgcn_target "amdgcn-amd-amdhsa--gfx950"
.text
.globl interleave_layers__grouped_kv_mqa__dense_activation_silu__prompt_kernel
.p2align 8
.type interleave_layers__grouped_kv_mqa__dense_activation_silu__prompt_kernel,@function
interleave_layers__grouped_kv_mqa__dense_activation_silu__prompt_kernel:
    s_cmp_ge_u32 s2, 256
    s_cbranch_scc1 Lend_1
    s_getpc_b64 s[56:57]
Lpc0:
    s_mov_b32 s58, Lend_1-Lpc0
    s_mov_b32 s59, 0x20000
    s_lshl_b32 s60, s2, 9
    s_and_b32 s60, s60, 0x1f000
    v_lshlrev_b32 v1, 4, v0
    buffer_load_dwordx4 v[224:227], v1, s[56:59], s60 offen
    s_load_dwordx2 s[42:43], s[0:1], 0
    s_load_dwordx4 s[48:51], s[0:1], 8
    s_load_dwordx2 s[52:53], s[0:1], 24
    s_load_dwordx2 s[66:67], s[0:1], 72
    s_load_dwordx2 s[4:5], s[0:1], 80
    s_load_dwordx2 s[8:9], s[0:1], 64
    s_cmp_lt_u32 s2, 80
    s_cselect_b32 s60, 32, 56
    s_cmp_ge_u32 s2, 136
    s_cselect_b32 s60, 48, s60
    s_load_dwordx2 s[34:35], s[0:1], s60
    s_memrealtime s[62:63]
    v_lshrrev_b32 v1, 6, v0
    s_nop 0
    v_readfirstlane_b32 s16, v1
    v_and_b32 v0, 63, v0
    s_and_b32 s17, s2, 31
    s_lshr_b32 s18, s2, 5
    v_lshlrev_b32 v1, 4, v0
    v_lshrrev_b32 v148, 4, v0
    v_xor_b32 v144, v0, v148
    v_and_b32 v144, 15, v144
    v_lshlrev_b32 v144, 4, v144
    v_lshl_add_u32 v144, v148, 10, v144
    v_xor_b32 v145, 64, v144
    v_add_u32 v145, 3072, v145
    v_xor_b32 v146, 128, v144
    v_add_u32 v146, 6144, v146
    v_xor_b32 v147, 192, v144
    v_add_u32 v147, 9216, v147
    v_lshrrev_b32 v149, 3, v0
    v_and_b32 v148, 3, v149
    v_lshlrev_b32 v148, 1, v148
    v_xor_b32 v148, v0, v148
    v_and_b32 v148, 7, v148
    v_lshlrev_b32 v148, 4, v148
    v_lshl_add_u32 v148, v149, 10, v148
    v_add_u32 v149, 7168, v148
    v_add_u32 v150, 14336, v148
    v_add_u32 v151, 21504, v148
    s_lshl_b32 s19, s16, 13
    s_lshl_b32 s30, s16, 14
    s_lshl_b32 s36, s16, 12
    s_lshl_b32 s60, s17, 16
    s_lshl_b32 s61, s16, 8
    s_add_u32 s61, s61, s60
    s_lshl_b32 s54, s16, 17
    s_lshl_b32 s55, s18, 7
    s_add_u32 s54, s54, s55
    s_add_u32 s55, s19, 131072
    s_waitcnt lgkmcnt(0)
    s_or_b32 s56, s2, s16
    s_cmp_lg_u32 s56, 0
    s_cbranch_scc1 Lnn_3
    s_lshl_b32 s62, s62, 4
    s_bitset1_b32 s62, 31
    v_mov_b32 v14, s62
    v_mov_b32 v15, 0
    s_mov_b64 exec, 1
    global_store_dword v15, v14, s[66:67] sc1
    s_mov_b64 exec, -1
Lnn_3:
    s_mov_b32 s6, 268435456
    s_mov_b32 s7, 0x20000
    s_cmp_lt_u32 s18, 6
    s_cbranch_scc1 Lnt_5
    s_mul_i32 s44, s18, 67584
    s_mul_i32 s45, s17, 2112
    s_add_u32 s44, s44, s45
    s_add_u32 s44, s44, 4444160
    s_lshl_b32 s45, s18, 13
    s_lshl_b32 s46, s17, 8
    s_add_u32 s45, s45, s46
    s_add_u32 s45, s45, 5070848
    s_cmp_eq_u32 s16, 1
    s_cselect_b32 s44, s45, s44
    s_cselect_b32 s45, 2, 5
    v_lshlrev_b32 v98, s45, v0
    s_cmp_ge_u32 s16, 2
    s_cbranch_scc1 Lnt_5
    buffer_load_dword v99, v98, s[4:7], s44 offen sc1
Lnt_5:
    s_lshl_b32 s56, s18, 13
    s_add_u32 s56, s56, s60
    s_lshr_b32 s57, s17, 3
    s_lshl_b32 s57, s57, 1
    s_and_b32 s58, s16, 1
    s_add_u32 s57, s57, s58
    s_lshl_b32 s57, s57, 16
    s_lshl_b32 s58, s18, 7
    s_add_u32 s57, s57, s58
    s_cmp_lt_u32 s16, 2
    s_cselect_b32 s56, s57, s56
    s_cselect_b32 s57, 10, 7
    s_cselect_b64 s[64:65], s[48:49], s[42:43]
    s_bitcmp1_b32 s2, 4
    s_cselect_b64 s[58:59], s[52:53], s[50:51]
    s_and_b32 s62, s2, 8
    s_lshl_b32 s62, s62, 10
    s_cmp_eq_u32 s16, 3
    s_cselect_b32 s56, s62, s56
    s_cselect_b64 s[64:65], s[58:59], s[64:65]
    v_lshlrev_b32 v96, s57, v0
    v_add_u32 v96, s56, v96
    global_load_dword v97, v96, s[64:65]
    s_add_u32 s68, s42, s61
    s_addc_u32 s69, s43, 0
    s_add_u32 s12, s48, s54
    s_addc_u32 s13, s49, 0
    s_add_u32 m0, s30, 0
    s_add_u32 s64, s68, 0
    s_addc_u32 s65, s69, 0
    global_load_lds_dwordx4 v144, s[64:65] offset:0
    global_load_lds_dwordx4 v145, s[64:65] offset:1024
    global_load_lds_dwordx4 v146, s[64:65] offset:2048
    global_load_lds_dwordx4 v147, s[64:65] offset:3072
    s_add_u32 m0, s30, 4096
    s_add_u32 s64, s68, 16384
    s_addc_u32 s65, s69, 0
    global_load_lds_dwordx4 v144, s[64:65] offset:0
    global_load_lds_dwordx4 v145, s[64:65] offset:1024
    global_load_lds_dwordx4 v146, s[64:65] offset:2048
    global_load_lds_dwordx4 v147, s[64:65] offset:3072
    s_mov_b32 s6, 268435456
    s_mov_b32 s7, 0x20000
    v_lshlrev_b32 v3, 2, v0
    s_and_b32 s60, s16, 1
    s_lshl_b32 s37, s60, 10
    s_lshl_b32 s60, s60, 8
    v_xor_b32 v2, s60, v1
    s_getreg_b32 s14, hwreg(HW_REG_XCC_ID)
    s_and_b32 s14, s14, 15
    v_mov_b32 v4, 0x3f803f80
    v_mov_b32 v5, 1
    v_mov_b32 v8, 0
    v_mov_b32 v9, 0
    v_mov_b32 v12, 0
    v_mov_b32 v13, 0
    s_xor_b32 s60, s16, 0
    s_lshl_b32 s30, s60, 14
    s_mul_i32 s60, s60, 7168
    s_add_u32 s26, s60, 135168
    s_xor_b32 s60, s16, 1
    s_lshl_b32 s31, s60, 14
    s_mul_i32 s60, s60, 7168
    s_add_u32 s27, s60, 135168
    s_xor_b32 s60, s16, 2
    s_lshl_b32 s32, s60, 14
    s_mul_i32 s60, s60, 7168
    s_add_u32 s28, s60, 135168
    s_xor_b32 s60, s16, 3
    s_lshl_b32 s33, s60, 14
    s_mul_i32 s60, s60, 7168
    s_add_u32 s29, s60, 135168
    v_and_b32 v152, 31, v0
    v_lshrrev_b32 v153, 5, v0
    v_lshlrev_b32 v214, 10, v152
    v_lshl_add_u32 v214, v153, 4, v214
    s_lshl_b32 s60, s18, 7
    s_mul_i32 s61, s16, -224
    s_add_u32 s60, s60, s61
    s_add_u32 s60, s60, 1024
    v_add_u32 v214, s60, v214
    v_and_b32 v154, 15, v152
    v_lshl_add_u32 v153, v154, 1, v153
    v_lshlrev_b32 v153, 3, v153
    v_lshl_add_u32 v152, v152, 8, v153
    v_add_u32 v152, s30, v152
    v_xor_b32 v153, 32, v152
    v_xor_b32 v154, 64, v152
    v_xor_b32 v155, 96, v152
    v_xor_b32 v156, 128, v152
    v_xor_b32 v157, 160, v152
    v_xor_b32 v158, 192, v152
    v_xor_b32 v159, 224, v152
    v_xor_b32 v216, 16, v152
    v_xor_b32 v217, 48, v152
    v_xor_b32 v218, 80, v152
    v_xor_b32 v219, 112, v152
    v_xor_b32 v220, 144, v152
    v_xor_b32 v221, 176, v152
    v_xor_b32 v222, 208, v152
    v_xor_b32 v223, 240, v152
    v_lshrrev_b32 v192, 5, v0
    v_bfe_u32 v194, v0, 2, 2
    v_lshl_add_u32 v192, v192, 2, v194
    v_lshlrev_b32 v192, 7, v192
    v_and_b32 v193, 3, v0
    v_lshl_add_u32 v192, v193, 3, v192
    v_bfe_u32 v193, v0, 4, 1
    v_xor_b32 v195, s16, v193
    v_xor_b32 v195, v195, v194
    v_lshl_add_u32 v195, v195, 5, v192
    s_add_u32 s60, s30, 65536
    v_add_u32 v195, s60, v195
    v_xor_b32 v196, 64, v195
    v_and_b32 v199, 124, v3
    s_lshl_b32 s61, s16, 6
    v_xor_b32 v197, s61, v199
    v_add_u32 v197, 65536, v197
    v_xor_b32 v198, 128, v197
    v_add_u32 v199, 131072, v199
    v_add_u32 v192, s30, v197
    v_add_u32 v193, s30, v198
    s_lshl_b32 s61, s16, 7
    v_add_u32 v194, s61, v199
    s_add_u32 s61, s19, 131072
    v_mov_b32 v112, v4
    v_mov_b32 v113, v4
    v_mov_b32 v114, v4
    v_mov_b32 v115, v4
    v_lshrrev_b32 v116, 5, v0
    v_bfe_u32 v118, v0, 2, 2
    v_lshl_add_u32 v116, v116, 2, v118
    v_lshlrev_b32 v116, 5, v116
    v_and_b32 v117, 3, v0
    v_lshl_add_u32 v116, v117, 3, v116
    v_bfe_u32 v117, v0, 4, 1
    v_lshl_add_u32 v116, v117, 12, v116
    v_add_u32 v116, s61, v116
    s_cmp_lt_u32 s2, 80
    s_cselect_b32 s60, 64, 80
    s_sub_u32 s60, s2, s60
    s_lshl_b32 s60, s60, 15
    s_lshr_b32 s61, s16, 1
    s_lshl_b32 s61, s61, 14
    s_add_u32 s60, s60, s61
    s_lshr_b32 s61, s37, 1
    s_add_u32 s60, s60, s61
    s_sub_u32 s61, s2, 136
    s_lshl_b32 s61, s61, 6
    s_mul_i32 s62, s16, 458752
    s_add_u32 s61, s61, s62
    s_cmp_ge_u32 s2, 136
    s_cselect_b32 s60, s61, s60
    s_cselect_b32 s3, 57344, 64
    s_movk_i32 s62, 1024
    s_cmovk_i32 s62, 3584
    s_sub_u32 s61, s2, 64
    s_cmp_ge_u32 s61, 128
    s_cmov_b32 s60, 0
    s_cmov_b32 s3, 0
    s_cmov_b32 s62, 0
    v_lshrrev_b32 v215, 2, v0
    v_mul_lo_u32 v215, v215, s62
    v_and_b32 v96, 48, v1
    v_add_u32 v215, v215, v96
    s_add_u32 s34, s34, s60
    s_addc_u32 s35, s35, 0
    v_mov_b32 v15, 0
    global_load_dword v14, v15, s[66:67] sc1
    s_cmp_ge_u32 s18, 2
    s_cbranch_scc1 Lnokv_6
    s_add_u32 m0, s19, 131072
    s_add_u32 s64, s50, s36
    s_addc_u32 s65, s51, 0
    global_load_lds_dwordx4 v1, s[64:65] offset:0
    global_load_lds_dwordx4 v1, s[64:65] offset:1024
    global_load_lds_dwordx4 v1, s[64:65] offset:2048
    global_load_lds_dwordx4 v1, s[64:65] offset:3072
    s_add_u32 m0, s19, 135168
    s_add_u32 s64, s52, s36
    s_addc_u32 s65, s53, 0
    global_load_lds_dwordx4 v1, s[64:65] offset:0
    global_load_lds_dwordx4 v1, s[64:65] offset:1024
    global_load_lds_dwordx4 v1, s[64:65] offset:2048
    global_load_lds_dwordx4 v1, s[64:65] offset:3072
    s_waitcnt vmcnt(9)
    ds_read_b64 v[32:33], v152 offset:0
    ds_read_b64 v[34:35], v216 offset:0
    ds_read_b64 v[36:37], v153 offset:0
    ds_read_b64 v[38:39], v217 offset:0
    ds_read_b64 v[40:41], v154 offset:0
    ds_read_b64 v[42:43], v218 offset:0
    ds_read_b64 v[44:45], v155 offset:0
    ds_read_b64 v[46:47], v219 offset:0
    ds_read_b64 v[48:49], v156 offset:0
    ds_read_b64 v[50:51], v220 offset:0
    ds_read_b64 v[52:53], v157 offset:0
    ds_read_b64 v[54:55], v221 offset:0
    ds_read_b64 v[56:57], v158 offset:0
    ds_read_b64 v[58:59], v222 offset:0
    ds_read_b64 v[60:61], v159 offset:0
    ds_read_b64 v[62:63], v223 offset:0
    s_waitcnt lgkmcnt(14)
    s_add_u32 m0, s30, 65536
    s_add_u32 s64, s12, 0
    s_addc_u32 s65, s13, 0
    global_load_lds_dwordx4 v148, s[64:65] offset:0
    v_dot2_f32_bf16 v24, v32, v4, 0
    v_dot2_f32_bf16 v25, v32, v32, 0
    v_dot2_f32_bf16 v24, v33, v4, v24
    v_dot2_f32_bf16 v25, v33, v33, v25
    v_dot2_f32_bf16 v24, v34, v4, v24
    v_dot2_f32_bf16 v25, v34, v34, v25
    v_dot2_f32_bf16 v24, v35, v4, v24
    v_dot2_f32_bf16 v25, v35, v35, v25
    s_waitcnt lgkmcnt(12)
    v_dot2_f32_bf16 v24, v36, v4, v24
    v_dot2_f32_bf16 v25, v36, v36, v25
    global_load_lds_dwordx4 v149, s[64:65] offset:1024
    v_dot2_f32_bf16 v24, v37, v4, v24
    v_dot2_f32_bf16 v25, v37, v37, v25
    v_dot2_f32_bf16 v24, v38, v4, v24
    v_dot2_f32_bf16 v25, v38, v38, v25
    v_dot2_f32_bf16 v24, v39, v4, v24
    v_dot2_f32_bf16 v25, v39, v39, v25
    s_waitcnt lgkmcnt(10)
    v_dot2_f32_bf16 v24, v40, v4, v24
    v_dot2_f32_bf16 v25, v40, v40, v25
    v_dot2_f32_bf16 v24, v41, v4, v24
    v_dot2_f32_bf16 v25, v41, v41, v25
    global_load_lds_dwordx4 v150, s[64:65] offset:2048
    v_dot2_f32_bf16 v24, v42, v4, v24
    v_dot2_f32_bf16 v25, v42, v42, v25
    v_dot2_f32_bf16 v24, v43, v4, v24
    v_dot2_f32_bf16 v25, v43, v43, v25
    s_waitcnt lgkmcnt(8)
    v_dot2_f32_bf16 v24, v44, v4, v24
    v_dot2_f32_bf16 v25, v44, v44, v25
    v_dot2_f32_bf16 v24, v45, v4, v24
    v_dot2_f32_bf16 v25, v45, v45, v25
    v_dot2_f32_bf16 v24, v46, v4, v24
    v_dot2_f32_bf16 v25, v46, v46, v25
    v_dot2_f32_bf16 v24, v47, v4, v24
    global_load_lds_dwordx4 v151, s[64:65] offset:3072
    v_dot2_f32_bf16 v25, v47, v47, v25
    s_waitcnt lgkmcnt(6)
    v_dot2_f32_bf16 v24, v48, v4, v24
    v_dot2_f32_bf16 v25, v48, v48, v25
    v_dot2_f32_bf16 v24, v49, v4, v24
    v_dot2_f32_bf16 v25, v49, v49, v25
    v_dot2_f32_bf16 v24, v50, v4, v24
    v_dot2_f32_bf16 v25, v50, v50, v25
    v_dot2_f32_bf16 v24, v51, v4, v24
    v_dot2_f32_bf16 v25, v51, v51, v25
    s_waitcnt lgkmcnt(4)
    s_add_u32 m0, s30, 69632
    s_add_u32 s64, s12, 32768
    s_addc_u32 s65, s13, 0
    global_load_lds_dwordx4 v148, s[64:65] offset:0
    v_dot2_f32_bf16 v24, v52, v4, v24
    v_dot2_f32_bf16 v25, v52, v52, v25
    v_dot2_f32_bf16 v24, v53, v4, v24
    v_dot2_f32_bf16 v25, v53, v53, v25
    v_dot2_f32_bf16 v24, v54, v4, v24
    v_dot2_f32_bf16 v25, v54, v54, v25
    v_dot2_f32_bf16 v24, v55, v4, v24
    v_dot2_f32_bf16 v25, v55, v55, v25
    s_waitcnt lgkmcnt(2)
    v_dot2_f32_bf16 v24, v56, v4, v24
    v_dot2_f32_bf16 v25, v56, v56, v25
    global_load_lds_dwordx4 v149, s[64:65] offset:1024
    v_dot2_f32_bf16 v24, v57, v4, v24
    v_dot2_f32_bf16 v25, v57, v57, v25
    v_dot2_f32_bf16 v24, v58, v4, v24
    v_dot2_f32_bf16 v25, v58, v58, v25
    v_dot2_f32_bf16 v24, v59, v4, v24
    v_dot2_f32_bf16 v25, v59, v59, v25
    s_waitcnt lgkmcnt(0)
    v_dot2_f32_bf16 v24, v60, v4, v24
    v_dot2_f32_bf16 v25, v60, v60, v25
    v_dot2_f32_bf16 v24, v61, v4, v24
    v_dot2_f32_bf16 v25, v61, v61, v25
    v_dot2_f32_bf16 v24, v62, v4, v24
    global_load_lds_dwordx4 v150, s[64:65] offset:2048
    v_dot2_f32_bf16 v25, v62, v62, v25
    v_dot2_f32_bf16 v24, v63, v4, v24
    v_dot2_f32_bf16 v25, v63, v63, v25
    s_nop 2
    v_permlane32_swap_b32 v24, v25
    v_add_f32 v24, v24, v25
    s_waitcnt vmcnt(7)
    ds_read_b64_tr_b16 a[160:161], v116 offset:0
    ds_read_b64_tr_b16 a[162:163], v116 offset:256
    ds_read_b64_tr_b16 a[164:165], v116 offset:512
    ds_read_b64_tr_b16 a[166:167], v116 offset:768
    ds_read_b64_tr_b16 a[168:169], v116 offset:1024
    global_load_lds_dwordx4 v151, s[64:65] offset:3072
    ds_read_b64_tr_b16 a[170:171], v116 offset:1280
    ds_read_b64_tr_b16 a[172:173], v116 offset:1536
    ds_read_b64_tr_b16 a[174:175], v116 offset:1792
    ds_read_b64_tr_b16 a[176:177], v116 offset:2048
    ds_read_b64_tr_b16 a[178:179], v116 offset:2304
    ds_read_b64_tr_b16 a[180:181], v116 offset:2560
    ds_read_b64_tr_b16 a[182:183], v116 offset:2816
    ds_read_b64_tr_b16 a[184:185], v116 offset:3072
    ds_read_b64_tr_b16 a[186:187], v116 offset:3328
    ds_read_b64_tr_b16 a[188:189], v116 offset:3584
    ds_read_b64_tr_b16 a[190:191], v116 offset:3840
    s_waitcnt lgkmcnt(14)
    v_mfma_f32_32x32x16_bf16 v[128:143], v[112:115], a[160:163], 0
    s_waitcnt lgkmcnt(12)
    v_mfma_f32_32x32x16_bf16 v[128:143], v[112:115], a[164:167], v[128:143]
    s_add_u32 m0, s30, 73728
    s_add_u32 s64, s12, 65536
    s_addc_u32 s65, s13, 0
    global_load_lds_dwordx4 v148, s[64:65] offset:0
    s_waitcnt lgkmcnt(10)
    v_mfma_f32_32x32x16_bf16 v[128:143], v[112:115], a[168:171], v[128:143]
    s_waitcnt lgkmcnt(8)
    v_mfma_f32_32x32x16_bf16 v[128:143], v[112:115], a[172:175], v[128:143]
    global_load_lds_dwordx4 v149, s[64:65] offset:1024
    s_waitcnt lgkmcnt(6)
    v_mfma_f32_32x32x16_bf16 v[128:143], v[112:115], a[176:179], v[128:143]
    s_waitcnt lgkmcnt(4)
    v_mfma_f32_32x32x16_bf16 v[128:143], v[112:115], a[180:183], v[128:143]
    global_load_lds_dwordx4 v150, s[64:65] offset:2048
    s_waitcnt lgkmcnt(2)
    v_mfma_f32_32x32x16_bf16 v[128:143], v[112:115], a[184:187], v[128:143]
    s_waitcnt lgkmcnt(0)
    v_mfma_f32_32x32x16_bf16 v[128:143], v[112:115], a[188:191], v[128:143]
    global_load_lds_dwordx4 v151, s[64:65] offset:3072
    s_barrier
    s_nop 9
    ds_write_b32 v194, v128
    s_add_u32 m0, s30, 77824
    s_add_u32 s64, s12, 98304
    s_addc_u32 s65, s13, 0
    global_load_lds_dwordx4 v148, s[64:65] offset:0
    global_load_lds_dwordx4 v149, s[64:65] offset:1024
    s_waitcnt lgkmcnt(0)
    s_barrier
    ds_read_b32 v64, v199 offset:0
    ds_read_b32 v65, v199 offset:128
    ds_read_b32 v66, v199 offset:256
    ds_read_b32 v67, v199 offset:384
    global_load_lds_dwordx4 v150, s[64:65] offset:2048
    global_load_lds_dwordx4 v151, s[64:65] offset:3072
    v_cmp_gt_u32 vcc, 32, v0
    s_waitcnt lgkmcnt(0)
    v_add_f32 v64, v64, v65
    v_add_f32 v66, v66, v67
    v_add_f32 v64, v64, v66
    v_cvt_pk_bf16_f32 v65, v64, v64
    v_and_b32 v65, 0xffff0000, v65
    v_sub_f32 v65, v64, v65
    v_cvt_pk_bf16_f32 v64, v64, v65
    v_cndmask_b32 v208, 0, v64, vcc
    v_cndmask_b32 v209, 0, v64, vcc
    s_branch Lm_7
Lnokv_6:
    s_add_u32 m0, s30, 65536
    s_add_u32 s64, s12, 0
    s_addc_u32 s65, s13, 0
    global_load_lds_dwordx4 v148, s[64:65] offset:0
    global_load_lds_dwordx4 v149, s[64:65] offset:1024
    global_load_lds_dwordx4 v150, s[64:65] offset:2048
    global_load_lds_dwordx4 v151, s[64:65] offset:3072
    s_waitcnt vmcnt(5)
    ds_read_b64 v[32:33], v152 offset:0
    ds_read_b64 v[34:35], v216 offset:0
    ds_read_b64 v[36:37], v153 offset:0
    ds_read_b64 v[38:39], v217 offset:0
    ds_read_b64 v[40:41], v154 offset:0
    ds_read_b64 v[42:43], v218 offset:0
    ds_read_b64 v[44:45], v155 offset:0
    ds_read_b64 v[46:47], v219 offset:0
    ds_read_b64 v[48:49], v156 offset:0
    ds_read_b64 v[50:51], v220 offset:0
    ds_read_b64 v[52:53], v157 offset:0
    ds_read_b64 v[54:55], v221 offset:0
    ds_read_b64 v[56:57], v158 offset:0
    ds_read_b64 v[58:59], v222 offset:0
    ds_read_b64 v[60:61], v159 offset:0
    ds_read_b64 v[62:63], v223 offset:0
    s_waitcnt lgkmcnt(14)
    s_add_u32 m0, s30, 69632
    s_add_u32 s64, s12, 32768
    s_addc_u32 s65, s13, 0
    global_load_lds_dwordx4 v148, s[64:65] offset:0
    v_dot2_f32_bf16 v24, v32, v4, 0
    v_dot2_f32_bf16 v25, v32, v32, 0
    v_dot2_f32_bf16 v24, v33, v4, v24
    v_dot2_f32_bf16 v25, v33, v33, v25
    v_dot2_f32_bf16 v24, v34, v4, v24
    v_dot2_f32_bf16 v25, v34, v34, v25
    global_load_lds_dwordx4 v149, s[64:65] offset:1024
    v_dot2_f32_bf16 v24, v35, v4, v24
    v_dot2_f32_bf16 v25, v35, v35, v25
    s_waitcnt lgkmcnt(12)
    v_dot2_f32_bf16 v24, v36, v4, v24
    v_dot2_f32_bf16 v25, v36, v36, v25
    v_dot2_f32_bf16 v24, v37, v4, v24
    global_load_lds_dwordx4 v150, s[64:65] offset:2048
    v_dot2_f32_bf16 v25, v37, v37, v25
    v_dot2_f32_bf16 v24, v38, v4, v24
    v_dot2_f32_bf16 v25, v38, v38, v25
    v_dot2_f32_bf16 v24, v39, v4, v24
    v_dot2_f32_bf16 v25, v39, v39, v25
    s_waitcnt lgkmcnt(10)
    global_load_lds_dwordx4 v151, s[64:65] offset:3072
    v_dot2_f32_bf16 v24, v40, v4, v24
    v_dot2_f32_bf16 v25, v40, v40, v25
    v_dot2_f32_bf16 v24, v41, v4, v24
    v_dot2_f32_bf16 v25, v41, v41, v25
    v_dot2_f32_bf16 v24, v42, v4, v24
    v_dot2_f32_bf16 v25, v42, v42, v25
    s_add_u32 m0, s30, 73728
    s_add_u32 s64, s12, 65536
    s_addc_u32 s65, s13, 0
    global_load_lds_dwordx4 v148, s[64:65] offset:0
    v_dot2_f32_bf16 v24, v43, v4, v24
    v_dot2_f32_bf16 v25, v43, v43, v25
    s_waitcnt lgkmcnt(8)
    v_dot2_f32_bf16 v24, v44, v4, v24
    v_dot2_f32_bf16 v25, v44, v44, v25
    v_dot2_f32_bf16 v24, v45, v4, v24
    global_load_lds_dwordx4 v149, s[64:65] offset:1024
    v_dot2_f32_bf16 v25, v45, v45, v25
    v_dot2_f32_bf16 v24, v46, v4, v24
    v_dot2_f32_bf16 v25, v46, v46, v25
    v_dot2_f32_bf16 v24, v47, v4, v24
    v_dot2_f32_bf16 v25, v47, v47, v25
    s_waitcnt lgkmcnt(6)
    v_dot2_f32_bf16 v24, v48, v4, v24
    global_load_lds_dwordx4 v150, s[64:65] offset:2048
    v_dot2_f32_bf16 v25, v48, v48, v25
    v_dot2_f32_bf16 v24, v49, v4, v24
    v_dot2_f32_bf16 v25, v49, v49, v25
    v_dot2_f32_bf16 v24, v50, v4, v24
    v_dot2_f32_bf16 v25, v50, v50, v25
    v_dot2_f32_bf16 v24, v51, v4, v24
    global_load_lds_dwordx4 v151, s[64:65] offset:3072
    v_dot2_f32_bf16 v25, v51, v51, v25
    s_waitcnt lgkmcnt(4)
    v_dot2_f32_bf16 v24, v52, v4, v24
    v_dot2_f32_bf16 v25, v52, v52, v25
    v_dot2_f32_bf16 v24, v53, v4, v24
    v_dot2_f32_bf16 v25, v53, v53, v25
    s_add_u32 m0, s30, 77824
    s_add_u32 s64, s12, 98304
    s_addc_u32 s65, s13, 0
    global_load_lds_dwordx4 v148, s[64:65] offset:0
    v_dot2_f32_bf16 v24, v54, v4, v24
    v_dot2_f32_bf16 v25, v54, v54, v25
    v_dot2_f32_bf16 v24, v55, v4, v24
    v_dot2_f32_bf16 v25, v55, v55, v25
    s_waitcnt lgkmcnt(2)
    v_dot2_f32_bf16 v24, v56, v4, v24
    global_load_lds_dwordx4 v149, s[64:65] offset:1024
    v_dot2_f32_bf16 v25, v56, v56, v25
    v_dot2_f32_bf16 v24, v57, v4, v24
    v_dot2_f32_bf16 v25, v57, v57, v25
    v_dot2_f32_bf16 v24, v58, v4, v24
    v_dot2_f32_bf16 v25, v58, v58, v25
    v_dot2_f32_bf16 v24, v59, v4, v24
    global_load_lds_dwordx4 v150, s[64:65] offset:2048
    v_dot2_f32_bf16 v25, v59, v59, v25
    s_waitcnt lgkmcnt(0)
    v_dot2_f32_bf16 v24, v60, v4, v24
    v_dot2_f32_bf16 v25, v60, v60, v25
    v_dot2_f32_bf16 v24, v61, v4, v24
    v_dot2_f32_bf16 v25, v61, v61, v25
    global_load_lds_dwordx4 v151, s[64:65] offset:3072
    v_dot2_f32_bf16 v24, v62, v4, v24
    v_dot2_f32_bf16 v25, v62, v62, v25
    v_dot2_f32_bf16 v24, v63, v4, v24
    v_dot2_f32_bf16 v25, v63, v63, v25
    s_nop 2
    v_permlane32_swap_b32 v24, v25
    v_add_f32 v24, v24, v25
Lm_7:
    s_waitcnt lgkmcnt(0)
    s_mov_b32 s0, 0
    s_mov_b32 s12, 0
    s_mov_b32 s13, 100000
    s_waitcnt vmcnt(16)
    v_readfirstlane_b32 s1, v14
    s_nop 0
    s_cmp_lg_u32 s1, 0
    s_cbranch_scc0 Lnr_9
Lnw_8:
    s_or_b32 s14, s14, s1
    v_add_u32 v124, s26, v1
    v_add_u32 v125, s27, v1
    v_add_u32 v126, s28, v1
    v_add_u32 v127, s29, v1
Lqst_10:
    v_add_u32 v25, s26, v3
    ds_write_b32 v25, v24 offset:6656
    v_mul_f32 v25, 0xbb000000, v24
    v_cvt_pk_bf16_f32 v10, v25, v25
    v_and_b32 v11, 0xffff0000, v10
    v_sub_f32 v25, v25, v11
    v_cvt_pk_bf16_f32 v11, v25, v25
    s_mov_b32 s15, 0
    s_cmp_lg_u32 s18, 0
    s_cbranch_scc1 Lnkv_11
    v_add_u32 v26, s26, v1
    s_lshl_b32 s61, s16, 11
    s_add_u32 s61, s61, 135168
    v_add_u32 v27, s61, v1
    v_add_u32 v28, 135168, v1
    v_mfma_f32_32x32x16_bf16 v[128:143], a[160:163], v[32:35], 0
    v_mfma_f32_32x32x16_bf16 v[128:143], a[164:167], v[36:39], v[128:143]
    v_mfma_f32_32x32x16_bf16 v[128:143], a[168:171], v[40:43], v[128:143]
    v_mfma_f32_32x32x16_bf16 v[128:143], a[172:175], v[44:47], v[128:143]
    v_mfma_f32_32x32x16_bf16 v[128:143], a[176:179], v[48:51], v[128:143]
    v_mfma_f32_32x32x16_bf16 v[128:143], a[180:183], v[52:55], v[128:143]
    v_mfma_f32_32x32x16_bf16 v[128:143], a[184:187], v[56:59], v[128:143]
    v_mfma_f32_32x32x16_bf16 v[128:143], a[188:191], v[60:63], v[128:143]
    v_mfma_f32_32x32x16_bf16 v[128:143], v[208:211], v[10:13], v[128:143]
    s_nop 11
    ds_write_b128 v26, v[128:131] offset:0
    ds_write_b128 v26, v[132:135] offset:1024
    ds_write_b128 v26, v[136:139] offset:2048
    ds_write_b128 v26, v[140:143] offset:3072
    s_waitcnt lgkmcnt(0)
    s_barrier
    s_cmp_ge_u32 s16, 2
    s_cbranch_scc1 Lnkv_11
    v_add_u32 v99, 135168, v3
    ds_read_b32 v96, v99 offset:6656
    ds_read_b32 v97, v99 offset:13824
    ds_read_b32 v98, v99 offset:20992
    ds_read_b32 v99, v99 offset:28160
    s_waitcnt vmcnt(14)
    ds_read_b64_tr_b16 a[192:193], v195 offset:0
    ds_read_b64_tr_b16 a[194:195], v195 offset:1024
    ds_read_b64_tr_b16 a[224:225], v196 offset:0
    ds_read_b64_tr_b16 a[226:227], v196 offset:1024
    s_add_u32 m0, s30, 8192
    s_add_u32 s64, s68, 32768
    s_addc_u32 s65, s69, 0
    global_load_lds_dwordx4 v144, s[64:65] offset:0
    global_load_lds_dwordx4 v145, s[64:65] offset:1024
    ds_read_b128 v[160:163], v27 offset:0
    ds_read_b128 v[164:167], v27 offset:1024
    ds_read_b128 v[168:171], v27 offset:7168
    ds_read_b128 v[172:175], v27 offset:8192
    ds_read_b128 v[176:179], v27 offset:14336
    s_waitcnt vmcnt(14)
    ds_read_b64_tr_b16 a[196:197], v195 offset:2048
    ds_read_b64_tr_b16 a[198:199], v195 offset:3072
    ds_read_b64_tr_b16 a[228:229], v196 offset:2048
    ds_read_b64_tr_b16 a[230:231], v196 offset:3072
    s_waitcnt lgkmcnt(9)
    v_mfma_f32_32x32x16_bf16 v[224:239], v[112:115], a[192:195], 0
    ds_read_b128 v[180:183], v27 offset:15360
    ds_read_b128 v[184:187], v27 offset:21504
    ds_read_b128 v[188:191], v27 offset:22528
    s_mul_i32 s61, s17, 2112
    s_add_u32 s61, s61, 4849664
    v_mfma_f32_32x32x16_bf16 v[240:255], v[112:115], a[224:227], 0
    global_load_lds_dwordx4 v146, s[64:65] offset:2048
    s_lshl_b32 s15, s17, 8
    s_add_u32 s15, s15, 5120000
    v_add_f32 v96, v96, v98
    v_add_f32 v97, v97, v99
    v_mfma_f32_32x32x16_bf16 v[64:79], a[192:195], v[32:35], 0
    v_add_f32 v96, v96, v97
    v_mov_b32 v97, v96
    s_nop 1
    v_permlane32_swap_b32 v96, v97
    v_mul_f32 v98, 0x3b000000, v96
    v_mul_f32 v97, 0x3b000000, v97
    v_mfma_f32_32x32x16_bf16 v[80:95], a[224:227], v[32:35], 0
    global_load_lds_dwordx4 v147, s[64:65] offset:3072
    v_fma_f32 v97, -v98, v98, v97
    v_max_f32 v97, 0, v97
    v_add_f32 v97, 0x3727c5ac, v97
    v_rsq_f32 v100, v97
    s_waitcnt vmcnt(14)
    ds_read_b64_tr_b16 a[200:201], v195 offset:4096
    ds_read_b64_tr_b16 a[202:203], v195 offset:5120
    ds_read_b64_tr_b16 a[232:233], v196 offset:4096
    ds_read_b64_tr_b16 a[234:235], v196 offset:5120
    s_waitcnt lgkmcnt(7)
    v_mfma_f32_32x32x16_bf16 v[224:239], v[112:115], a[196:199], v[224:239]
    s_mul_i32 s62, s16, 7168
    v_add_u32 v28, s62, v28
    s_add_u32 s62, s62, 135168
    v_bfe_u32 v96, v0, 3, 2
    v_mfma_f32_32x32x16_bf16 v[240:255], v[112:115], a[228:231], v[240:255]
    s_add_u32 m0, s30, 12288
    s_add_u32 s64, s68, 49152
    s_addc_u32 s65, s69, 0
    global_load_lds_dwordx4 v144, s[64:65] offset:0
    v_mul_u32_u24 v96, 272, v96
    v_add_u32 v96, s62, v96
    v_and_b32 v97, 7, v0
    v_lshl_add_u32 v97, v97, 1, v96
    v_mfma_f32_32x32x16_bf16 v[64:79], a[196:199], v[36:39], v[64:79]
    v_lshrrev_b32 v98, 5, v0
    v_lshl_add_u32 v97, v98, 6, v97
    v_add_f32 v160, v160, v168
    v_add_f32 v161, v161, v169
    v_mfma_f32_32x32x16_bf16 v[80:95], a[228:231], v[36:39], v[80:95]
    global_load_lds_dwordx4 v145, s[64:65] offset:1024
    v_add_f32 v162, v162, v170
    v_add_f32 v163, v163, v171
    v_add_f32 v164, v164, v172
    s_waitcnt vmcnt(14)
    ds_read_b64_tr_b16 a[204:205], v195 offset:6144
    ds_read_b64_tr_b16 a[206:207], v195 offset:7168
    ds_read_b64_tr_b16 a[236:237], v196 offset:6144
    ds_read_b64_tr_b16 a[238:239], v196 offset:7168
    s_waitcnt lgkmcnt(4)
    v_mfma_f32_32x32x16_bf16 v[224:239], v[112:115], a[200:203], v[224:239]
    v_add_f32 v165, v165, v173
    v_add_f32 v166, v166, v174
    v_add_f32 v167, v167, v175
    v_mfma_f32_32x32x16_bf16 v[240:255], v[112:115], a[232:235], v[240:255]
    global_load_lds_dwordx4 v146, s[64:65] offset:2048
    v_add_f32 v160, v160, v176
    v_add_f32 v161, v161, v177
    v_add_f32 v162, v162, v178
    v_add_f32 v163, v163, v179
    v_mfma_f32_32x32x16_bf16 v[64:79], a[200:203], v[40:43], v[64:79]
    v_add_f32 v164, v164, v180
    v_add_f32 v165, v165, v181
    v_add_f32 v166, v166, v182
    v_add_f32 v167, v167, v183
    v_mfma_f32_32x32x16_bf16 v[80:95], a[232:235], v[40:43], v[80:95]
    global_load_lds_dwordx4 v147, s[64:65] offset:3072
    v_add_f32 v160, v160, v184
    v_add_f32 v161, v161, v185
    v_add_f32 v162, v162, v186
    s_waitcnt vmcnt(14)
    ds_read_b64_tr_b16 a[208:209], v195 offset:8192
    ds_read_b64_tr_b16 a[210:211], v195 offset:9216
    ds_read_b64_tr_b16 a[240:241], v196 offset:8192
    ds_read_b64_tr_b16 a[242:243], v196 offset:9216
    s_waitcnt lgkmcnt(4)
    v_mfma_f32_32x32x16_bf16 v[224:239], v[112:115], a[204:207], v[224:239]
    v_add_f32 v163, v163, v187
    v_add_f32 v164, v164, v188
    v_add_f32 v165, v165, v189
    v_mfma_f32_32x32x16_bf16 v[240:255], v[112:115], a[236:239], v[240:255]
    global_load_dwordx4 v[16:19], v214, s[68:69] offset:-1024
    v_add_f32 v166, v166, v190
    v_add_f32 v167, v167, v191
    v_mul_f32 v160, v100, v160
    v_mul_f32 v161, v100, v161
    v_mul_f32 v162, v100, v162
    v_mfma_f32_32x32x16_bf16 v[64:79], a[204:207], v[44:47], v[64:79]
    v_mul_f32 v163, v100, v163
    v_mul_f32 v164, v100, v164
    v_mul_f32 v165, v100, v165
    v_mul_f32 v166, v100, v166
    v_mfma_f32_32x32x16_bf16 v[80:95], a[236:239], v[44:47], v[80:95]
    v_add_u32 v214, 32768, v214
    global_load_dwordx4 v[20:23], v214, s[68:69] offset:-1024
    v_mul_f32 v167, v100, v167
    v_cvt_pk_bf16_f32 v168, v160, v161
    v_cvt_pk_bf16_f32 v169, v162, v163
    v_cvt_pk_bf16_f32 v170, v164, v165
    s_waitcnt vmcnt(14)
    ds_read_b64_tr_b16 a[212:213], v195 offset:10240
    ds_read_b64_tr_b16 a[214:215], v195 offset:11264
    ds_read_b64_tr_b16 a[244:245], v196 offset:10240
    ds_read_b64_tr_b16 a[246:247], v196 offset:11264
    s_waitcnt lgkmcnt(4)
    v_mfma_f32_32x32x16_bf16 v[224:239], v[112:115], a[208:211], v[224:239]
    v_cvt_pk_bf16_f32 v171, v166, v167
    s_cmp_eq_u32 s16, 1
    s_cbranch_scc1 Lv_12
    buffer_store_dwordx4 v[168:171], v1, s[4:7], s61 offen sc1
    s_mov_b64 exec, -1
Lv_12:
    ds_write_b16 v97, v168 offset:4096
    ds_write_b16_d16_hi v97, v168 offset:4112
    ds_write_b16 v97, v169 offset:4128
    v_mfma_f32_32x32x16_bf16 v[240:255], v[112:115], a[240:243], v[240:255]
    s_add_u32 m0, s30, 66560
    s_nop 0
    global_load_lds_dwordx4 v215, s[34:35]
    s_add_u32 s34, s34, s3
    s_addc_u32 s35, s35, 0
    ds_write_b16_d16_hi v97, v169 offset:4144
    ds_write_b16 v97, v170 offset:4224
    ds_write_b16_d16_hi v97, v170 offset:4240
    ds_write_b16 v97, v171 offset:4256
    v_mfma_f32_32x32x16_bf16 v[64:79], a[208:211], v[48:51], v[64:79]
    ds_write_b16_d16_hi v97, v171 offset:4272
    v_mov_b32 v160, v4
    v_mov_b32 v161, v4
    v_mov_b32 v162, v4
    v_mfma_f32_32x32x16_bf16 v[80:95], a[240:243], v[48:51], v[80:95]
    s_add_u32 m0, s30, 67584
    s_nop 0
    global_load_lds_dwordx4 v215, s[34:35]
    s_add_u32 s34, s34, s3
    s_addc_u32 s35, s35, 0
    v_mov_b32 v163, v4
    ds_write_b128 v96, v[160:163] offset:4352
    ds_read_b128 v[172:175], v28 offset:4096
    ds_read_b128 v[176:179], v28 offset:5120
    s_waitcnt vmcnt(14)
    ds_read_b64_tr_b16 a[216:217], v195 offset:12288
    ds_read_b64_tr_b16 a[218:219], v195 offset:13312
    ds_read_b64_tr_b16 a[248:249], v196 offset:12288
    ds_read_b64_tr_b16 a[250:251], v196 offset:13312
    s_waitcnt lgkmcnt(15)
    v_mfma_f32_32x32x16_bf16 v[224:239], v[112:115], a[212:215], v[224:239]
    v_mfma_f32_32x32x16_bf16 v[240:255], v[112:115], a[244:247], v[240:255]
    s_add_u32 m0, s30, 68608
    s_nop 0
    global_load_lds_dwordx4 v215, s[34:35]
    s_add_u32 s34, s34, s3
    s_addc_u32 s35, s35, 0
    s_cmp_eq_u32 s16, 0
    s_cbranch_scc1 Lkf_13
    s_waitcnt lgkmcnt(4)
    s_add_u32 s15, s15, 128
    buffer_store_dwordx4 v[172:175], v1, s[4:7], s61 offen offset:1024 sc1
    s_mov_b64 exec, 15
    buffer_store_dwordx4 v[176:179], v1, s[4:7], s61 offen offset:2048 sc1
    s_mov_b64 exec, -1
Lkf_13:
    v_mfma_f32_32x32x16_bf16 v[64:79], a[212:215], v[52:55], v[64:79]
    v_mfma_f32_32x32x16_bf16 v[80:95], a[244:247], v[52:55], v[80:95]
    s_add_u32 m0, s30, 69632
    s_nop 0
    global_load_lds_dwordx4 v215, s[34:35]
    s_add_u32 s34, s34, s3
    s_addc_u32 s35, s35, 0
    s_waitcnt vmcnt(14)
    ds_read_b64_tr_b16 a[220:221], v195 offset:14336
    ds_read_b64_tr_b16 a[222:223], v195 offset:15360
    ds_read_b64_tr_b16 a[252:253], v196 offset:14336
    ds_read_b64_tr_b16 a[254:255], v196 offset:15360
    s_waitcnt lgkmcnt(4)
    v_mfma_f32_32x32x16_bf16 v[224:239], v[112:115], a[216:219], v[224:239]
    v_mfma_f32_32x32x16_bf16 v[240:255], v[112:115], a[248:251], v[240:255]
    s_add_u32 m0, s30, 70656
    s_nop 0
    global_load_lds_dwordx4 v215, s[34:35]
    s_add_u32 s34, s34, s3
    s_addc_u32 s35, s35, 0
    v_mfma_f32_32x32x16_bf16 v[64:79], a[216:219], v[56:59], v[64:79]
    v_mfma_f32_32x32x16_bf16 v[80:95], a[248:251], v[56:59], v[80:95]
    s_add_u32 m0, s30, 71680
    s_nop 0
    global_load_lds_dwordx4 v215, s[34:35]
    s_add_u32 s34, s34, s3
    s_addc_u32 s35, s35, 0
    s_waitcnt lgkmcnt(0)
    v_mfma_f32_32x32x16_bf16 v[224:239], v[112:115], a[220:223], v[224:239]
    v_mfma_f32_32x32x16_bf16 v[240:255], v[112:115], a[252:255], v[240:255]
    s_add_u32 m0, s30, 72704
    s_nop 0
    global_load_lds_dwordx4 v215, s[34:35]
    s_add_u32 s34, s34, s3
    s_addc_u32 s35, s35, 0
    v_mfma_f32_32x32x16_bf16 v[64:79], a[220:223], v[60:63], v[64:79]
    v_mfma_f32_32x32x16_bf16 v[80:95], a[252:255], v[60:63], v[80:95]
    s_add_u32 m0, s30, 73728
    s_nop 0
    global_load_lds_dwordx4 v215, s[34:35]
    s_add_u32 s34, s34, s3
    s_addc_u32 s35, s35, 0
    s_branch Lkj_14
Lnkv_11:
    s_waitcnt vmcnt(14)
    ds_read_b64_tr_b16 a[192:193], v195 offset:0
    ds_read_b64_tr_b16 a[194:195], v195 offset:1024
    ds_read_b64_tr_b16 a[224:225], v196 offset:0
    ds_read_b64_tr_b16 a[226:227], v196 offset:1024
    s_add_u32 m0, s30, 8192
    s_add_u32 s64, s68, 32768
    s_addc_u32 s65, s69, 0
    global_load_lds_dwordx4 v144, s[64:65] offset:0
    global_load_lds_dwordx4 v145, s[64:65] offset:1024
    s_waitcnt vmcnt(14)
    ds_read_b64_tr_b16 a[196:197], v195 offset:2048
    ds_read_b64_tr_b16 a[198:199], v195 offset:3072
    ds_read_b64_tr_b16 a[228:229], v196 offset:2048
    ds_read_b64_tr_b16 a[230:231], v196 offset:3072
    s_waitcnt lgkmcnt(4)
    v_mfma_f32_32x32x16_bf16 v[224:239], v[112:115], a[192:195], 0
    v_mfma_f32_32x32x16_bf16 v[240:255], v[112:115], a[224:227], 0
    global_load_lds_dwordx4 v146, s[64:65] offset:2048
    v_mfma_f32_32x32x16_bf16 v[64:79], a[192:195], v[32:35], 0
    v_mfma_f32_32x32x16_bf16 v[80:95], a[224:227], v[32:35], 0
    global_load_lds_dwordx4 v147, s[64:65] offset:3072
    s_waitcnt vmcnt(14)
    ds_read_b64_tr_b16 a[200:201], v195 offset:4096
    ds_read_b64_tr_b16 a[202:203], v195 offset:5120
    ds_read_b64_tr_b16 a[232:233], v196 offset:4096
    ds_read_b64_tr_b16 a[234:235], v196 offset:5120
    s_waitcnt lgkmcnt(4)
    v_mfma_f32_32x32x16_bf16 v[224:239], v[112:115], a[196:199], v[224:239]
    v_mfma_f32_32x32x16_bf16 v[240:255], v[112:115], a[228:231], v[240:255]
    s_add_u32 m0, s30, 12288
    s_add_u32 s64, s68, 49152
    s_addc_u32 s65, s69, 0
    global_load_lds_dwordx4 v144, s[64:65] offset:0
    v_mfma_f32_32x32x16_bf16 v[64:79], a[196:199], v[36:39], v[64:79]
    v_mfma_f32_32x32x16_bf16 v[80:95], a[228:231], v[36:39], v[80:95]
    global_load_lds_dwordx4 v145, s[64:65] offset:1024
    s_waitcnt vmcnt(14)
    ds_read_b64_tr_b16 a[204:205], v195 offset:6144
    ds_read_b64_tr_b16 a[206:207], v195 offset:7168
    ds_read_b64_tr_b16 a[236:237], v196 offset:6144
    ds_read_b64_tr_b16 a[238:239], v196 offset:7168
    s_waitcnt lgkmcnt(4)
    v_mfma_f32_32x32x16_bf16 v[224:239], v[112:115], a[200:203], v[224:239]
    v_mfma_f32_32x32x16_bf16 v[240:255], v[112:115], a[232:235], v[240:255]
    global_load_lds_dwordx4 v146, s[64:65] offset:2048
    v_mfma_f32_32x32x16_bf16 v[64:79], a[200:203], v[40:43], v[64:79]
    v_mfma_f32_32x32x16_bf16 v[80:95], a[232:235], v[40:43], v[80:95]
    global_load_lds_dwordx4 v147, s[64:65] offset:3072
    s_waitcnt vmcnt(14)
    ds_read_b64_tr_b16 a[208:209], v195 offset:8192
    ds_read_b64_tr_b16 a[210:211], v195 offset:9216
    ds_read_b64_tr_b16 a[240:241], v196 offset:8192
    ds_read_b64_tr_b16 a[242:243], v196 offset:9216
    s_waitcnt lgkmcnt(4)
    v_mfma_f32_32x32x16_bf16 v[224:239], v[112:115], a[204:207], v[224:239]
    v_mfma_f32_32x32x16_bf16 v[240:255], v[112:115], a[236:239], v[240:255]
    global_load_dwordx4 v[16:19], v214, s[68:69] offset:-1024
    v_mfma_f32_32x32x16_bf16 v[64:79], a[204:207], v[44:47], v[64:79]
    v_mfma_f32_32x32x16_bf16 v[80:95], a[236:239], v[44:47], v[80:95]
    v_add_u32 v214, 32768, v214
    global_load_dwordx4 v[20:23], v214, s[68:69] offset:-1024
    s_waitcnt vmcnt(14)
    ds_read_b64_tr_b16 a[212:213], v195 offset:10240
    ds_read_b64_tr_b16 a[214:215], v195 offset:11264
    ds_read_b64_tr_b16 a[244:245], v196 offset:10240
    ds_read_b64_tr_b16 a[246:247], v196 offset:11264
    s_waitcnt lgkmcnt(4)
    v_mfma_f32_32x32x16_bf16 v[224:239], v[112:115], a[208:211], v[224:239]
    v_mfma_f32_32x32x16_bf16 v[240:255], v[112:115], a[240:243], v[240:255]
    s_add_u32 m0, s30, 66560
    s_nop 0
    global_load_lds_dwordx4 v215, s[34:35]
    s_add_u32 s34, s34, s3
    s_addc_u32 s35, s35, 0
    v_mfma_f32_32x32x16_bf16 v[64:79], a[208:211], v[48:51], v[64:79]
    v_mfma_f32_32x32x16_bf16 v[80:95], a[240:243], v[48:51], v[80:95]
    s_add_u32 m0, s30, 67584
    s_nop 0
    global_load_lds_dwordx4 v215, s[34:35]
    s_add_u32 s34, s34, s3
    s_addc_u32 s35, s35, 0
    s_waitcnt vmcnt(14)
    ds_read_b64_tr_b16 a[216:217], v195 offset:12288
    ds_read_b64_tr_b16 a[218:219], v195 offset:13312
    ds_read_b64_tr_b16 a[248:249], v196 offset:12288
    ds_read_b64_tr_b16 a[250:251], v196 offset:13312
    s_waitcnt lgkmcnt(4)
    v_mfma_f32_32x32x16_bf16 v[224:239], v[112:115], a[212:215], v[224:239]
    v_mfma_f32_32x32x16_bf16 v[240:255], v[112:115], a[244:247], v[240:255]
    s_add_u32 m0, s30, 68608
    s_nop 0
    global_load_lds_dwordx4 v215, s[34:35]
    s_add_u32 s34, s34, s3
    s_addc_u32 s35, s35, 0
    v_mfma_f32_32x32x16_bf16 v[64:79], a[212:215], v[52:55], v[64:79]
    v_mfma_f32_32x32x16_bf16 v[80:95], a[244:247], v[52:55], v[80:95]
    s_add_u32 m0, s30, 69632
    s_nop 0
    global_load_lds_dwordx4 v215, s[34:35]
    s_add_u32 s34, s34, s3
    s_addc_u32 s35, s35, 0
    s_waitcnt vmcnt(14)
    ds_read_b64_tr_b16 a[220:221], v195 offset:14336
    ds_read_b64_tr_b16 a[222:223], v195 offset:15360
    ds_read_b64_tr_b16 a[252:253], v196 offset:14336
    ds_read_b64_tr_b16 a[254:255], v196 offset:15360
    s_waitcnt lgkmcnt(4)
    v_mfma_f32_32x32x16_bf16 v[224:239], v[112:115], a[216:219], v[224:239]
    v_mfma_f32_32x32x16_bf16 v[240:255], v[112:115], a[248:251], v[240:255]
    s_add_u32 m0, s30, 70656
    s_nop 0
    global_load_lds_dwordx4 v215, s[34:35]
    s_add_u32 s34, s34, s3
    s_addc_u32 s35, s35, 0
    v_mfma_f32_32x32x16_bf16 v[64:79], a[216:219], v[56:59], v[64:79]
    v_mfma_f32_32x32x16_bf16 v[80:95], a[248:251], v[56:59], v[80:95]
    s_add_u32 m0, s30, 71680
    s_nop 0
    global_load_lds_dwordx4 v215, s[34:35]
    s_add_u32 s34, s34, s3
    s_addc_u32 s35, s35, 0
    s_waitcnt lgkmcnt(0)
    v_mfma_f32_32x32x16_bf16 v[224:239], v[112:115], a[220:223], v[224:239]
    v_mfma_f32_32x32x16_bf16 v[240:255], v[112:115], a[252:255], v[240:255]
    s_add_u32 m0, s30, 72704
    s_nop 0
    global_load_lds_dwordx4 v215, s[34:35]
    s_add_u32 s34, s34, s3
    s_addc_u32 s35, s35, 0
    v_mfma_f32_32x32x16_bf16 v[64:79], a[220:223], v[60:63], v[64:79]
    v_mfma_f32_32x32x16_bf16 v[80:95], a[252:255], v[60:63], v[80:95]
    s_add_u32 m0, s30, 73728
    s_nop 0
    global_load_lds_dwordx4 v215, s[34:35]
    s_add_u32 s34, s34, s3
    s_addc_u32 s35, s35, 0
Lkj_14:
    s_mov_b32 s34, 1.0
    s_mov_b32 s35, 1.0
    ds_write_b32 v192, v224
    ds_write_b32 v193, v240
    s_waitcnt vmcnt(8)
    ds_read_b64 v[160:161], v152 offset:8192
    ds_read_b64 v[162:163], v216 offset:8192
    ds_read_b64 v[164:165], v153 offset:8192
    ds_read_b64 v[166:167], v217 offset:8192
    ds_read_b64 v[168:169], v154 offset:8192
    ds_read_b64 v[170:171], v218 offset:8192
    ds_read_b64 v[172:173], v155 offset:8192
    ds_read_b64 v[174:175], v219 offset:8192
    ds_read_b64 v[176:177], v156 offset:8192
    ds_read_b64 v[178:179], v220 offset:8192
    ds_read_b64 v[180:181], v157 offset:8192
    ds_read_b64 v[182:183], v221 offset:8192
    ds_read_b64 v[184:185], v158 offset:8192
    ds_read_b64 v[186:187], v222 offset:8192
    ds_read_b64 v[188:189], v159 offset:8192
    ds_read_b64 v[190:191], v223 offset:8192
    s_waitcnt lgkmcnt(15)
    s_barrier
    ds_read_b32 v224, v197 offset:0
    ds_read_b32 v225, v197 offset:16384
    ds_read_b32 v226, v197 offset:32768
    ds_read_b32 v227, v197 offset:49152
    ds_read_b32 v228, v198 offset:0
    ds_read_b32 v229, v198 offset:16384
    ds_read_b32 v230, v198 offset:32768
    ds_read_b32 v231, v198 offset:49152
    v_permlane32_swap_b32 v16, v18
    v_permlane32_swap_b32 v17, v19
    v_permlane32_swap_b32 v20, v22
    v_permlane32_swap_b32 v21, v23
    v_cmp_gt_u32 vcc, 32, v0
    s_waitcnt lgkmcnt(4)
    v_add_f32 v224, v224, v225
    v_add_f32 v226, v226, v227
    v_add_f32 v224, v224, v226
    v_cvt_pk_bf16_f32 v225, v224, v224
    v_and_b32 v225, 0xffff0000, v225
    v_sub_f32 v225, v224, v225
    v_cvt_pk_bf16_f32 v224, v224, v225
    v_cndmask_b32 v210, 0, v224, vcc
    v_cndmask_b32 v211, 0, v224, vcc
    s_waitcnt lgkmcnt(0)
    v_add_f32 v228, v228, v229
    v_add_f32 v230, v230, v231
    v_add_f32 v228, v228, v230
    v_cvt_pk_bf16_f32 v229, v228, v228
    v_and_b32 v229, 0xffff0000, v229
    v_sub_f32 v229, v228, v229
    v_cvt_pk_bf16_f32 v228, v228, v229
    v_cndmask_b32 v212, 0, v228, vcc
    v_cndmask_b32 v213, 0, v228, vcc
    s_nop 1
    v_mfma_f32_32x32x16_bf16 v[80:95], v[210:213], v[8:11], v[80:95]
    v_mfma_f32_32x32x16_bf16 v[64:79], v[210:213], v[10:13], v[64:79]
    s_nop 10
    ds_write_b128 v124, v[80:83] offset:2048
    ds_write_b128 v124, v[84:87] offset:3072
    ds_write_b128 v124, v[88:91] offset:4096
    ds_write_b128 v124, v[92:95] offset:5120
    ds_write_b128 v124, v[72:75] offset:0
    ds_write_b128 v124, v[76:79] offset:1024
    s_cmp_eq_u32 s15, 0
    s_cbranch_scc1 Lnkf_15
    s_waitcnt vmcnt(0)
    v_mov_b32 v14, s1
    s_mov_b64 exec, 1
    buffer_store_dword v14, off, s[4:7], s15 sc1
    s_mov_b64 exec, -1
Lnkf_15:
    v_dot2_f32_bf16 v200, v160, v4, 0
    v_dot2_f32_bf16 v201, v160, v160, 0
    v_dot2_f32_bf16 v200, v161, v4, v200
    v_dot2_f32_bf16 v201, v161, v161, v201
    v_dot2_f32_bf16 v200, v162, v4, v200
    v_dot2_f32_bf16 v201, v162, v162, v201
    v_dot2_f32_bf16 v200, v163, v4, v200
    v_dot2_f32_bf16 v201, v163, v163, v201
    v_dot2_f32_bf16 v200, v164, v4, v200
    v_dot2_f32_bf16 v201, v164, v164, v201
    v_dot2_f32_bf16 v200, v165, v4, v200
    v_dot2_f32_bf16 v201, v165, v165, v201
    v_dot2_f32_bf16 v200, v166, v4, v200
    v_dot2_f32_bf16 v201, v166, v166, v201
    v_dot2_f32_bf16 v200, v167, v4, v200
    v_dot2_f32_bf16 v201, v167, v167, v201
    v_dot2_f32_bf16 v200, v168, v4, v200
    v_dot2_f32_bf16 v201, v168, v168, v201
    v_dot2_f32_bf16 v200, v169, v4, v200
    v_dot2_f32_bf16 v201, v169, v169, v201
    v_dot2_f32_bf16 v200, v170, v4, v200
    v_dot2_f32_bf16 v201, v170, v170, v201
    v_dot2_f32_bf16 v200, v171, v4, v200
    v_dot2_f32_bf16 v201, v171, v171, v201
    v_dot2_f32_bf16 v200, v172, v4, v200
    v_dot2_f32_bf16 v201, v172, v172, v201
    v_dot2_f32_bf16 v200, v173, v4, v200
    v_dot2_f32_bf16 v201, v173, v173, v201
    v_dot2_f32_bf16 v200, v174, v4, v200
    v_dot2_f32_bf16 v201, v174, v174, v201
    v_dot2_f32_bf16 v200, v175, v4, v200
    v_dot2_f32_bf16 v201, v175, v175, v201
    v_dot2_f32_bf16 v200, v176, v4, v200
    v_dot2_f32_bf16 v201, v176, v176, v201
    v_dot2_f32_bf16 v200, v177, v4, v200
    v_dot2_f32_bf16 v201, v177, v177, v201
    v_dot2_f32_bf16 v200, v178, v4, v200
    v_dot2_f32_bf16 v201, v178, v178, v201
    v_dot2_f32_bf16 v200, v179, v4, v200
    v_dot2_f32_bf16 v201, v179, v179, v201
    v_dot2_f32_bf16 v200, v180, v4, v200
    v_dot2_f32_bf16 v201, v180, v180, v201
    v_dot2_f32_bf16 v200, v181, v4, v200
    v_dot2_f32_bf16 v201, v181, v181, v201
    v_dot2_f32_bf16 v200, v182, v4, v200
    v_dot2_f32_bf16 v201, v182, v182, v201
    v_dot2_f32_bf16 v200, v183, v4, v200
    v_dot2_f32_bf16 v201, v183, v183, v201
    v_dot2_f32_bf16 v200, v184, v4, v200
    v_dot2_f32_bf16 v201, v184, v184, v201
    v_dot2_f32_bf16 v200, v185, v4, v200
    v_dot2_f32_bf16 v201, v185, v185, v201
    v_dot2_f32_bf16 v200, v186, v4, v200
    v_dot2_f32_bf16 v201, v186, v186, v201
    v_dot2_f32_bf16 v200, v187, v4, v200
    v_dot2_f32_bf16 v201, v187, v187, v201
    v_dot2_f32_bf16 v200, v188, v4, v200
    v_dot2_f32_bf16 v201, v188, v188, v201
    v_dot2_f32_bf16 v200, v189, v4, v200
    v_dot2_f32_bf16 v201, v189, v189, v201
    v_dot2_f32_bf16 v200, v190, v4, v200
    v_dot2_f32_bf16 v201, v190, v190, v201
    v_dot2_f32_bf16 v200, v191, v4, v200
    v_dot2_f32_bf16 v201, v191, v191, v201
    s_nop 2
    v_permlane32_swap_b32 v200, v201
    v_add_f32 v200, v200, v201
    s_waitcnt lgkmcnt(0)
    s_barrier
    v_add_u32 v31, 135168, v3
    ds_read_b32 v28, v31 offset:6656
    ds_read_b32 v29, v31 offset:13824
    ds_read_b32 v30, v31 offset:20992
    ds_read_b32 v31, v31 offset:28160
    ds_read_b128 v[104:107], v126 offset:2048
    ds_read_b128 v[108:111], v126 offset:3072
    ds_read_b128 v[112:115], v127 offset:4096
    ds_read_b128 v[116:119], v127 offset:5120
    ds_read_b128 v[96:99], v125 offset:0
    ds_read_b128 v[100:103], v125 offset:1024
    s_waitcnt lgkmcnt(6)
    v_add_f32 v28, v28, v30
    v_add_f32 v29, v29, v31
    v_add_f32 v28, v28, v29
    v_mov_b32 v29, v28
    s_nop 1
    v_permlane32_swap_b32 v28, v29
    v_mul_f32 v30, 0x3b000000, v28
    v_mul_f32 v29, 0x3b000000, v29
    v_fma_f32 v29, -v30, v30, v29
    v_max_f32 v29, 0, v29
    v_add_f32 v29, 0x3727c5ac, v29
    v_rsq_f32 v24, v29
    s_nop 0
    v_mul_f32 v24, 0x3eb8aa3b, v24
    v_mov_b32 v25, v24
    s_waitcnt lgkmcnt(5)
    v_pk_add_f32 v[64:65], v[64:65], v[104:105]
    v_pk_add_f32 v[66:67], v[66:67], v[106:107]
    s_waitcnt lgkmcnt(4)
    v_pk_add_f32 v[68:69], v[68:69], v[108:109]
    v_pk_add_f32 v[70:71], v[70:71], v[110:111]
    s_waitcnt lgkmcnt(3)
    v_pk_add_f32 v[64:65], v[64:65], v[112:113]
    v_pk_add_f32 v[66:67], v[66:67], v[114:115]
    s_waitcnt lgkmcnt(2)
    v_pk_add_f32 v[68:69], v[68:69], v[116:117]
    v_pk_add_f32 v[70:71], v[70:71], v[118:119]
    s_waitcnt lgkmcnt(1)
    v_pk_add_f32 v[64:65], v[64:65], v[96:97]
    v_pk_add_f32 v[66:67], v[66:67], v[98:99]
    s_waitcnt lgkmcnt(0)
    v_pk_add_f32 v[68:69], v[68:69], v[100:101]
    v_pk_add_f32 v[70:71], v[70:71], v[102:103]
    v_pk_mul_f32 v[64:65], v[64:65], v[24:25]
    v_pk_mul_f32 v[66:67], v[66:67], v[24:25]
    v_pk_mul_f32 v[68:69], v[68:69], v[24:25]
    v_pk_mul_f32 v[70:71], v[70:71], v[24:25]
    v_cvt_pk_bf16_f32 v24, v64, v65
    v_cvt_pk_bf16_f32 v25, v66, v67
    v_cvt_pk_bf16_f32 v26, v68, v69
    v_cvt_pk_bf16_f32 v27, v70, v71
    v_add_u32 v124, s30, v1
    v_add_u32 v125, s31, v1
    v_add_u32 v126, s32, v1
    v_add_u32 v127, s33, v1
Lqst_16:
    v_add_u32 v201, s26, v3
    ds_write_b32 v201, v200 offset:6912
    v_mul_f32 v201, 0xbb000000, v200
    v_cvt_pk_bf16_f32 v10, v201, v201
    v_and_b32 v11, 0xffff0000, v10
    v_sub_f32 v201, v201, v11
    v_cvt_pk_bf16_f32 v11, v201, v201
    s_mov_b32 s15, 0
    s_cmp_lg_u32 s18, 1
    s_cbranch_scc1 Lnkv_17
    v_add_u32 v202, s30, v1
    s_lshl_b32 s61, s16, 11
    s_add_u32 s61, s61, 0
    v_add_u32 v203, s61, v1
    v_add_u32 v204, 0, v1
    v_mfma_f32_32x32x16_bf16 v[128:143], a[160:163], v[160:163], 0
    v_mfma_f32_32x32x16_bf16 v[128:143], a[164:167], v[164:167], v[128:143]
    v_mfma_f32_32x32x16_bf16 v[128:143], a[168:171], v[168:171], v[128:143]
    v_mfma_f32_32x32x16_bf16 v[128:143], a[172:175], v[172:175], v[128:143]
    v_mfma_f32_32x32x16_bf16 v[128:143], a[176:179], v[176:179], v[128:143]
    v_mfma_f32_32x32x16_bf16 v[128:143], a[180:183], v[180:183], v[128:143]
    v_mfma_f32_32x32x16_bf16 v[128:143], a[184:187], v[184:187], v[128:143]
    v_mfma_f32_32x32x16_bf16 v[128:143], a[188:191], v[188:191], v[128:143]
    v_mfma_f32_32x32x16_bf16 v[128:143], v[208:211], v[10:13], v[128:143]
    s_nop 11
    ds_write_b128 v202, v[128:131] offset:8192
    ds_write_b128 v202, v[132:135] offset:9216
    ds_write_b128 v202, v[136:139] offset:10240
    ds_write_b128 v202, v[140:143] offset:11264
    s_waitcnt lgkmcnt(0)
    s_barrier
    s_cmp_ge_u32 s16, 2
    s_cbranch_scc1 Lnkv_17
    v_add_u32 v99, 135168, v3
    ds_read_b32 v96, v99 offset:6912
    ds_read_b32 v97, v99 offset:14080
    ds_read_b32 v98, v99 offset:21248
    ds_read_b32 v99, v99 offset:28416
    v_mfma_f32_32x32x16_bf16 v[48:63], a[224:227], v[160:163], 0
    ds_read_b128 v[224:227], v203 offset:8192
    ds_read_b128 v[228:231], v203 offset:9216
    ds_read_b128 v[232:235], v203 offset:24576
    ds_read_b128 v[236:239], v203 offset:25600
    ds_read_b128 v[240:243], v203 offset:40960
    ds_read_b128 v[244:247], v203 offset:41984
    v_mfma_f32_32x32x16_bf16 v[48:63], a[228:231], v[164:167], v[48:63]
    ds_read_b128 v[248:251], v203 offset:57344
    ds_read_b128 v[252:255], v203 offset:58368
    s_mul_i32 s61, s17, 2112
    s_add_u32 s61, s61, 4917248
    s_lshl_b32 s15, s17, 8
    s_add_u32 s15, s15, 5128192
    s_waitcnt lgkmcnt(8)
    v_add_f32 v96, v96, v98
    v_mfma_f32_32x32x16_bf16 v[48:63], a[232:235], v[168:171], v[48:63]
    v_add_f32 v97, v97, v99
    v_add_f32 v96, v96, v97
    v_mov_b32 v97, v96
    s_nop 1
    v_permlane32_swap_b32 v96, v97
    v_mul_f32 v98, 0x3b000000, v96
    v_mfma_f32_32x32x16_bf16 v[48:63], a[236:239], v[172:175], v[48:63]
    v_mul_f32 v97, 0x3b000000, v97
    v_fma_f32 v97, -v98, v98, v97
    v_max_f32 v97, 0, v97
    v_add_f32 v97, 0x3727c5ac, v97
    v_rsq_f32 v100, v97
    s_mul_i32 s62, s16, 16384
    v_mfma_f32_32x32x16_bf16 v[48:63], a[240:243], v[176:179], v[48:63]
    v_add_u32 v204, s62, v204
    s_add_u32 s62, s62, 0
    v_bfe_u32 v96, v0, 3, 2
    v_mul_u32_u24 v96, 272, v96
    v_add_u32 v96, s62, v96
    v_and_b32 v97, 7, v0
    v_mfma_f32_32x32x16_bf16 v[48:63], a[244:247], v[180:183], v[48:63]
    v_lshl_add_u32 v97, v97, 1, v96
    v_lshrrev_b32 v98, 5, v0
    v_lshl_add_u32 v97, v98, 6, v97
    s_waitcnt lgkmcnt(5)
    v_add_f32 v224, v224, v232
    v_mfma_f32_32x32x16_bf16 v[48:63], a[248:251], v[184:187], v[48:63]
    v_add_f32 v225, v225, v233
    v_add_f32 v226, v226, v234
    v_add_f32 v227, v227, v235
    s_waitcnt lgkmcnt(4)
    v_add_f32 v228, v228, v236
    v_add_f32 v229, v229, v237
    v_mfma_f32_32x32x16_bf16 v[48:63], a[252:255], v[188:191], v[48:63]
    v_add_f32 v230, v230, v238
    v_add_f32 v231, v231, v239
    s_waitcnt lgkmcnt(3)
    v_add_f32 v224, v224, v240
    v_add_f32 v225, v225, v241
    v_mfma_f32_32x32x16_bf16 v[48:63], v[210:213], v[8:11], v[48:63]
    v_add_f32 v226, v226, v242
    v_add_f32 v227, v227, v243
    s_waitcnt lgkmcnt(2)
    v_add_f32 v228, v228, v244
    v_add_f32 v229, v229, v245
    v_add_f32 v230, v230, v246
    v_mfma_f32_32x32x16_bf16 v[32:47], a[192:195], v[160:163], 0
    v_add_f32 v231, v231, v247
    s_waitcnt lgkmcnt(1)
    v_add_f32 v224, v224, v248
    v_add_f32 v225, v225, v249
    v_add_f32 v226, v226, v250
    v_add_f32 v227, v227, v251
    v_mfma_f32_32x32x16_bf16 v[32:47], a[196:199], v[164:167], v[32:47]
    s_waitcnt lgkmcnt(0)
    v_add_f32 v228, v228, v252
    v_add_f32 v229, v229, v253
    v_add_f32 v230, v230, v254
    v_add_f32 v231, v231, v255
    v_mfma_f32_32x32x16_bf16 v[32:47], a[200:203], v[168:171], v[32:47]
    v_mul_f32 v224, v100, v224
    v_mul_f32 v225, v100, v225
    v_mul_f32 v226, v100, v226
    v_mul_f32 v227, v100, v227
    v_mul_f32 v228, v100, v228
    v_mul_f32 v229, v100, v229
    v_mfma_f32_32x32x16_bf16 v[32:47], a[204:207], v[172:175], v[32:47]
    v_mul_f32 v230, v100, v230
    v_mul_f32 v231, v100, v231
    v_cvt_pk_bf16_f32 v232, v224, v225
    v_cvt_pk_bf16_f32 v233, v226, v227
    v_cvt_pk_bf16_f32 v234, v228, v229
    v_cvt_pk_bf16_f32 v235, v230, v231
    v_mfma_f32_32x32x16_bf16 v[32:47], a[208:211], v[176:179], v[32:47]
    ds_write_b128 v124, v[48:51] offset:2048
    s_cmp_eq_u32 s16, 1
    s_cbranch_scc1 Lv_18
    buffer_store_dwordx4 v[232:235], v1, s[4:7], s61 offen sc1
    s_mov_b64 exec, -1
Lv_18:
    ds_write_b16 v97, v232 offset:12288
    ds_write_b16_d16_hi v97, v232 offset:12304
    ds_write_b16 v97, v233 offset:12320
    ds_write_b16_d16_hi v97, v233 offset:12336
    v_mfma_f32_32x32x16_bf16 v[32:47], a[212:215], v[180:183], v[32:47]
    ds_write_b128 v124, v[52:55] offset:3072
    ds_write_b16 v97, v234 offset:12416
    ds_write_b16_d16_hi v97, v234 offset:12432
    ds_write_b16 v97, v235 offset:12448
    ds_write_b16_d16_hi v97, v235 offset:12464
    v_mov_b32 v224, v4
    v_mov_b32 v225, v4
    v_mfma_f32_32x32x16_bf16 v[32:47], a[216:219], v[184:187], v[32:47]
    ds_write_b128 v124, v[56:59] offset:4096
    v_mov_b32 v226, v4
    v_mov_b32 v227, v4
    ds_write_b128 v96, v[224:227] offset:12544
    ds_read_b128 v[236:239], v204 offset:12288
    ds_read_b128 v[240:243], v204 offset:13312
    v_mfma_f32_32x32x16_bf16 v[32:47], a[220:223], v[188:191], v[32:47]
    ds_write_b128 v124, v[60:63] offset:5120
    v_mfma_f32_32x32x16_bf16 v[32:47], v[210:213], v[10:13], v[32:47]
    s_cmp_eq_u32 s16, 0
    s_cbranch_scc1 Lkf_19
    s_waitcnt lgkmcnt(1)
    s_add_u32 s15, s15, 128
    buffer_store_dwordx4 v[236:239], v1, s[4:7], s61 offen offset:1024 sc1
    s_mov_b64 exec, 15
    buffer_store_dwordx4 v[240:243], v1, s[4:7], s61 offen offset:2048 sc1
    s_mov_b64 exec, -1
Lkf_19:
    s_branch Lkj_20
Lnkv_17:
    v_mfma_f32_32x32x16_bf16 v[48:63], a[224:227], v[160:163], 0
    v_mfma_f32_32x32x16_bf16 v[48:63], a[228:231], v[164:167], v[48:63]
    v_mfma_f32_32x32x16_bf16 v[48:63], a[232:235], v[168:171], v[48:63]
    v_mfma_f32_32x32x16_bf16 v[48:63], a[236:239], v[172:175], v[48:63]
    v_mfma_f32_32x32x16_bf16 v[48:63], a[240:243], v[176:179], v[48:63]
    v_mfma_f32_32x32x16_bf16 v[48:63], a[244:247], v[180:183], v[48:63]
    v_mfma_f32_32x32x16_bf16 v[48:63], a[248:251], v[184:187], v[48:63]
    v_mfma_f32_32x32x16_bf16 v[48:63], a[252:255], v[188:191], v[48:63]
    v_mfma_f32_32x32x16_bf16 v[48:63], v[210:213], v[8:11], v[48:63]
    v_mfma_f32_32x32x16_bf16 v[32:47], a[192:195], v[160:163], 0
    v_mfma_f32_32x32x16_bf16 v[32:47], a[196:199], v[164:167], v[32:47]
    v_mfma_f32_32x32x16_bf16 v[32:47], a[200:203], v[168:171], v[32:47]
    v_mfma_f32_32x32x16_bf16 v[32:47], a[204:207], v[172:175], v[32:47]
    v_mfma_f32_32x32x16_bf16 v[32:47], a[208:211], v[176:179], v[32:47]
    s_nop 6
    ds_write_b128 v124, v[48:51] offset:2048
    v_mfma_f32_32x32x16_bf16 v[32:47], a[212:215], v[180:183], v[32:47]
    ds_write_b128 v124, v[52:55] offset:3072
    v_mfma_f32_32x32x16_bf16 v[32:47], a[216:219], v[184:187], v[32:47]
    ds_write_b128 v124, v[56:59] offset:4096
    v_mfma_f32_32x32x16_bf16 v[32:47], a[220:223], v[188:191], v[32:47]
    ds_write_b128 v124, v[60:63] offset:5120
    v_mfma_f32_32x32x16_bf16 v[32:47], v[210:213], v[10:13], v[32:47]
Lkj_20:
    s_nop 11
    ds_write_b128 v124, v[40:43] offset:0
    ds_write_b128 v124, v[44:47] offset:1024
    s_waitcnt lgkmcnt(0)
    s_barrier
    v_add_u32 v207, 135168, v3
    ds_read_b32 v204, v207 offset:6912
    ds_read_b32 v205, v207 offset:14080
    ds_read_b32 v206, v207 offset:21248
    ds_read_b32 v207, v207 offset:28416
    ds_read_b128 v[104:107], v126 offset:2048
    ds_read_b128 v[108:111], v126 offset:3072
    ds_read_b128 v[112:115], v127 offset:4096
    ds_read_b128 v[116:119], v127 offset:5120
    ds_read_b128 v[96:99], v125 offset:0
    ds_read_b128 v[100:103], v125 offset:1024
    s_cmp_eq_u32 s15, 0
    s_cbranch_scc1 Lnkf_21
    s_waitcnt vmcnt(0)
    v_mov_b32 v14, s1
    s_mov_b64 exec, 1
    buffer_store_dword v14, off, s[4:7], s15 sc1
    s_mov_b64 exec, -1
Lnkf_21:
    v_lshlrev_b32 v15, 7, v0
    v_mov_b32 v14, s1
    s_lshl_b32 s63, s16, 11
    s_add_u32 s63, s63, 5120000
    s_mov_b64 exec, 0xffff
    buffer_load_dword v14, v15, s[4:7], s63 offen sc1
    s_mov_b64 exec, -1
    s_waitcnt lgkmcnt(6)
    v_add_f32 v204, v204, v206
    v_add_f32 v205, v205, v207
    v_add_f32 v204, v204, v205
    v_mov_b32 v205, v204
    s_nop 1
    v_permlane32_swap_b32 v204, v205
    v_mul_f32 v206, 0x3b000000, v204
    v_mul_f32 v205, 0x3b000000, v205
    v_fma_f32 v205, -v206, v206, v205
    v_max_f32 v205, 0, v205
    v_add_f32 v205, 0x3727c5ac, v205
    v_rsq_f32 v200, v205
    s_nop 0
    v_mul_f32 v200, 0x3eb8aa3b, v200
    v_mov_b32 v201, v200
    s_waitcnt lgkmcnt(5)
    v_pk_add_f32 v[32:33], v[32:33], v[104:105]
    v_pk_add_f32 v[34:35], v[34:35], v[106:107]
    s_waitcnt lgkmcnt(4)
    v_pk_add_f32 v[36:37], v[36:37], v[108:109]
    v_pk_add_f32 v[38:39], v[38:39], v[110:111]
    s_waitcnt lgkmcnt(3)
    v_pk_add_f32 v[32:33], v[32:33], v[112:113]
    v_pk_add_f32 v[34:35], v[34:35], v[114:115]
    s_waitcnt lgkmcnt(2)
    v_pk_add_f32 v[36:37], v[36:37], v[116:117]
    v_pk_add_f32 v[38:39], v[38:39], v[118:119]
    s_waitcnt lgkmcnt(1)
    v_pk_add_f32 v[32:33], v[32:33], v[96:97]
    v_pk_add_f32 v[34:35], v[34:35], v[98:99]
    s_waitcnt lgkmcnt(0)
    v_pk_add_f32 v[36:37], v[36:37], v[100:101]
    v_pk_add_f32 v[38:39], v[38:39], v[102:103]
    v_pk_mul_f32 v[32:33], v[32:33], v[200:201]
    v_pk_mul_f32 v[34:35], v[34:35], v[200:201]
    v_pk_mul_f32 v[36:37], v[36:37], v[200:201]
    v_pk_mul_f32 v[38:39], v[38:39], v[200:201]
    v_cvt_pk_bf16_f32 v28, v32, v33
    v_cvt_pk_bf16_f32 v29, v34, v35
    v_cvt_pk_bf16_f32 v30, v36, v37
    v_cvt_pk_bf16_f32 v31, v38, v39
    s_sub_u32 s60, s2, 64
    s_cmp_ge_u32 s60, 128
    s_cbranch_scc1 Lnj_22
    v_lshrrev_b32 v152, 5, v0
    v_bfe_u32 v154, v0, 2, 2
    v_lshl_add_u32 v152, v152, 2, v154
    v_lshlrev_b32 v152, 6, v152
    v_and_b32 v153, 3, v0
    v_lshl_add_u32 v152, v153, 3, v152
    v_bfe_u32 v153, v0, 4, 1
    v_lshl_add_u32 v152, v153, 5, v152
    s_add_u32 s60, s30, 65536
    v_add_u32 v152, s60, v152
    s_waitcnt vmcnt(1)
    ds_read_b64_tr_b16 a[160:161], v152 offset:1024
    ds_read_b64_tr_b16 a[162:163], v152 offset:1536
    ds_read_b64_tr_b16 a[164:165], v152 offset:2048
    ds_read_b64_tr_b16 a[166:167], v152 offset:2560
    ds_read_b64_tr_b16 a[168:169], v152 offset:3072
    ds_read_b64_tr_b16 a[170:171], v152 offset:3584
    ds_read_b64_tr_b16 a[172:173], v152 offset:4096
    ds_read_b64_tr_b16 a[174:175], v152 offset:4608
    ds_read_b64_tr_b16 a[176:177], v152 offset:5120
    ds_read_b64_tr_b16 a[178:179], v152 offset:5632
    ds_read_b64_tr_b16 a[180:181], v152 offset:6144
    ds_read_b64_tr_b16 a[182:183], v152 offset:6656
    ds_read_b64_tr_b16 a[184:185], v152 offset:7168
    ds_read_b64_tr_b16 a[186:187], v152 offset:7680
    ds_read_b64_tr_b16 a[188:189], v152 offset:8192
    ds_read_b64_tr_b16 a[190:191], v152 offset:8704
    s_waitcnt lgkmcnt(0)
    s_cmp_lt_u32 s2, 136
    s_cbranch_scc1 Lnj_22
    v_mov_b32 v148, v4
    v_mov_b32 v149, v4
    v_mov_b32 v150, v4
    v_mov_b32 v151, v4
    s_nop 1
    v_mfma_f32_32x32x16_bf16 v[128:143], v[148:151], a[160:163], 0
    v_mfma_f32_32x32x16_bf16 v[128:143], v[148:151], a[164:167], v[128:143]
    v_mfma_f32_32x32x16_bf16 v[128:143], v[148:151], a[168:171], v[128:143]
    v_mfma_f32_32x32x16_bf16 v[128:143], v[148:151], a[172:175], v[128:143]
    v_mfma_f32_32x32x16_bf16 v[128:143], v[148:151], a[176:179], v[128:143]
    v_mfma_f32_32x32x16_bf16 v[128:143], v[148:151], a[180:183], v[128:143]
    v_mfma_f32_32x32x16_bf16 v[128:143], v[148:151], a[184:187], v[128:143]
    v_mfma_f32_32x32x16_bf16 v[128:143], v[148:151], a[188:191], v[128:143]
    v_add_u32 v152, s60, v3
    v_add_u32 v153, 65536, v3
    s_nop 9
    ds_write_b32 v152, v128
    s_waitcnt lgkmcnt(0)
    s_barrier
    ds_read_b32 v154, v153 offset:0
    ds_read_b32 v155, v153 offset:16384
    ds_read_b32 v156, v153 offset:32768
    ds_read_b32 v157, v153 offset:49152
    v_cmp_gt_u32 vcc, 32, v0
    s_waitcnt lgkmcnt(0)
    v_add_f32 v154, v154, v155
    v_add_f32 v156, v156, v157
    v_add_f32 v154, v154, v156
    v_cvt_pk_bf16_f32 v155, v154, v154
    v_and_b32 v155, 0xffff0000, v155
    v_sub_f32 v155, v154, v155
    v_cvt_pk_bf16_f32 v154, v154, v155
    v_cndmask_b32 v208, 0, v154, vcc
    v_cndmask_b32 v209, 0, v154, vcc
Lnj_22:
    s_add_u32 s56, s36, 4849664
    s_add_u32 s56, s4, s56
    s_addc_u32 s57, s5, 0
    s_add_u32 s58, s37, 4849664
    s_add_u32 s58, s4, s58
    s_addc_u32 s59, s5, 0
    s_waitcnt vmcnt(0)
    v_cmp_ne_u32 vcc, s1, v14
    s_nop 4
    s_cbranch_vccnz Lretry_23
Lback_24:
    s_barrier
    s_add_u32 m0, s36, 67584
    s_add_u32 s66, s56, 0
    s_addc_u32 s67, s57, 0
    global_load_lds_dwordx4 v1, s[66:67] offset:0
    global_load_lds_dwordx4 v1, s[66:67] offset:1024
    global_load_lds_dwordx4 v1, s[66:67] offset:2048
    global_load_lds_dwordx4 v1, s[66:67] offset:3072
    s_mov_b32 s10, 2097152
    s_mov_b32 s11, 0x20000
    s_lshl_b32 s3, s17, 20
    s_add_u32 s3, s3, 6291456
    s_add_u32 s38, s19, s3
    s_lshl_b32 s40, s16, 11
    s_add_u32 s40, s40, s3
    s_lshr_b32 s63, s16, 1
    s_lshl_b32 s62, s18, 1
    s_add_u32 s63, s63, s62
    s_lshl_b32 s44, s63, 15
    s_add_u32 s44, s44, s19
    s_xor_b32 s46, s44, 32768
    s_add_u32 s38, s4, s38
    s_addc_u32 s39, s5, 0
    s_add_u32 s40, s4, s40
    s_addc_u32 s41, s5, 0
    s_add_u32 s44, s4, s44
    s_addc_u32 s45, s5, 0
    s_add_u32 s46, s4, s46
    s_addc_u32 s47, s5, 0
    s_lshl_b32 s60, s18, 2
    s_add_u32 s60, s60, s16
    s_lshl_b32 s20, s60, 10
    s_add_u32 s20, s20, s3
    s_add_u32 s21, s60, s3
    s_add_u32 s21, s21, 458752
    s_lshl_b32 s22, s16, 3
    s_add_u32 s22, s22, s3
    s_add_u32 s22, s22, 458752
    s_lshl_b32 s23, s18, 10
    s_lshl_b32 s60, s16, 2
    s_add_u32 s23, s23, s60
    s_add_u32 s23, s23, s3
    s_mul_i32 s60, s18, 7
    s_lshl_b32 s61, s16, 1
    s_add_u32 s60, s60, s61
    s_lshl_b32 s24, s60, 11
    s_add_u32 s24, s24, s3
    s_add_u32 s24, s24, 196608
    s_add_u32 s25, s24, 2048
    s_lshl_b32 s52, s60, 15
    s_add_u32 s52, s52, 1048576
    s_add_u32 s54, s52, 32768
    s_cmp_eq_u32 s16, 3
    s_cselect_b32 s25, s24, s25
    s_cselect_b32 s54, s52, s54
    s_mul_i32 s42, s16, 28672
    s_mul_i32 s48, s63, 114688
    s_xor_b32 s63, s63, 1
    s_mul_i32 s50, s63, 114688
    s_add_u32 s60, s42, 2883584
    s_add_u32 s48, s48, s60
    s_add_u32 s50, s50, s60
    s_add_u32 s42, s42, s3
    s_add_u32 s42, s42, 196608
    s_add_u32 s42, s4, s42
    s_addc_u32 s43, s5, 0
    s_add_u32 s48, s4, s48
    s_addc_u32 s49, s5, 0
    s_add_u32 s50, s4, s50
    s_addc_u32 s51, s5, 0
    s_add_u32 s52, s4, s52
    s_addc_u32 s53, s5, 0
    s_mov_b32 s3, 0
    s_add_u32 m0, s36, 83968
    s_add_u32 s66, s56, 16384
    s_addc_u32 s67, s57, 0
    global_load_lds_dwordx4 v1, s[66:67] offset:0
    global_load_lds_dwordx4 v1, s[66:67] offset:1024
    v_mov_b32 v124, 0xdddddddd
    v_add_u32 v125, 67584, v1
    v_and_b32 v126, 31, v0
    v_min_u32 v126, 16, v126
    v_lshlrev_b32 v126, 4, v126
    v_lshrrev_b32 v127, 5, v0
    v_mul_u32_u24 v127, 272, v127
    v_add_u32 v126, v126, v127
    v_add_u32 v126, 67584, v126
    s_mov_b32 s61, 0xffee0000
    s_mov_b32 exec_lo, s61
    s_mov_b32 exec_hi, s61
    v_add_u32 v126, 0x100000, v126
    s_mov_b64 exec, -1
    v_mov_b32 v64, 0
    v_mov_b32 v65, 0
    v_mov_b32 v66, 0
    v_mov_b32 v67, 0
    v_mov_b32 v68, 0
    v_mov_b32 v69, 0
    v_mov_b32 v70, 0
    v_mov_b32 v71, 0
    v_mov_b32 v72, 0
    v_mov_b32 v73, 0
    v_mov_b32 v74, 0
    v_mov_b32 v75, 0
    v_mov_b32 v76, 0
    v_mov_b32 v77, 0
    v_mov_b32 v78, 0
    v_mov_b32 v79, 0
    v_mov_b32 v80, 0
    v_mov_b32 v81, 0
    v_mov_b32 v82, 0
    v_mov_b32 v83, 0
    v_mov_b32 v84, 0
    v_mov_b32 v85, 0
    v_mov_b32 v86, 0
    v_mov_b32 v87, 0
    v_mov_b32 v88, 0
    v_mov_b32 v89, 0
    v_mov_b32 v90, 0
    v_mov_b32 v91, 0
    v_mov_b32 v92, 0
    v_mov_b32 v93, 0
    v_mov_b32 v94, 0
    v_mov_b32 v95, 0
    v_lshlrev_b32 v232, 7, v0
    v_lshlrev_b32 v233, 10, v0
    v_mov_b32 v224, -1
    v_mov_b32 v225, -1
    v_mov_b32 v226, -1
    v_mov_b32 v227, -1
    global_load_lds_dwordx4 v1, s[66:67] offset:2048
    global_load_lds_dwordx4 v1, s[66:67] offset:3072
    s_waitcnt vmcnt(4)
    s_barrier
    s_cmp_ge_u32 s18, 2
    s_cbranch_scc1 Lnp_29
    s_mul_i32 s60, s18, 67584
    s_mul_i32 s61, s17, 2112
    s_add_u32 s60, s60, s61
    s_lshl_b32 s61, s16, 10
    s_add_u32 s60, s60, s61
    s_add_u32 s60, s60, 4984832
    s_lshl_b32 s61, s18, 13
    s_lshl_b32 s62, s17, 8
    s_add_u32 s61, s61, s62
    s_add_u32 s61, s61, 5136384
    s_cmp_eq_u32 s16, 2
    s_cselect_b64 exec, 15, -1
    s_cmp_eq_u32 s16, 3
    s_cselect_b32 s60, s61, s60
    s_cselect_b64 exec, 0xffff, exec
    buffer_store_dwordx4 v[224:227], v1, s[4:7], s60 offen sc1
    s_mov_b64 exec, -1
Lnp_29:
    s_cmp_gt_u32 s17, 8
    s_cbranch_scc1 Lng_26
    s_lshl_b32 s60, s17, 10
    v_add_u32 v144, s60, v2
    s_add_u32 s60, s60, s19
    s_add_u32 s60, s60, 4718592
    s_cmp_lg_u32 s17, 0
    s_cbranch_scc1 Lnk_30
    global_store_dwordx4 v144, a[192:195], s[44:45] sc1
    global_store_dwordx4 v144, a[224:227], s[46:47] sc1
    s_cmp_lg_u32 s18, 0
    s_cbranch_scc1 Lng_26
    buffer_store_dwordx4 a[160:163], v1, s[4:7], s60 offen sc1
    s_branch Lng_26
Lnk_30:
    s_cmp_lg_u32 s17, 1
    s_cbranch_scc1 Lnk_31
    global_store_dwordx4 v144, a[196:199], s[44:45] sc1
    global_store_dwordx4 v144, a[228:231], s[46:47] sc1
    s_cmp_lg_u32 s18, 0
    s_cbranch_scc1 Lng_26
    buffer_store_dwordx4 a[164:167], v1, s[4:7], s60 offen sc1
    s_branch Lng_26
Lnk_31:
    s_cmp_lg_u32 s17, 2
    s_cbranch_scc1 Lnk_32
    global_store_dwordx4 v144, a[200:203], s[44:45] sc1
    global_store_dwordx4 v144, a[232:235], s[46:47] sc1
    s_cmp_lg_u32 s18, 0
    s_cbranch_scc1 Lng_26
    buffer_store_dwordx4 a[168:171], v1, s[4:7], s60 offen sc1
    s_branch Lng_26
Lnk_32:
    s_cmp_lg_u32 s17, 3
    s_cbranch_scc1 Lnk_33
    global_store_dwordx4 v144, a[204:207], s[44:45] sc1
    global_store_dwordx4 v144, a[236:239], s[46:47] sc1
    s_cmp_lg_u32 s18, 0
    s_cbranch_scc1 Lng_26
    buffer_store_dwordx4 a[172:175], v1, s[4:7], s60 offen sc1
    s_branch Lng_26
Lnk_33:
    s_cmp_lg_u32 s17, 4
    s_cbranch_scc1 Lnk_34
    global_store_dwordx4 v144, a[208:211], s[44:45] sc1
    global_store_dwordx4 v144, a[240:243], s[46:47] sc1
    s_cmp_lg_u32 s18, 0
    s_cbranch_scc1 Lng_26
    buffer_store_dwordx4 a[176:179], v1, s[4:7], s60 offen sc1
    s_branch Lng_26
Lnk_34:
    s_cmp_lg_u32 s17, 5
    s_cbranch_scc1 Lnk_35
    global_store_dwordx4 v144, a[212:215], s[44:45] sc1
    global_store_dwordx4 v144, a[244:247], s[46:47] sc1
    s_cmp_lg_u32 s18, 0
    s_cbranch_scc1 Lng_26
    buffer_store_dwordx4 a[180:183], v1, s[4:7], s60 offen sc1
    s_branch Lng_26
Lnk_35:
    s_cmp_lg_u32 s17, 6
    s_cbranch_scc1 Lnk_36
    global_store_dwordx4 v144, a[216:219], s[44:45] sc1
    global_store_dwordx4 v144, a[248:251], s[46:47] sc1
    s_cmp_lg_u32 s18, 0
    s_cbranch_scc1 Lng_26
    buffer_store_dwordx4 a[184:187], v1, s[4:7], s60 offen sc1
    s_branch Lng_26
Lnk_36:
    s_cmp_lg_u32 s17, 7
    s_cbranch_scc1 Lnk_37
    global_store_dwordx4 v144, a[220:223], s[44:45] sc1
    global_store_dwordx4 v144, a[252:255], s[46:47] sc1
    s_cmp_lg_u32 s18, 0
    s_cbranch_scc1 Lng_26
    buffer_store_dwordx4 a[188:191], v1, s[4:7], s60 offen sc1
    s_branch Lng_26
Lnk_37:
    v_lshrrev_b32 v144, 1, v2
    s_lshr_b32 s61, s16, 1
    s_lshl_b32 s62, s18, 1
    s_add_u32 s61, s61, s62
    s_lshl_b32 s61, s61, 9
    s_add_u32 s61, s61, 4751360
    buffer_store_dwordx2 v[210:211], v144, s[4:7], s61 offen sc1
    s_xor_b32 s61, s61, 512
    buffer_store_dwordx2 v[212:213], v144, s[4:7], s61 offen sc1
    s_cmp_lg_u32 s18, 0
    s_cbranch_scc1 Lng_26
    v_lshrrev_b32 v144, 1, v1
    s_mov_b32 s61, 4759552
    buffer_store_dwordx2 v[208:209], v144, s[4:7], s61 offen  sc1
Lng_26:
    s_cmp_lg_u32 s18, 6
    s_cbranch_scc1 Lnz_27
    s_lshl_b32 s61, s16, 10
    s_and_b32 s60, s22, 0xffffff00
    s_add_u32 s61, s61, s60
    v_mov_b32 v148, 0
    v_mov_b32 v149, 0
    v_mov_b32 v150, 0
    v_mov_b32 v151, 0
    buffer_store_dwordx4 v[148:151], v1, s[4:7], s61 offen sc1
Lnz_27:
    s_movk_i32 s62, 1024
    s_sub_u32 s60, s2, 64
    s_cmp_ge_u32 s60, 128
    s_cbranch_scc1 Lnj_25
    s_lshl_b32 s61, s2, 15
    s_add_u32 s61, s61, s19
    s_add_u32 s61, s61, 0xffcc0000
    s_lshl_b32 s63, s2, 9
    s_add_u32 s63, s63, 4690432
    s_cmp_ge_u32 s2, 136
    s_cbranch_scc1 Lj1_28
    s_sub_u32 s60, s2, 80
    s_mul_i32 s61, s60, 37
    s_lshr_b32 s61, s61, 8
    s_mul_i32 s62, s61, 7
    s_sub_u32 s60, s60, s62
    s_and_b32 s62, s61, 1
    s_lshr_b32 s61, s61, 1
    s_mul_i32 s61, s61, 28
    s_add_u32 s61, s61, s60
    s_mul_i32 s63, s62, 6
    s_add_u32 s63, s63, 15
    s_lshl_b32 s62, s62, 3
    s_bitcmp1_b32 s60, 0
    s_cselect_b32 s62, s63, s62
    s_add_u32 s61, s61, s62
    s_lshl_b32 s61, s61, 10
    s_add_u32 s61, s61, 2883584
    s_lshl_b32 s63, s2, 11
    s_add_u32 s63, s63, 393216
    s_mov_b32 s62, 114688
    s_cmp_lt_u32 s2, 80
    s_cmov_b32 s62, 32768
    s_cmov_b32 s61, s63
    s_lshr_b32 s63, s16, 1
    s_lshl_b32 s63, s63, 10
    s_add_u32 s61, s61, s63
    s_and_b32 s63, s16, 1
    s_lshl_b32 s63, s63, 3
    s_mul_i32 s63, s63, s62
    s_add_u32 s61, s61, s63
Lj1_28:
    v_lshrrev_b32 v144, 1, v1
    buffer_store_dwordx4 a[160:163], v1, s[4:7], s61 offen sc1
    s_add_u32 s61, s61, s62
    buffer_store_dwordx4 a[164:167], v1, s[4:7], s61 offen sc1
    s_add_u32 s61, s61, s62
    buffer_store_dwordx4 a[168:171], v1, s[4:7], s61 offen sc1
    s_add_u32 s61, s61, s62
    buffer_store_dwordx4 a[172:175], v1, s[4:7], s61 offen sc1
    s_add_u32 s61, s61, s62
    buffer_store_dwordx4 a[176:179], v1, s[4:7], s61 offen sc1
    s_add_u32 s61, s61, s62
    buffer_store_dwordx4 a[180:183], v1, s[4:7], s61 offen sc1
    s_add_u32 s61, s61, s62
    buffer_store_dwordx4 a[184:187], v1, s[4:7], s61 offen sc1
    s_add_u32 s61, s61, s62
    buffer_store_dwordx4 a[188:191], v1, s[4:7], s61 offen sc1
    s_add_u32 s61, s61, s62
    s_cmp_eq_u32 s62, 1024
    s_cbranch_scc0 Lnj_25
    buffer_store_dwordx2 v[208:209], v144, s[4:7], s63 offen sc1
Lnj_25:
    ds_read_b128 v[96:99], v125 offset:0
    ds_read_b128 v[104:107], v126 offset:1024
    ds_read_b128 v[108:111], v126 offset:1568
    ds_read_b128 v[100:103], v125 offset:2112
    s_waitcnt lgkmcnt(3)
    v_mfma_f32_32x32x16_bf16 v[32:47], v[96:99], v[24:27], 0
    s_nop 11
    v_exp_f32 v32, v32
    v_exp_f32 v33, v33
    ds_read_b128 v[112:115], v126 offset:3136
    v_exp_f32 v34, v34
    v_exp_f32 v35, v35
    v_exp_f32 v36, v36
    v_mfma_f32_32x32x16_bf16 v[48:63], v[96:99], v[28:31], 0
    ds_read_b128 v[116:119], v126 offset:3680
    v_exp_f32 v37, v37
    v_exp_f32 v38, v38
    v_exp_f32 v39, v39
    v_exp_f32 v40, v40
    v_exp_f32 v41, v41
    s_waitcnt lgkmcnt(4)
    v_smfmac_f32_32x32x32_bf16 v[64:79], v[104:107], v[32:39], v124
    s_add_u32 m0, s36, 100352
    s_add_u32 s66, s56, 32768
    s_addc_u32 s67, s57, 0
    global_load_lds_dwordx4 v1, s[66:67] offset:0
    global_load_lds_dwordx4 v1, s[66:67] offset:1024
    v_exp_f32 v42, v42
    v_exp_f32 v43, v43
    v_exp_f32 v44, v44
    v_exp_f32 v45, v45
    v_exp_f32 v46, v46
    v_exp_f32 v47, v47
    v_exp_f32 v48, v48
    v_exp_f32 v49, v49
    s_waitcnt lgkmcnt(3)
    v_smfmac_f32_32x32x32_bf16 v[64:79], v[108:111], v[40:47], v124
    s_waitcnt lgkmcnt(0)
    v_exp_f32 v50, v50
    v_exp_f32 v51, v51
    v_exp_f32 v52, v52
    v_mfma_f32_32x32x16_bf16 v[32:47], v[100:103], v[24:27], 0
    global_load_lds_dwordx4 v1, s[66:67] offset:2048
    global_load_lds_dwordx4 v1, s[66:67] offset:3072
    v_exp_f32 v53, v53
    v_exp_f32 v54, v54
    v_exp_f32 v55, v55
    v_exp_f32 v56, v56
    v_exp_f32 v57, v57
    v_smfmac_f32_32x32x32_bf16 v[80:95], v[104:107], v[48:55], v124
    ds_read_b128 v[96:99], v125 offset:4224
    v_exp_f32 v58, v58
    v_exp_f32 v59, v59
    v_exp_f32 v60, v60
    v_exp_f32 v61, v61
    v_exp_f32 v62, v62
    v_exp_f32 v63, v63
    v_exp_f32 v32, v32
    v_exp_f32 v33, v33
    v_smfmac_f32_32x32x32_bf16 v[80:95], v[108:111], v[56:63], v124
    ds_read_b128 v[104:107], v126 offset:5248
    v_exp_f32 v34, v34
    v_exp_f32 v35, v35
    v_exp_f32 v36, v36
    v_mfma_f32_32x32x16_bf16 v[48:63], v[100:103], v[28:31], 0
    ds_read_b128 v[108:111], v126 offset:5792
    v_exp_f32 v37, v37
    v_exp_f32 v38, v38
    v_exp_f32 v39, v39
    v_exp_f32 v40, v40
    v_exp_f32 v41, v41
    v_smfmac_f32_32x32x32_bf16 v[64:79], v[112:115], v[32:39], v124
    s_add_u32 m0, s36, 116736
    s_add_u32 s66, s56, 49152
    s_addc_u32 s67, s57, 0
    global_load_lds_dwordx4 v1, s[66:67] offset:0
    global_load_lds_dwordx4 v1, s[66:67] offset:1024
    v_exp_f32 v42, v42
    v_exp_f32 v43, v43
    v_exp_f32 v44, v44
    v_exp_f32 v45, v45
    v_exp_f32 v46, v46
    v_exp_f32 v47, v47
    v_exp_f32 v48, v48
    v_exp_f32 v49, v49
    v_smfmac_f32_32x32x32_bf16 v[64:79], v[116:119], v[40:47], v124
    s_waitcnt lgkmcnt(0)
    v_exp_f32 v50, v50
    v_exp_f32 v51, v51
    v_exp_f32 v52, v52
    v_mfma_f32_32x32x16_bf16 v[32:47], v[96:99], v[24:27], 0
    global_load_lds_dwordx4 v1, s[66:67] offset:2048
    global_load_lds_dwordx4 v1, s[66:67] offset:3072
    v_exp_f32 v53, v53
    v_exp_f32 v54, v54
    v_exp_f32 v55, v55
    v_exp_f32 v56, v56
    v_exp_f32 v57, v57
    v_smfmac_f32_32x32x32_bf16 v[80:95], v[112:115], v[48:55], v124
    ds_read_b128 v[100:103], v125 offset:6336
    v_exp_f32 v58, v58
    v_exp_f32 v59, v59
    v_exp_f32 v60, v60
    v_exp_f32 v61, v61
    v_exp_f32 v62, v62
    v_exp_f32 v63, v63
    v_exp_f32 v32, v32
    v_exp_f32 v33, v33
    v_smfmac_f32_32x32x32_bf16 v[80:95], v[116:119], v[56:63], v124
    ds_read_b128 v[112:115], v126 offset:7360
    v_exp_f32 v34, v34
    v_exp_f32 v35, v35
    v_exp_f32 v36, v36
    v_mfma_f32_32x32x16_bf16 v[48:63], v[96:99], v[28:31], 0
    ds_read_b128 v[116:119], v126 offset:7904
    v_exp_f32 v37, v37
    v_exp_f32 v38, v38
    v_exp_f32 v39, v39
    v_exp_f32 v40, v40
    v_exp_f32 v41, v41
    v_smfmac_f32_32x32x32_bf16 v[64:79], v[104:107], v[32:39], v124
    s_add_u32 m0, s37, 133120
    s_add_u32 s66, s58, 65536
    s_addc_u32 s67, s59, 0
    global_load_lds_dwordx4 v1, s[66:67] offset:0
    v_exp_f32 v42, v42
    v_exp_f32 v43, v43
    v_exp_f32 v44, v44
    v_exp_f32 v45, v45
    v_exp_f32 v46, v46
    v_exp_f32 v47, v47
    v_exp_f32 v48, v48
    v_exp_f32 v49, v49
    v_smfmac_f32_32x32x32_bf16 v[64:79], v[108:111], v[40:47], v124
    s_waitcnt lgkmcnt(0)
    v_exp_f32 v50, v50
    v_exp_f32 v51, v51
    v_exp_f32 v52, v52
    v_mfma_f32_32x32x16_bf16 v[32:47], v[100:103], v[24:27], 0
    v_exp_f32 v53, v53
    v_exp_f32 v54, v54
    v_exp_f32 v55, v55
    v_exp_f32 v56, v56
    v_exp_f32 v57, v57
    v_smfmac_f32_32x32x32_bf16 v[80:95], v[104:107], v[48:55], v124
    ds_read_b128 v[96:99], v125 offset:8448
    v_exp_f32 v58, v58
    v_exp_f32 v59, v59
    v_exp_f32 v60, v60
    v_exp_f32 v61, v61
    v_exp_f32 v62, v62
    v_exp_f32 v63, v63
    v_exp_f32 v32, v32
    v_exp_f32 v33, v33
    v_smfmac_f32_32x32x32_bf16 v[80:95], v[108:111], v[56:63], v124
    ds_read_b128 v[104:107], v126 offset:9472
    v_exp_f32 v34, v34
    v_exp_f32 v35, v35
    v_exp_f32 v36, v36
    v_mfma_f32_32x32x16_bf16 v[48:63], v[100:103], v[28:31], 0
    ds_read_b128 v[108:111], v126 offset:10016
    v_exp_f32 v37, v37
    v_exp_f32 v38, v38
    v_exp_f32 v39, v39
    v_exp_f32 v40, v40
    v_exp_f32 v41, v41
    v_smfmac_f32_32x32x32_bf16 v[64:79], v[112:115], v[32:39], v124
    v_exp_f32 v42, v42
    v_exp_f32 v43, v43
    v_exp_f32 v44, v44
    v_exp_f32 v45, v45
    v_exp_f32 v46, v46
    v_exp_f32 v47, v47
    v_exp_f32 v48, v48
    v_exp_f32 v49, v49
    v_smfmac_f32_32x32x32_bf16 v[64:79], v[116:119], v[40:47], v124
    s_waitcnt lgkmcnt(0)
    v_exp_f32 v50, v50
    v_exp_f32 v51, v51
    v_exp_f32 v52, v52
    v_mfma_f32_32x32x16_bf16 v[32:47], v[96:99], v[24:27], 0
    v_exp_f32 v53, v53
    v_exp_f32 v54, v54
    v_exp_f32 v55, v55
    v_exp_f32 v56, v56
    v_exp_f32 v57, v57
    v_smfmac_f32_32x32x32_bf16 v[80:95], v[112:115], v[48:55], v124
    ds_read_b128 v[100:103], v125 offset:10560
    v_exp_f32 v58, v58
    v_exp_f32 v59, v59
    v_exp_f32 v60, v60
    v_exp_f32 v61, v61
    v_exp_f32 v62, v62
    v_exp_f32 v63, v63
    v_exp_f32 v32, v32
    v_exp_f32 v33, v33
    v_smfmac_f32_32x32x32_bf16 v[80:95], v[116:119], v[56:63], v124
    ds_read_b128 v[112:115], v126 offset:11584
    v_exp_f32 v34, v34
    v_exp_f32 v35, v35
    v_exp_f32 v36, v36
    v_mfma_f32_32x32x16_bf16 v[48:63], v[96:99], v[28:31], 0
    ds_read_b128 v[116:119], v126 offset:12128
    v_exp_f32 v37, v37
    v_exp_f32 v38, v38
    v_exp_f32 v39, v39
    v_exp_f32 v40, v40
    v_exp_f32 v41, v41
    v_smfmac_f32_32x32x32_bf16 v[64:79], v[104:107], v[32:39], v124
    v_exp_f32 v42, v42
    v_exp_f32 v43, v43
    v_exp_f32 v44, v44
    v_exp_f32 v45, v45
    v_exp_f32 v46, v46
    v_exp_f32 v47, v47
    v_exp_f32 v48, v48
    v_exp_f32 v49, v49
    v_smfmac_f32_32x32x32_bf16 v[64:79], v[108:111], v[40:47], v124
    s_waitcnt lgkmcnt(0)
    v_exp_f32 v50, v50
    v_exp_f32 v51, v51
    v_exp_f32 v52, v52
    v_mfma_f32_32x32x16_bf16 v[32:47], v[100:103], v[24:27], 0
    s_waitcnt vmcnt(0)
    s_barrier
    s_cmp_lg_u32 s16, 0
    s_cbranch_scc1 Lnx_38
    v_mov_b32 v14, s14
    s_lshl_b32 s61, s2, 7
    s_add_u32 s61, s61, 5152768
    s_mov_b64 exec, 1
    buffer_store_dword v14, off, s[4:7], s61 sc1
    s_mov_b64 exec, -1
Lnx_38:
    v_exp_f32 v53, v53
    v_exp_f32 v54, v54
    v_exp_f32 v55, v55
    v_exp_f32 v56, v56
    v_exp_f32 v57, v57
    v_smfmac_f32_32x32x32_bf16 v[80:95], v[104:107], v[48:55], v124
    ds_read_b128 v[96:99], v125 offset:12672
    v_exp_f32 v58, v58
    v_exp_f32 v59, v59
    v_exp_f32 v60, v60
    v_exp_f32 v61, v61
    v_exp_f32 v62, v62
    v_exp_f32 v63, v63
    v_exp_f32 v32, v32
    v_exp_f32 v33, v33
    v_smfmac_f32_32x32x32_bf16 v[80:95], v[108:111], v[56:63], v124
    ds_read_b128 v[104:107], v126 offset:13696
    v_exp_f32 v34, v34
    v_exp_f32 v35, v35
    v_exp_f32 v36, v36
    v_mfma_f32_32x32x16_bf16 v[48:63], v[100:103], v[28:31], 0
    ds_read_b128 v[108:111], v126 offset:14240
    v_exp_f32 v37, v37
    v_exp_f32 v38, v38
    v_exp_f32 v39, v39
    v_exp_f32 v40, v40
    v_exp_f32 v41, v41
    v_smfmac_f32_32x32x32_bf16 v[64:79], v[112:115], v[32:39], v124
    v_exp_f32 v42, v42
    v_exp_f32 v43, v43
    v_exp_f32 v44, v44
    v_exp_f32 v45, v45
    v_exp_f32 v46, v46
    v_exp_f32 v47, v47
    v_exp_f32 v48, v48
    v_exp_f32 v49, v49
    v_smfmac_f32_32x32x32_bf16 v[64:79], v[116:119], v[40:47], v124
    s_waitcnt lgkmcnt(0)
    v_exp_f32 v50, v50
    v_exp_f32 v51, v51
    v_exp_f32 v52, v52
    v_mfma_f32_32x32x16_bf16 v[32:47], v[96:99], v[24:27], 0
    v_exp_f32 v53, v53
    v_exp_f32 v54, v54
    v_exp_f32 v55, v55
    v_exp_f32 v56, v56
    v_exp_f32 v57, v57
    v_smfmac_f32_32x32x32_bf16 v[80:95], v[112:115], v[48:55], v124
    ds_read_b128 v[100:103], v125 offset:14784
    v_exp_f32 v58, v58
    v_exp_f32 v59, v59
    v_exp_f32 v60, v60
    v_exp_f32 v61, v61
    v_exp_f32 v62, v62
    v_exp_f32 v63, v63
    v_exp_f32 v32, v32
    v_exp_f32 v33, v33
    v_smfmac_f32_32x32x32_bf16 v[80:95], v[116:119], v[56:63], v124
    ds_read_b128 v[112:115], v126 offset:15808
    v_exp_f32 v34, v34
    v_exp_f32 v35, v35
    v_exp_f32 v36, v36
    v_mfma_f32_32x32x16_bf16 v[48:63], v[96:99], v[28:31], 0
    ds_read_b128 v[116:119], v126 offset:16352
    v_exp_f32 v37, v37
    v_exp_f32 v38, v38
    v_exp_f32 v39, v39
    v_exp_f32 v40, v40
    v_exp_f32 v41, v41
    v_smfmac_f32_32x32x32_bf16 v[64:79], v[104:107], v[32:39], v124
    v_lshlrev_b32 v15, 7, v0
    v_mov_b32 v14, s1
    s_lshl_b32 s63, s16, 11
    s_add_u32 s63, s63, 5128192
    s_mov_b64 exec, 0xffff
    buffer_load_dword v14, v15, s[4:7], s63 offen sc1
    s_mov_b64 exec, -1
    v_exp_f32 v42, v42
    v_exp_f32 v43, v43
    v_exp_f32 v44, v44
    v_exp_f32 v45, v45
    v_exp_f32 v46, v46
    v_exp_f32 v47, v47
    v_exp_f32 v48, v48
    v_exp_f32 v49, v49
    v_smfmac_f32_32x32x32_bf16 v[64:79], v[108:111], v[40:47], v124
    s_waitcnt lgkmcnt(0)
    v_exp_f32 v50, v50
    v_exp_f32 v51, v51
    v_exp_f32 v52, v52
    v_mfma_f32_32x32x16_bf16 v[32:47], v[100:103], v[24:27], 0
    v_exp_f32 v53, v53
    v_exp_f32 v54, v54
    v_exp_f32 v55, v55
    v_exp_f32 v56, v56
    v_exp_f32 v57, v57
    v_smfmac_f32_32x32x32_bf16 v[80:95], v[104:107], v[48:55], v124
    ds_read_b128 v[96:99], v125 offset:16896
    v_exp_f32 v58, v58
    v_exp_f32 v59, v59
    v_exp_f32 v60, v60
    v_exp_f32 v61, v61
    v_exp_f32 v62, v62
    v_exp_f32 v63, v63
    v_exp_f32 v32, v32
    v_exp_f32 v33, v33
    v_smfmac_f32_32x32x32_bf16 v[80:95], v[108:111], v[56:63], v124
    ds_read_b128 v[104:107], v126 offset:17920
    v_exp_f32 v34, v34
    v_exp_f32 v35, v35
    v_exp_f32 v36, v36
    v_mfma_f32_32x32x16_bf16 v[48:63], v[100:103], v[28:31], 0
    ds_read_b128 v[108:111], v126 offset:18464
    v_exp_f32 v37, v37
    v_exp_f32 v38, v38
    v_exp_f32 v39, v39
    v_exp_f32 v40, v40
    v_exp_f32 v41, v41
    v_smfmac_f32_32x32x32_bf16 v[64:79], v[112:115], v[32:39], v124
    v_exp_f32 v42, v42
    v_exp_f32 v43, v43
    v_exp_f32 v44, v44
    v_exp_f32 v45, v45
    v_exp_f32 v46, v46
    v_exp_f32 v47, v47
    v_exp_f32 v48, v48
    v_exp_f32 v49, v49
    v_smfmac_f32_32x32x32_bf16 v[64:79], v[116:119], v[40:47], v124
    s_waitcnt lgkmcnt(0)
    v_exp_f32 v50, v50
    v_exp_f32 v51, v51
    v_exp_f32 v52, v52
    v_mfma_f32_32x32x16_bf16 v[32:47], v[96:99], v[24:27], 0
    v_exp_f32 v53, v53
    v_exp_f32 v54, v54
    v_exp_f32 v55, v55
    v_exp_f32 v56, v56
    v_exp_f32 v57, v57
    v_smfmac_f32_32x32x32_bf16 v[80:95], v[112:115], v[48:55], v124
    ds_read_b128 v[100:103], v125 offset:19008
    v_exp_f32 v58, v58
    v_exp_f32 v59, v59
    v_exp_f32 v60, v60
    v_exp_f32 v61, v61
    v_exp_f32 v62, v62
    v_exp_f32 v63, v63
    v_exp_f32 v32, v32
    v_exp_f32 v33, v33
    v_smfmac_f32_32x32x32_bf16 v[80:95], v[116:119], v[56:63], v124
    ds_read_b128 v[112:115], v126 offset:20032
    v_exp_f32 v34, v34
    v_exp_f32 v35, v35
    v_exp_f32 v36, v36
    v_mfma_f32_32x32x16_bf16 v[48:63], v[96:99], v[28:31], 0
    ds_read_b128 v[116:119], v126 offset:20576
    v_exp_f32 v37, v37
    v_exp_f32 v38, v38
    v_exp_f32 v39, v39
    v_exp_f32 v40, v40
    v_exp_f32 v41, v41
    v_smfmac_f32_32x32x32_bf16 v[64:79], v[104:107], v[32:39], v124
    v_exp_f32 v42, v42
    v_exp_f32 v43, v43
    v_exp_f32 v44, v44
    v_exp_f32 v45, v45
    v_exp_f32 v46, v46
    v_exp_f32 v47, v47
    v_exp_f32 v48, v48
    v_exp_f32 v49, v49
    v_smfmac_f32_32x32x32_bf16 v[64:79], v[108:111], v[40:47], v124
    s_waitcnt lgkmcnt(0)
    v_exp_f32 v50, v50
    v_exp_f32 v51, v51
    v_exp_f32 v52, v52
    v_mfma_f32_32x32x16_bf16 v[32:47], v[100:103], v[24:27], 0
    v_exp_f32 v53, v53
    v_exp_f32 v54, v54
    v_exp_f32 v55, v55
    v_exp_f32 v56, v56
    v_exp_f32 v57, v57
    v_smfmac_f32_32x32x32_bf16 v[80:95], v[104:107], v[48:55], v124
    ds_read_b128 v[96:99], v125 offset:21120
    v_exp_f32 v58, v58
    v_exp_f32 v59, v59
    v_exp_f32 v60, v60
    v_exp_f32 v61, v61
    v_exp_f32 v62, v62
    v_exp_f32 v63, v63
    v_exp_f32 v32, v32
    v_exp_f32 v33, v33
    v_smfmac_f32_32x32x32_bf16 v[80:95], v[108:111], v[56:63], v124
    ds_read_b128 v[104:107], v126 offset:22144
    v_exp_f32 v34, v34
    v_exp_f32 v35, v35
    v_exp_f32 v36, v36
    v_mfma_f32_32x32x16_bf16 v[48:63], v[100:103], v[28:31], 0
    ds_read_b128 v[108:111], v126 offset:22688
    v_exp_f32 v37, v37
    v_exp_f32 v38, v38
    v_exp_f32 v39, v39
    v_exp_f32 v40, v40
    v_exp_f32 v41, v41
    v_smfmac_f32_32x32x32_bf16 v[64:79], v[112:115], v[32:39], v124
    v_exp_f32 v42, v42
    v_exp_f32 v43, v43
    v_exp_f32 v44, v44
    v_exp_f32 v45, v45
    v_exp_f32 v46, v46
    v_exp_f32 v47, v47
    v_exp_f32 v48, v48
    v_exp_f32 v49, v49
    v_smfmac_f32_32x32x32_bf16 v[64:79], v[116:119], v[40:47], v124
    s_waitcnt lgkmcnt(0)
    v_exp_f32 v50, v50
    v_exp_f32 v51, v51
    v_exp_f32 v52, v52
    v_mfma_f32_32x32x16_bf16 v[32:47], v[96:99], v[24:27], 0
    v_exp_f32 v53, v53
    v_exp_f32 v54, v54
    v_exp_f32 v55, v55
    v_exp_f32 v56, v56
    v_exp_f32 v57, v57
    v_smfmac_f32_32x32x32_bf16 v[80:95], v[112:115], v[48:55], v124
    ds_read_b128 v[100:103], v125 offset:23232
    v_exp_f32 v58, v58
    v_exp_f32 v59, v59
    v_exp_f32 v60, v60
    v_exp_f32 v61, v61
    v_exp_f32 v62, v62
    v_exp_f32 v63, v63
    v_exp_f32 v32, v32
    v_exp_f32 v33, v33
    v_smfmac_f32_32x32x32_bf16 v[80:95], v[116:119], v[56:63], v124
    ds_read_b128 v[112:115], v126 offset:24256
    v_exp_f32 v34, v34
    v_exp_f32 v35, v35
    v_exp_f32 v36, v36
    v_mfma_f32_32x32x16_bf16 v[48:63], v[96:99], v[28:31], 0
    ds_read_b128 v[116:119], v126 offset:24800
    v_exp_f32 v37, v37
    v_exp_f32 v38, v38
    v_exp_f32 v39, v39
    v_exp_f32 v40, v40
    v_exp_f32 v41, v41
    v_smfmac_f32_32x32x32_bf16 v[64:79], v[104:107], v[32:39], v124
    s_waitcnt vmcnt(0)
    v_cmp_ne_u32 vcc, s1, v14
    s_nop 4
    s_cbranch_vccnz Lretry_39
Lback_40:
    s_barrier
    v_exp_f32 v42, v42
    v_exp_f32 v43, v43
    v_exp_f32 v44, v44
    v_exp_f32 v45, v45
    v_exp_f32 v46, v46
    v_exp_f32 v47, v47
    v_exp_f32 v48, v48
    v_exp_f32 v49, v49
    v_smfmac_f32_32x32x32_bf16 v[64:79], v[108:111], v[40:47], v124
    s_waitcnt lgkmcnt(0)
    v_exp_f32 v50, v50
    v_exp_f32 v51, v51
    v_exp_f32 v52, v52
    v_mfma_f32_32x32x16_bf16 v[32:47], v[100:103], v[24:27], 0
    s_add_u32 m0, s36, 0
    s_add_u32 s66, s56, 67584
    s_addc_u32 s67, s57, 0
    global_load_lds_dwordx4 v1, s[66:67] offset:0
    global_load_lds_dwordx4 v1, s[66:67] offset:1024
    s_add_u32 s63, s19, 5152768
    buffer_load_dword v14, v15, s[4:7], s63 offen sc1
    v_exp_f32 v53, v53
    v_exp_f32 v54, v54
    v_exp_f32 v55, v55
    v_exp_f32 v56, v56
    v_exp_f32 v57, v57
    v_smfmac_f32_32x32x32_bf16 v[80:95], v[104:107], v[48:55], v124
    ds_read_b128 v[96:99], v125 offset:25344
    v_exp_f32 v58, v58
    v_exp_f32 v59, v59
    v_exp_f32 v60, v60
    v_exp_f32 v61, v61
    v_exp_f32 v62, v62
    v_exp_f32 v63, v63
    v_exp_f32 v32, v32
    v_exp_f32 v33, v33
    v_smfmac_f32_32x32x32_bf16 v[80:95], v[108:111], v[56:63], v124
    ds_read_b128 v[104:107], v126 offset:26368
    v_exp_f32 v34, v34
    v_exp_f32 v35, v35
    v_exp_f32 v36, v36
    v_mfma_f32_32x32x16_bf16 v[48:63], v[100:103], v[28:31], 0
    ds_read_b128 v[108:111], v126 offset:26912
    v_exp_f32 v37, v37
    v_exp_f32 v38, v38
    v_exp_f32 v39, v39
    v_exp_f32 v40, v40
    v_exp_f32 v41, v41
    v_smfmac_f32_32x32x32_bf16 v[64:79], v[112:115], v[32:39], v124
    global_load_lds_dwordx4 v1, s[66:67] offset:2048
    global_load_lds_dwordx4 v1, s[66:67] offset:3072
    v_exp_f32 v42, v42
    v_exp_f32 v43, v43
    v_exp_f32 v44, v44
    v_exp_f32 v45, v45
    v_exp_f32 v46, v46
    v_exp_f32 v47, v47
    v_exp_f32 v48, v48
    v_exp_f32 v49, v49
    v_smfmac_f32_32x32x32_bf16 v[64:79], v[116:119], v[40:47], v124
    s_waitcnt lgkmcnt(0)
    v_exp_f32 v50, v50
    v_exp_f32 v51, v51
    v_exp_f32 v52, v52
    v_mfma_f32_32x32x16_bf16 v[32:47], v[96:99], v[24:27], 0
    s_add_u32 m0, s36, 16384
    s_add_u32 s66, s56, 83968
    s_addc_u32 s67, s57, 0
    global_load_lds_dwordx4 v1, s[66:67] offset:0
    global_load_lds_dwordx4 v1, s[66:67] offset:1024
    v_exp_f32 v53, v53
    v_exp_f32 v54, v54
    v_exp_f32 v55, v55
    v_exp_f32 v56, v56
    v_exp_f32 v57, v57
    v_smfmac_f32_32x32x32_bf16 v[80:95], v[112:115], v[48:55], v124
    ds_read_b128 v[100:103], v125 offset:27456
    v_exp_f32 v58, v58
    v_exp_f32 v59, v59
    v_exp_f32 v60, v60
    v_exp_f32 v61, v61
    v_exp_f32 v62, v62
    v_exp_f32 v63, v63
    v_exp_f32 v32, v32
    v_exp_f32 v33, v33
    v_smfmac_f32_32x32x32_bf16 v[80:95], v[116:119], v[56:63], v124
    ds_read_b128 v[112:115], v126 offset:28480
    v_exp_f32 v34, v34
    v_exp_f32 v35, v35
    v_exp_f32 v36, v36
    v_mfma_f32_32x32x16_bf16 v[48:63], v[96:99], v[28:31], 0
    ds_read_b128 v[116:119], v126 offset:29024
    v_exp_f32 v37, v37
    v_exp_f32 v38, v38
    v_exp_f32 v39, v39
    v_exp_f32 v40, v40
    v_exp_f32 v41, v41
    v_smfmac_f32_32x32x32_bf16 v[64:79], v[104:107], v[32:39], v124
    global_load_lds_dwordx4 v1, s[66:67] offset:2048
    global_load_lds_dwordx4 v1, s[66:67] offset:3072
    v_exp_f32 v42, v42
    v_exp_f32 v43, v43
    v_exp_f32 v44, v44
    v_exp_f32 v45, v45
    v_exp_f32 v46, v46
    v_exp_f32 v47, v47
    v_exp_f32 v48, v48
    v_exp_f32 v49, v49
    v_smfmac_f32_32x32x32_bf16 v[64:79], v[108:111], v[40:47], v124
    s_waitcnt lgkmcnt(0)
    v_exp_f32 v50, v50
    v_exp_f32 v51, v51
    v_exp_f32 v52, v52
    v_mfma_f32_32x32x16_bf16 v[32:47], v[100:103], v[24:27], 0
    s_add_u32 m0, s36, 32768
    s_add_u32 s66, s56, 100352
    s_addc_u32 s67, s57, 0
    global_load_lds_dwordx4 v1, s[66:67] offset:0
    global_load_lds_dwordx4 v1, s[66:67] offset:1024
    v_exp_f32 v53, v53
    v_exp_f32 v54, v54
    v_exp_f32 v55, v55
    v_exp_f32 v56, v56
    v_exp_f32 v57, v57
    v_smfmac_f32_32x32x32_bf16 v[80:95], v[104:107], v[48:55], v124
    ds_read_b128 v[96:99], v125 offset:29568
    v_exp_f32 v58, v58
    v_exp_f32 v59, v59
    v_exp_f32 v60, v60
    v_exp_f32 v61, v61
    v_exp_f32 v62, v62
    v_exp_f32 v63, v63
    v_exp_f32 v32, v32
    v_exp_f32 v33, v33
    v_smfmac_f32_32x32x32_bf16 v[80:95], v[108:111], v[56:63], v124
    ds_read_b128 v[104:107], v126 offset:30592
    v_exp_f32 v34, v34
    v_exp_f32 v35, v35
    v_exp_f32 v36, v36
    v_mfma_f32_32x32x16_bf16 v[48:63], v[100:103], v[28:31], 0
    ds_read_b128 v[108:111], v126 offset:31136
    v_exp_f32 v37, v37
    v_exp_f32 v38, v38
    v_exp_f32 v39, v39
    v_exp_f32 v40, v40
    v_exp_f32 v41, v41
    v_smfmac_f32_32x32x32_bf16 v[64:79], v[112:115], v[32:39], v124
    global_load_lds_dwordx4 v1, s[66:67] offset:2048
    global_load_lds_dwordx4 v1, s[66:67] offset:3072
    v_exp_f32 v42, v42
    v_exp_f32 v43, v43
    v_exp_f32 v44, v44
    v_exp_f32 v45, v45
    v_exp_f32 v46, v46
    v_exp_f32 v47, v47
    v_exp_f32 v48, v48
    v_exp_f32 v49, v49
    v_smfmac_f32_32x32x32_bf16 v[64:79], v[116:119], v[40:47], v124
    s_waitcnt lgkmcnt(0)
    v_exp_f32 v50, v50
    v_exp_f32 v51, v51
    v_exp_f32 v52, v52
    v_mfma_f32_32x32x16_bf16 v[32:47], v[96:99], v[24:27], 0
    s_add_u32 m0, s36, 49152
    s_add_u32 s66, s56, 116736
    s_addc_u32 s67, s57, 0
    global_load_lds_dwordx4 v1, s[66:67] offset:0
    global_load_lds_dwordx4 v1, s[66:67] offset:1024
    v_exp_f32 v53, v53
    v_exp_f32 v54, v54
    v_exp_f32 v55, v55
    v_exp_f32 v56, v56
    v_exp_f32 v57, v57
    v_smfmac_f32_32x32x32_bf16 v[80:95], v[112:115], v[48:55], v124
    ds_read_b128 v[100:103], v125 offset:31680
    v_exp_f32 v58, v58
    v_exp_f32 v59, v59
    v_exp_f32 v60, v60
    v_exp_f32 v61, v61
    v_exp_f32 v62, v62
    v_exp_f32 v63, v63
    v_exp_f32 v32, v32
    v_exp_f32 v33, v33
    v_smfmac_f32_32x32x32_bf16 v[80:95], v[116:119], v[56:63], v124
    ds_read_b128 v[112:115], v126 offset:32704
    v_exp_f32 v34, v34
    v_exp_f32 v35, v35
    v_exp_f32 v36, v36
    v_mfma_f32_32x32x16_bf16 v[48:63], v[96:99], v[28:31], 0
    ds_read_b128 v[116:119], v126 offset:33248
    v_exp_f32 v37, v37
    v_exp_f32 v38, v38
    v_exp_f32 v39, v39
    v_exp_f32 v40, v40
    v_exp_f32 v41, v41
    v_smfmac_f32_32x32x32_bf16 v[64:79], v[104:107], v[32:39], v124
    global_load_lds_dwordx4 v1, s[66:67] offset:2048
    global_load_lds_dwordx4 v1, s[66:67] offset:3072
    v_exp_f32 v42, v42
    v_exp_f32 v43, v43
    v_exp_f32 v44, v44
    v_exp_f32 v45, v45
    v_exp_f32 v46, v46
    v_exp_f32 v47, v47
    v_exp_f32 v48, v48
    v_exp_f32 v49, v49
    v_smfmac_f32_32x32x32_bf16 v[64:79], v[108:111], v[40:47], v124
    s_waitcnt lgkmcnt(0)
    v_exp_f32 v50, v50
    v_exp_f32 v51, v51
    v_exp_f32 v52, v52
    v_mfma_f32_32x32x16_bf16 v[32:47], v[100:103], v[24:27], 0
    s_add_u32 m0, s37, 65536
    s_add_u32 s66, s58, 133120
    s_addc_u32 s67, s59, 0
    global_load_lds_dwordx4 v1, s[66:67] offset:0
    v_exp_f32 v53, v53
    v_exp_f32 v54, v54
    v_exp_f32 v55, v55
    v_exp_f32 v56, v56
    v_exp_f32 v57, v57
    v_smfmac_f32_32x32x32_bf16 v[80:95], v[104:107], v[48:55], v124
    ds_read_b128 v[96:99], v125 offset:33792
    v_exp_f32 v58, v58
    v_exp_f32 v59, v59
    v_exp_f32 v60, v60
    v_exp_f32 v61, v61
    v_exp_f32 v62, v62
    v_exp_f32 v63, v63
    v_exp_f32 v32, v32
    v_exp_f32 v33, v33
    v_smfmac_f32_32x32x32_bf16 v[80:95], v[108:111], v[56:63], v124
    ds_read_b128 v[104:107], v126 offset:34816
    v_exp_f32 v34, v34
    v_exp_f32 v35, v35
    v_exp_f32 v36, v36
    v_mfma_f32_32x32x16_bf16 v[48:63], v[100:103], v[28:31], 0
    ds_read_b128 v[108:111], v126 offset:35360
    v_exp_f32 v37, v37
    v_exp_f32 v38, v38
    v_exp_f32 v39, v39
    v_exp_f32 v40, v40
    v_exp_f32 v41, v41
    v_smfmac_f32_32x32x32_bf16 v[64:79], v[112:115], v[32:39], v124
    s_waitcnt vmcnt(15)
    v_xor_b32 v14, s1, v14
    v_cmp_lt_u32 vcc, 15, v14
    s_nop 4
    s_cbranch_vccnz Lretry_41
Lback_42:
    s_barrier
    v_and_b32 v15, 7, v0
    v_lshlrev_b32 v15, 12, v15
    s_lshl_b32 s63, s17, 7
    s_add_u32 s63, s63, 5152768
    buffer_load_dword v14, v15, s[4:7], s63 offen sc1
    v_exp_f32 v42, v42
    v_exp_f32 v43, v43
    v_exp_f32 v44, v44
    v_exp_f32 v45, v45
    v_exp_f32 v46, v46
    v_exp_f32 v47, v47
    v_exp_f32 v48, v48
    v_exp_f32 v49, v49
    v_smfmac_f32_32x32x32_bf16 v[64:79], v[116:119], v[40:47], v124
    s_waitcnt lgkmcnt(0)
    v_exp_f32 v50, v50
    v_exp_f32 v51, v51
    v_exp_f32 v52, v52
    v_mfma_f32_32x32x16_bf16 v[32:47], v[96:99], v[24:27], 0
    s_add_u32 s64, s52, 4096
    s_addc_u32 s65, s53, 0
    global_load_dwordx4 a[0:3], v1, s[64:65] offset:-4096
    global_load_dwordx4 a[4:7], v1, s[64:65] offset:-3072
    v_exp_f32 v53, v53
    v_exp_f32 v54, v54
    v_exp_f32 v55, v55
    v_exp_f32 v56, v56
    v_exp_f32 v57, v57
    v_smfmac_f32_32x32x32_bf16 v[80:95], v[112:115], v[48:55], v124
    ds_read_b128 v[100:103], v125 offset:35904
    v_exp_f32 v58, v58
    v_exp_f32 v59, v59
    v_exp_f32 v60, v60
    v_exp_f32 v61, v61
    v_exp_f32 v62, v62
    v_exp_f32 v63, v63
    v_exp_f32 v32, v32
    v_exp_f32 v33, v33
    v_smfmac_f32_32x32x32_bf16 v[80:95], v[116:119], v[56:63], v124
    ds_read_b128 v[112:115], v126 offset:36928
    v_exp_f32 v34, v34
    v_exp_f32 v35, v35
    v_exp_f32 v36, v36
    v_mfma_f32_32x32x16_bf16 v[48:63], v[96:99], v[28:31], 0
    ds_read_b128 v[116:119], v126 offset:37472
    v_exp_f32 v37, v37
    v_exp_f32 v38, v38
    v_exp_f32 v39, v39
    v_exp_f32 v40, v40
    v_exp_f32 v41, v41
    v_smfmac_f32_32x32x32_bf16 v[64:79], v[104:107], v[32:39], v124
    global_load_dwordx4 a[8:11], v1, s[64:65] offset:-2048
    global_load_dwordx4 a[12:15], v1, s[64:65] offset:-1024
    v_exp_f32 v42, v42
    v_exp_f32 v43, v43
    v_exp_f32 v44, v44
    v_exp_f32 v45, v45
    v_exp_f32 v46, v46
    v_exp_f32 v47, v47
    v_exp_f32 v48, v48
    v_exp_f32 v49, v49
    v_smfmac_f32_32x32x32_bf16 v[64:79], v[108:111], v[40:47], v124
    s_waitcnt lgkmcnt(0)
    v_exp_f32 v50, v50
    v_exp_f32 v51, v51
    v_exp_f32 v52, v52
    v_mfma_f32_32x32x16_bf16 v[32:47], v[100:103], v[24:27], 0
    global_load_dwordx4 a[16:19], v1, s[64:65] offset:0
    global_load_dwordx4 a[20:23], v1, s[64:65] offset:1024
    v_exp_f32 v53, v53
    v_exp_f32 v54, v54
    v_exp_f32 v55, v55
    v_exp_f32 v56, v56
    v_exp_f32 v57, v57
    v_smfmac_f32_32x32x32_bf16 v[80:95], v[104:107], v[48:55], v124
    ds_read_b128 v[96:99], v125 offset:38016
    v_exp_f32 v58, v58
    v_exp_f32 v59, v59
    v_exp_f32 v60, v60
    v_exp_f32 v61, v61
    v_exp_f32 v62, v62
    v_exp_f32 v63, v63
    v_exp_f32 v32, v32
    v_exp_f32 v33, v33
    v_smfmac_f32_32x32x32_bf16 v[80:95], v[108:111], v[56:63], v124
    ds_read_b128 v[104:107], v126 offset:39040
    v_exp_f32 v34, v34
    v_exp_f32 v35, v35
    v_exp_f32 v36, v36
    v_mfma_f32_32x32x16_bf16 v[48:63], v[100:103], v[28:31], 0
    ds_read_b128 v[108:111], v126 offset:39584
    v_exp_f32 v37, v37
    v_exp_f32 v38, v38
    v_exp_f32 v39, v39
    v_exp_f32 v40, v40
    v_exp_f32 v41, v41
    v_smfmac_f32_32x32x32_bf16 v[64:79], v[112:115], v[32:39], v124
    global_load_dwordx4 a[24:27], v1, s[64:65] offset:2048
    global_load_dwordx4 a[28:31], v1, s[64:65] offset:3072
    v_exp_f32 v42, v42
    v_exp_f32 v43, v43
    v_exp_f32 v44, v44
    v_exp_f32 v45, v45
    v_exp_f32 v46, v46
    v_exp_f32 v47, v47
    v_exp_f32 v48, v48
    v_exp_f32 v49, v49
    v_smfmac_f32_32x32x32_bf16 v[64:79], v[116:119], v[40:47], v124
    s_waitcnt lgkmcnt(0)
    v_exp_f32 v50, v50
    v_exp_f32 v51, v51
    v_exp_f32 v52, v52
    v_mfma_f32_32x32x16_bf16 v[32:47], v[96:99], v[24:27], 0
    s_add_u32 s64, s52, 12288
    s_addc_u32 s65, s53, 0
    global_load_dwordx4 a[32:35], v1, s[64:65] offset:-4096
    global_load_dwordx4 a[36:39], v1, s[64:65] offset:-3072
    v_exp_f32 v53, v53
    v_exp_f32 v54, v54
    v_exp_f32 v55, v55
    v_exp_f32 v56, v56
    v_exp_f32 v57, v57
    v_smfmac_f32_32x32x32_bf16 v[80:95], v[112:115], v[48:55], v124
    ds_read_b128 v[100:103], v125 offset:40128
    v_exp_f32 v58, v58
    v_exp_f32 v59, v59
    v_exp_f32 v60, v60
    v_exp_f32 v61, v61
    v_exp_f32 v62, v62
    v_exp_f32 v63, v63
    v_exp_f32 v32, v32
    v_exp_f32 v33, v33
    v_smfmac_f32_32x32x32_bf16 v[80:95], v[116:119], v[56:63], v124
    ds_read_b128 v[112:115], v126 offset:41152
    v_exp_f32 v34, v34
    v_exp_f32 v35, v35
    v_exp_f32 v36, v36
    v_mfma_f32_32x32x16_bf16 v[48:63], v[96:99], v[28:31], 0
    ds_read_b128 v[116:119], v126 offset:41696
    v_exp_f32 v37, v37
    v_exp_f32 v38, v38
    v_exp_f32 v39, v39
    v_exp_f32 v40, v40
    v_exp_f32 v41, v41
    v_smfmac_f32_32x32x32_bf16 v[64:79], v[104:107], v[32:39], v124
    global_load_dwordx4 a[40:43], v1, s[64:65] offset:-2048
    global_load_dwordx4 a[44:47], v1, s[64:65] offset:-1024
    v_exp_f32 v42, v42
    v_exp_f32 v43, v43
    v_exp_f32 v44, v44
    v_exp_f32 v45, v45
    v_exp_f32 v46, v46
    v_exp_f32 v47, v47
    v_exp_f32 v48, v48
    v_exp_f32 v49, v49
    v_smfmac_f32_32x32x32_bf16 v[64:79], v[108:111], v[40:47], v124
    s_waitcnt lgkmcnt(0)
    v_exp_f32 v50, v50
    v_exp_f32 v51, v51
    v_exp_f32 v52, v52
    v_mfma_f32_32x32x16_bf16 v[32:47], v[100:103], v[24:27], 0
    global_load_dwordx4 a[48:51], v1, s[64:65] offset:0
    global_load_dwordx4 a[52:55], v1, s[64:65] offset:1024
    v_exp_f32 v53, v53
    v_exp_f32 v54, v54
    v_exp_f32 v55, v55
    v_exp_f32 v56, v56
    v_exp_f32 v57, v57
    v_smfmac_f32_32x32x32_bf16 v[80:95], v[104:107], v[48:55], v124
    ds_read_b128 v[96:99], v125 offset:42240
    v_exp_f32 v58, v58
    v_exp_f32 v59, v59
    v_exp_f32 v60, v60
    v_exp_f32 v61, v61
    v_exp_f32 v62, v62
    v_exp_f32 v63, v63
    v_exp_f32 v32, v32
    v_exp_f32 v33, v33
    v_smfmac_f32_32x32x32_bf16 v[80:95], v[108:111], v[56:63], v124
    ds_read_b128 v[104:107], v126 offset:43264
    v_exp_f32 v34, v34
    v_exp_f32 v35, v35
    v_exp_f32 v36, v36
    v_mfma_f32_32x32x16_bf16 v[48:63], v[100:103], v[28:31], 0
    ds_read_b128 v[108:111], v126 offset:43808
    v_exp_f32 v37, v37
    v_exp_f32 v38, v38
    v_exp_f32 v39, v39
    v_exp_f32 v40, v40
    v_exp_f32 v41, v41
    v_smfmac_f32_32x32x32_bf16 v[64:79], v[112:115], v[32:39], v124
    global_load_dwordx4 a[56:59], v1, s[64:65] offset:2048
    global_load_dwordx4 a[60:63], v1, s[64:65] offset:3072
    v_exp_f32 v42, v42
    v_exp_f32 v43, v43
    v_exp_f32 v44, v44
    v_exp_f32 v45, v45
    v_exp_f32 v46, v46
    v_exp_f32 v47, v47
    v_exp_f32 v48, v48
    v_exp_f32 v49, v49
    v_smfmac_f32_32x32x32_bf16 v[64:79], v[116:119], v[40:47], v124
    s_waitcnt lgkmcnt(0)
    v_exp_f32 v50, v50
    v_exp_f32 v51, v51
    v_exp_f32 v52, v52
    v_mfma_f32_32x32x16_bf16 v[32:47], v[96:99], v[24:27], 0
    s_add_u32 s64, s52, 20480
    s_addc_u32 s65, s53, 0
    global_load_dwordx4 a[64:67], v1, s[64:65] offset:-4096
    global_load_dwordx4 a[68:71], v1, s[64:65] offset:-3072
    v_exp_f32 v53, v53
    v_exp_f32 v54, v54
    v_exp_f32 v55, v55
    v_exp_f32 v56, v56
    v_exp_f32 v57, v57
    v_smfmac_f32_32x32x32_bf16 v[80:95], v[112:115], v[48:55], v124
    ds_read_b128 v[100:103], v125 offset:44352
    v_exp_f32 v58, v58
    v_exp_f32 v59, v59
    v_exp_f32 v60, v60
    v_exp_f32 v61, v61
    v_exp_f32 v62, v62
    v_exp_f32 v63, v63
    v_exp_f32 v32, v32
    v_exp_f32 v33, v33
    v_smfmac_f32_32x32x32_bf16 v[80:95], v[116:119], v[56:63], v124
    ds_read_b128 v[112:115], v126 offset:45376
    v_exp_f32 v34, v34
    v_exp_f32 v35, v35
    v_exp_f32 v36, v36
    v_mfma_f32_32x32x16_bf16 v[48:63], v[96:99], v[28:31], 0
    ds_read_b128 v[116:119], v126 offset:45920
    v_exp_f32 v37, v37
    v_exp_f32 v38, v38
    v_exp_f32 v39, v39
    v_exp_f32 v40, v40
    v_exp_f32 v41, v41
    v_smfmac_f32_32x32x32_bf16 v[64:79], v[104:107], v[32:39], v124
    global_load_dwordx4 a[72:75], v1, s[64:65] offset:-2048
    global_load_dwordx4 a[76:79], v1, s[64:65] offset:-1024
    v_exp_f32 v42, v42
    v_exp_f32 v43, v43
    v_exp_f32 v44, v44
    v_exp_f32 v45, v45
    v_exp_f32 v46, v46
    v_exp_f32 v47, v47
    v_exp_f32 v48, v48
    v_exp_f32 v49, v49
    v_smfmac_f32_32x32x32_bf16 v[64:79], v[108:111], v[40:47], v124
    s_waitcnt lgkmcnt(0)
    v_exp_f32 v50, v50
    v_exp_f32 v51, v51
    v_exp_f32 v52, v52
    v_mfma_f32_32x32x16_bf16 v[32:47], v[100:103], v[24:27], 0
    global_load_dwordx4 a[80:83], v1, s[64:65] offset:0
    global_load_dwordx4 a[84:87], v1, s[64:65] offset:1024
    v_exp_f32 v53, v53
    v_exp_f32 v54, v54
    v_exp_f32 v55, v55
    v_exp_f32 v56, v56
    v_exp_f32 v57, v57
    v_smfmac_f32_32x32x32_bf16 v[80:95], v[104:107], v[48:55], v124
    ds_read_b128 v[96:99], v125 offset:46464
    v_exp_f32 v58, v58
    v_exp_f32 v59, v59
    v_exp_f32 v60, v60
    v_exp_f32 v61, v61
    v_exp_f32 v62, v62
    v_exp_f32 v63, v63
    v_exp_f32 v32, v32
    v_exp_f32 v33, v33
    v_smfmac_f32_32x32x32_bf16 v[80:95], v[108:111], v[56:63], v124
    ds_read_b128 v[104:107], v126 offset:47488
    v_exp_f32 v34, v34
    v_exp_f32 v35, v35
    v_exp_f32 v36, v36
    v_mfma_f32_32x32x16_bf16 v[48:63], v[100:103], v[28:31], 0
    ds_read_b128 v[108:111], v126 offset:48032
    v_exp_f32 v37, v37
    v_exp_f32 v38, v38
    v_exp_f32 v39, v39
    v_exp_f32 v40, v40
    v_exp_f32 v41, v41
    v_smfmac_f32_32x32x32_bf16 v[64:79], v[112:115], v[32:39], v124
    global_load_dwordx4 a[88:91], v1, s[64:65] offset:2048
    global_load_dwordx4 a[92:95], v1, s[64:65] offset:3072
    v_exp_f32 v42, v42
    v_exp_f32 v43, v43
    v_exp_f32 v44, v44
    v_exp_f32 v45, v45
    v_exp_f32 v46, v46
    v_exp_f32 v47, v47
    v_exp_f32 v48, v48
    v_exp_f32 v49, v49
    v_smfmac_f32_32x32x32_bf16 v[64:79], v[116:119], v[40:47], v124
    s_waitcnt lgkmcnt(0)
    v_exp_f32 v50, v50
    v_exp_f32 v51, v51
    v_exp_f32 v52, v52
    v_mfma_f32_32x32x16_bf16 v[32:47], v[96:99], v[24:27], 0
    s_add_u32 s64, s52, 28672
    s_addc_u32 s65, s53, 0
    global_load_dwordx4 a[96:99], v1, s[64:65] offset:-4096
    global_load_dwordx4 a[100:103], v1, s[64:65] offset:-3072
    v_exp_f32 v53, v53
    v_exp_f32 v54, v54
    v_exp_f32 v55, v55
    v_exp_f32 v56, v56
    v_exp_f32 v57, v57
    v_smfmac_f32_32x32x32_bf16 v[80:95], v[112:115], v[48:55], v124
    ds_read_b128 v[100:103], v125 offset:48576
    v_exp_f32 v58, v58
    v_exp_f32 v59, v59
    v_exp_f32 v60, v60
    v_exp_f32 v61, v61
    v_exp_f32 v62, v62
    v_exp_f32 v63, v63
    v_exp_f32 v32, v32
    v_exp_f32 v33, v33
    v_smfmac_f32_32x32x32_bf16 v[80:95], v[116:119], v[56:63], v124
    ds_read_b128 v[112:115], v126 offset:49600
    v_exp_f32 v34, v34
    v_exp_f32 v35, v35
    v_exp_f32 v36, v36
    v_mfma_f32_32x32x16_bf16 v[48:63], v[96:99], v[28:31], 0
    ds_read_b128 v[116:119], v126 offset:50144
    v_exp_f32 v37, v37
    v_exp_f32 v38, v38
    v_exp_f32 v39, v39
    v_exp_f32 v40, v40
    v_exp_f32 v41, v41
    v_smfmac_f32_32x32x32_bf16 v[64:79], v[104:107], v[32:39], v124
    s_waitcnt vmcnt(26)
    v_cmp_ne_u32 vcc, s14, v14
    s_nop 0
    s_cmp_eq_u64 vcc, 0
    s_cselect_b32 s12, 1, 0
    s_cmp_eq_u32 s16, 3
    s_cselect_b32 s14, 268435456, 0
    v_add_u32 v234, s14, v1
    s_barrier
    global_load_dwordx4 a[104:107], v1, s[64:65] offset:-2048
    global_load_dwordx4 a[108:111], v1, s[64:65] offset:-1024
    v_exp_f32 v42, v42
    v_exp_f32 v43, v43
    v_exp_f32 v44, v44
    v_exp_f32 v45, v45
    v_exp_f32 v46, v46
    v_exp_f32 v47, v47
    v_exp_f32 v48, v48
    v_exp_f32 v49, v49
    v_smfmac_f32_32x32x32_bf16 v[64:79], v[108:111], v[40:47], v124
    s_waitcnt lgkmcnt(0)
    v_exp_f32 v50, v50
    v_exp_f32 v51, v51
    v_exp_f32 v52, v52
    v_mfma_f32_32x32x16_bf16 v[32:47], v[100:103], v[24:27], 0
    s_and_b32 s61, s23, 0xffffff00
    s_and_b32 s62, s19, 24576
    s_add_u32 s61, s61, s62
    s_add_u32 s61, s61, 425984
    buffer_store_dwordx4 v[224:227], v1, s[4:7], s61 offen
    v_exp_f32 v53, v53
    v_exp_f32 v54, v54
    v_exp_f32 v55, v55
    v_exp_f32 v56, v56
    v_exp_f32 v57, v57
    v_smfmac_f32_32x32x32_bf16 v[80:95], v[104:107], v[48:55], v124
    ds_read_b128 v[96:99], v125 offset:50688
    v_exp_f32 v58, v58
    v_exp_f32 v59, v59
    v_exp_f32 v60, v60
    v_exp_f32 v61, v61
    v_exp_f32 v62, v62
    v_exp_f32 v63, v63
    v_exp_f32 v32, v32
    v_exp_f32 v33, v33
    v_smfmac_f32_32x32x32_bf16 v[80:95], v[108:111], v[56:63], v124
    ds_read_b128 v[104:107], v126 offset:51712
    v_exp_f32 v34, v34
    v_exp_f32 v35, v35
    v_exp_f32 v36, v36
    v_mfma_f32_32x32x16_bf16 v[48:63], v[100:103], v[28:31], 0
    ds_read_b128 v[108:111], v126 offset:52256
    v_exp_f32 v37, v37
    v_exp_f32 v38, v38
    v_exp_f32 v39, v39
    v_exp_f32 v40, v40
    v_exp_f32 v41, v41
    v_smfmac_f32_32x32x32_bf16 v[64:79], v[112:115], v[32:39], v124
    s_add_u32 s61, s20, 0
    buffer_store_dwordx4 v[224:227], v1, s[4:7], s61 offen offset:0
    v_exp_f32 v42, v42
    v_exp_f32 v43, v43
    v_exp_f32 v44, v44
    v_exp_f32 v45, v45
    v_exp_f32 v46, v46
    v_exp_f32 v47, v47
    v_exp_f32 v48, v48
    v_exp_f32 v49, v49
    v_smfmac_f32_32x32x32_bf16 v[64:79], v[116:119], v[40:47], v124
    s_waitcnt lgkmcnt(0)
    v_exp_f32 v50, v50
    v_exp_f32 v51, v51
    v_exp_f32 v52, v52
    v_mfma_f32_32x32x16_bf16 v[32:47], v[96:99], v[24:27], 0
    s_add_u32 s61, s20, 65536
    buffer_store_dwordx4 v[224:227], v1, s[4:7], s61 offen offset:0
    v_exp_f32 v53, v53
    v_exp_f32 v54, v54
    v_exp_f32 v55, v55
    v_exp_f32 v56, v56
    v_exp_f32 v57, v57
    v_smfmac_f32_32x32x32_bf16 v[80:95], v[112:115], v[48:55], v124
    ds_read_b128 v[100:103], v125 offset:52800
    v_exp_f32 v58, v58
    v_exp_f32 v59, v59
    v_exp_f32 v60, v60
    v_exp_f32 v61, v61
    v_exp_f32 v62, v62
    v_exp_f32 v63, v63
    v_exp_f32 v32, v32
    v_exp_f32 v33, v33
    v_smfmac_f32_32x32x32_bf16 v[80:95], v[116:119], v[56:63], v124
    ds_read_b128 v[112:115], v126 offset:53824
    v_exp_f32 v34, v34
    v_exp_f32 v35, v35
    v_exp_f32 v36, v36
    v_mfma_f32_32x32x16_bf16 v[48:63], v[96:99], v[28:31], 0
    ds_read_b128 v[116:119], v126 offset:54368
    v_exp_f32 v37, v37
    v_exp_f32 v38, v38
    v_exp_f32 v39, v39
    v_exp_f32 v40, v40
    v_exp_f32 v41, v41
    v_smfmac_f32_32x32x32_bf16 v[64:79], v[104:107], v[32:39], v124
    s_add_u32 s61, s24, 0
    buffer_store_dwordx4 v[224:227], v1, s[4:7], s61 offen offset:0
    v_exp_f32 v42, v42
    v_exp_f32 v43, v43
    v_exp_f32 v44, v44
    v_exp_f32 v45, v45
    v_exp_f32 v46, v46
    v_exp_f32 v47, v47
    v_exp_f32 v48, v48
    v_exp_f32 v49, v49
    v_smfmac_f32_32x32x32_bf16 v[64:79], v[108:111], v[40:47], v124
    s_waitcnt lgkmcnt(0)
    v_exp_f32 v50, v50
    v_exp_f32 v51, v51
    v_exp_f32 v52, v52
    v_mfma_f32_32x32x16_bf16 v[32:47], v[100:103], v[24:27], 0
    buffer_store_dwordx4 v[224:227], v1, s[4:7], s61 offen offset:1024
    v_exp_f32 v53, v53
    v_exp_f32 v54, v54
    v_exp_f32 v55, v55
    v_exp_f32 v56, v56
    v_exp_f32 v57, v57
    v_smfmac_f32_32x32x32_bf16 v[80:95], v[104:107], v[48:55], v124
    ds_read_b128 v[96:99], v125 offset:54912
    v_exp_f32 v58, v58
    v_exp_f32 v59, v59
    v_exp_f32 v60, v60
    v_exp_f32 v61, v61
    v_exp_f32 v62, v62
    v_exp_f32 v63, v63
    v_exp_f32 v32, v32
    v_exp_f32 v33, v33
    v_smfmac_f32_32x32x32_bf16 v[80:95], v[108:111], v[56:63], v124
    ds_read_b128 v[104:107], v126 offset:55936
    v_exp_f32 v34, v34
    v_exp_f32 v35, v35
    v_exp_f32 v36, v36
    v_mfma_f32_32x32x16_bf16 v[48:63], v[100:103], v[28:31], 0
    ds_read_b128 v[108:111], v126 offset:56480
    v_exp_f32 v37, v37
    v_exp_f32 v38, v38
    v_exp_f32 v39, v39
    v_exp_f32 v40, v40
    v_exp_f32 v41, v41
    v_smfmac_f32_32x32x32_bf16 v[64:79], v[112:115], v[32:39], v124
    s_add_u32 s61, s25, 0
    buffer_store_dwordx4 v[224:227], v234, s[4:7], s61 offen offset:0
    v_exp_f32 v42, v42
    v_exp_f32 v43, v43
    v_exp_f32 v44, v44
    v_exp_f32 v45, v45
    v_exp_f32 v46, v46
    v_exp_f32 v47, v47
    v_exp_f32 v48, v48
    v_exp_f32 v49, v49
    v_smfmac_f32_32x32x32_bf16 v[64:79], v[116:119], v[40:47], v124
    s_waitcnt lgkmcnt(0)
    v_exp_f32 v50, v50
    v_exp_f32 v51, v51
    v_exp_f32 v52, v52
    v_mfma_f32_32x32x16_bf16 v[32:47], v[96:99], v[24:27], 0
    buffer_store_dwordx4 v[224:227], v234, s[4:7], s61 offen offset:1024
    v_exp_f32 v53, v53
    v_exp_f32 v54, v54
    v_exp_f32 v55, v55
    v_exp_f32 v56, v56
    v_exp_f32 v57, v57
    v_smfmac_f32_32x32x32_bf16 v[80:95], v[112:115], v[48:55], v124
    ds_read_b128 v[100:103], v125 offset:57024
    v_exp_f32 v58, v58
    v_exp_f32 v59, v59
    v_exp_f32 v60, v60
    v_exp_f32 v61, v61
    v_exp_f32 v62, v62
    v_exp_f32 v63, v63
    v_exp_f32 v32, v32
    v_exp_f32 v33, v33
    v_smfmac_f32_32x32x32_bf16 v[80:95], v[116:119], v[56:63], v124
    ds_read_b128 v[112:115], v126 offset:58048
    v_exp_f32 v34, v34
    v_exp_f32 v35, v35
    v_exp_f32 v36, v36
    v_mfma_f32_32x32x16_bf16 v[48:63], v[96:99], v[28:31], 0
    ds_read_b128 v[116:119], v126 offset:58592
    v_exp_f32 v37, v37
    v_exp_f32 v38, v38
    v_exp_f32 v39, v39
    v_exp_f32 v40, v40
    v_exp_f32 v41, v41
    v_smfmac_f32_32x32x32_bf16 v[64:79], v[104:107], v[32:39], v124
    s_add_u32 s61, s20, 131072
    buffer_store_dwordx4 v[224:227], v1, s[4:7], s61 offen offset:0
    v_exp_f32 v42, v42
    v_exp_f32 v43, v43
    v_exp_f32 v44, v44
    v_exp_f32 v45, v45
    v_exp_f32 v46, v46
    v_exp_f32 v47, v47
    v_exp_f32 v48, v48
    v_exp_f32 v49, v49
    v_smfmac_f32_32x32x32_bf16 v[64:79], v[108:111], v[40:47], v124
    s_waitcnt lgkmcnt(0)
    v_exp_f32 v50, v50
    v_exp_f32 v51, v51
    v_exp_f32 v52, v52
    v_mfma_f32_32x32x16_bf16 v[32:47], v[100:103], v[24:27], 0
    s_add_u32 s61, s20, 32768
    buffer_store_dwordx4 v[224:227], v1, s[4:7], s61 offen offset:0
    v_exp_f32 v53, v53
    v_exp_f32 v54, v54
    v_exp_f32 v55, v55
    v_exp_f32 v56, v56
    v_exp_f32 v57, v57
    v_smfmac_f32_32x32x32_bf16 v[80:95], v[104:107], v[48:55], v124
    ds_read_b128 v[96:99], v125 offset:59136
    v_exp_f32 v58, v58
    v_exp_f32 v59, v59
    v_exp_f32 v60, v60
    v_exp_f32 v61, v61
    v_exp_f32 v62, v62
    v_exp_f32 v63, v63
    v_exp_f32 v32, v32
    v_exp_f32 v33, v33
    v_smfmac_f32_32x32x32_bf16 v[80:95], v[108:111], v[56:63], v124
    ds_read_b128 v[104:107], v126 offset:60160
    v_exp_f32 v34, v34
    v_exp_f32 v35, v35
    v_exp_f32 v36, v36
    v_mfma_f32_32x32x16_bf16 v[48:63], v[100:103], v[28:31], 0
    ds_read_b128 v[108:111], v126 offset:60704
    v_exp_f32 v37, v37
    v_exp_f32 v38, v38
    v_exp_f32 v39, v39
    v_exp_f32 v40, v40
    v_exp_f32 v41, v41
    v_smfmac_f32_32x32x32_bf16 v[64:79], v[112:115], v[32:39], v124
    s_add_u32 s61, s20, 98304
    buffer_store_dwordx4 v[224:227], v1, s[4:7], s61 offen offset:0
    v_exp_f32 v42, v42
    v_exp_f32 v43, v43
    v_exp_f32 v44, v44
    v_exp_f32 v45, v45
    v_exp_f32 v46, v46
    v_exp_f32 v47, v47
    v_exp_f32 v48, v48
    v_exp_f32 v49, v49
    v_smfmac_f32_32x32x32_bf16 v[64:79], v[116:119], v[40:47], v124
    s_waitcnt lgkmcnt(0)
    v_exp_f32 v50, v50
    v_exp_f32 v51, v51
    v_exp_f32 v52, v52
    v_mfma_f32_32x32x16_bf16 v[32:47], v[96:99], v[24:27], 0
    s_add_u32 s61, s24, 114688
    buffer_store_dwordx4 v[224:227], v1, s[4:7], s61 offen offset:0
    v_exp_f32 v53, v53
    v_exp_f32 v54, v54
    v_exp_f32 v55, v55
    v_exp_f32 v56, v56
    v_exp_f32 v57, v57
    v_smfmac_f32_32x32x32_bf16 v[80:95], v[112:115], v[48:55], v124
    ds_read_b128 v[100:103], v125 offset:61248
    v_exp_f32 v58, v58
    v_exp_f32 v59, v59
    v_exp_f32 v60, v60
    v_exp_f32 v61, v61
    v_exp_f32 v62, v62
    v_exp_f32 v63, v63
    v_exp_f32 v32, v32
    v_exp_f32 v33, v33
    v_smfmac_f32_32x32x32_bf16 v[80:95], v[116:119], v[56:63], v124
    ds_read_b128 v[112:115], v126 offset:62272
    v_exp_f32 v34, v34
    v_exp_f32 v35, v35
    v_exp_f32 v36, v36
    v_mfma_f32_32x32x16_bf16 v[48:63], v[96:99], v[28:31], 0
    ds_read_b128 v[116:119], v126 offset:62816
    v_exp_f32 v37, v37
    v_exp_f32 v38, v38
    v_exp_f32 v39, v39
    v_exp_f32 v40, v40
    v_exp_f32 v41, v41
    v_smfmac_f32_32x32x32_bf16 v[64:79], v[104:107], v[32:39], v124
    buffer_store_dwordx4 v[224:227], v1, s[4:7], s61 offen offset:1024
    v_exp_f32 v42, v42
    v_exp_f32 v43, v43
    v_exp_f32 v44, v44
    v_exp_f32 v45, v45
    v_exp_f32 v46, v46
    v_exp_f32 v47, v47
    v_exp_f32 v48, v48
    v_exp_f32 v49, v49
    v_smfmac_f32_32x32x32_bf16 v[64:79], v[108:111], v[40:47], v124
    s_waitcnt lgkmcnt(0)
    v_exp_f32 v50, v50
    v_exp_f32 v51, v51
    v_exp_f32 v52, v52
    v_mfma_f32_32x32x16_bf16 v[32:47], v[100:103], v[24:27], 0
    s_add_u32 s61, s25, 114688
    buffer_store_dwordx4 v[224:227], v234, s[4:7], s61 offen offset:0
    v_exp_f32 v53, v53
    v_exp_f32 v54, v54
    v_exp_f32 v55, v55
    v_exp_f32 v56, v56
    v_exp_f32 v57, v57
    v_smfmac_f32_32x32x32_bf16 v[80:95], v[104:107], v[48:55], v124
    ds_read_b128 v[96:99], v125 offset:63360
    v_exp_f32 v58, v58
    v_exp_f32 v59, v59
    v_exp_f32 v60, v60
    v_exp_f32 v61, v61
    v_exp_f32 v62, v62
    v_exp_f32 v63, v63
    v_exp_f32 v32, v32
    v_exp_f32 v33, v33
    v_smfmac_f32_32x32x32_bf16 v[80:95], v[108:111], v[56:63], v124
    ds_read_b128 v[104:107], v126 offset:64384
    v_exp_f32 v34, v34
    v_exp_f32 v35, v35
    v_exp_f32 v36, v36
    v_mfma_f32_32x32x16_bf16 v[48:63], v[100:103], v[28:31], 0
    ds_read_b128 v[108:111], v126 offset:64928
    v_exp_f32 v37, v37
    v_exp_f32 v38, v38
    v_exp_f32 v39, v39
    v_exp_f32 v40, v40
    v_exp_f32 v41, v41
    v_smfmac_f32_32x32x32_bf16 v[64:79], v[112:115], v[32:39], v124
    buffer_store_dwordx4 v[224:227], v234, s[4:7], s61 offen offset:1024
    v_exp_f32 v42, v42
    v_exp_f32 v43, v43
    v_exp_f32 v44, v44
    v_exp_f32 v45, v45
    v_exp_f32 v46, v46
    v_exp_f32 v47, v47
    v_exp_f32 v48, v48
    v_exp_f32 v49, v49
    v_smfmac_f32_32x32x32_bf16 v[64:79], v[116:119], v[40:47], v124
    s_waitcnt lgkmcnt(0)
    v_exp_f32 v50, v50
    v_exp_f32 v51, v51
    v_exp_f32 v52, v52
    v_mfma_f32_32x32x16_bf16 v[32:47], v[96:99], v[24:27], 0
    s_add_u32 s61, s20, 163840
    buffer_store_dwordx4 v[224:227], v1, s[4:7], s61 offen offset:0
    v_exp_f32 v53, v53
    v_exp_f32 v54, v54
    v_exp_f32 v55, v55
    v_exp_f32 v56, v56
    v_exp_f32 v57, v57
    v_smfmac_f32_32x32x32_bf16 v[80:95], v[112:115], v[48:55], v124
    ds_read_b128 v[100:103], v125 offset:65472
    v_exp_f32 v58, v58
    v_exp_f32 v59, v59
    v_exp_f32 v60, v60
    v_exp_f32 v61, v61
    v_exp_f32 v62, v62
    v_exp_f32 v63, v63
    v_exp_f32 v32, v32
    v_exp_f32 v33, v33
    v_smfmac_f32_32x32x32_bf16 v[80:95], v[116:119], v[56:63], v124
    v_add_u32 v126, 0xffc0, v126
    ds_read_b128 v[112:115], v126 offset:1024
    v_exp_f32 v34, v34
    v_exp_f32 v35, v35
    v_exp_f32 v36, v36
    v_mfma_f32_32x32x16_bf16 v[48:63], v[96:99], v[28:31], 0
    ds_read_b128 v[116:119], v126 offset:1568
    v_exp_f32 v37, v37
    v_exp_f32 v38, v38
    v_exp_f32 v39, v39
    v_exp_f32 v40, v40
    v_exp_f32 v41, v41
    v_smfmac_f32_32x32x32_bf16 v[64:79], v[104:107], v[32:39], v124
    global_load_dwordx4 a[112:115], v1, s[64:65] offset:0
    global_load_dwordx4 a[116:119], v1, s[64:65] offset:1024
    v_exp_f32 v42, v42
    v_exp_f32 v43, v43
    v_exp_f32 v44, v44
    v_exp_f32 v45, v45
    v_exp_f32 v46, v46
    v_exp_f32 v47, v47
    v_exp_f32 v48, v48
    v_exp_f32 v49, v49
    v_smfmac_f32_32x32x32_bf16 v[64:79], v[108:111], v[40:47], v124
    s_waitcnt lgkmcnt(0)
    v_exp_f32 v50, v50
    v_exp_f32 v51, v51
    v_exp_f32 v52, v52
    v_mfma_f32_32x32x16_bf16 v[32:47], v[100:103], v[24:27], 0
    global_load_dwordx4 a[120:123], v1, s[64:65] offset:2048
    global_load_dwordx4 a[124:127], v1, s[64:65] offset:3072
    v_exp_f32 v53, v53
    v_exp_f32 v54, v54
    v_exp_f32 v55, v55
    v_exp_f32 v56, v56
    v_exp_f32 v57, v57
    v_smfmac_f32_32x32x32_bf16 v[80:95], v[104:107], v[48:55], v124
    v_add_u32 v125, 0xfffef800, v125
    ds_read_b128 v[96:99], v125 offset:0
    v_exp_f32 v58, v58
    v_exp_f32 v59, v59
    v_exp_f32 v60, v60
    v_exp_f32 v61, v61
    v_exp_f32 v62, v62
    v_exp_f32 v63, v63
    v_exp_f32 v32, v32
    v_exp_f32 v33, v33
    v_smfmac_f32_32x32x32_bf16 v[80:95], v[108:111], v[56:63], v124
    v_add_u32 v126, 0xfffdf840, v126
    ds_read_b128 v[104:107], v126 offset:1024
    v_exp_f32 v34, v34
    v_exp_f32 v35, v35
    v_exp_f32 v36, v36
    v_mfma_f32_32x32x16_bf16 v[48:63], v[100:103], v[28:31], 0
    ds_read_b128 v[108:111], v126 offset:1568
    v_exp_f32 v37, v37
    v_exp_f32 v38, v38
    v_exp_f32 v39, v39
    v_exp_f32 v40, v40
    v_exp_f32 v41, v41
    v_smfmac_f32_32x32x32_bf16 v[64:79], v[112:115], v[32:39], v124
    s_add_u32 s64, s54, 0
    buffer_load_dwordx4 a[128:131], v234, s[4:7], s64 offen offset:0
    buffer_load_dwordx4 a[132:135], v234, s[4:7], s64 offen offset:1024
    v_exp_f32 v42, v42
    v_exp_f32 v43, v43
    v_exp_f32 v44, v44
    v_exp_f32 v45, v45
    v_exp_f32 v46, v46
    v_exp_f32 v47, v47
    v_exp_f32 v48, v48
    v_exp_f32 v49, v49
    v_smfmac_f32_32x32x32_bf16 v[64:79], v[116:119], v[40:47], v124
    s_waitcnt lgkmcnt(0)
    v_exp_f32 v50, v50
    v_exp_f32 v51, v51
    v_exp_f32 v52, v52
    v_mfma_f32_32x32x16_bf16 v[32:47], v[96:99], v[24:27], 0
    buffer_load_dwordx4 a[136:139], v234, s[4:7], s64 offen offset:2048
    buffer_load_dwordx4 a[140:143], v234, s[4:7], s64 offen offset:3072
    v_exp_f32 v53, v53
    v_exp_f32 v54, v54
    v_exp_f32 v55, v55
    v_exp_f32 v56, v56
    v_exp_f32 v57, v57
    v_smfmac_f32_32x32x32_bf16 v[80:95], v[112:115], v[48:55], v124
    ds_read_b128 v[100:103], v125 offset:2112
    v_exp_f32 v58, v58
    v_exp_f32 v59, v59
    v_exp_f32 v60, v60
    v_exp_f32 v61, v61
    v_exp_f32 v62, v62
    v_exp_f32 v63, v63
    v_exp_f32 v32, v32
    v_exp_f32 v33, v33
    v_smfmac_f32_32x32x32_bf16 v[80:95], v[116:119], v[56:63], v124
    s_waitcnt lgkmcnt(0)
    ds_read_b128 v[112:115], v126 offset:3136
    v_exp_f32 v34, v34
    v_exp_f32 v35, v35
    v_exp_f32 v36, v36
    v_mfma_f32_32x32x16_bf16 v[48:63], v[100:103], v[24:27], 0
    ds_read_b128 v[116:119], v126 offset:3680
    v_exp_f32 v37, v37
    v_exp_f32 v38, v38
    v_exp_f32 v39, v39
    v_exp_f32 v40, v40
    v_exp_f32 v41, v41
    v_smfmac_f32_32x32x32_bf16 v[64:79], v[104:107], v[32:39], v124
    ds_read_b128 v[96:99], v125 offset:4224
    v_exp_f32 v42, v42
    v_exp_f32 v43, v43
    v_exp_f32 v44, v44
    v_exp_f32 v45, v45
    v_exp_f32 v46, v46
    v_exp_f32 v47, v47
    v_exp_f32 v48, v48
    v_exp_f32 v49, v49
    v_smfmac_f32_32x32x32_bf16 v[64:79], v[108:111], v[40:47], v124
    s_waitcnt lgkmcnt(0)
    ds_read_b128 v[104:107], v126 offset:5248
    v_exp_f32 v50, v50
    v_exp_f32 v51, v51
    v_exp_f32 v52, v52
    v_mfma_f32_32x32x16_bf16 v[32:47], v[96:99], v[24:27], 0
    ds_read_b128 v[108:111], v126 offset:5792
    v_exp_f32 v53, v53
    v_exp_f32 v54, v54
    v_exp_f32 v55, v55
    v_exp_f32 v56, v56
    v_exp_f32 v57, v57
    v_smfmac_f32_32x32x32_bf16 v[64:79], v[112:115], v[48:55], v124
    ds_read_b128 v[100:103], v125 offset:6336
    v_exp_f32 v58, v58
    v_exp_f32 v59, v59
    v_exp_f32 v60, v60
    v_exp_f32 v61, v61
    v_exp_f32 v62, v62
    v_exp_f32 v63, v63
    v_exp_f32 v32, v32
    v_exp_f32 v33, v33
    v_smfmac_f32_32x32x32_bf16 v[64:79], v[116:119], v[56:63], v124
    s_waitcnt lgkmcnt(0)
    ds_read_b128 v[112:115], v126 offset:7360
    v_exp_f32 v34, v34
    v_exp_f32 v35, v35
    v_exp_f32 v36, v36
    v_mfma_f32_32x32x16_bf16 v[48:63], v[100:103], v[24:27], 0
    ds_read_b128 v[116:119], v126 offset:7904
    v_exp_f32 v37, v37
    v_exp_f32 v38, v38
    v_exp_f32 v39, v39
    v_exp_f32 v40, v40
    v_exp_f32 v41, v41
    v_smfmac_f32_32x32x32_bf16 v[64:79], v[104:107], v[32:39], v124
    ds_read_b128 v[96:99], v125 offset:8448
    v_exp_f32 v42, v42
    v_exp_f32 v43, v43
    v_exp_f32 v44, v44
    v_exp_f32 v45, v45
    v_exp_f32 v46, v46
    v_exp_f32 v47, v47
    v_exp_f32 v48, v48
    v_exp_f32 v49, v49
    v_smfmac_f32_32x32x32_bf16 v[64:79], v[108:111], v[40:47], v124
    s_waitcnt lgkmcnt(0)
    ds_read_b128 v[104:107], v126 offset:9472
    v_exp_f32 v50, v50
    v_exp_f32 v51, v51
    v_exp_f32 v52, v52
    v_mfma_f32_32x32x16_bf16 v[32:47], v[96:99], v[24:27], 0
    ds_read_b128 v[108:111], v126 offset:10016
    v_exp_f32 v53, v53
    v_exp_f32 v54, v54
    v_exp_f32 v55, v55
    v_exp_f32 v56, v56
    v_exp_f32 v57, v57
    v_smfmac_f32_32x32x32_bf16 v[64:79], v[112:115], v[48:55], v124
    ds_read_b128 v[100:103], v125 offset:10560
    v_exp_f32 v58, v58
    v_exp_f32 v59, v59
    v_exp_f32 v60, v60
    v_exp_f32 v61, v61
    v_exp_f32 v62, v62
    v_exp_f32 v63, v63
    v_exp_f32 v32, v32
    v_exp_f32 v33, v33
    v_smfmac_f32_32x32x32_bf16 v[64:79], v[116:119], v[56:63], v124
    s_waitcnt lgkmcnt(0)
    ds_read_b128 v[112:115], v126 offset:11584
    v_exp_f32 v34, v34
    v_exp_f32 v35, v35
    v_exp_f32 v36, v36
    v_mfma_f32_32x32x16_bf16 v[48:63], v[100:103], v[24:27], 0
    ds_read_b128 v[116:119], v126 offset:12128
    v_exp_f32 v37, v37
    v_exp_f32 v38, v38
    v_exp_f32 v39, v39
    v_exp_f32 v40, v40
    v_exp_f32 v41, v41
    v_smfmac_f32_32x32x32_bf16 v[64:79], v[104:107], v[32:39], v124
    ds_read_b128 v[96:99], v125 offset:12672
    v_exp_f32 v42, v42
    v_exp_f32 v43, v43
    v_exp_f32 v44, v44
    v_exp_f32 v45, v45
    v_exp_f32 v46, v46
    v_exp_f32 v47, v47
    v_exp_f32 v48, v48
    v_exp_f32 v49, v49
    v_smfmac_f32_32x32x32_bf16 v[64:79], v[108:111], v[40:47], v124
    s_waitcnt lgkmcnt(0)
    ds_read_b128 v[104:107], v126 offset:13696
    v_exp_f32 v50, v50
    v_exp_f32 v51, v51
    v_exp_f32 v52, v52
    v_mfma_f32_32x32x16_bf16 v[32:47], v[96:99], v[24:27], 0
    ds_read_b128 v[108:111], v126 offset:14240
    v_exp_f32 v53, v53
    v_exp_f32 v54, v54
    v_exp_f32 v55, v55
    v_exp_f32 v56, v56
    v_exp_f32 v57, v57
    v_smfmac_f32_32x32x32_bf16 v[64:79], v[112:115], v[48:55], v124
    ds_read_b128 v[100:103], v125 offset:14784
    v_exp_f32 v58, v58
    v_exp_f32 v59, v59
    v_exp_f32 v60, v60
    v_exp_f32 v61, v61
    v_exp_f32 v62, v62
    v_exp_f32 v63, v63
    v_exp_f32 v32, v32
    v_exp_f32 v33, v33
    v_smfmac_f32_32x32x32_bf16 v[64:79], v[116:119], v[56:63], v124
    ds_read_b128 v[112:115], v126 offset:15808
    v_exp_f32 v34, v34
    v_exp_f32 v35, v35
    v_exp_f32 v36, v36
    v_mfma_f32_32x32x16_bf16 v[48:63], v[96:99], v[28:31], 0
    ds_read_b128 v[116:119], v126 offset:16352
    v_exp_f32 v37, v37
    v_exp_f32 v38, v38
    v_exp_f32 v39, v39
    v_exp_f32 v40, v40
    v_exp_f32 v41, v41
    s_waitcnt lgkmcnt(4)
    v_smfmac_f32_32x32x32_bf16 v[64:79], v[104:107], v[32:39], v124
    s_barrier
    v_exp_f32 v42, v42
    v_exp_f32 v43, v43
    v_exp_f32 v44, v44
    v_exp_f32 v45, v45
    v_exp_f32 v46, v46
    v_exp_f32 v47, v47
    v_exp_f32 v48, v48
    v_exp_f32 v49, v49
    s_waitcnt lgkmcnt(3)
    v_smfmac_f32_32x32x32_bf16 v[64:79], v[108:111], v[40:47], v124
    s_waitcnt lgkmcnt(0)
    v_exp_f32 v50, v50
    v_exp_f32 v51, v51
    v_exp_f32 v52, v52
    v_mfma_f32_32x32x16_bf16 v[32:47], v[100:103], v[24:27], 0
    s_add_u32 m0, s30, 67584
    s_add_u32 s66, s44, 524288
    s_addc_u32 s67, s45, 0
    global_load_lds_dwordx4 v2, s[66:67] offset:0
    global_load_lds_dwordx4 v2, s[66:67] offset:1024
    v_exp_f32 v53, v53
    v_exp_f32 v54, v54
    v_exp_f32 v55, v55
    v_exp_f32 v56, v56
    v_exp_f32 v57, v57
    v_smfmac_f32_32x32x32_bf16 v[80:95], v[104:107], v[48:55], v124
    ds_read_b128 v[96:99], v125 offset:16896
    v_exp_f32 v58, v58
    v_exp_f32 v59, v59
    v_exp_f32 v60, v60
    v_exp_f32 v61, v61
    v_exp_f32 v62, v62
    v_exp_f32 v63, v63
    v_exp_f32 v32, v32
    v_exp_f32 v33, v33
    v_smfmac_f32_32x32x32_bf16 v[80:95], v[108:111], v[56:63], v124
    ds_read_b128 v[104:107], v126 offset:17920
    v_exp_f32 v34, v34
    v_exp_f32 v35, v35
    v_exp_f32 v36, v36
    v_mfma_f32_32x32x16_bf16 v[48:63], v[100:103], v[28:31], 0
    ds_read_b128 v[108:111], v126 offset:18464
    v_exp_f32 v37, v37
    v_exp_f32 v38, v38
    v_exp_f32 v39, v39
    v_exp_f32 v40, v40
    v_exp_f32 v41, v41
    v_smfmac_f32_32x32x32_bf16 v[64:79], v[112:115], v[32:39], v124
    global_load_lds_dwordx4 v2, s[66:67] offset:2048
    global_load_lds_dwordx4 v2, s[66:67] offset:3072
    v_exp_f32 v42, v42
    v_exp_f32 v43, v43
    v_exp_f32 v44, v44
    v_exp_f32 v45, v45
    v_exp_f32 v46, v46
    v_exp_f32 v47, v47
    v_exp_f32 v48, v48
    v_exp_f32 v49, v49
    v_smfmac_f32_32x32x32_bf16 v[64:79], v[116:119], v[40:47], v124
    s_waitcnt lgkmcnt(0)
    v_exp_f32 v50, v50
    v_exp_f32 v51, v51
    v_exp_f32 v52, v52
    v_mfma_f32_32x32x16_bf16 v[32:47], v[96:99], v[24:27], 0
    s_add_u32 m0, s30, 71680
    s_add_u32 s66, s44, 528384
    s_addc_u32 s67, s45, 0
    global_load_lds_dwordx4 v2, s[66:67] offset:0
    global_load_lds_dwordx4 v2, s[66:67] offset:1024
    v_exp_f32 v53, v53
    v_exp_f32 v54, v54
    v_exp_f32 v55, v55
    v_exp_f32 v56, v56
    v_exp_f32 v57, v57
    v_smfmac_f32_32x32x32_bf16 v[80:95], v[112:115], v[48:55], v124
    ds_read_b128 v[100:103], v125 offset:19008
    v_exp_f32 v58, v58
    v_exp_f32 v59, v59
    v_exp_f32 v60, v60
    v_exp_f32 v61, v61
    v_exp_f32 v62, v62
    v_exp_f32 v63, v63
    v_exp_f32 v32, v32
    v_exp_f32 v33, v33
    v_smfmac_f32_32x32x32_bf16 v[80:95], v[116:119], v[56:63], v124
    ds_read_b128 v[112:115], v126 offset:20032
    v_exp_f32 v34, v34
    v_exp_f32 v35, v35
    v_exp_f32 v36, v36
    v_mfma_f32_32x32x16_bf16 v[48:63], v[96:99], v[28:31], 0
    ds_read_b128 v[116:119], v126 offset:20576
    v_exp_f32 v37, v37
    v_exp_f32 v38, v38
    v_exp_f32 v39, v39
    v_exp_f32 v40, v40
    v_exp_f32 v41, v41
    v_smfmac_f32_32x32x32_bf16 v[64:79], v[104:107], v[32:39], v124
    global_load_lds_dwordx4 v2, s[66:67] offset:2048
    global_load_lds_dwordx4 v2, s[66:67] offset:3072
    v_exp_f32 v42, v42
    v_exp_f32 v43, v43
    v_exp_f32 v44, v44
    v_exp_f32 v45, v45
    v_exp_f32 v46, v46
    v_exp_f32 v47, v47
    v_exp_f32 v48, v48
    v_exp_f32 v49, v49
    v_smfmac_f32_32x32x32_bf16 v[64:79], v[108:111], v[40:47], v124
    s_waitcnt lgkmcnt(0)
    v_exp_f32 v50, v50
    v_exp_f32 v51, v51
    v_exp_f32 v52, v52
    v_mfma_f32_32x32x16_bf16 v[32:47], v[100:103], v[24:27], 0
    s_add_u32 m0, s30, 75776
    s_add_u32 s66, s46, 524288
    s_addc_u32 s67, s47, 0
    global_load_lds_dwordx4 v2, s[66:67] offset:0
    global_load_lds_dwordx4 v2, s[66:67] offset:1024
    v_exp_f32 v53, v53
    v_exp_f32 v54, v54
    v_exp_f32 v55, v55
    v_exp_f32 v56, v56
    v_exp_f32 v57, v57
    v_smfmac_f32_32x32x32_bf16 v[80:95], v[104:107], v[48:55], v124
    ds_read_b128 v[96:99], v125 offset:21120
    v_exp_f32 v58, v58
    v_exp_f32 v59, v59
    v_exp_f32 v60, v60
    v_exp_f32 v61, v61
    v_exp_f32 v62, v62
    v_exp_f32 v63, v63
    v_exp_f32 v32, v32
    v_exp_f32 v33, v33
    v_smfmac_f32_32x32x32_bf16 v[80:95], v[108:111], v[56:63], v124
    ds_read_b128 v[104:107], v126 offset:22144
    v_exp_f32 v34, v34
    v_exp_f32 v35, v35
    v_exp_f32 v36, v36
    v_mfma_f32_32x32x16_bf16 v[48:63], v[100:103], v[28:31], 0
    ds_read_b128 v[108:111], v126 offset:22688
    v_exp_f32 v37, v37
    v_exp_f32 v38, v38
    v_exp_f32 v39, v39
    v_exp_f32 v40, v40
    v_exp_f32 v41, v41
    v_smfmac_f32_32x32x32_bf16 v[64:79], v[112:115], v[32:39], v124
    global_load_lds_dwordx4 v2, s[66:67] offset:2048
    global_load_lds_dwordx4 v2, s[66:67] offset:3072
    v_exp_f32 v42, v42
    v_exp_f32 v43, v43
    v_exp_f32 v44, v44
    v_exp_f32 v45, v45
    v_exp_f32 v46, v46
    v_exp_f32 v47, v47
    v_exp_f32 v48, v48
    v_exp_f32 v49, v49
    v_smfmac_f32_32x32x32_bf16 v[64:79], v[116:119], v[40:47], v124
    s_waitcnt lgkmcnt(0)
    v_exp_f32 v50, v50
    v_exp_f32 v51, v51
    v_exp_f32 v52, v52
    v_mfma_f32_32x32x16_bf16 v[32:47], v[96:99], v[24:27], 0
    s_add_u32 m0, s30, 79872
    s_add_u32 s66, s46, 528384
    s_addc_u32 s67, s47, 0
    global_load_lds_dwordx4 v2, s[66:67] offset:0
    v_exp_f32 v53, v53
    v_exp_f32 v54, v54
    v_exp_f32 v55, v55
    v_exp_f32 v56, v56
    v_exp_f32 v57, v57
    v_smfmac_f32_32x32x32_bf16 v[80:95], v[112:115], v[48:55], v124
    ds_read_b128 v[100:103], v125 offset:23232
    v_exp_f32 v58, v58
    v_exp_f32 v59, v59
    v_exp_f32 v60, v60
    v_exp_f32 v61, v61
    v_exp_f32 v62, v62
    v_exp_f32 v63, v63
    v_exp_f32 v32, v32
    v_exp_f32 v33, v33
    v_smfmac_f32_32x32x32_bf16 v[80:95], v[116:119], v[56:63], v124
    ds_read_b128 v[112:115], v126 offset:24256
    v_exp_f32 v34, v34
    v_exp_f32 v35, v35
    v_exp_f32 v36, v36
    v_mfma_f32_32x32x16_bf16 v[48:63], v[96:99], v[28:31], 0
    ds_read_b128 v[116:119], v126 offset:24800
    v_exp_f32 v37, v37
    v_exp_f32 v38, v38
    v_exp_f32 v39, v39
    v_exp_f32 v40, v40
    v_exp_f32 v41, v41
    v_smfmac_f32_32x32x32_bf16 v[64:79], v[104:107], v[32:39], v124
    global_load_lds_dwordx4 v2, s[66:67] offset:1024
    global_load_lds_dwordx4 v2, s[66:67] offset:2048
    v_exp_f32 v42, v42
    v_exp_f32 v43, v43
    v_exp_f32 v44, v44
    v_exp_f32 v45, v45
    v_exp_f32 v46, v46
    v_exp_f32 v47, v47
    v_exp_f32 v48, v48
    v_exp_f32 v49, v49
    v_smfmac_f32_32x32x32_bf16 v[64:79], v[108:111], v[40:47], v124
    s_waitcnt lgkmcnt(0)
    v_exp_f32 v50, v50
    v_exp_f32 v51, v51
    v_exp_f32 v52, v52
    v_mfma_f32_32x32x16_bf16 v[32:47], v[100:103], v[24:27], 0
    global_load_lds_dwordx4 v2, s[66:67] offset:3072
    s_add_u32 s64, s54, 4096
    buffer_load_dwordx4 a[144:147], v234, s[4:7], s64 offen offset:0
    v_exp_f32 v53, v53
    v_exp_f32 v54, v54
    v_exp_f32 v55, v55
    v_exp_f32 v56, v56
    v_exp_f32 v57, v57
    v_smfmac_f32_32x32x32_bf16 v[80:95], v[104:107], v[48:55], v124
    ds_read_b128 v[96:99], v125 offset:25344
    v_exp_f32 v58, v58
    v_exp_f32 v59, v59
    v_exp_f32 v60, v60
    v_exp_f32 v61, v61
    v_exp_f32 v62, v62
    v_exp_f32 v63, v63
    v_exp_f32 v32, v32
    v_exp_f32 v33, v33
    v_smfmac_f32_32x32x32_bf16 v[80:95], v[108:111], v[56:63], v124
    ds_read_b128 v[104:107], v126 offset:26368
    v_exp_f32 v34, v34
    v_exp_f32 v35, v35
    v_exp_f32 v36, v36
    v_mfma_f32_32x32x16_bf16 v[48:63], v[100:103], v[28:31], 0
    ds_read_b128 v[108:111], v126 offset:26912
    v_exp_f32 v37, v37
    v_exp_f32 v38, v38
    v_exp_f32 v39, v39
    v_exp_f32 v40, v40
    v_exp_f32 v41, v41
    v_smfmac_f32_32x32x32_bf16 v[64:79], v[112:115], v[32:39], v124
    buffer_load_dwordx4 a[148:151], v234, s[4:7], s64 offen offset:1024
    buffer_load_dwordx4 a[152:155], v234, s[4:7], s64 offen offset:2048
    v_exp_f32 v42, v42
    v_exp_f32 v43, v43
    v_exp_f32 v44, v44
    v_exp_f32 v45, v45
    v_exp_f32 v46, v46
    v_exp_f32 v47, v47
    v_exp_f32 v48, v48
    v_exp_f32 v49, v49
    v_smfmac_f32_32x32x32_bf16 v[64:79], v[116:119], v[40:47], v124
    s_waitcnt lgkmcnt(0)
    v_exp_f32 v50, v50
    v_exp_f32 v51, v51
    v_exp_f32 v52, v52
    v_mfma_f32_32x32x16_bf16 v[32:47], v[96:99], v[24:27], 0
    buffer_load_dwordx4 a[156:159], v234, s[4:7], s64 offen offset:3072
    s_add_u32 s64, s54, 8192
    buffer_load_dwordx4 a[160:163], v234, s[4:7], s64 offen offset:0
    v_exp_f32 v53, v53
    v_exp_f32 v54, v54
    v_exp_f32 v55, v55
    v_exp_f32 v56, v56
    v_exp_f32 v57, v57
    v_smfmac_f32_32x32x32_bf16 v[80:95], v[112:115], v[48:55], v124
    ds_read_b128 v[100:103], v125 offset:27456
    v_exp_f32 v58, v58
    v_exp_f32 v59, v59
    v_exp_f32 v60, v60
    v_exp_f32 v61, v61
    v_exp_f32 v62, v62
    v_exp_f32 v63, v63
    v_exp_f32 v32, v32
    v_exp_f32 v33, v33
    v_smfmac_f32_32x32x32_bf16 v[80:95], v[116:119], v[56:63], v124
    ds_read_b128 v[112:115], v126 offset:28480
    v_exp_f32 v34, v34
    v_exp_f32 v35, v35
    v_exp_f32 v36, v36
    v_mfma_f32_32x32x16_bf16 v[48:63], v[96:99], v[28:31], 0
    ds_read_b128 v[116:119], v126 offset:29024
    v_exp_f32 v37, v37
    v_exp_f32 v38, v38
    v_exp_f32 v39, v39
    v_exp_f32 v40, v40
    v_exp_f32 v41, v41
    v_smfmac_f32_32x32x32_bf16 v[64:79], v[104:107], v[32:39], v124
    buffer_load_dwordx4 a[164:167], v234, s[4:7], s64 offen offset:1024
    buffer_load_dwordx4 a[168:171], v234, s[4:7], s64 offen offset:2048
    v_exp_f32 v42, v42
    v_exp_f32 v43, v43
    v_exp_f32 v44, v44
    v_exp_f32 v45, v45
    v_exp_f32 v46, v46
    v_exp_f32 v47, v47
    v_exp_f32 v48, v48
    v_exp_f32 v49, v49
    v_smfmac_f32_32x32x32_bf16 v[64:79], v[108:111], v[40:47], v124
    s_waitcnt lgkmcnt(0)
    v_exp_f32 v50, v50
    v_exp_f32 v51, v51
    v_exp_f32 v52, v52
    v_mfma_f32_32x32x16_bf16 v[32:47], v[100:103], v[24:27], 0
    buffer_load_dwordx4 a[172:175], v234, s[4:7], s64 offen offset:3072
    v_exp_f32 v53, v53
    v_exp_f32 v54, v54
    v_exp_f32 v55, v55
    v_exp_f32 v56, v56
    v_exp_f32 v57, v57
    v_smfmac_f32_32x32x32_bf16 v[80:95], v[104:107], v[48:55], v124
    ds_read_b128 v[96:99], v125 offset:29568
    v_exp_f32 v58, v58
    v_exp_f32 v59, v59
    v_exp_f32 v60, v60
    v_exp_f32 v61, v61
    v_exp_f32 v62, v62
    v_exp_f32 v63, v63
    v_exp_f32 v32, v32
    v_exp_f32 v33, v33
    v_smfmac_f32_32x32x32_bf16 v[80:95], v[108:111], v[56:63], v124
    ds_read_b128 v[104:107], v126 offset:30592
    v_exp_f32 v34, v34
    v_exp_f32 v35, v35
    v_exp_f32 v36, v36
    v_mfma_f32_32x32x16_bf16 v[48:63], v[100:103], v[28:31], 0
    ds_read_b128 v[108:111], v126 offset:31136
    v_exp_f32 v37, v37
    v_exp_f32 v38, v38
    v_exp_f32 v39, v39
    v_exp_f32 v40, v40
    v_exp_f32 v41, v41
    v_smfmac_f32_32x32x32_bf16 v[64:79], v[112:115], v[32:39], v124
    s_add_u32 s64, s54, 12288
    buffer_load_dwordx4 a[176:179], v234, s[4:7], s64 offen offset:0
    buffer_load_dwordx4 a[180:183], v234, s[4:7], s64 offen offset:1024
    v_exp_f32 v42, v42
    v_exp_f32 v43, v43
    v_exp_f32 v44, v44
    v_exp_f32 v45, v45
    v_exp_f32 v46, v46
    v_exp_f32 v47, v47
    v_exp_f32 v48, v48
    v_exp_f32 v49, v49
    v_smfmac_f32_32x32x32_bf16 v[64:79], v[116:119], v[40:47], v124
    s_waitcnt lgkmcnt(0)
    v_exp_f32 v50, v50
    v_exp_f32 v51, v51
    v_exp_f32 v52, v52
    v_mfma_f32_32x32x16_bf16 v[32:47], v[96:99], v[24:27], 0
    buffer_load_dwordx4 a[184:187], v234, s[4:7], s64 offen offset:2048
    buffer_load_dwordx4 a[188:191], v234, s[4:7], s64 offen offset:3072
    v_exp_f32 v53, v53
    v_exp_f32 v54, v54
    v_exp_f32 v55, v55
    v_exp_f32 v56, v56
    v_exp_f32 v57, v57
    v_smfmac_f32_32x32x32_bf16 v[80:95], v[112:115], v[48:55], v124
    ds_read_b128 v[100:103], v125 offset:31680
    v_exp_f32 v58, v58
    v_exp_f32 v59, v59
    v_exp_f32 v60, v60
    v_exp_f32 v61, v61
    v_exp_f32 v62, v62
    v_exp_f32 v63, v63
    v_exp_f32 v32, v32
    v_exp_f32 v33, v33
    v_smfmac_f32_32x32x32_bf16 v[80:95], v[116:119], v[56:63], v124
    ds_read_b128 v[112:115], v126 offset:32704
    v_exp_f32 v34, v34
    v_exp_f32 v35, v35
    v_exp_f32 v36, v36
    v_mfma_f32_32x32x16_bf16 v[48:63], v[96:99], v[28:31], 0
    ds_read_b128 v[116:119], v126 offset:33248
    v_exp_f32 v37, v37
    v_exp_f32 v38, v38
    v_exp_f32 v39, v39
    v_exp_f32 v40, v40
    v_exp_f32 v41, v41
    v_smfmac_f32_32x32x32_bf16 v[64:79], v[104:107], v[32:39], v124
    s_add_u32 s64, s54, 16384
    buffer_load_dwordx4 a[192:195], v234, s[4:7], s64 offen offset:0
    buffer_load_dwordx4 a[196:199], v234, s[4:7], s64 offen offset:1024
    v_exp_f32 v42, v42
    v_exp_f32 v43, v43
    v_exp_f32 v44, v44
    v_exp_f32 v45, v45
    v_exp_f32 v46, v46
    v_exp_f32 v47, v47
    v_exp_f32 v48, v48
    v_exp_f32 v49, v49
    v_smfmac_f32_32x32x32_bf16 v[64:79], v[108:111], v[40:47], v124
    s_waitcnt lgkmcnt(0)
    v_exp_f32 v50, v50
    v_exp_f32 v51, v51
    v_exp_f32 v52, v52
    v_mfma_f32_32x32x16_bf16 v[32:47], v[100:103], v[24:27], 0
    buffer_load_dwordx4 a[200:203], v234, s[4:7], s64 offen offset:2048
    buffer_load_dwordx4 a[204:207], v234, s[4:7], s64 offen offset:3072
    v_exp_f32 v53, v53
    v_exp_f32 v54, v54
    v_exp_f32 v55, v55
    v_exp_f32 v56, v56
    v_exp_f32 v57, v57
    v_smfmac_f32_32x32x32_bf16 v[80:95], v[104:107], v[48:55], v124
    ds_read_b128 v[96:99], v125 offset:33792
    v_exp_f32 v58, v58
    v_exp_f32 v59, v59
    v_exp_f32 v60, v60
    v_exp_f32 v61, v61
    v_exp_f32 v62, v62
    v_exp_f32 v63, v63
    v_exp_f32 v32, v32
    v_exp_f32 v33, v33
    v_smfmac_f32_32x32x32_bf16 v[80:95], v[108:111], v[56:63], v124
    ds_read_b128 v[104:107], v126 offset:34816
    v_exp_f32 v34, v34
    v_exp_f32 v35, v35
    v_exp_f32 v36, v36
    v_mfma_f32_32x32x16_bf16 v[48:63], v[100:103], v[28:31], 0
    ds_read_b128 v[108:111], v126 offset:35360
    v_exp_f32 v37, v37
    v_exp_f32 v38, v38
    v_exp_f32 v39, v39
    v_exp_f32 v40, v40
    v_exp_f32 v41, v41
    v_smfmac_f32_32x32x32_bf16 v[64:79], v[112:115], v[32:39], v124
    s_add_u32 s64, s54, 20480
    buffer_load_dwordx4 a[208:211], v234, s[4:7], s64 offen offset:0
    buffer_load_dwordx4 a[212:215], v234, s[4:7], s64 offen offset:1024
    v_exp_f32 v42, v42
    v_exp_f32 v43, v43
    v_exp_f32 v44, v44
    v_exp_f32 v45, v45
    v_exp_f32 v46, v46
    v_exp_f32 v47, v47
    v_exp_f32 v48, v48
    v_exp_f32 v49, v49
    v_smfmac_f32_32x32x32_bf16 v[64:79], v[116:119], v[40:47], v124
    s_waitcnt lgkmcnt(0)
    v_exp_f32 v50, v50
    v_exp_f32 v51, v51
    v_exp_f32 v52, v52
    v_mfma_f32_32x32x16_bf16 v[32:47], v[96:99], v[24:27], 0
    buffer_load_dwordx4 a[216:219], v234, s[4:7], s64 offen offset:2048
    v_exp_f32 v53, v53
    v_exp_f32 v54, v54
    v_exp_f32 v55, v55
    v_exp_f32 v56, v56
    v_exp_f32 v57, v57
    v_smfmac_f32_32x32x32_bf16 v[80:95], v[112:115], v[48:55], v124
    ds_read_b128 v[100:103], v125 offset:35904
    v_exp_f32 v58, v58
    v_exp_f32 v59, v59
    v_exp_f32 v60, v60
    v_exp_f32 v61, v61
    v_exp_f32 v62, v62
    v_exp_f32 v63, v63
    v_exp_f32 v32, v32
    v_exp_f32 v33, v33
    v_smfmac_f32_32x32x32_bf16 v[80:95], v[116:119], v[56:63], v124
    ds_read_b128 v[112:115], v126 offset:36928
    v_exp_f32 v34, v34
    v_exp_f32 v35, v35
    v_exp_f32 v36, v36
    v_mfma_f32_32x32x16_bf16 v[48:63], v[96:99], v[28:31], 0
    ds_read_b128 v[116:119], v126 offset:37472
    v_exp_f32 v37, v37
    v_exp_f32 v38, v38
    v_exp_f32 v39, v39
    v_exp_f32 v40, v40
    v_exp_f32 v41, v41
    v_smfmac_f32_32x32x32_bf16 v[64:79], v[104:107], v[32:39], v124
    buffer_load_dwordx4 a[220:223], v234, s[4:7], s64 offen offset:3072
    s_add_u32 s64, s54, 24576
    buffer_load_dwordx4 a[224:227], v234, s[4:7], s64 offen offset:0
    v_exp_f32 v42, v42
    v_exp_f32 v43, v43
    v_exp_f32 v44, v44
    v_exp_f32 v45, v45
    v_exp_f32 v46, v46
    v_exp_f32 v47, v47
    v_exp_f32 v48, v48
    v_exp_f32 v49, v49
    v_smfmac_f32_32x32x32_bf16 v[64:79], v[108:111], v[40:47], v124
    s_waitcnt lgkmcnt(0)
    v_exp_f32 v50, v50
    v_exp_f32 v51, v51
    v_exp_f32 v52, v52
    v_mfma_f32_32x32x16_bf16 v[32:47], v[100:103], v[24:27], 0
    buffer_load_dwordx4 a[228:231], v234, s[4:7], s64 offen offset:1024
    buffer_load_dwordx4 a[232:235], v234, s[4:7], s64 offen offset:2048
    v_exp_f32 v53, v53
    v_exp_f32 v54, v54
    v_exp_f32 v55, v55
    v_exp_f32 v56, v56
    v_exp_f32 v57, v57
    v_smfmac_f32_32x32x32_bf16 v[80:95], v[104:107], v[48:55], v124
    ds_read_b128 v[96:99], v125 offset:38016
    v_exp_f32 v58, v58
    v_exp_f32 v59, v59
    v_exp_f32 v60, v60
    v_exp_f32 v61, v61
    v_exp_f32 v62, v62
    v_exp_f32 v63, v63
    v_exp_f32 v32, v32
    v_exp_f32 v33, v33
    v_smfmac_f32_32x32x32_bf16 v[80:95], v[108:111], v[56:63], v124
    ds_read_b128 v[104:107], v126 offset:39040
    v_exp_f32 v34, v34
    v_exp_f32 v35, v35
    v_exp_f32 v36, v36
    v_mfma_f32_32x32x16_bf16 v[48:63], v[100:103], v[28:31], 0
    ds_read_b128 v[108:111], v126 offset:39584
    v_exp_f32 v37, v37
    v_exp_f32 v38, v38
    v_exp_f32 v39, v39
    v_exp_f32 v40, v40
    v_exp_f32 v41, v41
    v_smfmac_f32_32x32x32_bf16 v[64:79], v[112:115], v[32:39], v124
    buffer_load_dwordx4 a[236:239], v234, s[4:7], s64 offen offset:3072
    s_add_u32 s64, s54, 28672
    buffer_load_dwordx4 a[240:243], v234, s[4:7], s64 offen offset:0
    v_exp_f32 v42, v42
    v_exp_f32 v43, v43
    v_exp_f32 v44, v44
    v_exp_f32 v45, v45
    v_exp_f32 v46, v46
    v_exp_f32 v47, v47
    v_exp_f32 v48, v48
    v_exp_f32 v49, v49
    v_smfmac_f32_32x32x32_bf16 v[64:79], v[116:119], v[40:47], v124
    s_waitcnt lgkmcnt(0)
    v_exp_f32 v50, v50
    v_exp_f32 v51, v51
    v_exp_f32 v52, v52
    v_mfma_f32_32x32x16_bf16 v[32:47], v[96:99], v[24:27], 0
    buffer_load_dwordx4 a[244:247], v234, s[4:7], s64 offen offset:1024
    buffer_load_dwordx4 a[248:251], v234, s[4:7], s64 offen offset:2048
    v_exp_f32 v53, v53
    v_exp_f32 v54, v54
    v_exp_f32 v55, v55
    v_exp_f32 v56, v56
    v_exp_f32 v57, v57
    v_smfmac_f32_32x32x32_bf16 v[80:95], v[112:115], v[48:55], v124
    ds_read_b128 v[100:103], v125 offset:40128
    v_exp_f32 v58, v58
    v_exp_f32 v59, v59
    v_exp_f32 v60, v60
    v_exp_f32 v61, v61
    v_exp_f32 v62, v62
    v_exp_f32 v63, v63
    v_exp_f32 v32, v32
    v_exp_f32 v33, v33
    v_smfmac_f32_32x32x32_bf16 v[80:95], v[116:119], v[56:63], v124
    ds_read_b128 v[112:115], v126 offset:41152
    v_exp_f32 v34, v34
    v_exp_f32 v35, v35
    v_exp_f32 v36, v36
    v_mfma_f32_32x32x16_bf16 v[48:63], v[96:99], v[28:31], 0
    ds_read_b128 v[116:119], v126 offset:41696
    v_exp_f32 v37, v37
    v_exp_f32 v38, v38
    v_exp_f32 v39, v39
    v_exp_f32 v40, v40
    v_exp_f32 v41, v41
    v_smfmac_f32_32x32x32_bf16 v[64:79], v[104:107], v[32:39], v124
    buffer_load_dwordx4 a[252:255], v234, s[4:7], s64 offen offset:3072
    s_add_u32 s64, s48, 4096
    s_addc_u32 s65, s49, 0
    global_load_dwordx4 v[128:131], v2, s[64:65] offset:-4096
    s_waitcnt vmcnt(53)
    s_cmp_eq_u32 s12, 0
    s_cbranch_scc1 Lslow_44
    buffer_store_byte v5, off, s[4:7], s21 offset:2048
Lback_45:
    v_exp_f32 v42, v42
    v_exp_f32 v43, v43
    v_exp_f32 v44, v44
    v_exp_f32 v45, v45
    v_exp_f32 v46, v46
    v_exp_f32 v47, v47
    v_exp_f32 v48, v48
    v_exp_f32 v49, v49
    v_smfmac_f32_32x32x32_bf16 v[64:79], v[108:111], v[40:47], v124
    s_waitcnt lgkmcnt(0)
    v_exp_f32 v50, v50
    v_exp_f32 v51, v51
    v_exp_f32 v52, v52
    v_mfma_f32_32x32x16_bf16 v[32:47], v[100:103], v[24:27], 0
    global_load_dwordx4 v[136:139], v2, s[64:65] offset:-3072
    v_exp_f32 v53, v53
    v_exp_f32 v54, v54
    v_exp_f32 v55, v55
    v_exp_f32 v56, v56
    v_exp_f32 v57, v57
    v_smfmac_f32_32x32x32_bf16 v[80:95], v[104:107], v[48:55], v124
    ds_read_b128 v[96:99], v125 offset:42240
    v_exp_f32 v58, v58
    v_exp_f32 v59, v59
    v_exp_f32 v60, v60
    v_exp_f32 v61, v61
    v_exp_f32 v62, v62
    v_exp_f32 v63, v63
    v_exp_f32 v32, v32
    v_exp_f32 v33, v33
    v_smfmac_f32_32x32x32_bf16 v[80:95], v[108:111], v[56:63], v124
    ds_read_b128 v[104:107], v126 offset:43264
    v_exp_f32 v34, v34
    v_exp_f32 v35, v35
    v_exp_f32 v36, v36
    v_mfma_f32_32x32x16_bf16 v[48:63], v[100:103], v[28:31], 0
    ds_read_b128 v[108:111], v126 offset:43808
    v_exp_f32 v37, v37
    v_exp_f32 v38, v38
    v_exp_f32 v39, v39
    v_exp_f32 v40, v40
    v_exp_f32 v41, v41
    v_smfmac_f32_32x32x32_bf16 v[64:79], v[112:115], v[32:39], v124
    global_load_dwordx4 v[144:147], v2, s[64:65] offset:-2048
    global_load_dwordx4 v[152:155], v2, s[64:65] offset:-1024
    v_exp_f32 v42, v42
    v_exp_f32 v43, v43
    v_exp_f32 v44, v44
    v_exp_f32 v45, v45
    v_exp_f32 v46, v46
    v_exp_f32 v47, v47
    v_exp_f32 v48, v48
    v_exp_f32 v49, v49
    v_smfmac_f32_32x32x32_bf16 v[64:79], v[116:119], v[40:47], v124
    s_waitcnt lgkmcnt(0)
    v_exp_f32 v50, v50
    v_exp_f32 v51, v51
    v_exp_f32 v52, v52
    v_mfma_f32_32x32x16_bf16 v[32:47], v[96:99], v[24:27], 0
    global_load_dwordx4 v[160:163], v2, s[64:65] offset:0
    global_load_dwordx4 v[168:171], v2, s[64:65] offset:1024
    v_exp_f32 v53, v53
    v_exp_f32 v54, v54
    v_exp_f32 v55, v55
    v_exp_f32 v56, v56
    v_exp_f32 v57, v57
    v_smfmac_f32_32x32x32_bf16 v[80:95], v[112:115], v[48:55], v124
    ds_read_b128 v[100:103], v125 offset:44352
    v_exp_f32 v58, v58
    v_exp_f32 v59, v59
    v_exp_f32 v60, v60
    v_exp_f32 v61, v61
    v_exp_f32 v62, v62
    v_exp_f32 v63, v63
    v_exp_f32 v32, v32
    v_exp_f32 v33, v33
    v_smfmac_f32_32x32x32_bf16 v[80:95], v[116:119], v[56:63], v124
    ds_read_b128 v[112:115], v126 offset:45376
    v_exp_f32 v34, v34
    v_exp_f32 v35, v35
    v_exp_f32 v36, v36
    v_mfma_f32_32x32x16_bf16 v[48:63], v[96:99], v[28:31], 0
    ds_read_b128 v[116:119], v126 offset:45920
    v_exp_f32 v37, v37
    v_exp_f32 v38, v38
    v_exp_f32 v39, v39
    v_exp_f32 v40, v40
    v_exp_f32 v41, v41
    v_smfmac_f32_32x32x32_bf16 v[64:79], v[104:107], v[32:39], v124
    global_load_dwordx4 v[176:179], v2, s[64:65] offset:2048
    global_load_dwordx4 v[184:187], v2, s[64:65] offset:3072
    v_exp_f32 v42, v42
    v_exp_f32 v43, v43
    v_exp_f32 v44, v44
    v_exp_f32 v45, v45
    v_exp_f32 v46, v46
    v_exp_f32 v47, v47
    v_exp_f32 v48, v48
    v_exp_f32 v49, v49
    v_smfmac_f32_32x32x32_bf16 v[64:79], v[108:111], v[40:47], v124
    s_waitcnt lgkmcnt(0)
    v_exp_f32 v50, v50
    v_exp_f32 v51, v51
    v_exp_f32 v52, v52
    v_mfma_f32_32x32x16_bf16 v[32:47], v[100:103], v[24:27], 0
    s_add_u32 s64, s48, 12288
    s_addc_u32 s65, s49, 0
    global_load_dwordx4 v[192:195], v2, s[64:65] offset:-4096
    global_load_dwordx4 v[200:203], v2, s[64:65] offset:-3072
    v_exp_f32 v53, v53
    v_exp_f32 v54, v54
    v_exp_f32 v55, v55
    v_exp_f32 v56, v56
    v_exp_f32 v57, v57
    v_smfmac_f32_32x32x32_bf16 v[80:95], v[104:107], v[48:55], v124
    ds_read_b128 v[96:99], v125 offset:46464
    v_exp_f32 v58, v58
    v_exp_f32 v59, v59
    v_exp_f32 v60, v60
    v_exp_f32 v61, v61
    v_exp_f32 v62, v62
    v_exp_f32 v63, v63
    v_exp_f32 v32, v32
    v_exp_f32 v33, v33
    v_smfmac_f32_32x32x32_bf16 v[80:95], v[108:111], v[56:63], v124
    ds_read_b128 v[104:107], v126 offset:47488
    v_exp_f32 v34, v34
    v_exp_f32 v35, v35
    v_exp_f32 v36, v36
    v_mfma_f32_32x32x16_bf16 v[48:63], v[100:103], v[28:31], 0
    ds_read_b128 v[108:111], v126 offset:48032
    v_exp_f32 v37, v37
    v_exp_f32 v38, v38
    v_exp_f32 v39, v39
    v_exp_f32 v40, v40
    v_exp_f32 v41, v41
    v_smfmac_f32_32x32x32_bf16 v[64:79], v[112:115], v[32:39], v124
    global_load_dwordx4 v[208:211], v2, s[64:65] offset:-2048
    global_load_dwordx4 v[216:219], v2, s[64:65] offset:-1024
    v_exp_f32 v42, v42
    v_exp_f32 v43, v43
    v_exp_f32 v44, v44
    v_exp_f32 v45, v45
    v_exp_f32 v46, v46
    v_exp_f32 v47, v47
    v_exp_f32 v48, v48
    v_exp_f32 v49, v49
    v_smfmac_f32_32x32x32_bf16 v[64:79], v[116:119], v[40:47], v124
    s_waitcnt lgkmcnt(0)
    v_exp_f32 v50, v50
    v_exp_f32 v51, v51
    v_exp_f32 v52, v52
    v_mfma_f32_32x32x16_bf16 v[32:47], v[96:99], v[24:27], 0
    s_add_u32 s64, s50, 4096
    s_addc_u32 s65, s51, 0
    global_load_dwordx4 v[132:135], v2, s[64:65] offset:-4096
    v_exp_f32 v53, v53
    v_exp_f32 v54, v54
    v_exp_f32 v55, v55
    v_exp_f32 v56, v56
    v_exp_f32 v57, v57
    v_smfmac_f32_32x32x32_bf16 v[80:95], v[112:115], v[48:55], v124
    ds_read_b128 v[100:103], v125 offset:48576
    v_exp_f32 v58, v58
    v_exp_f32 v59, v59
    v_exp_f32 v60, v60
    v_exp_f32 v61, v61
    v_exp_f32 v62, v62
    v_exp_f32 v63, v63
    v_exp_f32 v32, v32
    v_exp_f32 v33, v33
    v_smfmac_f32_32x32x32_bf16 v[80:95], v[116:119], v[56:63], v124
    ds_read_b128 v[112:115], v126 offset:49600
    v_exp_f32 v34, v34
    v_exp_f32 v35, v35
    v_exp_f32 v36, v36
    v_mfma_f32_32x32x16_bf16 v[48:63], v[96:99], v[28:31], 0
    ds_read_b128 v[116:119], v126 offset:50144
    v_exp_f32 v37, v37
    v_exp_f32 v38, v38
    v_exp_f32 v39, v39
    v_exp_f32 v40, v40
    v_exp_f32 v41, v41
    v_smfmac_f32_32x32x32_bf16 v[64:79], v[104:107], v[32:39], v124
    global_load_dwordx4 v[140:143], v2, s[64:65] offset:-3072
    global_load_dwordx4 v[148:151], v2, s[64:65] offset:-2048
    v_exp_f32 v42, v42
    v_exp_f32 v43, v43
    v_exp_f32 v44, v44
    v_exp_f32 v45, v45
    v_exp_f32 v46, v46
    v_exp_f32 v47, v47
    v_exp_f32 v48, v48
    v_exp_f32 v49, v49
    v_smfmac_f32_32x32x32_bf16 v[64:79], v[108:111], v[40:47], v124
    s_waitcnt lgkmcnt(0)
    v_exp_f32 v50, v50
    v_exp_f32 v51, v51
    v_exp_f32 v52, v52
    v_mfma_f32_32x32x16_bf16 v[32:47], v[100:103], v[24:27], 0
    global_load_dwordx4 v[156:159], v2, s[64:65] offset:-1024
    global_load_dwordx4 v[164:167], v2, s[64:65] offset:0
    v_exp_f32 v53, v53
    v_exp_f32 v54, v54
    v_exp_f32 v55, v55
    v_exp_f32 v56, v56
    v_exp_f32 v57, v57
    v_smfmac_f32_32x32x32_bf16 v[80:95], v[104:107], v[48:55], v124
    ds_read_b128 v[96:99], v125 offset:50688
    v_exp_f32 v58, v58
    v_exp_f32 v59, v59
    v_exp_f32 v60, v60
    v_exp_f32 v61, v61
    v_exp_f32 v62, v62
    v_exp_f32 v63, v63
    v_exp_f32 v32, v32
    v_exp_f32 v33, v33
    v_smfmac_f32_32x32x32_bf16 v[80:95], v[108:111], v[56:63], v124
    ds_read_b128 v[104:107], v126 offset:51712
    v_exp_f32 v34, v34
    v_exp_f32 v35, v35
    v_exp_f32 v36, v36
    v_mfma_f32_32x32x16_bf16 v[48:63], v[100:103], v[28:31], 0
    ds_read_b128 v[108:111], v126 offset:52256
    v_exp_f32 v37, v37
    v_exp_f32 v38, v38
    v_exp_f32 v39, v39
    v_exp_f32 v40, v40
    v_exp_f32 v41, v41
    v_smfmac_f32_32x32x32_bf16 v[64:79], v[112:115], v[32:39], v124
    global_load_dwordx4 v[172:175], v2, s[64:65] offset:1024
    global_load_dwordx4 v[180:183], v2, s[64:65] offset:2048
    v_exp_f32 v42, v42
    v_exp_f32 v43, v43
    v_exp_f32 v44, v44
    v_exp_f32 v45, v45
    v_exp_f32 v46, v46
    v_exp_f32 v47, v47
    v_exp_f32 v48, v48
    v_exp_f32 v49, v49
    v_smfmac_f32_32x32x32_bf16 v[64:79], v[116:119], v[40:47], v124
    s_waitcnt lgkmcnt(0)
    v_exp_f32 v50, v50
    v_exp_f32 v51, v51
    v_exp_f32 v52, v52
    v_mfma_f32_32x32x16_bf16 v[32:47], v[96:99], v[24:27], 0
    global_load_dwordx4 v[188:191], v2, s[64:65] offset:3072
    s_add_u32 s64, s50, 12288
    s_addc_u32 s65, s51, 0
    global_load_dwordx4 v[196:199], v2, s[64:65] offset:-4096
    v_exp_f32 v53, v53
    v_exp_f32 v54, v54
    v_exp_f32 v55, v55
    v_exp_f32 v56, v56
    v_exp_f32 v57, v57
    v_smfmac_f32_32x32x32_bf16 v[80:95], v[112:115], v[48:55], v124
    ds_read_b128 v[100:103], v125 offset:52800
    v_exp_f32 v58, v58
    v_exp_f32 v59, v59
    v_exp_f32 v60, v60
    v_exp_f32 v61, v61
    v_exp_f32 v62, v62
    v_exp_f32 v63, v63
    v_exp_f32 v32, v32
    v_exp_f32 v33, v33
    v_smfmac_f32_32x32x32_bf16 v[80:95], v[116:119], v[56:63], v124
    ds_read_b128 v[112:115], v126 offset:53824
    v_exp_f32 v34, v34
    v_exp_f32 v35, v35
    v_exp_f32 v36, v36
    v_mfma_f32_32x32x16_bf16 v[48:63], v[96:99], v[28:31], 0
    ds_read_b128 v[116:119], v126 offset:54368
    v_exp_f32 v37, v37
    v_exp_f32 v38, v38
    v_exp_f32 v39, v39
    v_exp_f32 v40, v40
    v_exp_f32 v41, v41
    v_smfmac_f32_32x32x32_bf16 v[64:79], v[104:107], v[32:39], v124
    global_load_dwordx4 v[204:207], v2, s[64:65] offset:-3072
    global_load_dwordx4 v[212:215], v2, s[64:65] offset:-2048
    v_exp_f32 v42, v42
    v_exp_f32 v43, v43
    v_exp_f32 v44, v44
    v_exp_f32 v45, v45
    v_exp_f32 v46, v46
    v_exp_f32 v47, v47
    v_exp_f32 v48, v48
    v_exp_f32 v49, v49
    v_smfmac_f32_32x32x32_bf16 v[64:79], v[108:111], v[40:47], v124
    s_waitcnt lgkmcnt(0)
    v_exp_f32 v50, v50
    v_exp_f32 v51, v51
    v_exp_f32 v52, v52
    v_mfma_f32_32x32x16_bf16 v[32:47], v[100:103], v[24:27], 0
    global_load_dwordx4 v[220:223], v2, s[64:65] offset:-1024
    v_exp_f32 v53, v53
    v_exp_f32 v54, v54
    v_exp_f32 v55, v55
    v_exp_f32 v56, v56
    v_exp_f32 v57, v57
    v_smfmac_f32_32x32x32_bf16 v[80:95], v[104:107], v[48:55], v124
    ds_read_b128 v[96:99], v125 offset:54912
    v_exp_f32 v58, v58
    v_exp_f32 v59, v59
    v_exp_f32 v60, v60
    v_exp_f32 v61, v61
    v_exp_f32 v62, v62
    v_exp_f32 v63, v63
    v_exp_f32 v32, v32
    v_exp_f32 v33, v33
    v_smfmac_f32_32x32x32_bf16 v[80:95], v[108:111], v[56:63], v124
    ds_read_b128 v[104:107], v126 offset:55936
    v_exp_f32 v34, v34
    v_exp_f32 v35, v35
    v_exp_f32 v36, v36
    v_mfma_f32_32x32x16_bf16 v[48:63], v[100:103], v[28:31], 0
    ds_read_b128 v[108:111], v126 offset:56480
    v_exp_f32 v37, v37
    v_exp_f32 v38, v38
    v_exp_f32 v39, v39
    v_exp_f32 v40, v40
    v_exp_f32 v41, v41
    v_smfmac_f32_32x32x32_bf16 v[64:79], v[112:115], v[32:39], v124
    buffer_load_dwordx2 v[14:15], off, s[4:7], s22 offset:2048 sc1
    v_exp_f32 v42, v42
    v_exp_f32 v43, v43
    v_exp_f32 v44, v44
    v_exp_f32 v45, v45
    v_exp_f32 v46, v46
    v_exp_f32 v47, v47
    v_exp_f32 v48, v48
    v_exp_f32 v49, v49
    v_smfmac_f32_32x32x32_bf16 v[64:79], v[116:119], v[40:47], v124
    s_waitcnt lgkmcnt(0)
    v_exp_f32 v50, v50
    v_exp_f32 v51, v51
    v_exp_f32 v52, v52
    v_mfma_f32_32x32x16_bf16 v[32:47], v[96:99], v[24:27], 0
    s_mul_i32 s61, s18, 3584
    s_lshl_b32 s62, s16, 10
    s_add_u32 s61, s61, s62
    s_add_u32 s61, s61, 4760064
    v_lshrrev_b32 v127, 1, v1
    buffer_load_dwordx2 v[120:121], v127, s[4:7], s61 offen
    s_cmp_eq_u32 s16, 3
    s_cselect_b32 s62, 0, 512
    s_add_u32 s61, s61, s62
    v_add_u32 v127, s14, v127
    buffer_load_dwordx2 v[122:123], v127, s[4:7], s61 offen
    v_exp_f32 v53, v53
    v_exp_f32 v54, v54
    v_exp_f32 v55, v55
    v_exp_f32 v56, v56
    v_exp_f32 v57, v57
    v_smfmac_f32_32x32x32_bf16 v[80:95], v[112:115], v[48:55], v124
    ds_read_b128 v[100:103], v125 offset:57024
    v_exp_f32 v58, v58
    v_exp_f32 v59, v59
    v_exp_f32 v60, v60
    v_exp_f32 v61, v61
    v_exp_f32 v62, v62
    v_exp_f32 v63, v63
    v_exp_f32 v32, v32
    v_exp_f32 v33, v33
    v_smfmac_f32_32x32x32_bf16 v[80:95], v[116:119], v[56:63], v124
    ds_read_b128 v[112:115], v126 offset:58048
    v_exp_f32 v34, v34
    v_exp_f32 v35, v35
    v_exp_f32 v36, v36
    v_mfma_f32_32x32x16_bf16 v[48:63], v[96:99], v[28:31], 0
    ds_read_b128 v[116:119], v126 offset:58592
    v_exp_f32 v37, v37
    v_exp_f32 v38, v38
    v_exp_f32 v39, v39
    v_exp_f32 v40, v40
    v_exp_f32 v41, v41
    v_smfmac_f32_32x32x32_bf16 v[64:79], v[104:107], v[32:39], v124
    s_getpc_b64 s[68:69]
Lpc_43:
    s_lshr_b32 s61, s2, 3
    s_lshl_b32 s61, s61, 2
    s_add_u32 s61, s61, s16
    s_lshl_b32 s61, s61, 8
    s_add_u32 s61, s61, 2048
    s_min_u32 s61, s61, Lend_1-Lpc_43-256
    s_add_u32 s68, s68, s61
    s_addc_u32 s69, s69, 0
    global_load_dword v230, v3, s[68:69]
    v_exp_f32 v42, v42
    v_exp_f32 v43, v43
    v_exp_f32 v44, v44
    v_exp_f32 v45, v45
    v_exp_f32 v46, v46
    v_exp_f32 v47, v47
    v_exp_f32 v48, v48
    v_exp_f32 v49, v49
    v_smfmac_f32_32x32x32_bf16 v[64:79], v[108:111], v[40:47], v124
    s_waitcnt lgkmcnt(0)
    v_exp_f32 v50, v50
    v_exp_f32 v51, v51
    v_exp_f32 v52, v52
    v_mfma_f32_32x32x16_bf16 v[32:47], v[100:103], v[24:27], 0
    v_exp_f32 v53, v53
    v_exp_f32 v54, v54
    v_exp_f32 v55, v55
    v_exp_f32 v56, v56
    v_exp_f32 v57, v57
    v_smfmac_f32_32x32x32_bf16 v[80:95], v[104:107], v[48:55], v124
    ds_read_b128 v[96:99], v125 offset:59136
    v_exp_f32 v58, v58
    v_exp_f32 v59, v59
    v_exp_f32 v60, v60
    v_exp_f32 v61, v61
    v_exp_f32 v62, v62
    v_exp_f32 v63, v63
    v_exp_f32 v32, v32
    v_exp_f32 v33, v33
    v_smfmac_f32_32x32x32_bf16 v[80:95], v[108:111], v[56:63], v124
    ds_read_b128 v[104:107], v126 offset:60160
    v_exp_f32 v34, v34
    v_exp_f32 v35, v35
    v_exp_f32 v36, v36
    v_mfma_f32_32x32x16_bf16 v[48:63], v[100:103], v[28:31], 0
    ds_read_b128 v[108:111], v126 offset:60704
    v_exp_f32 v37, v37
    v_exp_f32 v38, v38
    v_exp_f32 v39, v39
    v_exp_f32 v40, v40
    v_exp_f32 v41, v41
    v_smfmac_f32_32x32x32_bf16 v[64:79], v[112:115], v[32:39], v124
    v_exp_f32 v42, v42
    v_exp_f32 v43, v43
    v_exp_f32 v44, v44
    v_exp_f32 v45, v45
    v_exp_f32 v46, v46
    v_exp_f32 v47, v47
    v_exp_f32 v48, v48
    v_exp_f32 v49, v49
    v_smfmac_f32_32x32x32_bf16 v[64:79], v[116:119], v[40:47], v124
    s_waitcnt lgkmcnt(0)
    v_exp_f32 v50, v50
    v_exp_f32 v51, v51
    v_exp_f32 v52, v52
    v_mfma_f32_32x32x16_bf16 v[32:47], v[96:99], v[24:27], 0
    v_exp_f32 v53, v53
    v_exp_f32 v54, v54
    v_exp_f32 v55, v55
    v_exp_f32 v56, v56
    v_exp_f32 v57, v57
    v_smfmac_f32_32x32x32_bf16 v[80:95], v[112:115], v[48:55], v124
    ds_read_b128 v[100:103], v125 offset:61248
    v_exp_f32 v58, v58
    v_exp_f32 v59, v59
    v_exp_f32 v60, v60
    v_exp_f32 v61, v61
    v_exp_f32 v62, v62
    v_exp_f32 v63, v63
    v_exp_f32 v32, v32
    v_exp_f32 v33, v33
    v_smfmac_f32_32x32x32_bf16 v[80:95], v[116:119], v[56:63], v124
    ds_read_b128 v[112:115], v126 offset:62272
    v_exp_f32 v34, v34
    v_exp_f32 v35, v35
    v_exp_f32 v36, v36
    v_mfma_f32_32x32x16_bf16 v[48:63], v[96:99], v[28:31], 0
    ds_read_b128 v[116:119], v126 offset:62816
    v_exp_f32 v37, v37
    v_exp_f32 v38, v38
    v_exp_f32 v39, v39
    v_exp_f32 v40, v40
    v_exp_f32 v41, v41
    v_smfmac_f32_32x32x32_bf16 v[64:79], v[104:107], v[32:39], v124
    v_exp_f32 v42, v42
    v_exp_f32 v43, v43
    v_exp_f32 v44, v44
    v_exp_f32 v45, v45
    v_exp_f32 v46, v46
    v_exp_f32 v47, v47
    v_exp_f32 v48, v48
    v_exp_f32 v49, v49
    v_smfmac_f32_32x32x32_bf16 v[64:79], v[108:111], v[40:47], v124
    s_waitcnt lgkmcnt(0)
    v_exp_f32 v50, v50
    v_exp_f32 v51, v51
    v_exp_f32 v52, v52
    v_mfma_f32_32x32x16_bf16 v[32:47], v[100:103], v[24:27], 0
    v_exp_f32 v53, v53
    v_exp_f32 v54, v54
    v_exp_f32 v55, v55
    v_exp_f32 v56, v56
    v_exp_f32 v57, v57
    v_smfmac_f32_32x32x32_bf16 v[80:95], v[104:107], v[48:55], v124
    ds_read_b128 v[96:99], v125 offset:63360
    v_exp_f32 v58, v58
    v_exp_f32 v59, v59
    v_exp_f32 v60, v60
    v_exp_f32 v61, v61
    v_exp_f32 v62, v62
    v_exp_f32 v63, v63
    v_exp_f32 v32, v32
    v_exp_f32 v33, v33
    v_smfmac_f32_32x32x32_bf16 v[80:95], v[108:111], v[56:63], v124
    ds_read_b128 v[104:107], v126 offset:64384
    v_exp_f32 v34, v34
    v_exp_f32 v35, v35
    v_exp_f32 v36, v36
    v_mfma_f32_32x32x16_bf16 v[48:63], v[100:103], v[28:31], 0
    ds_read_b128 v[108:111], v126 offset:64928
    v_exp_f32 v37, v37
    v_exp_f32 v38, v38
    v_exp_f32 v39, v39
    v_exp_f32 v40, v40
    v_exp_f32 v41, v41
    v_smfmac_f32_32x32x32_bf16 v[64:79], v[112:115], v[32:39], v124
    v_exp_f32 v42, v42
    v_exp_f32 v43, v43
    v_exp_f32 v44, v44
    v_exp_f32 v45, v45
    v_exp_f32 v46, v46
    v_exp_f32 v47, v47
    v_exp_f32 v48, v48
    v_exp_f32 v49, v49
    v_smfmac_f32_32x32x32_bf16 v[64:79], v[116:119], v[40:47], v124
    s_waitcnt lgkmcnt(0)
    v_exp_f32 v50, v50
    v_exp_f32 v51, v51
    v_exp_f32 v52, v52
    v_mfma_f32_32x32x16_bf16 v[32:47], v[96:99], v[24:27], 0
    v_exp_f32 v53, v53
    v_exp_f32 v54, v54
    v_exp_f32 v55, v55
    v_exp_f32 v56, v56
    v_exp_f32 v57, v57
    v_smfmac_f32_32x32x32_bf16 v[80:95], v[112:115], v[48:55], v124
    ds_read_b128 v[100:103], v125 offset:65472
    v_exp_f32 v58, v58
    v_exp_f32 v59, v59
    v_exp_f32 v60, v60
    v_exp_f32 v61, v61
    v_exp_f32 v62, v62
    v_exp_f32 v63, v63
    v_exp_f32 v32, v32
    v_exp_f32 v33, v33
    v_smfmac_f32_32x32x32_bf16 v[80:95], v[116:119], v[56:63], v124
    v_add_u32 v126, 0xffc0, v126
    ds_read_b128 v[112:115], v126 offset:1024
    v_exp_f32 v34, v34
    v_exp_f32 v35, v35
    v_exp_f32 v36, v36
    v_mfma_f32_32x32x16_bf16 v[48:63], v[96:99], v[28:31], 0
    ds_read_b128 v[116:119], v126 offset:1568
    v_exp_f32 v37, v37
    v_exp_f32 v38, v38
    v_exp_f32 v39, v39
    v_exp_f32 v40, v40
    v_exp_f32 v41, v41
    v_smfmac_f32_32x32x32_bf16 v[64:79], v[104:107], v[32:39], v124
    s_waitcnt vmcnt(3)
    v_and_b32 v14, v14, v15
    s_nop 0
    v_readfirstlane_b32 s60, v14
    s_nop 0
    s_cmp_eq_u32 s60, 0x01010101
    s_cbranch_scc0 Lretry_46
Lback_47:
    v_exp_f32 v42, v42
    v_exp_f32 v43, v43
    v_exp_f32 v44, v44
    v_exp_f32 v45, v45
    v_exp_f32 v46, v46
    v_exp_f32 v47, v47
    v_exp_f32 v48, v48
    v_exp_f32 v49, v49
    v_smfmac_f32_32x32x32_bf16 v[64:79], v[108:111], v[40:47], v124
    s_waitcnt lgkmcnt(0)
    v_exp_f32 v50, v50
    v_exp_f32 v51, v51
    v_exp_f32 v52, v52
    v_mfma_f32_32x32x16_bf16 v[32:47], v[100:103], v[24:27], 0
    v_exp_f32 v53, v53
    v_exp_f32 v54, v54
    v_exp_f32 v55, v55
    v_exp_f32 v56, v56
    v_exp_f32 v57, v57
    v_smfmac_f32_32x32x32_bf16 v[80:95], v[104:107], v[48:55], v124
    ds_read_b128 v[96:99], v125 offset:0
    v_exp_f32 v58, v58
    v_exp_f32 v59, v59
    v_exp_f32 v60, v60
    v_exp_f32 v61, v61
    v_exp_f32 v62, v62
    v_exp_f32 v63, v63
    v_exp_f32 v32, v32
    v_exp_f32 v33, v33
    v_smfmac_f32_32x32x32_bf16 v[80:95], v[108:111], v[56:63], v124
    v_add_u32 v126, 0xffff0040, v126
    ds_read_b128 v[104:107], v126 offset:1024
    v_exp_f32 v34, v34
    v_exp_f32 v35, v35
    v_exp_f32 v36, v36
    v_mfma_f32_32x32x16_bf16 v[48:63], v[100:103], v[28:31], 0
    ds_read_b128 v[108:111], v126 offset:1568
    v_exp_f32 v37, v37
    v_exp_f32 v38, v38
    v_exp_f32 v39, v39
    v_exp_f32 v40, v40
    v_exp_f32 v41, v41
    v_smfmac_f32_32x32x32_bf16 v[64:79], v[112:115], v[32:39], v124
    v_exp_f32 v42, v42
    v_exp_f32 v43, v43
    v_exp_f32 v44, v44
    v_exp_f32 v45, v45
    v_exp_f32 v46, v46
    v_exp_f32 v47, v47
    v_exp_f32 v48, v48
    v_exp_f32 v49, v49
    v_smfmac_f32_32x32x32_bf16 v[64:79], v[116:119], v[40:47], v124
    s_waitcnt lgkmcnt(0)
    v_exp_f32 v50, v50
    v_exp_f32 v51, v51
    v_exp_f32 v52, v52
    v_mfma_f32_32x32x16_bf16 v[32:47], v[96:99], v[28:31], 0
    v_exp_f32 v53, v53
    v_exp_f32 v54, v54
    v_exp_f32 v55, v55
    v_exp_f32 v56, v56
    v_exp_f32 v57, v57
    v_smfmac_f32_32x32x32_bf16 v[80:95], v[112:115], v[48:55], v124
    ds_read_b128 v[100:103], v125 offset:2112
    v_rcp_f32 v74, v72
    v_subrev_u32 v73, 0x21800000, v72
    v_mul_f32 v64, v74, v64
    v_mul_f32 v65, v74, v65
    v_mul_f32 v66, v74, v66
    v_mul_f32 v67, v74, v67
    v_mul_f32 v68, v74, v68
    v_mul_f32 v69, v74, v69
    v_mul_f32 v70, v74, v70
    v_mul_f32 v71, v74, v71
    v_cmp_lt_u32 vcc, 0x50000000, v73
    v_add_f32 v76, v64, v68
    v_add_f32 v77, v65, v69
    v_add_f32 v78, v66, v70
    v_add_f32 v79, v67, v71
    v_add_f32 v76, v76, v77
    v_add_f32 v78, v78, v79
    s_mov_b32 s61, 0x207
    v_add_f32 v76, v76, v78
    v_cmp_class_f32 s[68:69], v76, s61
    s_add_u32 s61, s20, 0
    s_or_b64 vcc, vcc, s[68:69]
    s_cbranch_vccnz Lfb_48
Lfbback_49:
    v_cvt_pk_bf16_f32 v76, v64, v65
    v_cvt_pk_bf16_f32 v77, v66, v67
    v_cvt_pk_bf16_f32 v78, v68, v69
    v_cvt_pk_bf16_f32 v79, v70, v71
    s_cmp_eq_u32 s12, 0
    s_cbranch_scc1 Lslow_52
    buffer_store_dwordx4 v[76:79], v1, s[4:7], s61 offen
Lback_53:
    v_exp_f32 v58, v58
    v_exp_f32 v59, v59
    v_exp_f32 v60, v60
    v_exp_f32 v61, v61
    v_exp_f32 v62, v62
    v_exp_f32 v63, v63
    v_exp_f32 v32, v32
    v_exp_f32 v33, v33
    v_smfmac_f32_32x32x32_bf16 v[80:95], v[116:119], v[56:63], v124
    s_waitcnt lgkmcnt(0)
    ds_read_b128 v[112:115], v126 offset:3136
    v_exp_f32 v34, v34
    v_exp_f32 v35, v35
    v_exp_f32 v36, v36
    v_mfma_f32_32x32x16_bf16 v[48:63], v[100:103], v[28:31], 0
    ds_read_b128 v[116:119], v126 offset:3680
    v_exp_f32 v37, v37
    v_exp_f32 v38, v38
    v_exp_f32 v39, v39
    v_exp_f32 v40, v40
    v_exp_f32 v41, v41
    v_smfmac_f32_32x32x32_bf16 v[80:95], v[104:107], v[32:39], v124
    ds_read_b128 v[96:99], v125 offset:4224
    v_exp_f32 v42, v42
    v_exp_f32 v43, v43
    v_exp_f32 v44, v44
    v_exp_f32 v45, v45
    v_exp_f32 v46, v46
    v_exp_f32 v47, v47
    v_exp_f32 v48, v48
    v_exp_f32 v49, v49
    v_smfmac_f32_32x32x32_bf16 v[80:95], v[108:111], v[40:47], v124
    s_waitcnt lgkmcnt(0)
    ds_read_b128 v[104:107], v126 offset:5248
    v_exp_f32 v50, v50
    v_exp_f32 v51, v51
    v_exp_f32 v52, v52
    v_mfma_f32_32x32x16_bf16 v[32:47], v[96:99], v[28:31], 0
    ds_read_b128 v[108:111], v126 offset:5792
    v_exp_f32 v53, v53
    v_exp_f32 v54, v54
    v_exp_f32 v55, v55
    v_exp_f32 v56, v56
    v_exp_f32 v57, v57
    v_smfmac_f32_32x32x32_bf16 v[80:95], v[112:115], v[48:55], v124
    ds_read_b128 v[100:103], v125 offset:6336
    v_exp_f32 v58, v58
    v_exp_f32 v59, v59
    v_exp_f32 v60, v60
    v_exp_f32 v61, v61
    v_exp_f32 v62, v62
    v_exp_f32 v63, v63
    v_exp_f32 v32, v32
    v_exp_f32 v33, v33
    v_smfmac_f32_32x32x32_bf16 v[80:95], v[116:119], v[56:63], v124
    s_waitcnt lgkmcnt(0)
    ds_read_b128 v[112:115], v126 offset:7360
    v_exp_f32 v34, v34
    v_exp_f32 v35, v35
    v_exp_f32 v36, v36
    v_mfma_f32_32x32x16_bf16 v[48:63], v[100:103], v[28:31], 0
    ds_read_b128 v[116:119], v126 offset:7904
    v_exp_f32 v37, v37
    v_exp_f32 v38, v38
    v_exp_f32 v39, v39
    v_exp_f32 v40, v40
    v_exp_f32 v41, v41
    v_smfmac_f32_32x32x32_bf16 v[80:95], v[104:107], v[32:39], v124
    ds_read_b128 v[96:99], v125 offset:8448
    v_exp_f32 v42, v42
    v_exp_f32 v43, v43
    v_exp_f32 v44, v44
    v_exp_f32 v45, v45
    v_exp_f32 v46, v46
    v_exp_f32 v47, v47
    v_exp_f32 v48, v48
    v_exp_f32 v49, v49
    v_smfmac_f32_32x32x32_bf16 v[80:95], v[108:111], v[40:47], v124
    s_waitcnt lgkmcnt(0)
    ds_read_b128 v[104:107], v126 offset:9472
    v_exp_f32 v50, v50
    v_exp_f32 v51, v51
    v_exp_f32 v52, v52
    v_mfma_f32_32x32x16_bf16 v[32:47], v[96:99], v[28:31], 0
    ds_read_b128 v[108:111], v126 offset:10016
    v_exp_f32 v53, v53
    v_exp_f32 v54, v54
    v_exp_f32 v55, v55
    v_exp_f32 v56, v56
    v_exp_f32 v57, v57
    v_smfmac_f32_32x32x32_bf16 v[80:95], v[112:115], v[48:55], v124
    ds_read_b128 v[100:103], v125 offset:10560
    s_waitcnt vmcnt(0)
    s_cmp_eq_u32 s12, 0
    s_cbranch_scc1 Lslow_54
    buffer_store_byte v5, off, s[4:7], s21 offset:0
Lback_55:
    v_exp_f32 v58, v58
    v_exp_f32 v59, v59
    v_exp_f32 v60, v60
    v_exp_f32 v61, v61
    v_exp_f32 v62, v62
    v_exp_f32 v63, v63
    v_exp_f32 v32, v32
    v_exp_f32 v33, v33
    v_smfmac_f32_32x32x32_bf16 v[80:95], v[116:119], v[56:63], v124
    s_waitcnt lgkmcnt(0)
    ds_read_b128 v[112:115], v126 offset:11584
    v_exp_f32 v34, v34
    v_exp_f32 v35, v35
    v_exp_f32 v36, v36
    v_mfma_f32_32x32x16_bf16 v[48:63], v[100:103], v[28:31], 0
    ds_read_b128 v[116:119], v126 offset:12128
    v_exp_f32 v37, v37
    v_exp_f32 v38, v38
    v_exp_f32 v39, v39
    v_exp_f32 v40, v40
    v_exp_f32 v41, v41
    v_smfmac_f32_32x32x32_bf16 v[80:95], v[104:107], v[32:39], v124
    s_cmp_eq_u32 s12, 0
    s_cbranch_scc1 Lgate_56
Lback_57:
    s_add_u32 s64, s38, 4096
    s_addc_u32 s65, s39, 0
    global_load_dwordx4 v[224:227], v1, s[64:65] offset:-4096 sc1
    global_load_dwordx4 v[228:231], v1, s[64:65] offset:-3072 sc1
    v_exp_f32 v42, v42
    v_exp_f32 v43, v43
    v_exp_f32 v44, v44
    v_exp_f32 v45, v45
    v_exp_f32 v46, v46
    v_exp_f32 v47, v47
    v_exp_f32 v48, v48
    v_exp_f32 v49, v49
    v_smfmac_f32_32x32x32_bf16 v[80:95], v[108:111], v[40:47], v124
    global_load_dwordx4 v[232:235], v1, s[64:65] offset:-2048 sc1
    global_load_dwordx4 v[236:239], v1, s[64:65] offset:-1024 sc1
    v_exp_f32 v50, v50
    v_exp_f32 v51, v51
    v_exp_f32 v52, v52
    global_load_dwordx4 v[240:243], v1, s[64:65] offset:0 sc1
    global_load_dwordx4 v[244:247], v1, s[64:65] offset:1024 sc1
    v_exp_f32 v53, v53
    v_exp_f32 v54, v54
    v_exp_f32 v55, v55
    v_exp_f32 v56, v56
    v_exp_f32 v57, v57
    s_waitcnt lgkmcnt(1)
    v_smfmac_f32_32x32x32_bf16 v[80:95], v[112:115], v[48:55], v124
    global_load_dwordx4 v[248:251], v1, s[64:65] offset:2048 sc1
    global_load_dwordx4 v[252:255], v1, s[64:65] offset:3072 sc1
    v_exp_f32 v58, v58
    v_exp_f32 v59, v59
    v_exp_f32 v60, v60
    v_exp_f32 v61, v61
    v_exp_f32 v62, v62
    v_exp_f32 v63, v63
    s_add_u32 s61, s30, 67584
    v_add_u32 v6, s61, v1
    s_waitcnt lgkmcnt(0)
    v_smfmac_f32_32x32x32_bf16 v[80:95], v[116:119], v[56:63], v124
    ds_read_b128 v[96:99], v6 offset:8192
    ds_read_b128 v[100:103], v6 offset:9216
    ds_read_b128 v[104:107], v6 offset:10240
    ds_read_b128 v[108:111], v6 offset:11264
    ds_read_b128 v[112:115], v6 offset:12288
    ds_read_b128 v[116:119], v6 offset:13312
    s_nop 5
    v_rcp_f32 v90, v88
    v_subrev_u32 v89, 0x21800000, v88
    v_mul_f32 v80, v90, v80
    v_mul_f32 v81, v90, v81
    v_mul_f32 v82, v90, v82
    v_mul_f32 v83, v90, v83
    v_mul_f32 v84, v90, v84
    v_mul_f32 v85, v90, v85
    v_mul_f32 v86, v90, v86
    v_mul_f32 v87, v90, v87
    v_cmp_lt_u32 vcc, 0x50000000, v89
    v_add_f32 v92, v80, v84
    v_add_f32 v93, v81, v85
    v_add_f32 v94, v82, v86
    v_add_f32 v95, v83, v87
    v_add_f32 v92, v92, v93
    v_add_f32 v94, v94, v95
    s_mov_b32 s61, 0x207
    v_add_f32 v92, v92, v94
    v_cmp_class_f32 s[68:69], v92, s61
    s_add_u32 s61, s20, 32768
    s_or_b64 vcc, vcc, s[68:69]
    s_cbranch_vccnz Lfb_61
Lfbback_62:
    v_cvt_pk_bf16_f32 v92, v80, v81
    v_cvt_pk_bf16_f32 v93, v82, v83
    v_cvt_pk_bf16_f32 v94, v84, v85
    v_cvt_pk_bf16_f32 v95, v86, v87
    s_cmp_eq_u32 s12, 0
    s_cbranch_scc1 Lslow_65
    buffer_store_dwordx4 v[92:95], v1, s[4:7], s61 offen
Lback_66:
Lopst_67:
    s_waitcnt vmcnt(8)
    s_waitcnt lgkmcnt(5)
    v_mfma_f32_32x32x16_bf16 v[48:63], v[96:99], v[224:227], 0
    ds_read_b128 v[96:99], v6 offset:14336
    v_lshlrev_b32 v32, 16, v16
    v_and_b32 v33, 0xffff0000, v16
    v_lshlrev_b32 v34, 16, v17
    s_waitcnt vmcnt(7)
    s_waitcnt lgkmcnt(5)
    v_mfma_f32_32x32x16_bf16 v[48:63], v[100:103], v[228:231], v[48:63]
    ds_read_b128 v[100:103], v6 offset:15360
    v_and_b32 v35, 0xffff0000, v17
    v_lshlrev_b32 v36, 16, v18
    v_and_b32 v37, 0xffff0000, v18
    s_waitcnt vmcnt(6)
    s_waitcnt lgkmcnt(5)
    v_mfma_f32_32x32x16_bf16 v[48:63], v[104:107], v[232:235], v[48:63]
    ds_read_b128 v[104:107], v6 offset:0
    v_lshlrev_b32 v38, 16, v19
    v_and_b32 v39, 0xffff0000, v19
    v_mov_b32 v40, 0
    s_waitcnt vmcnt(5)
    s_waitcnt lgkmcnt(5)
    v_mfma_f32_32x32x16_bf16 v[48:63], v[108:111], v[236:239], v[48:63]
    ds_read_b128 v[108:111], v6 offset:1024
    v_mov_b32 v41, 0
    v_mov_b32 v42, 0
    v_mov_b32 v43, 0
    s_waitcnt vmcnt(4)
    s_waitcnt lgkmcnt(5)
    v_mfma_f32_32x32x16_bf16 v[48:63], v[112:115], v[240:243], v[48:63]
    ds_read_b128 v[112:115], v6 offset:2048
    v_mov_b32 v44, 0
    v_mov_b32 v45, 0
    v_mov_b32 v46, 0
    s_waitcnt vmcnt(3)
    s_waitcnt lgkmcnt(5)
    v_mfma_f32_32x32x16_bf16 v[48:63], v[116:119], v[244:247], v[48:63]
    ds_read_b128 v[116:119], v6 offset:3072
    v_mov_b32 v47, 0
    v_add_u32 v124, s26, v1
    v_add_u32 v125, s27, v1
    s_waitcnt vmcnt(2)
    s_waitcnt lgkmcnt(5)
    v_mfma_f32_32x32x16_bf16 v[48:63], v[96:99], v[248:251], v[48:63]
    ds_read_b128 v[96:99], v6 offset:4096
    v_add_u32 v126, s28, v1
    v_add_u32 v127, s29, v1
    s_waitcnt vmcnt(1)
    s_waitcnt lgkmcnt(5)
    v_mfma_f32_32x32x16_bf16 v[48:63], v[100:103], v[252:255], v[48:63]
    ds_read_b128 v[100:103], v6 offset:5120
    s_waitcnt lgkmcnt(5)
    v_mfma_f32_32x32x16_bf16 v[32:47], v[104:107], v[224:227], v[32:47]
    ds_read_b128 v[104:107], v6 offset:6144
    s_waitcnt lgkmcnt(5)
    v_mfma_f32_32x32x16_bf16 v[32:47], v[108:111], v[228:231], v[32:47]
    ds_read_b128 v[108:111], v6 offset:7168
    s_waitcnt lgkmcnt(5)
    v_mfma_f32_32x32x16_bf16 v[32:47], v[112:115], v[232:235], v[32:47]
    s_nop 2
    v_cmp_u_f32 vcc, v48, v48
    s_waitcnt lgkmcnt(4)
    v_mfma_f32_32x32x16_bf16 v[32:47], v[116:119], v[236:239], v[32:47]
    s_nop 2
    s_cbranch_vccnz Lredo_68
Lback_69:
    s_waitcnt lgkmcnt(3)
    v_mfma_f32_32x32x16_bf16 v[32:47], v[96:99], v[240:243], v[32:47]
    ds_write_b128 v124, v[48:51] offset:2048
    s_waitcnt lgkmcnt(3)
    v_mfma_f32_32x32x16_bf16 v[32:47], v[100:103], v[244:247], v[32:47]
    ds_write_b128 v124, v[52:55] offset:3072
    s_waitcnt lgkmcnt(3)
    v_mfma_f32_32x32x16_bf16 v[32:47], v[104:107], v[248:251], v[32:47]
    ds_write_b128 v124, v[56:59] offset:4096
    s_waitcnt lgkmcnt(3)
    v_mfma_f32_32x32x16_bf16 v[32:47], v[108:111], v[252:255], v[32:47]
    ds_write_b128 v124, v[60:63] offset:5120
    s_waitcnt vmcnt(0)
    s_cmp_eq_u32 s12, 0
    s_cbranch_scc1 Lslow_73
    buffer_store_byte v5, off, s[4:7], s21 offset:128
Lback_74:
    s_cmp_eq_u32 s12, 0
    s_cbranch_scc1 Lgate_75
Lback_76:
    s_add_u32 s64, s38, 36864
    s_addc_u32 s65, s39, 0
    global_load_dwordx4 v[224:227], v1, s[64:65] offset:-4096 sc1
    global_load_dwordx4 v[228:231], v1, s[64:65] offset:-3072 sc1
    global_load_dwordx4 v[232:235], v1, s[64:65] offset:-2048 sc1
    ds_write_b128 v124, v[40:43] offset:0
    ds_write_b128 v124, v[44:47] offset:1024
    s_waitcnt lgkmcnt(0)
    s_barrier
    ds_read_b128 v[104:107], v126 offset:2048
    ds_read_b128 v[108:111], v126 offset:3072
    ds_read_b128 v[112:115], v127 offset:4096
    ds_read_b128 v[116:119], v127 offset:5120
    ds_read_b128 v[96:99], v125 offset:0
    ds_read_b128 v[100:103], v125 offset:1024
    global_load_dwordx4 v[236:239], v1, s[64:65] offset:-1024 sc1
    global_load_dwordx4 v[240:243], v1, s[64:65] offset:0 sc1
    s_waitcnt lgkmcnt(5)
    v_pk_add_f32 v[32:33], v[32:33], v[104:105]
    v_pk_add_f32 v[34:35], v[34:35], v[106:107]
    global_load_dwordx4 v[244:247], v1, s[64:65] offset:1024 sc1
    s_waitcnt lgkmcnt(4)
    v_pk_add_f32 v[36:37], v[36:37], v[108:109]
    v_pk_add_f32 v[38:39], v[38:39], v[110:111]
    s_waitcnt lgkmcnt(3)
    v_pk_add_f32 v[32:33], v[32:33], v[112:113]
    v_pk_add_f32 v[34:35], v[34:35], v[114:115]
    s_waitcnt lgkmcnt(2)
    v_pk_add_f32 v[36:37], v[36:37], v[116:117]
    v_pk_add_f32 v[38:39], v[38:39], v[118:119]
    s_waitcnt lgkmcnt(1)
    v_pk_add_f32 v[32:33], v[32:33], v[96:97]
    v_pk_add_f32 v[34:35], v[34:35], v[98:99]
    global_load_dwordx4 v[248:251], v1, s[64:65] offset:2048 sc1
    s_waitcnt lgkmcnt(0)
    v_pk_add_f32 v[36:37], v[36:37], v[100:101]
    v_pk_add_f32 v[38:39], v[38:39], v[102:103]
    ds_read_b128 v[96:99], v6 offset:8192
    ds_read_b128 v[100:103], v6 offset:9216
    ds_read_b128 v[104:107], v6 offset:10240
    ds_read_b128 v[108:111], v6 offset:11264
    ds_read_b128 v[112:115], v6 offset:12288
    ds_read_b128 v[116:119], v6 offset:13312
    s_add_u32 s61, s20, 65536
    s_add_u32 s62, s23, 425984
    v_cvt_pk_bf16_f32 v16, v32, v33
    v_cvt_pk_bf16_f32 v17, v34, v35
    global_load_dwordx4 v[252:255], v1, s[64:65] offset:3072 sc1
    v_cvt_pk_bf16_f32 v18, v36, v37
    v_cvt_pk_bf16_f32 v19, v38, v39
    v_dot2_f32_bf16 v40, v16, v4, 0
    v_dot2_f32_bf16 v41, v16, v16, 0
    v_dot2_f32_bf16 v40, v17, v4, v40
    v_dot2_f32_bf16 v41, v17, v17, v41
    v_dot2_f32_bf16 v40, v18, v4, v40
    v_dot2_f32_bf16 v41, v18, v18, v41
    v_dot2_f32_bf16 v40, v19, v4, v40
    v_dot2_f32_bf16 v41, v19, v19, v41
    s_nop 2
    v_permlane32_swap_b32 v40, v41
    v_add_f32 v40, v40, v41
    s_cmp_eq_u32 s12, 0
    s_cbranch_scc1 Lslow_80
    buffer_store_dwordx4 v[16:19], v1, s[4:7], s61 offen
    buffer_store_dword v40, v1, s[4:7], s62 offen
Lback_81:
Lopst_82:
    s_waitcnt vmcnt(9)
    s_waitcnt lgkmcnt(5)
    v_mfma_f32_32x32x16_bf16 v[80:95], v[96:99], v[224:227], 0
    ds_read_b128 v[96:99], v6 offset:14336
    v_lshlrev_b32 v64, 16, v20
    v_and_b32 v65, 0xffff0000, v20
    v_lshlrev_b32 v66, 16, v21
    s_waitcnt vmcnt(8)
    s_waitcnt lgkmcnt(5)
    v_mfma_f32_32x32x16_bf16 v[80:95], v[100:103], v[228:231], v[80:95]
    ds_read_b128 v[100:103], v6 offset:15360
    v_and_b32 v67, 0xffff0000, v21
    v_lshlrev_b32 v68, 16, v22
    v_and_b32 v69, 0xffff0000, v22
    s_waitcnt vmcnt(7)
    s_waitcnt lgkmcnt(5)
    v_mfma_f32_32x32x16_bf16 v[80:95], v[104:107], v[232:235], v[80:95]
    ds_read_b128 v[104:107], v6 offset:0
    v_lshlrev_b32 v70, 16, v23
    v_and_b32 v71, 0xffff0000, v23
    v_mov_b32 v72, 0
    s_waitcnt vmcnt(6)
    s_waitcnt lgkmcnt(5)
    v_mfma_f32_32x32x16_bf16 v[80:95], v[108:111], v[236:239], v[80:95]
    ds_read_b128 v[108:111], v6 offset:1024
    v_mov_b32 v73, 0
    v_mov_b32 v74, 0
    v_mov_b32 v75, 0
    s_waitcnt vmcnt(5)
    s_waitcnt lgkmcnt(5)
    v_mfma_f32_32x32x16_bf16 v[80:95], v[112:115], v[240:243], v[80:95]
    ds_read_b128 v[112:115], v6 offset:2048
    v_mov_b32 v76, 0
    v_mov_b32 v77, 0
    v_mov_b32 v78, 0
    s_waitcnt vmcnt(4)
    s_waitcnt lgkmcnt(5)
    v_mfma_f32_32x32x16_bf16 v[80:95], v[116:119], v[244:247], v[80:95]
    ds_read_b128 v[116:119], v6 offset:3072
    v_mov_b32 v79, 0
    s_add_u32 s61, s30, 67584
    v_add_u32 v124, s61, v1
    s_add_u32 s61, s31, 67584
    v_add_u32 v125, s61, v1
    s_waitcnt vmcnt(3)
    s_waitcnt lgkmcnt(5)
    v_mfma_f32_32x32x16_bf16 v[80:95], v[96:99], v[248:251], v[80:95]
    ds_read_b128 v[96:99], v6 offset:4096
    s_add_u32 s61, s32, 67584
    v_add_u32 v126, s61, v1
    s_add_u32 s61, s33, 67584
    v_add_u32 v127, s61, v1
    s_waitcnt vmcnt(2)
    s_waitcnt lgkmcnt(5)
    v_mfma_f32_32x32x16_bf16 v[80:95], v[100:103], v[252:255], v[80:95]
    ds_read_b128 v[100:103], v6 offset:5120
    s_waitcnt lgkmcnt(5)
    v_mfma_f32_32x32x16_bf16 v[64:79], v[104:107], v[224:227], v[64:79]
    ds_read_b128 v[104:107], v6 offset:6144
    s_waitcnt lgkmcnt(5)
    v_mfma_f32_32x32x16_bf16 v[64:79], v[108:111], v[228:231], v[64:79]
    ds_read_b128 v[108:111], v6 offset:7168
    s_waitcnt lgkmcnt(5)
    v_mfma_f32_32x32x16_bf16 v[64:79], v[112:115], v[232:235], v[64:79]
    s_nop 2
    v_cmp_u_f32 vcc, v80, v80
    s_waitcnt lgkmcnt(4)
    v_mfma_f32_32x32x16_bf16 v[64:79], v[116:119], v[236:239], v[64:79]
    s_nop 2
    s_cbranch_vccnz Lredo_83
Lback_84:
    s_waitcnt lgkmcnt(3)
    v_mfma_f32_32x32x16_bf16 v[64:79], v[96:99], v[240:243], v[64:79]
    ds_write_b128 v124, v[80:83] offset:2048
    s_cmp_eq_u32 s12, 0
    s_cbranch_scc1 Lgate_88
Lback_89:
    s_add_u32 s66, s40, 430080
    s_addc_u32 s67, s41, 0
    global_load_dwordx4 v[24:27], v1, s[66:67] offset:-4096 sc1
    s_waitcnt lgkmcnt(3)
    v_mfma_f32_32x32x16_bf16 v[64:79], v[100:103], v[244:247], v[64:79]
    ds_write_b128 v124, v[84:87] offset:3072
    global_load_dwordx4 v[28:31], v1, s[66:67] offset:-3072 sc1
    s_waitcnt lgkmcnt(3)
    v_mfma_f32_32x32x16_bf16 v[64:79], v[104:107], v[248:251], v[64:79]
    ds_write_b128 v124, v[88:91] offset:4096
    s_add_u32 m0, s19, 0
    s_add_u32 s66, s38, 65536
    s_addc_u32 s67, s39, 0
    global_load_lds_dwordx4 v1, s[66:67] offset:0 sc1
    s_waitcnt lgkmcnt(3)
    v_mfma_f32_32x32x16_bf16 v[64:79], v[108:111], v[252:255], v[64:79]
    ds_write_b128 v124, v[92:95] offset:5120
    global_load_lds_dwordx4 v1, s[66:67] offset:1024 sc1
    global_load_lds_dwordx4 v1, s[66:67] offset:2048 sc1
    global_load_lds_dwordx4 v1, s[66:67] offset:3072 sc1
    s_waitcnt vmcnt(6)
    s_cmp_eq_u32 s12, 0
    s_cbranch_scc1 Lslow_93
    buffer_store_byte v5, off, s[4:7], s21 offset:256
Lback_94:
    s_nop 3
    ds_write_b128 v124, v[72:75] offset:0
    ds_write_b128 v124, v[76:79] offset:1024
    s_waitcnt lgkmcnt(0)
    s_barrier
    ds_read_b128 v[104:107], v126 offset:2048
    ds_read_b128 v[108:111], v126 offset:3072
    ds_read_b128 v[112:115], v127 offset:4096
    ds_read_b128 v[116:119], v127 offset:5120
    ds_read_b128 v[96:99], v125 offset:0
    ds_read_b128 v[100:103], v125 offset:1024
    s_add_u32 m0, s19, 4096
    s_add_u32 s66, s38, 69632
    s_addc_u32 s67, s39, 0
    global_load_lds_dwordx4 v1, s[66:67] offset:0 sc1
    global_load_lds_dwordx4 v1, s[66:67] offset:1024 sc1
    s_waitcnt lgkmcnt(5)
    v_pk_add_f32 v[64:65], v[64:65], v[104:105]
    v_pk_add_f32 v[66:67], v[66:67], v[106:107]
    global_load_lds_dwordx4 v1, s[66:67] offset:2048 sc1
    s_waitcnt lgkmcnt(4)
    v_pk_add_f32 v[68:69], v[68:69], v[108:109]
    v_pk_add_f32 v[70:71], v[70:71], v[110:111]
    global_load_lds_dwordx4 v1, s[66:67] offset:3072 sc1
    s_waitcnt lgkmcnt(3)
    v_pk_add_f32 v[64:65], v[64:65], v[112:113]
    v_pk_add_f32 v[66:67], v[66:67], v[114:115]
    s_waitcnt lgkmcnt(2)
    v_pk_add_f32 v[68:69], v[68:69], v[116:117]
    v_pk_add_f32 v[70:71], v[70:71], v[118:119]
    s_waitcnt lgkmcnt(1)
    v_pk_add_f32 v[64:65], v[64:65], v[96:97]
    v_pk_add_f32 v[66:67], v[66:67], v[98:99]
    s_waitcnt lgkmcnt(0)
    v_pk_add_f32 v[68:69], v[68:69], v[100:101]
    v_pk_add_f32 v[70:71], v[70:71], v[102:103]
    s_add_u32 s61, s20, 98304
    s_add_u32 s62, s23, 434176
    v_cvt_pk_bf16_f32 v20, v64, v65
    v_cvt_pk_bf16_f32 v21, v66, v67
    v_cvt_pk_bf16_f32 v22, v68, v69
    v_cvt_pk_bf16_f32 v23, v70, v71
    v_dot2_f32_bf16 v72, v20, v4, 0
    v_dot2_f32_bf16 v73, v20, v20, 0
    v_dot2_f32_bf16 v72, v21, v4, v72
    v_dot2_f32_bf16 v73, v21, v21, v73
    v_dot2_f32_bf16 v72, v22, v4, v72
    v_dot2_f32_bf16 v73, v22, v22, v73
    v_dot2_f32_bf16 v72, v23, v4, v72
    v_dot2_f32_bf16 v73, v23, v23, v73
    s_nop 2
    v_permlane32_swap_b32 v72, v73
    v_add_f32 v72, v72, v73
    s_cmp_eq_u32 s12, 0
    s_cbranch_scc1 Lslow_95
    buffer_store_dwordx4 v[20:23], v1, s[4:7], s61 offen
    buffer_store_dword v72, v1, s[4:7], s62 offen
Lback_96:
Lf1sy_97:
    s_waitcnt vmcnt(11)
    v_add_f32 v24, v24, v28
    v_add_f32 v25, v25, v29
    v_add_f32 v26, v26, v30
    v_add_f32 v27, v27, v31
    v_add_f32 v24, v24, v26
    v_add_f32 v25, v25, v27
    v_add_f32 v24, v24, v25
    v_cmp_u_f32 vcc, v24, v24
    v_add_u32 v25, s26, v3
    ds_write_b32 v25, v24 offset:6144
    s_waitcnt vmcnt(2)
    s_waitcnt lgkmcnt(0)
    s_nop 0
    s_cbranch_vccnz Lredo_98
Lback_99:
    s_barrier
Lf1st_103:
    ds_read_b128 v[96:99], v1 offset:0
    ds_read_b128 v[100:103], v1 offset:1024
    ds_read_b128 v[104:107], v1 offset:2048
    s_waitcnt lgkmcnt(2)
    v_mfma_f32_32x32x16_bf16 v[32:47], a[0:3], v[96:99], 0
    ds_read_b128 v[108:111], v1 offset:3072
    s_waitcnt lgkmcnt(2)
    v_add_u32 v31, 135168, v3
    ds_read_b32 v28, v31 offset:6144
    ds_read_b32 v29, v31 offset:13312
    ds_read_b32 v30, v31 offset:20480
    ds_read_b32 v31, v31 offset:27648
    v_mfma_f32_32x32x16_bf16 v[32:47], a[4:7], v[100:103], v[32:47]
    ds_read_b128 v[96:99], v1 offset:4096
    s_waitcnt lgkmcnt(6)
    v_mfma_f32_32x32x16_bf16 v[32:47], a[8:11], v[104:107], v[32:47]
    ds_read_b128 v[100:103], v1 offset:5120
    s_waitcnt lgkmcnt(6)
    s_waitcnt lgkmcnt(2)
    v_add_f32 v28, v28, v30
    v_add_f32 v29, v29, v31
    v_add_f32 v28, v28, v29
    v_mov_b32 v29, v28
    v_mfma_f32_32x32x16_bf16 v[32:47], a[12:15], v[108:111], v[32:47]
    ds_read_b128 v[104:107], v1 offset:6144
    s_waitcnt lgkmcnt(2)
    v_permlane32_swap_b32 v28, v29
    v_mul_f32 v30, 0x3b000000, v28
    v_mul_f32 v29, 0x3b000000, v29
    v_fma_f32 v29, -v30, v30, v29
    s_waitcnt vmcnt(0)
    s_cmp_eq_u32 s12, 0
    s_cbranch_scc1 Lslow_109
    buffer_store_byte v5, off, s[4:7], s21 offset:384
Lback_110:
    v_mfma_f32_32x32x16_bf16 v[32:47], a[16:19], v[96:99], v[32:47]
    ds_read_b128 v[108:111], v1 offset:7168
    s_waitcnt lgkmcnt(2)
    v_max_f32 v29, 0, v29
    v_add_f32 v29, 0x3727c5ac, v29
    v_rsq_f32 v6, v29
    s_add_u32 s64, s48, 16384
    s_addc_u32 s65, s49, 0
    global_load_dwordx4 v[224:227], v2, s[64:65] offset:-4096
    v_mfma_f32_32x32x16_bf16 v[32:47], a[20:23], v[100:103], v[32:47]
    ds_read_b128 v[96:99], v1 offset:8192
    s_waitcnt lgkmcnt(2)
    v_mul_f32 v29, 0xbb000000, v28
    v_cvt_pk_bf16_f32 v10, v29, v29
    v_and_b32 v11, 0xffff0000, v10
    v_sub_f32 v29, v29, v11
    v_cvt_pk_bf16_f32 v11, v29, v29
    v_mfma_f32_32x32x16_bf16 v[32:47], a[24:27], v[104:107], v[32:47]
    ds_read_b128 v[100:103], v1 offset:9216
    s_waitcnt lgkmcnt(2)
    v_mul_f32 v124, 0xbfb8aa3b, v6
    v_mov_b32 v125, v124
    global_load_dwordx4 v[232:235], v2, s[64:65] offset:-3072
    v_mfma_f32_32x32x16_bf16 v[32:47], a[28:31], v[108:111], v[32:47]
    ds_read_b128 v[104:107], v1 offset:10240
    s_waitcnt lgkmcnt(2)
    v_mfma_f32_32x32x16_bf16 v[32:47], a[32:35], v[96:99], v[32:47]
    ds_read_b128 v[108:111], v1 offset:11264
    s_waitcnt lgkmcnt(2)
    global_load_dwordx4 v[240:243], v2, s[64:65] offset:-2048
    v_mfma_f32_32x32x16_bf16 v[32:47], a[36:39], v[100:103], v[32:47]
    ds_read_b128 v[96:99], v1 offset:12288
    s_waitcnt lgkmcnt(2)
    v_mfma_f32_32x32x16_bf16 v[32:47], a[40:43], v[104:107], v[32:47]
    ds_read_b128 v[100:103], v1 offset:13312
    s_waitcnt lgkmcnt(2)
    global_load_dwordx4 v[248:251], v2, s[64:65] offset:-1024
    v_mfma_f32_32x32x16_bf16 v[32:47], a[44:47], v[108:111], v[32:47]
    ds_read_b128 v[104:107], v1 offset:14336
    s_waitcnt lgkmcnt(2)
    v_mfma_f32_32x32x16_bf16 v[32:47], a[48:51], v[96:99], v[32:47]
    ds_read_b128 v[108:111], v1 offset:15360
    s_waitcnt lgkmcnt(2)
    buffer_load_dwordx2 v[14:15], off, s[4:7], s22 offset:384 sc1
    v_mfma_f32_32x32x16_bf16 v[32:47], a[52:55], v[100:103], v[32:47]
    ds_read_b128 v[96:99], v1 offset:16384
    s_waitcnt lgkmcnt(2)
    s_add_u32 s64, s50, 16384
    s_addc_u32 s65, s51, 0
    global_load_dwordx4 v[228:231], v2, s[64:65] offset:-4096
    v_mfma_f32_32x32x16_bf16 v[32:47], a[56:59], v[104:107], v[32:47]
    ds_read_b128 v[100:103], v1 offset:17408
    s_waitcnt lgkmcnt(2)
    v_mfma_f32_32x32x16_bf16 v[32:47], a[60:63], v[108:111], v[32:47]
    ds_read_b128 v[104:107], v1 offset:18432
    s_waitcnt lgkmcnt(2)
    global_load_dwordx4 v[236:239], v2, s[64:65] offset:-3072
    v_mfma_f32_32x32x16_bf16 v[32:47], a[64:67], v[96:99], v[32:47]
    ds_read_b128 v[108:111], v1 offset:19456
    s_waitcnt lgkmcnt(2)
    v_mfma_f32_32x32x16_bf16 v[32:47], a[68:71], v[100:103], v[32:47]
    ds_read_b128 v[96:99], v1 offset:20480
    s_waitcnt lgkmcnt(2)
    global_load_dwordx4 v[244:247], v2, s[64:65] offset:-2048
    v_mfma_f32_32x32x16_bf16 v[32:47], a[72:75], v[104:107], v[32:47]
    ds_read_b128 v[100:103], v1 offset:21504
    s_waitcnt lgkmcnt(2)
    v_mfma_f32_32x32x16_bf16 v[32:47], a[76:79], v[108:111], v[32:47]
    ds_read_b128 v[104:107], v1 offset:22528
    s_waitcnt lgkmcnt(2)
    global_load_dwordx4 v[252:255], v2, s[64:65] offset:-1024
    v_mfma_f32_32x32x16_bf16 v[32:47], a[80:83], v[96:99], v[32:47]
    ds_read_b128 v[108:111], v1 offset:23552
    s_waitcnt lgkmcnt(2)
    v_mfma_f32_32x32x16_bf16 v[32:47], a[84:87], v[100:103], v[32:47]
    ds_read_b128 v[96:99], v1 offset:24576
    s_waitcnt lgkmcnt(2)
    v_mfma_f32_32x32x16_bf16 v[32:47], a[88:91], v[104:107], v[32:47]
    ds_read_b128 v[100:103], v1 offset:25600
    s_waitcnt lgkmcnt(2)
    v_mfma_f32_32x32x16_bf16 v[32:47], a[92:95], v[108:111], v[32:47]
    ds_read_b128 v[104:107], v1 offset:26624
    s_waitcnt lgkmcnt(2)
    s_waitcnt vmcnt(4)
    v_and_b32 v14, v14, v15
    s_nop 0
    v_readfirstlane_b32 s60, v14
    s_nop 0
    s_cmp_eq_u32 s60, 0x01010101
    s_cbranch_scc0 Lretry_111
Lback_112:
    v_mfma_f32_32x32x16_bf16 v[32:47], a[96:99], v[96:99], v[32:47]
    ds_read_b128 v[108:111], v1 offset:27648
    s_waitcnt lgkmcnt(2)
    s_add_u32 s66, s40, 438272
    s_addc_u32 s67, s41, 0
    global_load_dwordx4 v[24:27], v1, s[66:67] offset:-4096 sc1
    v_mfma_f32_32x32x16_bf16 v[32:47], a[100:103], v[100:103], v[32:47]
    ds_read_b128 v[96:99], v1 offset:28672
    s_waitcnt lgkmcnt(2)
    global_load_dwordx4 v[28:31], v1, s[66:67] offset:-3072 sc1
    v_mfma_f32_32x32x16_bf16 v[32:47], a[104:107], v[104:107], v[32:47]
    ds_read_b128 v[100:103], v1 offset:29696
    s_waitcnt lgkmcnt(2)
    v_mfma_f32_32x32x16_bf16 v[32:47], a[108:111], v[108:111], v[32:47]
    ds_read_b128 v[104:107], v1 offset:30720
    s_waitcnt lgkmcnt(2)
    s_add_u32 m0, s19, 32768
    s_add_u32 s66, s38, 98304
    s_addc_u32 s67, s39, 0
    global_load_lds_dwordx4 v1, s[66:67] offset:0 sc1
    v_mfma_f32_32x32x16_bf16 v[32:47], a[112:115], v[96:99], v[32:47]
    ds_read_b128 v[108:111], v1 offset:31744
    s_waitcnt lgkmcnt(2)
    v_mfma_f32_32x32x16_bf16 v[32:47], a[116:119], v[100:103], v[32:47]
    ds_read_b128 v[96:99], v1 offset:0
    s_waitcnt lgkmcnt(2)
    global_load_lds_dwordx4 v1, s[66:67] offset:1024 sc1
    v_mfma_f32_32x32x16_bf16 v[32:47], a[120:123], v[104:107], v[32:47]
    ds_read_b128 v[100:103], v1 offset:1024
    s_waitcnt lgkmcnt(2)
    v_mfma_f32_32x32x16_bf16 v[32:47], a[124:127], v[108:111], v[32:47]
    ds_read_b128 v[104:107], v1 offset:2048
    s_waitcnt lgkmcnt(2)
    v_mfma_f32_32x32x16_bf16 v[32:47], v[120:123], v[10:13], v[32:47]
    global_load_lds_dwordx4 v1, s[66:67] offset:2048 sc1
    v_mfma_f32_32x32x16_bf16 v[48:63], a[128:131], v[96:99], 0
    ds_read_b128 v[108:111], v1 offset:3072
    s_waitcnt lgkmcnt(2)
    v_mfma_f32_32x32x16_bf16 v[48:63], a[132:135], v[100:103], v[48:63]
    ds_read_b128 v[96:99], v1 offset:4096
    s_waitcnt lgkmcnt(2)
    global_load_lds_dwordx4 v1, s[66:67] offset:3072 sc1
    v_mfma_f32_32x32x16_bf16 v[48:63], a[136:139], v[104:107], v[48:63]
    ds_read_b128 v[100:103], v1 offset:5120
    s_waitcnt lgkmcnt(2)
    s_nop 0
    v_cmp_u_f32 vcc, v32, v32
    s_add_u32 m0, s19, 36864
    s_add_u32 s66, s38, 102400
    s_addc_u32 s67, s39, 0
    global_load_lds_dwordx4 v1, s[66:67] offset:0 sc1
    v_mfma_f32_32x32x16_bf16 v[48:63], a[140:143], v[108:111], v[48:63]
    ds_read_b128 v[104:107], v1 offset:6144
    s_waitcnt lgkmcnt(2)
    s_cbranch_vccnz Lredo_104
Lback_105:
    v_mfma_f32_32x32x16_bf16 v[48:63], a[144:147], v[96:99], v[48:63]
    ds_read_b128 v[108:111], v1 offset:7168
    s_waitcnt lgkmcnt(2)
    global_load_lds_dwordx4 v1, s[66:67] offset:1024 sc1
    v_mul_f32 v112, v124, v32
    v_mul_f32 v113, v124, v33
    v_mul_f32 v114, v124, v34
    v_mul_f32 v115, v124, v35
    v_mul_f32 v116, v124, v36
    v_mul_f32 v117, v124, v37
    v_exp_f32 v112, v112
    v_exp_f32 v113, v113
    v_mfma_f32_32x32x16_bf16 v[48:63], a[148:151], v[100:103], v[48:63]
    ds_read_b128 v[96:99], v1 offset:8192
    s_waitcnt lgkmcnt(2)
    v_mul_f32 v118, v124, v38
    v_exp_f32 v114, v114
    v_exp_f32 v115, v115
    v_mfma_f32_32x32x16_bf16 v[48:63], a[152:155], v[104:107], v[48:63]
    ds_read_b128 v[100:103], v1 offset:9216
    s_waitcnt lgkmcnt(2)
    global_load_lds_dwordx4 v1, s[66:67] offset:2048 sc1
    v_mul_f32 v119, v124, v39
    v_exp_f32 v116, v116
    v_exp_f32 v117, v117
    v_mfma_f32_32x32x16_bf16 v[48:63], a[156:159], v[108:111], v[48:63]
    ds_read_b128 v[104:107], v1 offset:10240
    s_waitcnt lgkmcnt(2)
    v_add_f32 v112, 1.0, v112
    v_exp_f32 v118, v118
    v_exp_f32 v119, v119
    v_mfma_f32_32x32x16_bf16 v[48:63], a[160:163], v[96:99], v[48:63]
    ds_read_b128 v[108:111], v1 offset:11264
    s_waitcnt lgkmcnt(2)
    global_load_lds_dwordx4 v1, s[66:67] offset:3072 sc1
    v_add_f32 v113, 1.0, v113
    v_add_f32 v114, 1.0, v114
    v_add_f32 v115, 1.0, v115
    v_rcp_f32 v112, v112
    v_mfma_f32_32x32x16_bf16 v[48:63], a[164:167], v[100:103], v[48:63]
    ds_read_b128 v[96:99], v1 offset:12288
    s_waitcnt lgkmcnt(2)
    v_add_f32 v116, 1.0, v116
    v_rcp_f32 v113, v113
    v_rcp_f32 v114, v114
    v_mfma_f32_32x32x16_bf16 v[48:63], a[168:171], v[104:107], v[48:63]
    ds_read_b128 v[100:103], v1 offset:13312
    s_waitcnt lgkmcnt(2)
    s_add_u32 m0, s30, 67584
    s_add_u32 s66, s44, 0
    s_addc_u32 s67, s45, 0
    global_load_lds_dwordx4 v2, s[66:67] offset:0
    v_add_f32 v117, 1.0, v117
    v_rcp_f32 v115, v115
    v_rcp_f32 v116, v116
    v_mfma_f32_32x32x16_bf16 v[48:63], a[172:175], v[108:111], v[48:63]
    ds_read_b128 v[104:107], v1 offset:14336
    s_waitcnt lgkmcnt(2)
    v_add_f32 v118, 1.0, v118
    v_add_f32 v119, 1.0, v119
    v_mul_f32 v112, v32, v112
    v_rcp_f32 v117, v117
    v_mfma_f32_32x32x16_bf16 v[48:63], a[176:179], v[96:99], v[48:63]
    ds_read_b128 v[108:111], v1 offset:15360
    s_waitcnt lgkmcnt(2)
    global_load_lds_dwordx4 v2, s[66:67] offset:1024
    v_mul_f32 v113, v33, v113
    v_rcp_f32 v118, v118
    v_rcp_f32 v119, v119
    v_mfma_f32_32x32x16_bf16 v[48:63], a[180:183], v[100:103], v[48:63]
    ds_read_b128 v[96:99], v1 offset:16384
    s_waitcnt lgkmcnt(2)
    v_mul_f32 v114, v34, v114
    v_mul_f32 v115, v35, v115
    v_mul_f32 v116, v36, v116
    v_mul_f32 v117, v37, v117
    v_mul_f32 v118, v38, v118
    v_mfma_f32_32x32x16_bf16 v[48:63], a[184:187], v[104:107], v[48:63]
    ds_read_b128 v[100:103], v1 offset:17408
    s_waitcnt lgkmcnt(2)
    global_load_lds_dwordx4 v2, s[66:67] offset:2048
    v_mul_f32 v119, v39, v119
    v_cvt_pk_bf16_f32 v32, v112, v113
    v_cvt_pk_bf16_f32 v33, v114, v115
    v_cvt_pk_bf16_f32 v34, v116, v117
    v_cvt_pk_bf16_f32 v35, v118, v119
    v_mfma_f32_32x32x16_bf16 v[48:63], a[188:191], v[108:111], v[48:63]
    ds_read_b128 v[104:107], v1 offset:18432
    s_waitcnt lgkmcnt(2)
    s_add_u32 s61, s24, 0
    s_cmp_eq_u32 s12, 0
    s_cbranch_scc1 Lslow_113
    buffer_store_dwordx4 v[32:35], v1, s[4:7], s61 offen
Lback_114:
    v_mfma_f32_32x32x16_bf16 v[48:63], a[192:195], v[96:99], v[48:63]
    ds_read_b128 v[108:111], v1 offset:19456
    s_waitcnt lgkmcnt(2)
    global_load_lds_dwordx4 v2, s[66:67] offset:3072
    v_mul_f32 v112, v124, v40
    v_mul_f32 v113, v124, v41
    v_mul_f32 v114, v124, v42
    v_mul_f32 v115, v124, v43
    v_mul_f32 v116, v124, v44
    v_mul_f32 v117, v124, v45
    v_exp_f32 v112, v112
    v_exp_f32 v113, v113
    v_mfma_f32_32x32x16_bf16 v[48:63], a[196:199], v[100:103], v[48:63]
    ds_read_b128 v[96:99], v1 offset:20480
    s_waitcnt lgkmcnt(2)
    v_mul_f32 v118, v124, v46
    v_exp_f32 v114, v114
    v_exp_f32 v115, v115
    v_mfma_f32_32x32x16_bf16 v[48:63], a[200:203], v[104:107], v[48:63]
    ds_read_b128 v[100:103], v1 offset:21504
    s_waitcnt lgkmcnt(2)
    s_add_u32 m0, s30, 71680
    s_add_u32 s66, s44, 4096
    s_addc_u32 s67, s45, 0
    global_load_lds_dwordx4 v2, s[66:67] offset:0
    v_mul_f32 v119, v124, v47
    v_exp_f32 v116, v116
    v_exp_f32 v117, v117
    v_mfma_f32_32x32x16_bf16 v[48:63], a[204:207], v[108:111], v[48:63]
    ds_read_b128 v[104:107], v1 offset:22528
    s_waitcnt lgkmcnt(2)
    v_add_f32 v112, 1.0, v112
    v_exp_f32 v118, v118
    v_exp_f32 v119, v119
    v_mfma_f32_32x32x16_bf16 v[48:63], a[208:211], v[96:99], v[48:63]
    ds_read_b128 v[108:111], v1 offset:23552
    s_waitcnt lgkmcnt(2)
    global_load_lds_dwordx4 v2, s[66:67] offset:1024
    v_add_f32 v113, 1.0, v113
    v_add_f32 v114, 1.0, v114
    v_add_f32 v115, 1.0, v115
    v_rcp_f32 v112, v112
    v_mfma_f32_32x32x16_bf16 v[48:63], a[212:215], v[100:103], v[48:63]
    ds_read_b128 v[96:99], v1 offset:24576
    s_waitcnt lgkmcnt(2)
    v_add_f32 v116, 1.0, v116
    v_rcp_f32 v113, v113
    v_rcp_f32 v114, v114
    v_mfma_f32_32x32x16_bf16 v[48:63], a[216:219], v[104:107], v[48:63]
    ds_read_b128 v[100:103], v1 offset:25600
    s_waitcnt lgkmcnt(2)
    global_load_lds_dwordx4 v2, s[66:67] offset:2048
    v_add_f32 v117, 1.0, v117
    v_rcp_f32 v115, v115
    v_rcp_f32 v116, v116
    v_mfma_f32_32x32x16_bf16 v[48:63], a[220:223], v[108:111], v[48:63]
    ds_read_b128 v[104:107], v1 offset:26624
    s_waitcnt lgkmcnt(2)
    v_add_f32 v118, 1.0, v118
    v_add_f32 v119, 1.0, v119
    v_mul_f32 v112, v40, v112
    v_rcp_f32 v117, v117
    v_mfma_f32_32x32x16_bf16 v[48:63], a[224:227], v[96:99], v[48:63]
    ds_read_b128 v[108:111], v1 offset:27648
    s_waitcnt lgkmcnt(2)
    global_load_lds_dwordx4 v2, s[66:67] offset:3072
    v_mul_f32 v113, v41, v113
    v_rcp_f32 v118, v118
    v_rcp_f32 v119, v119
    v_mfma_f32_32x32x16_bf16 v[48:63], a[228:231], v[100:103], v[48:63]
    ds_read_b128 v[96:99], v1 offset:28672
    s_waitcnt lgkmcnt(2)
    v_mul_f32 v114, v42, v114
    v_mul_f32 v115, v43, v115
    v_mul_f32 v116, v44, v116
    v_mul_f32 v117, v45, v117
    v_mul_f32 v118, v46, v118
    v_mfma_f32_32x32x16_bf16 v[48:63], a[232:235], v[104:107], v[48:63]
    ds_read_b128 v[100:103], v1 offset:29696
    s_waitcnt lgkmcnt(2)
    s_add_u32 m0, s30, 75776
    s_add_u32 s66, s46, 0
    s_addc_u32 s67, s47, 0
    global_load_lds_dwordx4 v2, s[66:67] offset:0
    v_mul_f32 v119, v47, v119
    v_cvt_pk_bf16_f32 v40, v112, v113
    v_cvt_pk_bf16_f32 v41, v114, v115
    v_cvt_pk_bf16_f32 v42, v116, v117
    v_cvt_pk_bf16_f32 v43, v118, v119
    v_mfma_f32_32x32x16_bf16 v[48:63], a[236:239], v[108:111], v[48:63]
    ds_read_b128 v[104:107], v1 offset:30720
    s_waitcnt lgkmcnt(2)
    s_add_u32 s61, s24, 1024
    s_cmp_eq_u32 s12, 0
    s_cbranch_scc1 Lslow_115
    buffer_store_dwordx4 v[40:43], v1, s[4:7], s61 offen
Lback_116:
    v_mfma_f32_32x32x16_bf16 v[48:63], a[240:243], v[96:99], v[48:63]
    ds_read_b128 v[108:111], v1 offset:31744
    s_waitcnt lgkmcnt(2)
    global_load_lds_dwordx4 v2, s[66:67] offset:1024
Lf1sy_117:
    s_waitcnt vmcnt(20)
    v_add_f32 v24, v24, v28
    v_add_f32 v25, v25, v29
    v_add_f32 v26, v26, v30
    v_add_f32 v27, v27, v31
    v_add_f32 v24, v24, v26
    v_add_f32 v25, v25, v27
    v_add_f32 v24, v24, v25
    v_add_u32 v25, s26, v3
    ds_write_b32 v25, v24 offset:6400
    s_waitcnt vmcnt(12)
    s_waitcnt lgkmcnt(0)
    s_barrier
    v_mfma_f32_32x32x16_bf16 v[48:63], a[244:247], v[100:103], v[48:63]
    ds_read_b128 v[96:99], v1 offset:32768
    v_add_u32 v31, 135168, v3
    ds_read_b32 v28, v31 offset:6400
    ds_read_b32 v29, v31 offset:13568
    ds_read_b32 v30, v31 offset:20736
    ds_read_b32 v31, v31 offset:27904
    v_mfma_f32_32x32x16_bf16 v[48:63], a[248:251], v[104:107], v[48:63]
    ds_read_b128 v[100:103], v1 offset:33792
    global_load_lds_dwordx4 v2, s[66:67] offset:2048
    s_waitcnt lgkmcnt(1)
    v_add_f32 v28, v28, v30
    v_add_f32 v29, v29, v31
    v_add_f32 v28, v28, v29
    v_mov_b32 v29, v28
    v_mfma_f32_32x32x16_bf16 v[48:63], a[252:255], v[108:111], v[48:63]
    ds_read_b128 v[104:107], v1 offset:34816
    v_mfma_f32_32x32x16_bf16 v[48:63], v[120:123], v[8:11], v[48:63]
    v_permlane32_swap_b32 v28, v29
    v_mul_f32 v30, 0x3b000000, v28
    v_mul_f32 v29, 0x3b000000, v29
    v_fma_f32 v29, -v30, v30, v29
    v_mfma_f32_32x32x16_bf16 v[64:79], a[0:3], v[96:99], 0
    ds_read_b128 v[108:111], v1 offset:35840
    s_waitcnt lgkmcnt(2)
    global_load_lds_dwordx4 v2, s[66:67] offset:3072
    v_max_f32 v29, 0, v29
    v_add_f32 v29, 0x3727c5ac, v29
    v_rsq_f32 v7, v29
    v_mfma_f32_32x32x16_bf16 v[64:79], a[4:7], v[100:103], v[64:79]
    ds_read_b128 v[96:99], v1 offset:36864
    s_waitcnt lgkmcnt(2)
    v_mul_f32 v29, 0xbb000000, v28
    v_cvt_pk_bf16_f32 v10, v29, v29
    v_and_b32 v11, 0xffff0000, v10
    v_sub_f32 v29, v29, v11
    v_cvt_pk_bf16_f32 v11, v29, v29
    v_mul_f32 v126, 0xbfb8aa3b, v7
    v_mov_b32 v127, v126
    v_mfma_f32_32x32x16_bf16 v[64:79], a[8:11], v[104:107], v[64:79]
    ds_read_b128 v[100:103], v1 offset:37888
    s_waitcnt lgkmcnt(2)
    v_mul_f32 v112, v124, v48
    v_mul_f32 v113, v124, v49
    v_mul_f32 v114, v124, v50
    v_mul_f32 v115, v124, v51
    v_mul_f32 v116, v124, v52
    s_add_u32 m0, s30, 79872
    s_add_u32 s66, s46, 4096
    s_addc_u32 s67, s47, 0
    global_load_lds_dwordx4 v2, s[66:67] offset:0
    v_mfma_f32_32x32x16_bf16 v[64:79], a[12:15], v[108:111], v[64:79]
    ds_read_b128 v[104:107], v1 offset:38912
    s_waitcnt lgkmcnt(2)
    v_mul_f32 v117, v124, v53
    v_exp_f32 v112, v112
    v_exp_f32 v113, v113
    global_load_lds_dwordx4 v2, s[66:67] offset:1024
    v_mfma_f32_32x32x16_bf16 v[64:79], a[16:19], v[96:99], v[64:79]
    ds_read_b128 v[108:111], v1 offset:39936
    s_waitcnt lgkmcnt(2)
    v_mul_f32 v118, v124, v54
    v_exp_f32 v114, v114
    v_exp_f32 v115, v115
    global_load_lds_dwordx4 v2, s[66:67] offset:2048
    v_mfma_f32_32x32x16_bf16 v[64:79], a[20:23], v[100:103], v[64:79]
    ds_read_b128 v[96:99], v1 offset:40960
    s_waitcnt lgkmcnt(2)
    v_mul_f32 v119, v124, v55
    v_exp_f32 v116, v116
    v_exp_f32 v117, v117
    v_mfma_f32_32x32x16_bf16 v[64:79], a[24:27], v[104:107], v[64:79]
    ds_read_b128 v[100:103], v1 offset:41984
    s_waitcnt lgkmcnt(2)
    v_add_f32 v112, 1.0, v112
    v_exp_f32 v118, v118
    v_exp_f32 v119, v119
    global_load_lds_dwordx4 v2, s[66:67] offset:3072
    v_mfma_f32_32x32x16_bf16 v[64:79], a[28:31], v[108:111], v[64:79]
    ds_read_b128 v[104:107], v1 offset:43008
    s_waitcnt lgkmcnt(2)
    v_add_f32 v113, 1.0, v113
    v_add_f32 v114, 1.0, v114
    v_add_f32 v115, 1.0, v115
    v_rcp_f32 v112, v112
    s_add_u32 s64, s48, 20480
    s_addc_u32 s65, s49, 0
    global_load_dwordx4 a[0:3], v2, s[64:65] offset:-4096
    v_mfma_f32_32x32x16_bf16 v[64:79], a[32:35], v[96:99], v[64:79]
    ds_read_b128 v[108:111], v1 offset:44032
    s_waitcnt lgkmcnt(2)
    v_add_f32 v116, 1.0, v116
    v_rcp_f32 v113, v113
    v_rcp_f32 v114, v114
    v_mfma_f32_32x32x16_bf16 v[64:79], a[36:39], v[100:103], v[64:79]
    ds_read_b128 v[96:99], v1 offset:45056
    s_waitcnt lgkmcnt(2)
    v_add_f32 v117, 1.0, v117
    v_rcp_f32 v115, v115
    v_rcp_f32 v116, v116
    s_add_u32 s68, s50, 20480
    s_addc_u32 s69, s51, 0
    global_load_dwordx4 a[4:7], v2, s[68:69] offset:-4096
    v_mfma_f32_32x32x16_bf16 v[64:79], a[40:43], v[104:107], v[64:79]
    ds_read_b128 v[100:103], v1 offset:46080
    s_waitcnt lgkmcnt(2)
    v_add_f32 v118, 1.0, v118
    v_add_f32 v119, 1.0, v119
    v_mul_f32 v112, v48, v112
    v_rcp_f32 v117, v117
    global_load_dwordx4 a[8:11], v2, s[64:65] offset:-3072
    v_mfma_f32_32x32x16_bf16 v[64:79], a[44:47], v[108:111], v[64:79]
    ds_read_b128 v[104:107], v1 offset:47104
    s_waitcnt lgkmcnt(2)
    v_mul_f32 v113, v49, v113
    v_rcp_f32 v118, v118
    v_rcp_f32 v119, v119
    v_mfma_f32_32x32x16_bf16 v[64:79], a[48:51], v[96:99], v[64:79]
    ds_read_b128 v[108:111], v1 offset:48128
    s_waitcnt lgkmcnt(2)
    v_mul_f32 v114, v50, v114
    v_mul_f32 v115, v51, v115
    v_mul_f32 v116, v52, v116
    v_mul_f32 v117, v53, v117
    v_mul_f32 v118, v54, v118
    global_load_dwordx4 a[12:15], v2, s[68:69] offset:-3072
    v_mfma_f32_32x32x16_bf16 v[64:79], a[52:55], v[100:103], v[64:79]
    ds_read_b128 v[96:99], v1 offset:49152
    s_waitcnt lgkmcnt(2)
    v_mul_f32 v119, v55, v119
    v_cvt_pk_bf16_f32 v48, v112, v113
    v_cvt_pk_bf16_f32 v49, v114, v115
    v_cvt_pk_bf16_f32 v50, v116, v117
    v_cvt_pk_bf16_f32 v51, v118, v119
    global_load_dwordx4 a[16:19], v2, s[64:65] offset:-2048
    v_mfma_f32_32x32x16_bf16 v[64:79], a[56:59], v[104:107], v[64:79]
    ds_read_b128 v[100:103], v1 offset:50176
    s_waitcnt lgkmcnt(2)
    s_add_u32 s61, s25, 0
    v_add_u32 v52, s14, v1
    s_cmp_eq_u32 s12, 0
    s_cbranch_scc1 Lslow_118
    buffer_store_dwordx4 v[48:51], v52, s[4:7], s61 offen
Lback_119:
    global_load_dwordx4 a[20:23], v2, s[68:69] offset:-2048
    v_mfma_f32_32x32x16_bf16 v[64:79], a[60:63], v[108:111], v[64:79]
    ds_read_b128 v[104:107], v1 offset:51200
    s_waitcnt lgkmcnt(2)
    v_mul_f32 v112, v124, v56
    v_mul_f32 v113, v124, v57
    v_mul_f32 v114, v124, v58
    v_mul_f32 v115, v124, v59
    v_mul_f32 v116, v124, v60
    v_mfma_f32_32x32x16_bf16 v[64:79], a[64:67], v[96:99], v[64:79]
    ds_read_b128 v[108:111], v1 offset:52224
    s_waitcnt lgkmcnt(2)
    v_mul_f32 v117, v124, v61
    v_exp_f32 v112, v112
    v_exp_f32 v113, v113
    global_load_dwordx4 a[24:27], v2, s[64:65] offset:-1024
    v_mfma_f32_32x32x16_bf16 v[64:79], a[68:71], v[100:103], v[64:79]
    ds_read_b128 v[96:99], v1 offset:53248
    s_waitcnt lgkmcnt(2)
    v_mul_f32 v118, v124, v62
    v_exp_f32 v114, v114
    v_exp_f32 v115, v115
    global_load_dwordx4 a[28:31], v2, s[68:69] offset:-1024
    v_mfma_f32_32x32x16_bf16 v[64:79], a[72:75], v[104:107], v[64:79]
    ds_read_b128 v[100:103], v1 offset:54272
    s_waitcnt lgkmcnt(2)
    v_mul_f32 v119, v124, v63
    v_exp_f32 v116, v116
    v_exp_f32 v117, v117
    v_mfma_f32_32x32x16_bf16 v[64:79], a[76:79], v[108:111], v[64:79]
    ds_read_b128 v[104:107], v1 offset:55296
    s_waitcnt lgkmcnt(2)
    v_add_f32 v112, 1.0, v112
    v_exp_f32 v118, v118
    v_exp_f32 v119, v119
    global_load_dwordx4 a[32:35], v2, s[64:65] offset:0
    v_mfma_f32_32x32x16_bf16 v[64:79], a[80:83], v[96:99], v[64:79]
    ds_read_b128 v[108:111], v1 offset:56320
    s_waitcnt lgkmcnt(2)
    v_add_f32 v113, 1.0, v113
    v_add_f32 v114, 1.0, v114
    v_add_f32 v115, 1.0, v115
    v_rcp_f32 v112, v112
    global_load_dwordx4 a[36:39], v2, s[68:69] offset:0
    v_mfma_f32_32x32x16_bf16 v[64:79], a[84:87], v[100:103], v[64:79]
    ds_read_b128 v[96:99], v1 offset:57344
    s_waitcnt lgkmcnt(2)
    v_add_f32 v116, 1.0, v116
    v_rcp_f32 v113, v113
    v_rcp_f32 v114, v114
    v_mfma_f32_32x32x16_bf16 v[64:79], a[88:91], v[104:107], v[64:79]
    ds_read_b128 v[100:103], v1 offset:58368
    s_waitcnt lgkmcnt(2)
    v_add_f32 v117, 1.0, v117
    v_rcp_f32 v115, v115
    v_rcp_f32 v116, v116
    global_load_dwordx4 a[40:43], v2, s[64:65] offset:1024
    v_mfma_f32_32x32x16_bf16 v[64:79], a[92:95], v[108:111], v[64:79]
    ds_read_b128 v[104:107], v1 offset:59392
    s_waitcnt lgkmcnt(2)
    v_add_f32 v118, 1.0, v118
    v_add_f32 v119, 1.0, v119
    v_mul_f32 v112, v56, v112
    v_rcp_f32 v117, v117
    global_load_dwordx4 a[44:47], v2, s[68:69] offset:1024
    v_mfma_f32_32x32x16_bf16 v[64:79], a[96:99], v[96:99], v[64:79]
    ds_read_b128 v[108:111], v1 offset:60416
    s_waitcnt lgkmcnt(2)
    v_mul_f32 v113, v57, v113
    v_rcp_f32 v118, v118
    v_rcp_f32 v119, v119
    global_load_dwordx4 a[48:51], v2, s[64:65] offset:2048
    v_mfma_f32_32x32x16_bf16 v[64:79], a[100:103], v[100:103], v[64:79]
    ds_read_b128 v[96:99], v1 offset:61440
    s_waitcnt lgkmcnt(2)
    v_mul_f32 v114, v58, v114
    v_mul_f32 v115, v59, v115
    v_mul_f32 v116, v60, v116
    v_mul_f32 v117, v61, v117
    v_mul_f32 v118, v62, v118
    v_mfma_f32_32x32x16_bf16 v[64:79], a[104:107], v[104:107], v[64:79]
    ds_read_b128 v[100:103], v1 offset:62464
    s_waitcnt lgkmcnt(2)
    v_mul_f32 v119, v63, v119
    v_cvt_pk_bf16_f32 v56, v112, v113
    v_cvt_pk_bf16_f32 v57, v114, v115
    v_cvt_pk_bf16_f32 v58, v116, v117
    v_cvt_pk_bf16_f32 v59, v118, v119
    global_load_dwordx4 a[52:55], v2, s[68:69] offset:2048
    v_mfma_f32_32x32x16_bf16 v[64:79], a[108:111], v[108:111], v[64:79]
    ds_read_b128 v[104:107], v1 offset:63488
    s_waitcnt lgkmcnt(2)
    s_add_u32 s61, s25, 1024
    v_add_u32 v60, s14, v1
    s_cmp_eq_u32 s12, 0
    s_cbranch_scc1 Lslow_120
    buffer_store_dwordx4 v[56:59], v60, s[4:7], s61 offen
Lback_121:
    global_load_dwordx4 a[56:59], v2, s[64:65] offset:3072
    v_mfma_f32_32x32x16_bf16 v[64:79], a[112:115], v[96:99], v[64:79]
    ds_read_b128 v[108:111], v1 offset:64512
    s_waitcnt lgkmcnt(2)
    v_mfma_f32_32x32x16_bf16 v[64:79], a[116:119], v[100:103], v[64:79]
    ds_read_b128 v[96:99], v1 offset:32768
    s_waitcnt lgkmcnt(2)
    global_load_dwordx4 a[60:63], v2, s[68:69] offset:3072
    v_mfma_f32_32x32x16_bf16 v[64:79], a[120:123], v[104:107], v[64:79]
    ds_read_b128 v[100:103], v1 offset:33792
    s_waitcnt lgkmcnt(2)
    s_add_u32 s64, s48, 28672
    s_addc_u32 s65, s49, 0
    global_load_dwordx4 a[64:67], v2, s[64:65] offset:-4096
    v_mfma_f32_32x32x16_bf16 v[64:79], a[124:127], v[108:111], v[64:79]
    ds_read_b128 v[104:107], v1 offset:34816
    s_waitcnt lgkmcnt(2)
    v_mfma_f32_32x32x16_bf16 v[64:79], v[120:123], v[10:13], v[64:79]
    v_mfma_f32_32x32x16_bf16 v[80:95], a[128:131], v[96:99], 0
    ds_read_b128 v[108:111], v1 offset:35840
    s_waitcnt lgkmcnt(2)
    s_add_u32 s68, s50, 28672
    s_addc_u32 s69, s51, 0
    global_load_dwordx4 a[68:71], v2, s[68:69] offset:-4096
    v_mfma_f32_32x32x16_bf16 v[80:95], a[132:135], v[100:103], v[80:95]
    ds_read_b128 v[96:99], v1 offset:36864
    s_waitcnt lgkmcnt(2)
    global_load_dwordx4 a[72:75], v2, s[64:65] offset:-3072
    v_mfma_f32_32x32x16_bf16 v[80:95], a[136:139], v[104:107], v[80:95]
    ds_read_b128 v[100:103], v1 offset:37888
    s_waitcnt lgkmcnt(2)
    global_load_dwordx4 a[76:79], v2, s[68:69] offset:-3072
    v_mul_f32 v112, v126, v64
    v_mul_f32 v113, v126, v65
    v_mul_f32 v114, v126, v66
    v_mul_f32 v115, v126, v67
    v_mul_f32 v116, v126, v68
    v_mfma_f32_32x32x16_bf16 v[80:95], a[140:143], v[108:111], v[80:95]
    ds_read_b128 v[104:107], v1 offset:38912
    s_waitcnt lgkmcnt(2)
    v_mul_f32 v117, v126, v69
    v_exp_f32 v112, v112
    v_exp_f32 v113, v113
    v_mfma_f32_32x32x16_bf16 v[80:95], a[144:147], v[96:99], v[80:95]
    ds_read_b128 v[108:111], v1 offset:39936
    s_waitcnt lgkmcnt(2)
    global_load_dwordx4 a[80:83], v2, s[64:65] offset:-2048
    v_mul_f32 v118, v126, v70
    v_exp_f32 v114, v114
    v_exp_f32 v115, v115
    v_mfma_f32_32x32x16_bf16 v[80:95], a[148:151], v[100:103], v[80:95]
    ds_read_b128 v[96:99], v1 offset:40960
    s_waitcnt lgkmcnt(2)
    global_load_dwordx4 a[84:87], v2, s[68:69] offset:-2048
    v_mul_f32 v119, v126, v71
    v_exp_f32 v116, v116
    v_exp_f32 v117, v117
    v_mfma_f32_32x32x16_bf16 v[80:95], a[152:155], v[104:107], v[80:95]
    ds_read_b128 v[100:103], v1 offset:41984
    s_waitcnt lgkmcnt(2)
    v_add_f32 v112, 1.0, v112
    v_exp_f32 v118, v118
    v_exp_f32 v119, v119
    v_mfma_f32_32x32x16_bf16 v[80:95], a[156:159], v[108:111], v[80:95]
    ds_read_b128 v[104:107], v1 offset:43008
    s_waitcnt lgkmcnt(2)
    global_load_dwordx4 a[88:91], v2, s[64:65] offset:-1024
    v_add_f32 v113, 1.0, v113
    v_add_f32 v114, 1.0, v114
    v_add_f32 v115, 1.0, v115
    v_rcp_f32 v112, v112
    v_mfma_f32_32x32x16_bf16 v[80:95], a[160:163], v[96:99], v[80:95]
    ds_read_b128 v[108:111], v1 offset:44032
    s_waitcnt lgkmcnt(2)
    global_load_dwordx4 a[92:95], v2, s[68:69] offset:-1024
    v_add_f32 v116, 1.0, v116
    v_rcp_f32 v113, v113
    v_rcp_f32 v114, v114
    v_mfma_f32_32x32x16_bf16 v[80:95], a[164:167], v[100:103], v[80:95]
    ds_read_b128 v[96:99], v1 offset:45056
    s_waitcnt lgkmcnt(2)
    v_add_f32 v117, 1.0, v117
    v_rcp_f32 v115, v115
    v_rcp_f32 v116, v116
    v_mfma_f32_32x32x16_bf16 v[80:95], a[168:171], v[104:107], v[80:95]
    ds_read_b128 v[100:103], v1 offset:46080
    s_waitcnt lgkmcnt(2)
    v_add_f32 v118, 1.0, v118
    v_add_f32 v119, 1.0, v119
    v_mul_f32 v112, v64, v112
    v_rcp_f32 v117, v117
    s_cmp_eq_u32 s12, 0
    s_cbranch_scc1 Lgate_126
Lback_127:
    s_add_u32 s66, s42, 4096
    s_addc_u32 s67, s43, 0
    global_load_dwordx4 a[96:99], v1, s[66:67] offset:-4096 sc1
    v_mfma_f32_32x32x16_bf16 v[80:95], a[172:175], v[108:111], v[80:95]
    ds_read_b128 v[104:107], v1 offset:47104
    s_waitcnt lgkmcnt(2)
    v_mul_f32 v113, v65, v113
    v_rcp_f32 v118, v118
    v_rcp_f32 v119, v119
    global_load_dwordx4 a[100:103], v1, s[66:67] offset:-3072 sc1
    v_mfma_f32_32x32x16_bf16 v[80:95], a[176:179], v[96:99], v[80:95]
    ds_read_b128 v[108:111], v1 offset:48128
    s_waitcnt lgkmcnt(2)
    v_mul_f32 v114, v66, v114
    v_mul_f32 v115, v67, v115
    v_mul_f32 v116, v68, v116
    v_mul_f32 v117, v69, v117
    v_mul_f32 v118, v70, v118
    v_mfma_f32_32x32x16_bf16 v[80:95], a[180:183], v[100:103], v[80:95]
    ds_read_b128 v[96:99], v1 offset:49152
    s_waitcnt lgkmcnt(2)
    v_mul_f32 v119, v71, v119
    v_cvt_pk_bf16_f32 v64, v112, v113
    v_cvt_pk_bf16_f32 v65, v114, v115
    v_cvt_pk_bf16_f32 v66, v116, v117
    v_cvt_pk_bf16_f32 v67, v118, v119
    global_load_dwordx4 a[104:107], v1, s[66:67] offset:0 sc1
    v_mfma_f32_32x32x16_bf16 v[80:95], a[184:187], v[104:107], v[80:95]
    ds_read_b128 v[100:103], v1 offset:50176
    s_waitcnt lgkmcnt(2)
    s_add_u32 s61, s24, 114688
    s_cmp_eq_u32 s12, 0
    s_cbranch_scc1 Lslow_122
    buffer_store_dwordx4 v[64:67], v1, s[4:7], s61 offen
Lback_123:
    v_mfma_f32_32x32x16_bf16 v[80:95], a[188:191], v[108:111], v[80:95]
    ds_read_b128 v[104:107], v1 offset:51200
    s_waitcnt lgkmcnt(2)
    v_mul_f32 v112, v126, v72
    v_mul_f32 v113, v126, v73
    v_mul_f32 v114, v126, v74
    v_mul_f32 v115, v126, v75
    v_mul_f32 v116, v126, v76
    global_load_dwordx4 a[108:111], v1, s[66:67] offset:1024 sc1
    v_mfma_f32_32x32x16_bf16 v[80:95], a[192:195], v[96:99], v[80:95]
    ds_read_b128 v[108:111], v1 offset:52224
    s_waitcnt lgkmcnt(2)
    v_mul_f32 v117, v126, v77
    v_exp_f32 v112, v112
    v_exp_f32 v113, v113
    v_mfma_f32_32x32x16_bf16 v[80:95], a[196:199], v[100:103], v[80:95]
    ds_read_b128 v[96:99], v1 offset:53248
    s_waitcnt lgkmcnt(2)
    v_mul_f32 v118, v126, v78
    v_exp_f32 v114, v114
    v_exp_f32 v115, v115
    s_add_u32 s66, s42, 12288
    s_addc_u32 s67, s43, 0
    global_load_dwordx4 a[112:115], v1, s[66:67] offset:-4096 sc1
    v_mfma_f32_32x32x16_bf16 v[80:95], a[200:203], v[104:107], v[80:95]
    ds_read_b128 v[100:103], v1 offset:54272
    s_waitcnt lgkmcnt(2)
    v_mul_f32 v119, v126, v79
    v_exp_f32 v116, v116
    v_exp_f32 v117, v117
    v_mfma_f32_32x32x16_bf16 v[80:95], a[204:207], v[108:111], v[80:95]
    ds_read_b128 v[104:107], v1 offset:55296
    s_waitcnt lgkmcnt(2)
    v_add_f32 v112, 1.0, v112
    v_exp_f32 v118, v118
    v_exp_f32 v119, v119
    global_load_dwordx4 a[116:119], v1, s[66:67] offset:-3072 sc1
    v_mfma_f32_32x32x16_bf16 v[80:95], a[208:211], v[96:99], v[80:95]
    ds_read_b128 v[108:111], v1 offset:56320
    s_waitcnt lgkmcnt(2)
    v_add_f32 v113, 1.0, v113
    v_add_f32 v114, 1.0, v114
    v_add_f32 v115, 1.0, v115
    v_rcp_f32 v112, v112
    v_mfma_f32_32x32x16_bf16 v[80:95], a[212:215], v[100:103], v[80:95]
    ds_read_b128 v[96:99], v1 offset:57344
    s_waitcnt lgkmcnt(2)
    v_add_f32 v116, 1.0, v116
    v_rcp_f32 v113, v113
    v_rcp_f32 v114, v114
    global_load_dwordx4 a[120:123], v1, s[66:67] offset:0 sc1
    v_mfma_f32_32x32x16_bf16 v[80:95], a[216:219], v[104:107], v[80:95]
    ds_read_b128 v[100:103], v1 offset:58368
    s_waitcnt lgkmcnt(2)
    v_add_f32 v117, 1.0, v117
    v_rcp_f32 v115, v115
    v_rcp_f32 v116, v116
    global_load_dwordx4 a[124:127], v1, s[66:67] offset:1024 sc1
    v_mfma_f32_32x32x16_bf16 v[80:95], a[220:223], v[108:111], v[80:95]
    ds_read_b128 v[104:107], v1 offset:59392
    s_waitcnt lgkmcnt(2)
    v_add_f32 v118, 1.0, v118
    v_add_f32 v119, 1.0, v119
    v_mul_f32 v112, v72, v112
    v_rcp_f32 v117, v117
    v_mfma_f32_32x32x16_bf16 v[80:95], a[224:227], v[96:99], v[80:95]
    ds_read_b128 v[108:111], v1 offset:60416
    s_waitcnt lgkmcnt(2)
    v_mul_f32 v113, v73, v113
    v_rcp_f32 v118, v118
    v_rcp_f32 v119, v119
    global_load_dwordx4 a[128:131], v1, s[66:67] offset:2048 sc1
    v_mfma_f32_32x32x16_bf16 v[80:95], a[228:231], v[100:103], v[80:95]
    ds_read_b128 v[96:99], v1 offset:61440
    s_waitcnt lgkmcnt(2)
    v_mul_f32 v114, v74, v114
    v_mul_f32 v115, v75, v115
    v_mul_f32 v116, v76, v116
    v_mul_f32 v117, v77, v117
    v_mul_f32 v118, v78, v118
    v_mfma_f32_32x32x16_bf16 v[80:95], a[232:235], v[104:107], v[80:95]
    ds_read_b128 v[100:103], v1 offset:62464
    s_waitcnt lgkmcnt(2)
    v_mul_f32 v119, v79, v119
    v_cvt_pk_bf16_f32 v72, v112, v113
    v_cvt_pk_bf16_f32 v73, v114, v115
    v_cvt_pk_bf16_f32 v74, v116, v117
    v_cvt_pk_bf16_f32 v75, v118, v119
    global_load_dwordx4 a[132:135], v1, s[66:67] offset:3072 sc1
    v_mfma_f32_32x32x16_bf16 v[80:95], a[236:239], v[108:111], v[80:95]
    ds_read_b128 v[104:107], v1 offset:63488
    s_waitcnt lgkmcnt(2)
    s_add_u32 s61, s24, 115712
    s_cmp_eq_u32 s12, 0
    s_cbranch_scc1 Lslow_124
    buffer_store_dwordx4 v[72:75], v1, s[4:7], s61 offen
Lback_125:
    v_mfma_f32_32x32x16_bf16 v[80:95], a[240:243], v[96:99], v[80:95]
    ds_read_b128 v[108:111], v1 offset:64512
    s_waitcnt lgkmcnt(2)
    s_add_u32 s66, s42, 22528
    s_addc_u32 s67, s43, 0
    global_load_dwordx4 a[136:139], v1, s[66:67] offset:-4096 sc1
    v_mfma_f32_32x32x16_bf16 v[80:95], a[244:247], v[100:103], v[80:95]
    s_waitcnt lgkmcnt(1)
    v_mfma_f32_32x32x16_bf16 v[80:95], a[248:251], v[104:107], v[80:95]
    s_waitcnt lgkmcnt(0)
    global_load_dwordx4 a[140:143], v1, s[66:67] offset:-3072 sc1
    v_mfma_f32_32x32x16_bf16 v[80:95], a[252:255], v[108:111], v[80:95]
    v_mfma_f32_32x32x16_bf16 v[80:95], v[120:123], v[8:11], v[80:95]
    s_waitcnt vmcnt(13)
    v_mfma_f32_32x32x16_bf16 v[48:63], v[132:135], a[96:99], 0
    s_add_u32 s66, s42, 26624
    s_addc_u32 s67, s43, 0
    global_load_dwordx4 a[144:147], v1, s[66:67] offset:-4096 sc1
    v_mfma_f32_32x32x16_bf16 v[32:47], v[128:131], a[96:99], 0
    global_load_dwordx4 a[148:151], v1, s[66:67] offset:-3072 sc1
    s_nop 4
    v_mul_f32 v112, v126, v80
    v_mul_f32 v113, v126, v81
    v_mul_f32 v114, v126, v82
    v_mul_f32 v115, v126, v83
    v_mul_f32 v116, v126, v84
    s_waitcnt vmcnt(14)
    v_mfma_f32_32x32x16_bf16 v[48:63], v[140:143], a[100:103], v[48:63]
    v_mul_f32 v117, v126, v85
    v_exp_f32 v112, v112
    v_exp_f32 v113, v113
    v_mfma_f32_32x32x16_bf16 v[32:47], v[136:139], a[100:103], v[32:47]
    global_load_dwordx4 a[152:155], v1, s[66:67] offset:0 sc1
    s_waitcnt vmcnt(14)
    v_mfma_f32_32x32x16_bf16 v[48:63], v[148:151], a[104:107], v[48:63]
    global_load_dwordx4 a[156:159], v1, s[66:67] offset:1024 sc1
    v_mul_f32 v118, v126, v86
    v_exp_f32 v114, v114
    v_exp_f32 v115, v115
    v_mfma_f32_32x32x16_bf16 v[32:47], v[144:147], a[104:107], v[32:47]
    v_mul_f32 v119, v126, v87
    v_exp_f32 v116, v116
    v_exp_f32 v117, v117
    s_waitcnt vmcnt(13)
    v_mfma_f32_32x32x16_bf16 v[48:63], v[156:159], a[108:111], v[48:63]
    s_add_u32 s66, s42, 6144
    s_addc_u32 s67, s43, 0
    global_load_dwordx4 a[96:99], v1, s[66:67] offset:-4096 sc1
    v_mfma_f32_32x32x16_bf16 v[32:47], v[152:155], a[108:111], v[32:47]
    global_load_dwordx4 a[100:103], v1, s[66:67] offset:-3072 sc1
    v_add_f32 v112, 1.0, v112
    v_exp_f32 v118, v118
    v_exp_f32 v119, v119
    s_waitcnt vmcnt(14)
    v_mfma_f32_32x32x16_bf16 v[48:63], v[164:167], a[112:115], v[48:63]
    v_add_f32 v113, 1.0, v113
    v_add_f32 v114, 1.0, v114
    v_add_f32 v115, 1.0, v115
    v_rcp_f32 v112, v112
    v_mfma_f32_32x32x16_bf16 v[32:47], v[160:163], a[112:115], v[32:47]
    global_load_dwordx4 a[104:107], v1, s[66:67] offset:0 sc1
    s_waitcnt vmcnt(14)
    v_mfma_f32_32x32x16_bf16 v[48:63], v[172:175], a[116:119], v[48:63]
    global_load_dwordx4 a[108:111], v1, s[66:67] offset:1024 sc1
    v_add_f32 v116, 1.0, v116
    v_rcp_f32 v113, v113
    v_rcp_f32 v114, v114
    v_mfma_f32_32x32x16_bf16 v[32:47], v[168:171], a[116:119], v[32:47]
    v_add_f32 v117, 1.0, v117
    v_rcp_f32 v115, v115
    v_rcp_f32 v116, v116
    s_waitcnt vmcnt(14)
    v_mfma_f32_32x32x16_bf16 v[48:63], v[180:183], a[120:123], v[48:63]
    s_add_u32 s66, s42, 14336
    s_addc_u32 s67, s43, 0
    global_load_dwordx4 a[112:115], v1, s[66:67] offset:-4096 sc1
    v_mfma_f32_32x32x16_bf16 v[32:47], v[176:179], a[120:123], v[32:47]
    global_load_dwordx4 a[116:119], v1, s[66:67] offset:-3072 sc1
    v_add_f32 v118, 1.0, v118
    v_add_f32 v119, 1.0, v119
    v_mul_f32 v112, v80, v112
    v_rcp_f32 v117, v117
    s_waitcnt vmcnt(15)
    v_mfma_f32_32x32x16_bf16 v[48:63], v[188:191], a[124:127], v[48:63]
    v_mul_f32 v113, v81, v113
    v_rcp_f32 v118, v118
    v_rcp_f32 v119, v119
    v_mfma_f32_32x32x16_bf16 v[32:47], v[184:187], a[124:127], v[32:47]
    global_load_dwordx4 a[120:123], v1, s[66:67] offset:2048 sc1
    s_waitcnt vmcnt(15)
    v_mfma_f32_32x32x16_bf16 v[48:63], v[196:199], a[128:131], v[48:63]
    global_load_dwordx4 a[124:127], v1, s[66:67] offset:3072 sc1
    v_mul_f32 v114, v82, v114
    v_mul_f32 v115, v83, v115
    v_mul_f32 v116, v84, v116
    v_mul_f32 v117, v85, v117
    v_mul_f32 v118, v86, v118
    v_mfma_f32_32x32x16_bf16 v[32:47], v[192:195], a[128:131], v[32:47]
    v_mul_f32 v119, v87, v119
    v_cvt_pk_bf16_f32 v80, v112, v113
    v_cvt_pk_bf16_f32 v81, v114, v115
    v_cvt_pk_bf16_f32 v82, v116, v117
    v_cvt_pk_bf16_f32 v83, v118, v119
    s_waitcnt vmcnt(15)
    v_mfma_f32_32x32x16_bf16 v[48:63], v[204:207], a[132:135], v[48:63]
    s_add_u32 s66, s42, 24576
    s_addc_u32 s67, s43, 0
    global_load_dwordx4 a[128:131], v1, s[66:67] offset:-4096 sc1
    v_mfma_f32_32x32x16_bf16 v[32:47], v[200:203], a[132:135], v[32:47]
    global_load_dwordx4 a[132:135], v1, s[66:67] offset:-3072 sc1
    s_add_u32 s61, s25, 114688
    v_add_u32 v84, s14, v1
    s_cmp_eq_u32 s12, 0
    s_cbranch_scc1 Lslow_132
    buffer_store_dwordx4 v[80:83], v84, s[4:7], s61 offen
Lback_133:
    s_waitcnt vmcnt(16)
    v_mfma_f32_32x32x16_bf16 v[48:63], v[212:215], a[136:139], v[48:63]
    v_mul_f32 v112, v126, v88
    v_mul_f32 v113, v126, v89
    v_mul_f32 v114, v126, v90
    v_mul_f32 v115, v126, v91
    v_mul_f32 v116, v126, v92
    v_mfma_f32_32x32x16_bf16 v[32:47], v[208:211], a[136:139], v[32:47]
    global_load_dwordx4 a[136:139], v1, s[66:67] offset:0 sc1
    s_waitcnt vmcnt(16)
    v_mfma_f32_32x32x16_bf16 v[48:63], v[220:223], a[140:143], v[48:63]
    v_mul_f32 v117, v126, v93
    v_exp_f32 v112, v112
    v_exp_f32 v113, v113
    v_mfma_f32_32x32x16_bf16 v[32:47], v[216:219], a[140:143], v[32:47]
    global_load_dwordx4 a[140:143], v1, s[66:67] offset:1024 sc1
    v_mul_f32 v118, v126, v94
    v_exp_f32 v114, v114
    v_exp_f32 v115, v115
    s_waitcnt vmcnt(16)
    v_mfma_f32_32x32x16_bf16 v[48:63], v[228:231], a[144:147], v[48:63]
    v_mfma_f32_32x32x16_bf16 v[32:47], v[224:227], a[144:147], v[32:47]
    v_mul_f32 v119, v126, v95
    v_exp_f32 v116, v116
    v_exp_f32 v117, v117
    s_add_u32 s66, s42, 118784
    s_addc_u32 s67, s43, 0
    global_load_dwordx4 a[144:147], v1, s[66:67] offset:-4096 sc1
    s_waitcnt vmcnt(16)
    v_mfma_f32_32x32x16_bf16 v[48:63], v[236:239], a[148:151], v[48:63]
    v_add_f32 v112, 1.0, v112
    v_exp_f32 v118, v118
    v_exp_f32 v119, v119
    v_mfma_f32_32x32x16_bf16 v[32:47], v[232:235], a[148:151], v[32:47]
    global_load_dwordx4 a[148:151], v1, s[66:67] offset:-3072 sc1
    s_waitcnt vmcnt(16)
    v_mfma_f32_32x32x16_bf16 v[48:63], v[244:247], a[152:155], v[48:63]
    v_add_f32 v113, 1.0, v113
    v_add_f32 v114, 1.0, v114
    v_add_f32 v115, 1.0, v115
    v_rcp_f32 v112, v112
    v_mfma_f32_32x32x16_bf16 v[32:47], v[240:243], a[152:155], v[32:47]
    v_add_f32 v116, 1.0, v116
    v_rcp_f32 v113, v113
    v_rcp_f32 v114, v114
    global_load_dwordx4 a[152:155], v1, s[66:67] offset:0 sc1
    s_waitcnt vmcnt(16)
    v_mfma_f32_32x32x16_bf16 v[48:63], v[252:255], a[156:159], v[48:63]
    v_mfma_f32_32x32x16_bf16 v[32:47], v[248:251], a[156:159], v[32:47]
    v_add_f32 v117, 1.0, v117
    v_rcp_f32 v115, v115
    v_rcp_f32 v116, v116
    global_load_dwordx4 a[156:159], v1, s[66:67] offset:1024 sc1
    s_waitcnt vmcnt(16)
    v_mfma_f32_32x32x16_bf16 v[48:63], a[4:7], a[96:99], v[48:63]
    v_add_f32 v118, 1.0, v118
    v_add_f32 v119, 1.0, v119
    v_mul_f32 v112, v88, v112
    v_rcp_f32 v117, v117
    v_mfma_f32_32x32x16_bf16 v[32:47], a[0:3], a[96:99], v[32:47]
    s_add_u32 s66, s42, 126976
    s_addc_u32 s67, s43, 0
    global_load_dwordx4 a[96:99], v1, s[66:67] offset:-4096 sc1
    s_waitcnt vmcnt(16)
    v_mfma_f32_32x32x16_bf16 v[48:63], a[12:15], a[100:103], v[48:63]
    v_mul_f32 v113, v89, v113
    v_rcp_f32 v118, v118
    v_rcp_f32 v119, v119
    v_mfma_f32_32x32x16_bf16 v[32:47], a[8:11], a[100:103], v[32:47]
    v_mul_f32 v114, v90, v114
    v_mul_f32 v115, v91, v115
    v_mul_f32 v116, v92, v116
    v_mul_f32 v117, v93, v117
    v_mul_f32 v118, v94, v118
    global_load_dwordx4 a[100:103], v1, s[66:67] offset:-3072 sc1
    s_waitcnt vmcnt(16)
    v_mfma_f32_32x32x16_bf16 v[48:63], a[20:23], a[104:107], v[48:63]
    s_add_u32 s61, s30, 67584
    v_add_u32 v124, s61, v1
    ds_read_b128 a[192:195], v124 offset:0
    v_mfma_f32_32x32x16_bf16 v[32:47], a[16:19], a[104:107], v[32:47]
    v_mul_f32 v119, v95, v119
    v_cvt_pk_bf16_f32 v88, v112, v113
    v_cvt_pk_bf16_f32 v89, v114, v115
    v_cvt_pk_bf16_f32 v90, v116, v117
    v_cvt_pk_bf16_f32 v91, v118, v119
    ds_read_b128 a[196:199], v124 offset:1024
    global_load_dwordx4 a[104:107], v1, s[66:67] offset:0 sc1
    s_waitcnt vmcnt(16)
    v_mfma_f32_32x32x16_bf16 v[48:63], a[28:31], a[108:111], v[48:63]
    s_add_u32 s61, s25, 115712
    v_add_u32 v92, s14, v1
    s_cmp_eq_u32 s12, 0
    s_cbranch_scc1 Lslow_134
    buffer_store_dwordx4 v[88:91], v92, s[4:7], s61 offen
Lback_135:
    ds_read_b128 a[200:203], v124 offset:2048
    ds_read_b128 a[204:207], v124 offset:3072
    v_mfma_f32_32x32x16_bf16 v[32:47], a[24:27], a[108:111], v[32:47]
    ds_read_b128 a[208:211], v124 offset:4096
    global_load_dwordx4 a[108:111], v1, s[66:67] offset:1024 sc1
    s_waitcnt vmcnt(17)
    v_mfma_f32_32x32x16_bf16 v[48:63], a[36:39], a[112:115], v[48:63]
    ds_read_b128 a[212:215], v124 offset:5120
    ds_read_b128 a[216:219], v124 offset:6144
    v_mfma_f32_32x32x16_bf16 v[32:47], a[32:35], a[112:115], v[32:47]
    ds_read_b128 a[220:223], v124 offset:7168
    global_load_dwordx4 a[112:115], v1, s[66:67] offset:2048 sc1
    s_waitcnt vmcnt(17)
    v_mfma_f32_32x32x16_bf16 v[48:63], a[44:47], a[116:119], v[48:63]
    s_cmp_eq_u32 s12, 0
    s_cbranch_scc1 Lslow_136
    buffer_store_byte v5, off, s[4:7], s21 offset:512
Lback_137:
    ds_read_b128 a[224:227], v124 offset:8192
    v_mfma_f32_32x32x16_bf16 v[32:47], a[40:43], a[116:119], v[32:47]
    ds_read_b128 a[228:231], v124 offset:9216
    ds_read_b128 a[232:235], v124 offset:10240
    global_load_dwordx4 a[116:119], v1, s[66:67] offset:3072 sc1
    s_waitcnt vmcnt(18)
    v_mfma_f32_32x32x16_bf16 v[48:63], a[52:55], a[120:123], v[48:63]
    ds_read_b128 a[236:239], v124 offset:11264
    s_cmp_eq_u32 s12, 0
    s_cbranch_scc1 Lgate_138
Lback_139:
    s_waitcnt vmcnt(17)
    v_mfma_f32_32x32x16_bf16 v[48:63], a[60:63], a[124:127], v[48:63]
    ds_read_b128 a[240:243], v124 offset:12288
    ds_read_b128 a[244:247], v124 offset:13312
    s_waitcnt vmcnt(16)
    v_mfma_f32_32x32x16_bf16 v[48:63], a[68:71], a[128:131], v[48:63]
    ds_read_b128 a[248:251], v124 offset:14336
    s_waitcnt vmcnt(15)
    v_mfma_f32_32x32x16_bf16 v[48:63], a[76:79], a[132:135], v[48:63]
    ds_read_b128 a[252:255], v124 offset:15360
    s_waitcnt vmcnt(13)
    v_mfma_f32_32x32x16_bf16 v[48:63], a[84:87], a[136:139], v[48:63]
    v_add_u32 v124, s26, v1
    v_add_u32 v125, s27, v1
    v_add_u32 v126, s28, v1
    v_add_u32 v127, s29, v1
    s_waitcnt vmcnt(12)
    v_mfma_f32_32x32x16_bf16 v[48:63], a[92:95], a[140:143], v[48:63]
    v_mfma_f32_32x32x16_bf16 v[32:47], a[48:51], a[120:123], v[32:47]
    v_mfma_f32_32x32x16_bf16 v[32:47], a[56:59], a[124:127], v[32:47]
    v_mfma_f32_32x32x16_bf16 v[32:47], a[64:67], a[128:131], v[32:47]
    s_nop 8
    v_cmp_u_f32 vcc, v48, v48
    v_mfma_f32_32x32x16_bf16 v[32:47], a[72:75], a[132:135], v[32:47]
    s_nop 3
    s_cbranch_vccnz Lredo_143
Lback_144:
Lf2st_131:
    ds_write_b128 v124, v[48:51] offset:2048
    v_mfma_f32_32x32x16_bf16 v[32:47], a[80:83], a[136:139], v[32:47]
    ds_write_b128 v124, v[52:55] offset:3072
    v_mfma_f32_32x32x16_bf16 v[32:47], a[88:91], a[140:143], v[32:47]
    ds_write_b128 v124, v[56:59] offset:4096
    ds_write_b128 v124, v[60:63] offset:5120
    s_add_u32 s66, s42, 137216
    s_addc_u32 s67, s43, 0
    global_load_dwordx4 a[120:123], v1, s[66:67] offset:-4096 sc1
    global_load_dwordx4 a[124:127], v1, s[66:67] offset:-3072 sc1
    s_nop 5
    ds_write_b128 v124, v[40:43] offset:0
    ds_write_b128 v124, v[44:47] offset:1024
    s_waitcnt lgkmcnt(0)
    s_barrier
    ds_read_b128 v[104:107], v126 offset:2048
    ds_read_b128 v[108:111], v126 offset:3072
    ds_read_b128 v[112:115], v127 offset:4096
    ds_read_b128 v[116:119], v127 offset:5120
    ds_read_b128 v[96:99], v125 offset:0
    ds_read_b128 v[100:103], v125 offset:1024
    s_add_u32 s66, s42, 141312
    s_addc_u32 s67, s43, 0
    global_load_dwordx4 a[128:131], v1, s[66:67] offset:-4096 sc1
    global_load_dwordx4 a[132:135], v1, s[66:67] offset:-3072 sc1
    global_load_dwordx4 a[136:139], v1, s[66:67] offset:0 sc1
    global_load_dwordx4 a[140:143], v1, s[66:67] offset:1024 sc1
    v_lshlrev_b32 v40, 16, v16
    v_and_b32 v41, 0xffff0000, v16
    v_lshlrev_b32 v42, 16, v17
    v_and_b32 v43, 0xffff0000, v17
    v_lshlrev_b32 v44, 16, v18
    v_and_b32 v45, 0xffff0000, v18
    v_lshlrev_b32 v46, 16, v19
    v_and_b32 v47, 0xffff0000, v19
    s_waitcnt lgkmcnt(5)
    v_pk_add_f32 v[32:33], v[32:33], v[104:105]
    v_pk_add_f32 v[34:35], v[34:35], v[106:107]
    s_waitcnt lgkmcnt(4)
    v_pk_add_f32 v[36:37], v[36:37], v[108:109]
    v_pk_add_f32 v[38:39], v[38:39], v[110:111]
    s_waitcnt lgkmcnt(3)
    v_pk_add_f32 v[32:33], v[32:33], v[112:113]
    v_pk_add_f32 v[34:35], v[34:35], v[114:115]
    s_waitcnt lgkmcnt(2)
    v_pk_add_f32 v[36:37], v[36:37], v[116:117]
    v_pk_add_f32 v[38:39], v[38:39], v[118:119]
    s_waitcnt lgkmcnt(1)
    v_pk_add_f32 v[32:33], v[32:33], v[96:97]
    v_pk_add_f32 v[34:35], v[34:35], v[98:99]
    s_waitcnt lgkmcnt(0)
    v_pk_add_f32 v[36:37], v[36:37], v[100:101]
    v_pk_add_f32 v[38:39], v[38:39], v[102:103]
    v_fma_f32 v32, v6, v32, v40
    v_fma_f32 v33, v6, v33, v41
    v_fma_f32 v34, v6, v34, v42
    v_fma_f32 v35, v6, v35, v43
    v_fma_f32 v36, v6, v36, v44
    v_fma_f32 v37, v6, v37, v45
    v_fma_f32 v38, v6, v38, v46
    v_fma_f32 v39, v6, v39, v47
    s_add_u32 s61, s20, 131072
    s_add_u32 s62, s23, 442368
    v_cvt_pk_bf16_f32 v16, v32, v33
    v_cvt_pk_bf16_f32 v17, v34, v35
    v_cvt_pk_bf16_f32 v18, v36, v37
    v_cvt_pk_bf16_f32 v19, v38, v39
    v_dot2_f32_bf16 v40, v16, v4, 0
    v_dot2_f32_bf16 v41, v16, v16, 0
    v_dot2_f32_bf16 v40, v17, v4, v40
    v_dot2_f32_bf16 v41, v17, v17, v41
    v_dot2_f32_bf16 v40, v18, v4, v40
    v_dot2_f32_bf16 v41, v18, v18, v41
    v_dot2_f32_bf16 v40, v19, v4, v40
    v_dot2_f32_bf16 v41, v19, v19, v41
    s_nop 2
    v_permlane32_swap_b32 v40, v41
    v_add_f32 v40, v40, v41
    s_cmp_eq_u32 s12, 0
    s_cbranch_scc1 Lslow_148
    buffer_store_dwordx4 v[16:19], v1, s[4:7], s61 offen
    buffer_store_dword v40, v1, s[4:7], s62 offen
Lback_149:
Lf2st_150:
    s_waitcnt vmcnt(19)
    v_mfma_f32_32x32x16_bf16 v[80:95], v[132:135], a[144:147], 0
    v_mfma_f32_32x32x16_bf16 v[64:79], v[128:131], a[144:147], 0
    s_add_u32 s66, s42, 120832
    s_addc_u32 s67, s43, 0
    global_load_dwordx4 a[144:147], v1, s[66:67] offset:-4096 sc1
    s_waitcnt vmcnt(19)
    v_mfma_f32_32x32x16_bf16 v[80:95], v[140:143], a[148:151], v[80:95]
    s_waitcnt vmcnt(13)
    s_cmp_eq_u32 s12, 0
    s_cbranch_scc1 Lslow_151
    buffer_store_byte v5, off, s[4:7], s21 offset:640
Lback_152:
    v_mfma_f32_32x32x16_bf16 v[64:79], v[136:139], a[148:151], v[64:79]
    global_load_dwordx4 a[148:151], v1, s[66:67] offset:-3072 sc1
    v_mfma_f32_32x32x16_bf16 v[80:95], v[148:151], a[152:155], v[80:95]
    v_mfma_f32_32x32x16_bf16 v[64:79], v[144:147], a[152:155], v[64:79]
    global_load_dwordx4 a[152:155], v1, s[66:67] offset:0 sc1
    v_mfma_f32_32x32x16_bf16 v[80:95], v[156:159], a[156:159], v[80:95]
    v_mfma_f32_32x32x16_bf16 v[64:79], v[152:155], a[156:159], v[64:79]
    global_load_dwordx4 a[156:159], v1, s[66:67] offset:1024 sc1
    v_mfma_f32_32x32x16_bf16 v[80:95], v[164:167], a[96:99], v[80:95]
    v_mfma_f32_32x32x16_bf16 v[64:79], v[160:163], a[96:99], v[64:79]
    s_add_u32 s66, s42, 129024
    s_addc_u32 s67, s43, 0
    global_load_dwordx4 a[96:99], v1, s[66:67] offset:-4096 sc1
    v_mfma_f32_32x32x16_bf16 v[80:95], v[172:175], a[100:103], v[80:95]
    v_mfma_f32_32x32x16_bf16 v[64:79], v[168:171], a[100:103], v[64:79]
    global_load_dwordx4 a[100:103], v1, s[66:67] offset:-3072 sc1
    v_mfma_f32_32x32x16_bf16 v[80:95], v[180:183], a[104:107], v[80:95]
    v_mfma_f32_32x32x16_bf16 v[64:79], v[176:179], a[104:107], v[64:79]
    global_load_dwordx4 a[104:107], v1, s[66:67] offset:2048 sc1
    s_waitcnt vmcnt(19)
    v_mfma_f32_32x32x16_bf16 v[80:95], v[188:191], a[108:111], v[80:95]
    v_mfma_f32_32x32x16_bf16 v[64:79], v[184:187], a[108:111], v[64:79]
    global_load_dwordx4 a[108:111], v1, s[66:67] offset:3072 sc1
    s_waitcnt vmcnt(19)
    v_mfma_f32_32x32x16_bf16 v[80:95], v[196:199], a[112:115], v[80:95]
    v_mfma_f32_32x32x16_bf16 v[64:79], v[192:195], a[112:115], v[64:79]
    s_add_u32 s66, s42, 139264
    s_addc_u32 s67, s43, 0
    global_load_dwordx4 a[112:115], v1, s[66:67] offset:-4096 sc1
    s_waitcnt vmcnt(18)
    v_mfma_f32_32x32x16_bf16 v[80:95], v[204:207], a[116:119], v[80:95]
    v_mfma_f32_32x32x16_bf16 v[64:79], v[200:203], a[116:119], v[64:79]
    global_load_dwordx4 a[116:119], v1, s[66:67] offset:-3072 sc1
    s_waitcnt vmcnt(18)
    v_mfma_f32_32x32x16_bf16 v[80:95], v[212:215], a[120:123], v[80:95]
    v_mfma_f32_32x32x16_bf16 v[64:79], v[208:211], a[120:123], v[64:79]
    global_load_dwordx4 a[120:123], v1, s[66:67] offset:0 sc1
    s_waitcnt vmcnt(18)
    v_mfma_f32_32x32x16_bf16 v[80:95], v[220:223], a[124:127], v[80:95]
    v_mfma_f32_32x32x16_bf16 v[64:79], v[216:219], a[124:127], v[64:79]
    global_load_dwordx4 a[124:127], v1, s[66:67] offset:1024 sc1
    s_waitcnt vmcnt(18)
    v_mfma_f32_32x32x16_bf16 v[80:95], v[228:231], a[128:131], v[80:95]
    s_cmp_ge_u32 s18, 2
    s_cbranch_scc1 Lnokv_153
    s_add_u32 s68, s4, s19
    s_addc_u32 s69, s5, 0
    s_add_u32 s68, s68, 4722688
    s_addc_u32 s69, s69, 0
    global_load_dwordx4 a[160:163], v1, s[68:69] offset:-4096
    global_load_dwordx4 a[164:167], v1, s[68:69] offset:-3072
    global_load_dwordx4 a[168:171], v1, s[68:69] offset:-2048
    global_load_dwordx4 a[172:175], v1, s[68:69] offset:-1024
    global_load_dwordx4 a[176:179], v1, s[68:69] offset:0
    global_load_dwordx4 a[180:183], v1, s[68:69] offset:1024
    global_load_dwordx4 a[184:187], v1, s[68:69] offset:2048
    global_load_dwordx4 a[188:191], v1, s[68:69] offset:3072
Lnokv_153:
    v_mfma_f32_32x32x16_bf16 v[64:79], v[224:227], a[128:131], v[64:79]
    s_waitcnt vmcnt(17)
    v_mfma_f32_32x32x16_bf16 v[80:95], v[236:239], a[132:135], v[80:95]
    s_cmp_eq_u32 s12, 0
    s_cbranch_scc1 Lgate_154
Lback_155:
    s_add_u32 s64, s40, 446464
    s_addc_u32 s65, s41, 0
    global_load_dwordx4 v[24:27], v1, s[64:65] offset:-4096 sc1
    v_mfma_f32_32x32x16_bf16 v[64:79], v[232:235], a[132:135], v[64:79]
    s_waitcnt vmcnt(17)
    v_mfma_f32_32x32x16_bf16 v[80:95], v[244:247], a[136:139], v[80:95]
    global_load_dwordx4 v[28:31], v1, s[64:65] offset:-3072 sc1
    v_mfma_f32_32x32x16_bf16 v[64:79], v[240:243], a[136:139], v[64:79]
    s_waitcnt vmcnt(17)
    v_mfma_f32_32x32x16_bf16 v[80:95], v[252:255], a[140:143], v[80:95]
    s_add_u32 s64, s38, 135168
    s_addc_u32 s65, s39, 0
    global_load_dwordx4 v[32:35], v1, s[64:65] offset:-4096 sc1
    v_mfma_f32_32x32x16_bf16 v[64:79], v[248:251], a[140:143], v[64:79]
    s_waitcnt vmcnt(15)
    v_mfma_f32_32x32x16_bf16 v[80:95], a[4:7], a[144:147], v[80:95]
    global_load_dwordx4 v[36:39], v1, s[64:65] offset:-3072 sc1
    v_mfma_f32_32x32x16_bf16 v[64:79], a[0:3], a[144:147], v[64:79]
    s_waitcnt vmcnt(14)
    v_mfma_f32_32x32x16_bf16 v[80:95], a[12:15], a[148:151], v[80:95]
    global_load_dwordx4 v[40:43], v1, s[64:65] offset:-2048 sc1
    s_cmp_eq_u32 s12, 0
    s_cbranch_scc1 Lslow_159
    buffer_store_byte v5, off, s[4:7], s21 offset:768
Lback_160:
    v_mfma_f32_32x32x16_bf16 v[64:79], a[8:11], a[148:151], v[64:79]
    s_waitcnt vmcnt(15)
    v_mfma_f32_32x32x16_bf16 v[80:95], a[20:23], a[152:155], v[80:95]
    global_load_dwordx4 v[44:47], v1, s[64:65] offset:-1024 sc1
    v_mfma_f32_32x32x16_bf16 v[64:79], a[16:19], a[152:155], v[64:79]
    s_waitcnt vmcnt(15)
    v_mfma_f32_32x32x16_bf16 v[80:95], a[28:31], a[156:159], v[80:95]
    global_load_dwordx4 v[48:51], v1, s[64:65] offset:0 sc1
    v_mfma_f32_32x32x16_bf16 v[64:79], a[24:27], a[156:159], v[64:79]
    s_waitcnt vmcnt(15)
    v_mfma_f32_32x32x16_bf16 v[80:95], a[36:39], a[96:99], v[80:95]
    global_load_dwordx4 v[52:55], v1, s[64:65] offset:1024 sc1
    v_mfma_f32_32x32x16_bf16 v[64:79], a[32:35], a[96:99], v[64:79]
    s_waitcnt vmcnt(15)
    v_mfma_f32_32x32x16_bf16 v[80:95], a[44:47], a[100:103], v[80:95]
    global_load_dwordx4 v[56:59], v1, s[64:65] offset:2048 sc1
    v_mfma_f32_32x32x16_bf16 v[64:79], a[40:43], a[100:103], v[64:79]
    s_waitcnt vmcnt(15)
    v_mfma_f32_32x32x16_bf16 v[80:95], a[52:55], a[104:107], v[80:95]
    global_load_dwordx4 v[60:63], v1, s[64:65] offset:3072 sc1
    s_waitcnt vmcnt(15)
    v_mfma_f32_32x32x16_bf16 v[80:95], a[60:63], a[108:111], v[80:95]
    s_waitcnt vmcnt(14)
    v_mfma_f32_32x32x16_bf16 v[80:95], a[68:71], a[112:115], v[80:95]
    s_waitcnt vmcnt(13)
    v_mfma_f32_32x32x16_bf16 v[80:95], a[76:79], a[116:119], v[80:95]
    s_waitcnt vmcnt(12)
    v_mfma_f32_32x32x16_bf16 v[80:95], a[84:87], a[120:123], v[80:95]
    v_add_u32 v124, s30, v1
    v_add_u32 v125, s31, v1
    v_add_u32 v126, s32, v1
    v_add_u32 v127, s33, v1
    s_waitcnt vmcnt(11)
    v_mfma_f32_32x32x16_bf16 v[80:95], a[92:95], a[124:127], v[80:95]
    v_mfma_f32_32x32x16_bf16 v[64:79], a[48:51], a[104:107], v[64:79]
    v_mfma_f32_32x32x16_bf16 v[64:79], a[56:59], a[108:111], v[64:79]
    v_mfma_f32_32x32x16_bf16 v[64:79], a[64:67], a[112:115], v[64:79]
    s_nop 8
    v_cmp_u_f32 vcc, v80, v80
    v_mfma_f32_32x32x16_bf16 v[64:79], a[72:75], a[116:119], v[64:79]
    s_nop 3
    s_cbranch_vccnz Lredo_161
Lback_162:
    ds_write_b128 v124, v[80:83] offset:2048
    v_mfma_f32_32x32x16_bf16 v[64:79], a[80:83], a[120:123], v[64:79]
    v_lshrrev_b32 v96, 1, v2
    s_lshr_b32 s61, s16, 1
    s_lshl_b32 s62, s18, 1
    s_add_u32 s61, s61, s62
    s_lshl_b32 s61, s61, 9
    s_add_u32 s61, s61, 4751360
    buffer_load_dwordx2 v[210:211], v96, s[4:7], s61 offen
    s_xor_b32 s61, s61, 512
    buffer_load_dwordx2 v[212:213], v96, s[4:7], s61 offen
    v_lshrrev_b32 v96, 1, v1
    s_mov_b32 s61, 4759552
    buffer_load_dwordx2 v[208:209], v96, s[4:7], s61 offen
    ds_write_b128 v124, v[84:87] offset:3072
    v_mfma_f32_32x32x16_bf16 v[64:79], a[88:91], a[124:127], v[64:79]
    ds_write_b128 v124, v[88:91] offset:4096
    ds_write_b128 v124, v[92:95] offset:5120
    s_nop 9
    ds_write_b128 v124, v[72:75] offset:0
    ds_write_b128 v124, v[76:79] offset:1024
    s_waitcnt lgkmcnt(0)
    s_barrier
    ds_read_b128 v[104:107], v126 offset:2048
    ds_read_b128 v[108:111], v126 offset:3072
    ds_read_b128 v[112:115], v127 offset:4096
    ds_read_b128 v[116:119], v127 offset:5120
    ds_read_b128 v[96:99], v125 offset:0
    ds_read_b128 v[100:103], v125 offset:1024
    v_lshlrev_b32 v72, 16, v20
    v_and_b32 v73, 0xffff0000, v20
    v_lshlrev_b32 v74, 16, v21
    v_and_b32 v75, 0xffff0000, v21
    v_lshlrev_b32 v76, 16, v22
    v_and_b32 v77, 0xffff0000, v22
    v_lshlrev_b32 v78, 16, v23
    v_and_b32 v79, 0xffff0000, v23
    s_waitcnt lgkmcnt(5)
    v_pk_add_f32 v[64:65], v[64:65], v[104:105]
    v_pk_add_f32 v[66:67], v[66:67], v[106:107]
    s_waitcnt lgkmcnt(4)
    v_pk_add_f32 v[68:69], v[68:69], v[108:109]
    v_pk_add_f32 v[70:71], v[70:71], v[110:111]
    s_waitcnt lgkmcnt(3)
    v_pk_add_f32 v[64:65], v[64:65], v[112:113]
    v_pk_add_f32 v[66:67], v[66:67], v[114:115]
    s_waitcnt lgkmcnt(2)
    v_pk_add_f32 v[68:69], v[68:69], v[116:117]
    v_pk_add_f32 v[70:71], v[70:71], v[118:119]
    s_waitcnt lgkmcnt(1)
    v_pk_add_f32 v[64:65], v[64:65], v[96:97]
    v_pk_add_f32 v[66:67], v[66:67], v[98:99]
    s_waitcnt lgkmcnt(0)
    v_pk_add_f32 v[68:69], v[68:69], v[100:101]
    v_pk_add_f32 v[70:71], v[70:71], v[102:103]
    v_fma_f32 v64, v7, v64, v72
    v_fma_f32 v65, v7, v65, v73
    v_fma_f32 v66, v7, v66, v74
    v_fma_f32 v67, v7, v67, v75
    v_fma_f32 v68, v7, v68, v76
    v_fma_f32 v69, v7, v69, v77
    v_fma_f32 v70, v7, v70, v78
    v_fma_f32 v71, v7, v71, v79
    s_add_u32 s61, s20, 163840
    s_add_u32 s62, s23, 450560
    v_cvt_pk_bf16_f32 v20, v64, v65
    v_cvt_pk_bf16_f32 v21, v66, v67
    v_cvt_pk_bf16_f32 v22, v68, v69
    v_cvt_pk_bf16_f32 v23, v70, v71
    v_dot2_f32_bf16 v72, v20, v4, 0
    v_dot2_f32_bf16 v73, v20, v20, 0
    v_dot2_f32_bf16 v72, v21, v4, v72
    v_dot2_f32_bf16 v73, v21, v21, v73
    v_dot2_f32_bf16 v72, v22, v4, v72
    v_dot2_f32_bf16 v73, v22, v22, v73
    v_dot2_f32_bf16 v72, v23, v4, v72
    v_dot2_f32_bf16 v73, v23, v23, v73
    s_nop 2
    v_permlane32_swap_b32 v72, v73
    v_add_f32 v72, v72, v73
    s_cmp_eq_u32 s12, 0
    s_cbranch_scc1 Lslow_166
    buffer_store_dwordx4 v[20:23], v1, s[4:7], s61 offen
    buffer_store_dword v72, v1, s[4:7], s62 offen
Lback_167:
    v_add_u32 v124, s26, v1
    v_add_u32 v125, s27, v1
    v_add_u32 v126, s28, v1
    v_add_u32 v127, s29, v1
Lqst_168:
    s_waitcnt vmcnt(14)
    v_add_f32 v24, v24, v28
    v_add_f32 v25, v25, v29
    v_add_f32 v26, v26, v30
    v_add_f32 v27, v27, v31
    v_add_f32 v24, v24, v26
    v_add_f32 v25, v25, v27
    v_add_f32 v24, v24, v25
    v_cmp_u_f32 vcc, v24, v24
    v_add_u32 v25, s26, v3
    ds_write_b32 v25, v24 offset:6656
    v_mul_f32 v25, 0xbb000000, v24
    v_cvt_pk_bf16_f32 v10, v25, v25
    v_and_b32 v11, 0xffff0000, v10
    v_sub_f32 v25, v25, v11
    v_cvt_pk_bf16_f32 v11, v25, v25
    s_cbranch_vccnz Lredo_169
Lback_170:
    s_mov_b32 s15, 0
    s_cmp_lg_u32 s18, 0
    s_cbranch_scc1 Lnkv_174
    v_add_u32 v26, s30, v1
    s_lshl_b32 s61, s16, 11
    s_add_u32 s61, s61, 0
    v_add_u32 v27, s61, v1
    v_add_u32 v28, 0, v1
    s_waitcnt vmcnt(13)
    v_mfma_f32_32x32x16_bf16 v[128:143], a[160:163], v[32:35], 0
    s_waitcnt vmcnt(12)
    v_mfma_f32_32x32x16_bf16 v[128:143], a[164:167], v[36:39], v[128:143]
    s_waitcnt vmcnt(11)
    v_mfma_f32_32x32x16_bf16 v[128:143], a[168:171], v[40:43], v[128:143]
    s_waitcnt vmcnt(9)
    v_mfma_f32_32x32x16_bf16 v[128:143], a[172:175], v[44:47], v[128:143]
    s_waitcnt vmcnt(8)
    v_mfma_f32_32x32x16_bf16 v[128:143], a[176:179], v[48:51], v[128:143]
    s_waitcnt vmcnt(7)
    v_mfma_f32_32x32x16_bf16 v[128:143], a[180:183], v[52:55], v[128:143]
    s_waitcnt vmcnt(6)
    v_mfma_f32_32x32x16_bf16 v[128:143], a[184:187], v[56:59], v[128:143]
    s_waitcnt vmcnt(5)
    v_mfma_f32_32x32x16_bf16 v[128:143], a[188:191], v[60:63], v[128:143]
    s_waitcnt vmcnt(2)
    v_mfma_f32_32x32x16_bf16 v[128:143], v[208:211], v[10:13], v[128:143]
    s_nop 11
    v_cmp_u_f32 vcc, v128, v128
    s_nop 4
    s_cbranch_vccnz Lredo_177
Lback_178:
    s_mov_b32 s3, 7
    ds_write_b128 v26, v[128:131] offset:8192
    ds_write_b128 v26, v[132:135] offset:9216
    ds_write_b128 v26, v[136:139] offset:10240
    ds_write_b128 v26, v[140:143] offset:11264
    s_waitcnt lgkmcnt(0)
    s_barrier
    s_cmp_ge_u32 s16, 2
    s_cbranch_scc1 Lnkv_174
    v_add_u32 v99, 135168, v3
    ds_read_b32 v96, v99 offset:6656
    ds_read_b32 v97, v99 offset:13824
    ds_read_b32 v98, v99 offset:20992
    ds_read_b32 v99, v99 offset:28160
    v_mfma_f32_32x32x16_bf16 v[80:95], a[224:227], v[32:35], 0
    ds_read_b128 v[224:227], v27 offset:8192
    ds_read_b128 v[228:231], v27 offset:9216
    ds_read_b128 v[232:235], v27 offset:24576
    ds_read_b128 v[236:239], v27 offset:25600
    ds_read_b128 v[240:243], v27 offset:40960
    ds_read_b128 v[244:247], v27 offset:41984
    v_mfma_f32_32x32x16_bf16 v[80:95], a[228:231], v[36:39], v[80:95]
    ds_read_b128 v[248:251], v27 offset:57344
    ds_read_b128 v[252:255], v27 offset:58368
    s_mul_i32 s61, s17, 2112
    s_add_u32 s61, s61, 4984832
    s_lshl_b32 s15, s17, 8
    s_add_u32 s15, s15, 5136384
    s_waitcnt lgkmcnt(8)
    v_add_f32 v96, v96, v98
    v_mfma_f32_32x32x16_bf16 v[80:95], a[232:235], v[40:43], v[80:95]
    v_add_f32 v97, v97, v99
    v_add_f32 v96, v96, v97
    v_mov_b32 v97, v96
    s_nop 1
    v_permlane32_swap_b32 v96, v97
    v_mul_f32 v98, 0x3b000000, v96
    v_mfma_f32_32x32x16_bf16 v[80:95], a[236:239], v[44:47], v[80:95]
    v_mul_f32 v97, 0x3b000000, v97
    v_fma_f32 v97, -v98, v98, v97
    v_max_f32 v97, 0, v97
    v_add_f32 v97, 0x3727c5ac, v97
    v_rsq_f32 v100, v97
    s_mul_i32 s62, s16, 16384
    v_mfma_f32_32x32x16_bf16 v[80:95], a[240:243], v[48:51], v[80:95]
    v_add_u32 v28, s62, v28
    s_add_u32 s62, s62, 0
    v_bfe_u32 v96, v0, 3, 2
    v_mul_u32_u24 v96, 272, v96
    v_add_u32 v96, s62, v96
    v_and_b32 v97, 7, v0
    v_mfma_f32_32x32x16_bf16 v[80:95], a[244:247], v[52:55], v[80:95]
    v_lshl_add_u32 v97, v97, 1, v96
    v_lshrrev_b32 v98, 5, v0
    v_lshl_add_u32 v97, v98, 6, v97
    s_waitcnt lgkmcnt(5)
    v_add_f32 v224, v224, v232
    v_mfma_f32_32x32x16_bf16 v[80:95], a[248:251], v[56:59], v[80:95]
    v_add_f32 v225, v225, v233
    v_add_f32 v226, v226, v234
    v_add_f32 v227, v227, v235
    s_waitcnt lgkmcnt(4)
    v_add_f32 v228, v228, v236
    v_add_f32 v229, v229, v237
    v_mfma_f32_32x32x16_bf16 v[80:95], a[252:255], v[60:63], v[80:95]
    v_add_f32 v230, v230, v238
    v_add_f32 v231, v231, v239
    s_waitcnt lgkmcnt(3)
    v_add_f32 v224, v224, v240
    v_add_f32 v225, v225, v241
    v_mfma_f32_32x32x16_bf16 v[80:95], v[210:213], v[8:11], v[80:95]
    v_add_f32 v226, v226, v242
    v_add_f32 v227, v227, v243
    s_waitcnt lgkmcnt(2)
    v_add_f32 v228, v228, v244
    v_add_f32 v229, v229, v245
    v_add_f32 v230, v230, v246
    v_mfma_f32_32x32x16_bf16 v[64:79], a[192:195], v[32:35], 0
    v_add_f32 v231, v231, v247
    s_waitcnt lgkmcnt(1)
    v_add_f32 v224, v224, v248
    v_add_f32 v225, v225, v249
    v_add_f32 v226, v226, v250
    v_add_f32 v227, v227, v251
    v_mfma_f32_32x32x16_bf16 v[64:79], a[196:199], v[36:39], v[64:79]
    s_waitcnt lgkmcnt(0)
    v_add_f32 v228, v228, v252
    v_add_f32 v229, v229, v253
    v_add_f32 v230, v230, v254
    v_add_f32 v231, v231, v255
    v_mfma_f32_32x32x16_bf16 v[64:79], a[200:203], v[40:43], v[64:79]
    v_mul_f32 v224, v100, v224
    v_mul_f32 v225, v100, v225
    v_mul_f32 v226, v100, v226
    v_mul_f32 v227, v100, v227
    v_mul_f32 v228, v100, v228
    v_mul_f32 v229, v100, v229
    v_mfma_f32_32x32x16_bf16 v[64:79], a[204:207], v[44:47], v[64:79]
    v_mul_f32 v230, v100, v230
    v_mul_f32 v231, v100, v231
    v_cvt_pk_bf16_f32 v232, v224, v225
    v_cvt_pk_bf16_f32 v233, v226, v227
    v_cvt_pk_bf16_f32 v234, v228, v229
    v_cvt_pk_bf16_f32 v235, v230, v231
    v_mfma_f32_32x32x16_bf16 v[64:79], a[208:211], v[48:51], v[64:79]
    ds_write_b128 v124, v[80:83] offset:2048
    s_cmp_eq_u32 s16, 1
    s_cbranch_scc1 Lv_175
    buffer_store_dwordx4 v[232:235], v1, s[4:7], s61 offen sc1
    v_mov_b32 v14, s1
    s_mov_b64 exec, 1
    buffer_store_dword v14, off, s[4:7], s15 sc1
    s_mov_b64 exec, -1
Lv_175:
    ds_write_b16 v97, v232 offset:12288
    ds_write_b16_d16_hi v97, v232 offset:12304
    ds_write_b16 v97, v233 offset:12320
    ds_write_b16_d16_hi v97, v233 offset:12336
    v_mfma_f32_32x32x16_bf16 v[64:79], a[212:215], v[52:55], v[64:79]
    ds_write_b128 v124, v[84:87] offset:3072
    ds_write_b16 v97, v234 offset:12416
    ds_write_b16_d16_hi v97, v234 offset:12432
    ds_write_b16 v97, v235 offset:12448
    ds_write_b16_d16_hi v97, v235 offset:12464
    v_mov_b32 v224, v4
    v_mov_b32 v225, v4
    v_mfma_f32_32x32x16_bf16 v[64:79], a[216:219], v[56:59], v[64:79]
    ds_write_b128 v124, v[88:91] offset:4096
    v_mov_b32 v226, v4
    v_mov_b32 v227, v4
    ds_write_b128 v96, v[224:227] offset:12544
    ds_read_b128 v[236:239], v28 offset:12288
    ds_read_b128 v[240:243], v28 offset:13312
    v_mfma_f32_32x32x16_bf16 v[64:79], a[220:223], v[60:63], v[64:79]
    ds_write_b128 v124, v[92:95] offset:5120
    v_mfma_f32_32x32x16_bf16 v[64:79], v[210:213], v[10:13], v[64:79]
    s_cmp_eq_u32 s16, 0
    s_cbranch_scc1 Lkf_176
    s_waitcnt lgkmcnt(1)
    s_add_u32 s15, s15, 128
    buffer_store_dwordx4 v[236:239], v1, s[4:7], s61 offen offset:1024 sc1
    s_mov_b64 exec, 15
    buffer_store_dwordx4 v[240:243], v1, s[4:7], s61 offen offset:2048 sc1
    v_mov_b32 v14, s1
    s_mov_b64 exec, 1
    buffer_store_dword v14, off, s[4:7], s15 sc1
    s_mov_b64 exec, -1
Lkf_176:
    s_branch Lkj_182
Lnkv_174:
    s_waitcnt vmcnt(13)
    v_mfma_f32_32x32x16_bf16 v[80:95], a[224:227], v[32:35], 0
    s_waitcnt vmcnt(12)
    v_mfma_f32_32x32x16_bf16 v[80:95], a[228:231], v[36:39], v[80:95]
    s_waitcnt vmcnt(11)
    v_mfma_f32_32x32x16_bf16 v[80:95], a[232:235], v[40:43], v[80:95]
    s_waitcnt vmcnt(9)
    v_mfma_f32_32x32x16_bf16 v[80:95], a[236:239], v[44:47], v[80:95]
    s_waitcnt vmcnt(8)
    v_mfma_f32_32x32x16_bf16 v[80:95], a[240:243], v[48:51], v[80:95]
    s_waitcnt vmcnt(7)
    v_mfma_f32_32x32x16_bf16 v[80:95], a[244:247], v[52:55], v[80:95]
    s_waitcnt vmcnt(6)
    v_mfma_f32_32x32x16_bf16 v[80:95], a[248:251], v[56:59], v[80:95]
    s_waitcnt vmcnt(5)
    v_mfma_f32_32x32x16_bf16 v[80:95], a[252:255], v[60:63], v[80:95]
    s_waitcnt vmcnt(2)
    v_mfma_f32_32x32x16_bf16 v[80:95], v[210:213], v[8:11], v[80:95]
    v_mfma_f32_32x32x16_bf16 v[64:79], a[192:195], v[32:35], 0
    v_mfma_f32_32x32x16_bf16 v[64:79], a[196:199], v[36:39], v[64:79]
    v_mfma_f32_32x32x16_bf16 v[64:79], a[200:203], v[40:43], v[64:79]
    v_mfma_f32_32x32x16_bf16 v[64:79], a[204:207], v[44:47], v[64:79]
    s_nop 7
    v_cmp_u_f32 vcc, v80, v80
    v_mfma_f32_32x32x16_bf16 v[64:79], a[208:211], v[48:51], v[64:79]
    s_nop 3
    s_cbranch_vccnz Lredo_183
Lback_184:
    v_mfma_f32_32x32x16_bf16 v[64:79], a[212:215], v[52:55], v[64:79]
    ds_write_b128 v124, v[80:83] offset:2048
    v_mfma_f32_32x32x16_bf16 v[64:79], a[216:219], v[56:59], v[64:79]
    ds_write_b128 v124, v[84:87] offset:3072
    v_mfma_f32_32x32x16_bf16 v[64:79], a[220:223], v[60:63], v[64:79]
    ds_write_b128 v124, v[88:91] offset:4096
    v_mfma_f32_32x32x16_bf16 v[64:79], v[210:213], v[10:13], v[64:79]
    ds_write_b128 v124, v[92:95] offset:5120
Lkj_182:
    s_cmp_eq_u32 s12, 0
    s_cbranch_scc1 Lgate_189
Lback_190:
    s_add_u32 s64, s40, 454656
    s_addc_u32 s65, s41, 0
    global_load_dwordx4 v[200:203], v1, s[64:65] offset:-4096 sc1
    global_load_dwordx4 v[204:207], v1, s[64:65] offset:-3072 sc1
    s_add_u32 s64, s38, 167936
    s_addc_u32 s65, s39, 0
    global_load_dwordx4 v[160:163], v1, s[64:65] offset:-4096 sc1
    global_load_dwordx4 v[164:167], v1, s[64:65] offset:-3072 sc1
    global_load_dwordx4 v[168:171], v1, s[64:65] offset:-2048 sc1
    ds_write_b128 v124, v[72:75] offset:0
    ds_write_b128 v124, v[76:79] offset:1024
    s_waitcnt lgkmcnt(0)
    s_barrier
    v_add_u32 v31, 135168, v3
    ds_read_b32 v28, v31 offset:6656
    ds_read_b32 v29, v31 offset:13824
    ds_read_b32 v30, v31 offset:20992
    ds_read_b32 v31, v31 offset:28160
    ds_read_b128 v[104:107], v126 offset:2048
    ds_read_b128 v[108:111], v126 offset:3072
    ds_read_b128 v[112:115], v127 offset:4096
    ds_read_b128 v[116:119], v127 offset:5120
    ds_read_b128 v[96:99], v125 offset:0
    ds_read_b128 v[100:103], v125 offset:1024
    s_waitcnt lgkmcnt(6)
    global_load_dwordx4 v[172:175], v1, s[64:65] offset:-1024 sc1
    v_add_f32 v28, v28, v30
    v_add_f32 v29, v29, v31
    global_load_dwordx4 v[176:179], v1, s[64:65] offset:0 sc1
    v_add_f32 v28, v28, v29
    v_mov_b32 v29, v28
    global_load_dwordx4 v[180:183], v1, s[64:65] offset:1024 sc1
    s_nop 0
    v_permlane32_swap_b32 v28, v29
    v_mul_f32 v30, 0x3b000000, v28
    v_mul_f32 v29, 0x3b000000, v29
    global_load_dwordx4 v[184:187], v1, s[64:65] offset:2048 sc1
    v_fma_f32 v29, -v30, v30, v29
    v_max_f32 v29, 0, v29
    global_load_dwordx4 v[188:191], v1, s[64:65] offset:3072 sc1
    v_add_f32 v29, 0x3727c5ac, v29
    v_rsq_f32 v24, v29
    s_nop 0
    v_mul_f32 v24, 0x3eb8aa3b, v24
    v_mov_b32 v25, v24
    s_waitcnt lgkmcnt(5)
    v_pk_add_f32 v[64:65], v[64:65], v[104:105]
    v_pk_add_f32 v[66:67], v[66:67], v[106:107]
    s_waitcnt lgkmcnt(4)
    v_pk_add_f32 v[68:69], v[68:69], v[108:109]
    v_pk_add_f32 v[70:71], v[70:71], v[110:111]
    s_waitcnt lgkmcnt(3)
    v_pk_add_f32 v[64:65], v[64:65], v[112:113]
    v_pk_add_f32 v[66:67], v[66:67], v[114:115]
    s_waitcnt lgkmcnt(2)
    v_pk_add_f32 v[68:69], v[68:69], v[116:117]
    v_pk_add_f32 v[70:71], v[70:71], v[118:119]
    s_waitcnt lgkmcnt(1)
    v_pk_add_f32 v[64:65], v[64:65], v[96:97]
    v_pk_add_f32 v[66:67], v[66:67], v[98:99]
    s_waitcnt lgkmcnt(0)
    v_pk_add_f32 v[68:69], v[68:69], v[100:101]
    v_pk_add_f32 v[70:71], v[70:71], v[102:103]
    v_pk_mul_f32 v[64:65], v[64:65], v[24:25]
    v_pk_mul_f32 v[66:67], v[66:67], v[24:25]
    v_pk_mul_f32 v[68:69], v[68:69], v[24:25]
    v_pk_mul_f32 v[70:71], v[70:71], v[24:25]
    v_cvt_pk_bf16_f32 v24, v64, v65
    v_cvt_pk_bf16_f32 v25, v66, v67
    v_cvt_pk_bf16_f32 v26, v68, v69
    v_cvt_pk_bf16_f32 v27, v70, v71
    v_add_u32 v124, s30, v1
    v_add_u32 v125, s31, v1
    v_add_u32 v126, s32, v1
    v_add_u32 v127, s33, v1
Lqst_194:
    s_waitcnt vmcnt(8)
    v_add_f32 v200, v200, v204
    v_add_f32 v201, v201, v205
    v_add_f32 v202, v202, v206
    v_add_f32 v203, v203, v207
    v_add_f32 v200, v200, v202
    v_add_f32 v201, v201, v203
    v_add_f32 v200, v200, v201
    s_cmp_eq_u32 s12, 0
    s_cbranch_scc1 Lslow_195
    buffer_store_byte v5, off, s[4:7], s21 offset:896
Lback_196:
    v_cmp_u_f32 vcc, v200, v200
    v_add_u32 v201, s26, v3
    ds_write_b32 v201, v200 offset:6912
    v_mul_f32 v201, 0xbb000000, v200
    v_cvt_pk_bf16_f32 v10, v201, v201
    v_and_b32 v11, 0xffff0000, v10
    v_sub_f32 v201, v201, v11
    v_cvt_pk_bf16_f32 v11, v201, v201
    s_cbranch_vccnz Lredo_197
Lback_198:
    s_cmp_lg_u32 s18, 1
    s_cbranch_scc1 Lnkv_202
    v_add_u32 v202, s30, v1
    s_lshl_b32 s61, s16, 11
    s_add_u32 s61, s61, 0
    v_add_u32 v203, s61, v1
    v_add_u32 v204, 0, v1
    s_waitcnt vmcnt(8)
    v_mfma_f32_32x32x16_bf16 v[128:143], a[160:163], v[160:163], 0
    s_waitcnt vmcnt(7)
    v_mfma_f32_32x32x16_bf16 v[128:143], a[164:167], v[164:167], v[128:143]
    s_waitcnt vmcnt(6)
    v_mfma_f32_32x32x16_bf16 v[128:143], a[168:171], v[168:171], v[128:143]
    s_waitcnt vmcnt(5)
    v_mfma_f32_32x32x16_bf16 v[128:143], a[172:175], v[172:175], v[128:143]
    s_waitcnt vmcnt(4)
    v_mfma_f32_32x32x16_bf16 v[128:143], a[176:179], v[176:179], v[128:143]
    s_waitcnt vmcnt(3)
    v_mfma_f32_32x32x16_bf16 v[128:143], a[180:183], v[180:183], v[128:143]
    s_waitcnt vmcnt(2)
    v_mfma_f32_32x32x16_bf16 v[128:143], a[184:187], v[184:187], v[128:143]
    s_waitcnt vmcnt(1)
    v_mfma_f32_32x32x16_bf16 v[128:143], a[188:191], v[188:191], v[128:143]
    v_mfma_f32_32x32x16_bf16 v[128:143], v[208:211], v[10:13], v[128:143]
    s_nop 11
    v_cmp_u_f32 vcc, v128, v128
    s_nop 4
    s_cbranch_vccnz Lredo_205
Lback_206:
    s_mov_b32 s3, 8
    ds_write_b128 v202, v[128:131] offset:8192
    ds_write_b128 v202, v[132:135] offset:9216
    ds_write_b128 v202, v[136:139] offset:10240
    ds_write_b128 v202, v[140:143] offset:11264
    s_waitcnt lgkmcnt(0)
    s_barrier
    s_cmp_ge_u32 s16, 2
    s_cbranch_scc1 Lnkv_202
    v_add_u32 v99, 135168, v3
    ds_read_b32 v96, v99 offset:6912
    ds_read_b32 v97, v99 offset:14080
    ds_read_b32 v98, v99 offset:21248
    ds_read_b32 v99, v99 offset:28416
    v_mfma_f32_32x32x16_bf16 v[48:63], a[224:227], v[160:163], 0
    ds_read_b128 v[224:227], v203 offset:8192
    ds_read_b128 v[228:231], v203 offset:9216
    ds_read_b128 v[232:235], v203 offset:24576
    ds_read_b128 v[236:239], v203 offset:25600
    ds_read_b128 v[240:243], v203 offset:40960
    ds_read_b128 v[244:247], v203 offset:41984
    v_mfma_f32_32x32x16_bf16 v[48:63], a[228:231], v[164:167], v[48:63]
    ds_read_b128 v[248:251], v203 offset:57344
    ds_read_b128 v[252:255], v203 offset:58368
    s_mul_i32 s61, s17, 2112
    s_add_u32 s61, s61, 5052416
    s_lshl_b32 s15, s17, 8
    s_add_u32 s15, s15, 5144576
    s_waitcnt lgkmcnt(8)
    v_add_f32 v96, v96, v98
    v_mfma_f32_32x32x16_bf16 v[48:63], a[232:235], v[168:171], v[48:63]
    v_add_f32 v97, v97, v99
    v_add_f32 v96, v96, v97
    v_mov_b32 v97, v96
    s_nop 1
    v_permlane32_swap_b32 v96, v97
    v_mul_f32 v98, 0x3b000000, v96
    v_mfma_f32_32x32x16_bf16 v[48:63], a[236:239], v[172:175], v[48:63]
    v_mul_f32 v97, 0x3b000000, v97
    v_fma_f32 v97, -v98, v98, v97
    v_max_f32 v97, 0, v97
    v_add_f32 v97, 0x3727c5ac, v97
    v_rsq_f32 v100, v97
    s_mul_i32 s62, s16, 16384
    v_mfma_f32_32x32x16_bf16 v[48:63], a[240:243], v[176:179], v[48:63]
    v_add_u32 v204, s62, v204
    s_add_u32 s62, s62, 0
    v_bfe_u32 v96, v0, 3, 2
    v_mul_u32_u24 v96, 272, v96
    v_add_u32 v96, s62, v96
    v_and_b32 v97, 7, v0
    v_mfma_f32_32x32x16_bf16 v[48:63], a[244:247], v[180:183], v[48:63]
    v_lshl_add_u32 v97, v97, 1, v96
    v_lshrrev_b32 v98, 5, v0
    v_lshl_add_u32 v97, v98, 6, v97
    s_waitcnt lgkmcnt(5)
    v_add_f32 v224, v224, v232
    v_mfma_f32_32x32x16_bf16 v[48:63], a[248:251], v[184:187], v[48:63]
    v_add_f32 v225, v225, v233
    v_add_f32 v226, v226, v234
    v_add_f32 v227, v227, v235
    s_waitcnt lgkmcnt(4)
    v_add_f32 v228, v228, v236
    v_add_f32 v229, v229, v237
    v_mfma_f32_32x32x16_bf16 v[48:63], a[252:255], v[188:191], v[48:63]
    v_add_f32 v230, v230, v238
    v_add_f32 v231, v231, v239
    s_waitcnt lgkmcnt(3)
    v_add_f32 v224, v224, v240
    v_add_f32 v225, v225, v241
    v_mfma_f32_32x32x16_bf16 v[48:63], v[210:213], v[8:11], v[48:63]
    v_add_f32 v226, v226, v242
    v_add_f32 v227, v227, v243
    s_waitcnt lgkmcnt(2)
    v_add_f32 v228, v228, v244
    v_add_f32 v229, v229, v245
    v_add_f32 v230, v230, v246
    v_mfma_f32_32x32x16_bf16 v[32:47], a[192:195], v[160:163], 0
    v_add_f32 v231, v231, v247
    s_waitcnt lgkmcnt(1)
    v_add_f32 v224, v224, v248
    v_add_f32 v225, v225, v249
    v_add_f32 v226, v226, v250
    v_add_f32 v227, v227, v251
    v_mfma_f32_32x32x16_bf16 v[32:47], a[196:199], v[164:167], v[32:47]
    s_waitcnt lgkmcnt(0)
    v_add_f32 v228, v228, v252
    v_add_f32 v229, v229, v253
    v_add_f32 v230, v230, v254
    v_add_f32 v231, v231, v255
    v_mfma_f32_32x32x16_bf16 v[32:47], a[200:203], v[168:171], v[32:47]
    v_mul_f32 v224, v100, v224
    v_mul_f32 v225, v100, v225
    v_mul_f32 v226, v100, v226
    v_mul_f32 v227, v100, v227
    v_mul_f32 v228, v100, v228
    v_mul_f32 v229, v100, v229
    v_mfma_f32_32x32x16_bf16 v[32:47], a[204:207], v[172:175], v[32:47]
    v_mul_f32 v230, v100, v230
    v_mul_f32 v231, v100, v231
    v_cvt_pk_bf16_f32 v232, v224, v225
    v_cvt_pk_bf16_f32 v233, v226, v227
    v_cvt_pk_bf16_f32 v234, v228, v229
    v_cvt_pk_bf16_f32 v235, v230, v231
    v_mfma_f32_32x32x16_bf16 v[32:47], a[208:211], v[176:179], v[32:47]
    ds_write_b128 v124, v[48:51] offset:2048
    s_cmp_eq_u32 s16, 1
    s_cbranch_scc1 Lv_203
    buffer_store_dwordx4 v[232:235], v1, s[4:7], s61 offen sc1
    v_mov_b32 v14, s1
    s_mov_b64 exec, 1
    buffer_store_dword v14, off, s[4:7], s15 sc1
    s_mov_b64 exec, -1
Lv_203:
    ds_write_b16 v97, v232 offset:12288
    ds_write_b16_d16_hi v97, v232 offset:12304
    ds_write_b16 v97, v233 offset:12320
    ds_write_b16_d16_hi v97, v233 offset:12336
    v_mfma_f32_32x32x16_bf16 v[32:47], a[212:215], v[180:183], v[32:47]
    ds_write_b128 v124, v[52:55] offset:3072
    ds_write_b16 v97, v234 offset:12416
    ds_write_b16_d16_hi v97, v234 offset:12432
    ds_write_b16 v97, v235 offset:12448
    ds_write_b16_d16_hi v97, v235 offset:12464
    v_mov_b32 v224, v4
    v_mov_b32 v225, v4
    v_mfma_f32_32x32x16_bf16 v[32:47], a[216:219], v[184:187], v[32:47]
    ds_write_b128 v124, v[56:59] offset:4096
    v_mov_b32 v226, v4
    v_mov_b32 v227, v4
    ds_write_b128 v96, v[224:227] offset:12544
    ds_read_b128 v[236:239], v204 offset:12288
    ds_read_b128 v[240:243], v204 offset:13312
    v_mfma_f32_32x32x16_bf16 v[32:47], a[220:223], v[188:191], v[32:47]
    ds_write_b128 v124, v[60:63] offset:5120
    v_mfma_f32_32x32x16_bf16 v[32:47], v[210:213], v[10:13], v[32:47]
    s_cmp_eq_u32 s16, 0
    s_cbranch_scc1 Lkf_204
    s_waitcnt lgkmcnt(1)
    s_add_u32 s15, s15, 128
    buffer_store_dwordx4 v[236:239], v1, s[4:7], s61 offen offset:1024 sc1
    s_mov_b64 exec, 15
    buffer_store_dwordx4 v[240:243], v1, s[4:7], s61 offen offset:2048 sc1
    v_mov_b32 v14, s1
    s_mov_b64 exec, 1
    buffer_store_dword v14, off, s[4:7], s15 sc1
    s_mov_b64 exec, -1
Lkf_204:
    s_branch Lkj_210
Lnkv_202:
    s_waitcnt vmcnt(8)
    v_mfma_f32_32x32x16_bf16 v[48:63], a[224:227], v[160:163], 0
    s_waitcnt vmcnt(7)
    v_mfma_f32_32x32x16_bf16 v[48:63], a[228:231], v[164:167], v[48:63]
    s_waitcnt vmcnt(6)
    v_mfma_f32_32x32x16_bf16 v[48:63], a[232:235], v[168:171], v[48:63]
    s_waitcnt vmcnt(5)
    v_mfma_f32_32x32x16_bf16 v[48:63], a[236:239], v[172:175], v[48:63]
    s_waitcnt vmcnt(4)
    v_mfma_f32_32x32x16_bf16 v[48:63], a[240:243], v[176:179], v[48:63]
    s_waitcnt vmcnt(3)
    v_mfma_f32_32x32x16_bf16 v[48:63], a[244:247], v[180:183], v[48:63]
    s_waitcnt vmcnt(2)
    v_mfma_f32_32x32x16_bf16 v[48:63], a[248:251], v[184:187], v[48:63]
    s_waitcnt vmcnt(1)
    v_mfma_f32_32x32x16_bf16 v[48:63], a[252:255], v[188:191], v[48:63]
    v_mfma_f32_32x32x16_bf16 v[48:63], v[210:213], v[8:11], v[48:63]
    v_mfma_f32_32x32x16_bf16 v[32:47], a[192:195], v[160:163], 0
    v_mfma_f32_32x32x16_bf16 v[32:47], a[196:199], v[164:167], v[32:47]
    v_mfma_f32_32x32x16_bf16 v[32:47], a[200:203], v[168:171], v[32:47]
    v_mfma_f32_32x32x16_bf16 v[32:47], a[204:207], v[172:175], v[32:47]
    s_nop 7
    v_cmp_u_f32 vcc, v48, v48
    v_mfma_f32_32x32x16_bf16 v[32:47], a[208:211], v[176:179], v[32:47]
    s_nop 3
    s_cbranch_vccnz Lredo_211
Lback_212:
    v_mfma_f32_32x32x16_bf16 v[32:47], a[212:215], v[180:183], v[32:47]
    ds_write_b128 v124, v[48:51] offset:2048
    v_mfma_f32_32x32x16_bf16 v[32:47], a[216:219], v[184:187], v[32:47]
    ds_write_b128 v124, v[52:55] offset:3072
    v_mfma_f32_32x32x16_bf16 v[32:47], a[220:223], v[188:191], v[32:47]
    ds_write_b128 v124, v[56:59] offset:4096
    v_mfma_f32_32x32x16_bf16 v[32:47], v[210:213], v[10:13], v[32:47]
    ds_write_b128 v124, v[60:63] offset:5120
Lkj_210:
    s_nop 10
    ds_write_b128 v124, v[40:43] offset:0
    ds_write_b128 v124, v[44:47] offset:1024
    s_waitcnt lgkmcnt(0)
    s_barrier
    v_add_u32 v207, 135168, v3
    ds_read_b32 v204, v207 offset:6912
    ds_read_b32 v205, v207 offset:14080
    ds_read_b32 v206, v207 offset:21248
    ds_read_b32 v207, v207 offset:28416
    ds_read_b128 v[104:107], v126 offset:2048
    ds_read_b128 v[108:111], v126 offset:3072
    ds_read_b128 v[112:115], v127 offset:4096
    ds_read_b128 v[116:119], v127 offset:5120
    ds_read_b128 v[96:99], v125 offset:0
    ds_read_b128 v[100:103], v125 offset:1024
    v_lshlrev_b32 v15, 7, v0
    v_mov_b32 v14, s1
    s_lshl_b32 s63, s16, 11
    s_add_u32 s63, s63, 5136384
    s_mov_b64 exec, 0xffff
    buffer_load_dword v14, v15, s[4:7], s63 offen sc1
    s_mov_b64 exec, -1
    s_waitcnt lgkmcnt(6)
    v_add_f32 v204, v204, v206
    v_add_f32 v205, v205, v207
    v_add_f32 v204, v204, v205
    v_mov_b32 v205, v204
    s_nop 1
    v_permlane32_swap_b32 v204, v205
    v_mul_f32 v206, 0x3b000000, v204
    v_mul_f32 v205, 0x3b000000, v205
    v_fma_f32 v205, -v206, v206, v205
    v_max_f32 v205, 0, v205
    v_add_f32 v205, 0x3727c5ac, v205
    v_rsq_f32 v200, v205
    s_nop 0
    v_mul_f32 v200, 0x3eb8aa3b, v200
    v_mov_b32 v201, v200
    s_waitcnt lgkmcnt(5)
    v_pk_add_f32 v[32:33], v[32:33], v[104:105]
    v_pk_add_f32 v[34:35], v[34:35], v[106:107]
    s_waitcnt lgkmcnt(4)
    v_pk_add_f32 v[36:37], v[36:37], v[108:109]
    v_pk_add_f32 v[38:39], v[38:39], v[110:111]
    s_waitcnt lgkmcnt(3)
    v_pk_add_f32 v[32:33], v[32:33], v[112:113]
    v_pk_add_f32 v[34:35], v[34:35], v[114:115]
    s_waitcnt lgkmcnt(2)
    v_pk_add_f32 v[36:37], v[36:37], v[116:117]
    v_pk_add_f32 v[38:39], v[38:39], v[118:119]
    s_waitcnt lgkmcnt(1)
    v_pk_add_f32 v[32:33], v[32:33], v[96:97]
    v_pk_add_f32 v[34:35], v[34:35], v[98:99]
    s_waitcnt lgkmcnt(0)
    v_pk_add_f32 v[36:37], v[36:37], v[100:101]
    v_pk_add_f32 v[38:39], v[38:39], v[102:103]
    v_pk_mul_f32 v[32:33], v[32:33], v[200:201]
    v_pk_mul_f32 v[34:35], v[34:35], v[200:201]
    v_pk_mul_f32 v[36:37], v[36:37], v[200:201]
    v_pk_mul_f32 v[38:39], v[38:39], v[200:201]
    v_cvt_pk_bf16_f32 v28, v32, v33
    v_cvt_pk_bf16_f32 v29, v34, v35
    v_cvt_pk_bf16_f32 v30, v36, v37
    v_cvt_pk_bf16_f32 v31, v38, v39
    s_waitcnt vmcnt(0)
    v_cmp_ne_u32 vcc, s1, v14
    s_nop 4
    s_cbranch_vccnz Lretry_217
Lback_218:
    s_barrier
    s_add_u32 m0, s36, 67584
    s_add_u32 s66, s56, 135168
    s_addc_u32 s67, s57, 0
    global_load_lds_dwordx4 v1, s[66:67] offset:0
    global_load_lds_dwordx4 v1, s[66:67] offset:1024
    global_load_lds_dwordx4 v1, s[66:67] offset:2048
    global_load_lds_dwordx4 v1, s[66:67] offset:3072
    s_add_u32 m0, s36, 83968
    s_add_u32 s66, s56, 151552
    s_addc_u32 s67, s57, 0
    global_load_lds_dwordx4 v1, s[66:67] offset:0
    global_load_lds_dwordx4 v1, s[66:67] offset:1024
    v_mov_b32 v124, 0xdddddddd
    v_add_u32 v125, 67584, v1
    v_and_b32 v126, 31, v0
    v_min_u32 v126, 16, v126
    v_lshlrev_b32 v126, 4, v126
    v_lshrrev_b32 v127, 5, v0
    v_mul_u32_u24 v127, 272, v127
    v_add_u32 v126, v126, v127
    v_add_u32 v126, 67584, v126
    s_mov_b32 s61, 0xffee0000
    s_mov_b32 exec_lo, s61
    s_mov_b32 exec_hi, s61
    v_add_u32 v126, 0x100000, v126
    s_mov_b64 exec, -1
    v_mov_b32 v64, 0
    v_mov_b32 v65, 0
    v_mov_b32 v66, 0
    v_mov_b32 v67, 0
    v_mov_b32 v68, 0
    v_mov_b32 v69, 0
    v_mov_b32 v70, 0
    v_mov_b32 v71, 0
    v_mov_b32 v72, 0
    v_mov_b32 v73, 0
    v_mov_b32 v74, 0
    v_mov_b32 v75, 0
    v_mov_b32 v76, 0
    v_mov_b32 v77, 0
    v_mov_b32 v78, 0
    v_mov_b32 v79, 0
    v_mov_b32 v80, 0
    v_mov_b32 v81, 0
    v_mov_b32 v82, 0
    v_mov_b32 v83, 0
    v_mov_b32 v84, 0
    v_mov_b32 v85, 0
    v_mov_b32 v86, 0
    v_mov_b32 v87, 0
    v_mov_b32 v88, 0
    v_mov_b32 v89, 0
    v_mov_b32 v90, 0
    v_mov_b32 v91, 0
    v_mov_b32 v92, 0
    v_mov_b32 v93, 0
    v_mov_b32 v94, 0
    v_mov_b32 v95, 0
    v_lshlrev_b32 v232, 7, v0
    v_lshlrev_b32 v233, 10, v0
    v_mov_b32 v224, -1
    v_mov_b32 v225, -1
    v_mov_b32 v226, -1
    v_mov_b32 v227, -1
    v_add_u32 v234, s14, v1
    global_load_lds_dwordx4 v1, s[66:67] offset:2048
    global_load_lds_dwordx4 v1, s[66:67] offset:3072
    s_waitcnt vmcnt(4)
    s_barrier
    s_cmp_eq_u32 s15, 0
    s_cbranch_scc1 Lnkf_216
    v_mov_b32 v14, s1
    s_mov_b64 exec, 1
    buffer_store_dword v14, off, s[4:7], s15 offset:4 sc1
    s_mov_b64 exec, -1
Lnkf_216:
    ds_read_b128 v[96:99], v125 offset:0
    ds_read_b128 v[104:107], v126 offset:1024
    ds_read_b128 v[108:111], v126 offset:1568
    ds_read_b128 v[100:103], v125 offset:2112
    s_waitcnt lgkmcnt(3)
    v_mfma_f32_32x32x16_bf16 v[32:47], v[96:99], v[24:27], 0
    s_nop 11
    v_exp_f32 v32, v32
    v_exp_f32 v33, v33
    ds_read_b128 v[112:115], v126 offset:3136
    v_exp_f32 v34, v34
    v_exp_f32 v35, v35
    v_exp_f32 v36, v36
    v_mfma_f32_32x32x16_bf16 v[48:63], v[96:99], v[28:31], 0
    ds_read_b128 v[116:119], v126 offset:3680
    v_exp_f32 v37, v37
    v_exp_f32 v38, v38
    v_exp_f32 v39, v39
    v_exp_f32 v40, v40
    v_exp_f32 v41, v41
    s_waitcnt lgkmcnt(4)
    v_smfmac_f32_32x32x32_bf16 v[64:79], v[104:107], v[32:39], v124
    s_add_u32 m0, s36, 100352
    s_add_u32 s66, s56, 167936
    s_addc_u32 s67, s57, 0
    global_load_lds_dwordx4 v1, s[66:67] offset:0
    global_load_lds_dwordx4 v1, s[66:67] offset:1024
    v_exp_f32 v42, v42
    v_exp_f32 v43, v43
    v_exp_f32 v44, v44
    v_exp_f32 v45, v45
    v_exp_f32 v46, v46
    v_exp_f32 v47, v47
    v_exp_f32 v48, v48
    v_exp_f32 v49, v49
    s_waitcnt lgkmcnt(3)
    v_smfmac_f32_32x32x32_bf16 v[64:79], v[108:111], v[40:47], v124
    s_waitcnt lgkmcnt(0)
    v_exp_f32 v50, v50
    v_exp_f32 v51, v51
    v_exp_f32 v52, v52
    v_mfma_f32_32x32x16_bf16 v[32:47], v[100:103], v[24:27], 0
    global_load_lds_dwordx4 v1, s[66:67] offset:2048
    global_load_lds_dwordx4 v1, s[66:67] offset:3072
    v_exp_f32 v53, v53
    v_exp_f32 v54, v54
    v_exp_f32 v55, v55
    v_exp_f32 v56, v56
    v_exp_f32 v57, v57
    v_smfmac_f32_32x32x32_bf16 v[80:95], v[104:107], v[48:55], v124
    ds_read_b128 v[96:99], v125 offset:4224
    v_exp_f32 v58, v58
    v_exp_f32 v59, v59
    v_exp_f32 v60, v60
    v_exp_f32 v61, v61
    v_exp_f32 v62, v62
    v_exp_f32 v63, v63
    v_exp_f32 v32, v32
    v_exp_f32 v33, v33
    v_smfmac_f32_32x32x32_bf16 v[80:95], v[108:111], v[56:63], v124
    ds_read_b128 v[104:107], v126 offset:5248
    v_exp_f32 v34, v34
    v_exp_f32 v35, v35
    v_exp_f32 v36, v36
    v_mfma_f32_32x32x16_bf16 v[48:63], v[100:103], v[28:31], 0
    ds_read_b128 v[108:111], v126 offset:5792
    v_exp_f32 v37, v37
    v_exp_f32 v38, v38
    v_exp_f32 v39, v39
    v_exp_f32 v40, v40
    v_exp_f32 v41, v41
    v_smfmac_f32_32x32x32_bf16 v[64:79], v[112:115], v[32:39], v124
    s_add_u32 m0, s36, 116736
    s_add_u32 s66, s56, 184320
    s_addc_u32 s67, s57, 0
    global_load_lds_dwordx4 v1, s[66:67] offset:0
    global_load_lds_dwordx4 v1, s[66:67] offset:1024
    v_exp_f32 v42, v42
    v_exp_f32 v43, v43
    v_exp_f32 v44, v44
    v_exp_f32 v45, v45
    v_exp_f32 v46, v46
    v_exp_f32 v47, v47
    v_exp_f32 v48, v48
    v_exp_f32 v49, v49
    v_smfmac_f32_32x32x32_bf16 v[64:79], v[116:119], v[40:47], v124
    s_waitcnt lgkmcnt(0)
    v_exp_f32 v50, v50
    v_exp_f32 v51, v51
    v_exp_f32 v52, v52
    v_mfma_f32_32x32x16_bf16 v[32:47], v[96:99], v[24:27], 0
    global_load_lds_dwordx4 v1, s[66:67] offset:2048
    global_load_lds_dwordx4 v1, s[66:67] offset:3072
    v_exp_f32 v53, v53
    v_exp_f32 v54, v54
    v_exp_f32 v55, v55
    v_exp_f32 v56, v56
    v_exp_f32 v57, v57
    v_smfmac_f32_32x32x32_bf16 v[80:95], v[112:115], v[48:55], v124
    ds_read_b128 v[100:103], v125 offset:6336
    v_exp_f32 v58, v58
    v_exp_f32 v59, v59
    v_exp_f32 v60, v60
    v_exp_f32 v61, v61
    v_exp_f32 v62, v62
    v_exp_f32 v63, v63
    v_exp_f32 v32, v32
    v_exp_f32 v33, v33
    v_smfmac_f32_32x32x32_bf16 v[80:95], v[116:119], v[56:63], v124
    ds_read_b128 v[112:115], v126 offset:7360
    v_exp_f32 v34, v34
    v_exp_f32 v35, v35
    v_exp_f32 v36, v36
    v_mfma_f32_32x32x16_bf16 v[48:63], v[96:99], v[28:31], 0
    ds_read_b128 v[116:119], v126 offset:7904
    v_exp_f32 v37, v37
    v_exp_f32 v38, v38
    v_exp_f32 v39, v39
    v_exp_f32 v40, v40
    v_exp_f32 v41, v41
    v_smfmac_f32_32x32x32_bf16 v[64:79], v[104:107], v[32:39], v124
    s_add_u32 m0, s37, 133120
    s_add_u32 s66, s58, 200704
    s_addc_u32 s67, s59, 0
    global_load_lds_dwordx4 v1, s[66:67] offset:0
    s_add_u32 s64, s52, 4096
    s_addc_u32 s65, s53, 0
    global_load_dwordx4 a[0:3], v1, s[64:65] offset:-4096
    v_exp_f32 v42, v42
    v_exp_f32 v43, v43
    v_exp_f32 v44, v44
    v_exp_f32 v45, v45
    v_exp_f32 v46, v46
    v_exp_f32 v47, v47
    v_exp_f32 v48, v48
    v_exp_f32 v49, v49
    v_smfmac_f32_32x32x32_bf16 v[64:79], v[108:111], v[40:47], v124
    s_waitcnt lgkmcnt(0)
    v_exp_f32 v50, v50
    v_exp_f32 v51, v51
    v_exp_f32 v52, v52
    v_mfma_f32_32x32x16_bf16 v[32:47], v[100:103], v[24:27], 0
    global_load_dwordx4 a[4:7], v1, s[64:65] offset:-3072
    v_exp_f32 v53, v53
    v_exp_f32 v54, v54
    v_exp_f32 v55, v55
    v_exp_f32 v56, v56
    v_exp_f32 v57, v57
    v_smfmac_f32_32x32x32_bf16 v[80:95], v[104:107], v[48:55], v124
    ds_read_b128 v[96:99], v125 offset:8448
    v_exp_f32 v58, v58
    v_exp_f32 v59, v59
    v_exp_f32 v60, v60
    v_exp_f32 v61, v61
    v_exp_f32 v62, v62
    v_exp_f32 v63, v63
    v_exp_f32 v32, v32
    v_exp_f32 v33, v33
    v_smfmac_f32_32x32x32_bf16 v[80:95], v[108:111], v[56:63], v124
    ds_read_b128 v[104:107], v126 offset:9472
    v_exp_f32 v34, v34
    v_exp_f32 v35, v35
    v_exp_f32 v36, v36
    v_mfma_f32_32x32x16_bf16 v[48:63], v[100:103], v[28:31], 0
    ds_read_b128 v[108:111], v126 offset:10016
    v_exp_f32 v37, v37
    v_exp_f32 v38, v38
    v_exp_f32 v39, v39
    v_exp_f32 v40, v40
    v_exp_f32 v41, v41
    v_smfmac_f32_32x32x32_bf16 v[64:79], v[112:115], v[32:39], v124
    global_load_dwordx4 a[8:11], v1, s[64:65] offset:-2048
    v_exp_f32 v42, v42
    v_exp_f32 v43, v43
    v_exp_f32 v44, v44
    v_exp_f32 v45, v45
    v_exp_f32 v46, v46
    v_exp_f32 v47, v47
    v_exp_f32 v48, v48
    v_exp_f32 v49, v49
    v_smfmac_f32_32x32x32_bf16 v[64:79], v[116:119], v[40:47], v124
    s_waitcnt lgkmcnt(0)
    v_exp_f32 v50, v50
    v_exp_f32 v51, v51
    v_exp_f32 v52, v52
    v_mfma_f32_32x32x16_bf16 v[32:47], v[96:99], v[24:27], 0
    global_load_dwordx4 a[12:15], v1, s[64:65] offset:-1024
    v_exp_f32 v53, v53
    v_exp_f32 v54, v54
    v_exp_f32 v55, v55
    v_exp_f32 v56, v56
    v_exp_f32 v57, v57
    v_smfmac_f32_32x32x32_bf16 v[80:95], v[112:115], v[48:55], v124
    ds_read_b128 v[100:103], v125 offset:10560
    v_exp_f32 v58, v58
    v_exp_f32 v59, v59
    v_exp_f32 v60, v60
    v_exp_f32 v61, v61
    v_exp_f32 v62, v62
    v_exp_f32 v63, v63
    v_exp_f32 v32, v32
    v_exp_f32 v33, v33
    v_smfmac_f32_32x32x32_bf16 v[80:95], v[116:119], v[56:63], v124
    ds_read_b128 v[112:115], v126 offset:11584
    v_exp_f32 v34, v34
    v_exp_f32 v35, v35
    v_exp_f32 v36, v36
    v_mfma_f32_32x32x16_bf16 v[48:63], v[96:99], v[28:31], 0
    ds_read_b128 v[116:119], v126 offset:12128
    v_exp_f32 v37, v37
    v_exp_f32 v38, v38
    v_exp_f32 v39, v39
    v_exp_f32 v40, v40
    v_exp_f32 v41, v41
    v_smfmac_f32_32x32x32_bf16 v[64:79], v[104:107], v[32:39], v124
    global_load_dwordx4 a[16:19], v1, s[64:65] offset:0
    v_exp_f32 v42, v42
    v_exp_f32 v43, v43
    v_exp_f32 v44, v44
    v_exp_f32 v45, v45
    v_exp_f32 v46, v46
    v_exp_f32 v47, v47
    v_exp_f32 v48, v48
    v_exp_f32 v49, v49
    v_smfmac_f32_32x32x32_bf16 v[64:79], v[108:111], v[40:47], v124
    s_waitcnt lgkmcnt(0)
    v_exp_f32 v50, v50
    v_exp_f32 v51, v51
    v_exp_f32 v52, v52
    v_mfma_f32_32x32x16_bf16 v[32:47], v[100:103], v[24:27], 0
    s_waitcnt vmcnt(5)
    s_barrier
    global_load_dwordx4 a[20:23], v1, s[64:65] offset:1024
    v_exp_f32 v53, v53
    v_exp_f32 v54, v54
    v_exp_f32 v55, v55
    v_exp_f32 v56, v56
    v_exp_f32 v57, v57
    v_smfmac_f32_32x32x32_bf16 v[80:95], v[104:107], v[48:55], v124
    ds_read_b128 v[96:99], v125 offset:12672
    v_exp_f32 v58, v58
    v_exp_f32 v59, v59
    v_exp_f32 v60, v60
    v_exp_f32 v61, v61
    v_exp_f32 v62, v62
    v_exp_f32 v63, v63
    v_exp_f32 v32, v32
    v_exp_f32 v33, v33
    v_smfmac_f32_32x32x32_bf16 v[80:95], v[108:111], v[56:63], v124
    ds_read_b128 v[104:107], v126 offset:13696
    v_exp_f32 v34, v34
    v_exp_f32 v35, v35
    v_exp_f32 v36, v36
    v_mfma_f32_32x32x16_bf16 v[48:63], v[100:103], v[28:31], 0
    ds_read_b128 v[108:111], v126 offset:14240
    v_exp_f32 v37, v37
    v_exp_f32 v38, v38
    v_exp_f32 v39, v39
    v_exp_f32 v40, v40
    v_exp_f32 v41, v41
    v_smfmac_f32_32x32x32_bf16 v[64:79], v[112:115], v[32:39], v124
    s_getpc_b64 s[68:69]
Lpc_219:
    s_lshr_b32 s61, s2, 3
    s_lshl_b32 s61, s61, 2
    s_add_u32 s61, s61, s16
    s_lshl_b32 s61, s61, 8
    s_add_u32 s61, s61, 2048
    s_min_u32 s61, s61, Lend_1-Lpc_219-256
    s_add_u32 s68, s68, s61
    s_addc_u32 s69, s69, 0
    global_load_dword v230, v3, s[68:69]
    global_load_dwordx4 a[24:27], v1, s[64:65] offset:2048
    v_exp_f32 v42, v42
    v_exp_f32 v43, v43
    v_exp_f32 v44, v44
    v_exp_f32 v45, v45
    v_exp_f32 v46, v46
    v_exp_f32 v47, v47
    v_exp_f32 v48, v48
    v_exp_f32 v49, v49
    v_smfmac_f32_32x32x32_bf16 v[64:79], v[116:119], v[40:47], v124
    s_waitcnt lgkmcnt(0)
    v_exp_f32 v50, v50
    v_exp_f32 v51, v51
    v_exp_f32 v52, v52
    v_mfma_f32_32x32x16_bf16 v[32:47], v[96:99], v[24:27], 0
    global_load_dwordx4 a[28:31], v1, s[64:65] offset:3072
    v_exp_f32 v53, v53
    v_exp_f32 v54, v54
    v_exp_f32 v55, v55
    v_exp_f32 v56, v56
    v_exp_f32 v57, v57
    v_smfmac_f32_32x32x32_bf16 v[80:95], v[112:115], v[48:55], v124
    ds_read_b128 v[100:103], v125 offset:14784
    v_exp_f32 v58, v58
    v_exp_f32 v59, v59
    v_exp_f32 v60, v60
    v_exp_f32 v61, v61
    v_exp_f32 v62, v62
    v_exp_f32 v63, v63
    v_exp_f32 v32, v32
    v_exp_f32 v33, v33
    v_smfmac_f32_32x32x32_bf16 v[80:95], v[116:119], v[56:63], v124
    ds_read_b128 v[112:115], v126 offset:15808
    v_exp_f32 v34, v34
    v_exp_f32 v35, v35
    v_exp_f32 v36, v36
    v_mfma_f32_32x32x16_bf16 v[48:63], v[96:99], v[28:31], 0
    ds_read_b128 v[116:119], v126 offset:16352
    v_exp_f32 v37, v37
    v_exp_f32 v38, v38
    v_exp_f32 v39, v39
    v_exp_f32 v40, v40
    v_exp_f32 v41, v41
    v_smfmac_f32_32x32x32_bf16 v[64:79], v[104:107], v[32:39], v124
    v_lshlrev_b32 v15, 7, v0
    v_mov_b32 v14, s1
    s_lshl_b32 s63, s16, 11
    s_add_u32 s63, s63, 5144576
    s_mov_b64 exec, 0xffff
    buffer_load_dword v14, v15, s[4:7], s63 offen sc1
    s_mov_b64 exec, -1
    v_exp_f32 v42, v42
    v_exp_f32 v43, v43
    v_exp_f32 v44, v44
    v_exp_f32 v45, v45
    v_exp_f32 v46, v46
    v_exp_f32 v47, v47
    v_exp_f32 v48, v48
    v_exp_f32 v49, v49
    v_smfmac_f32_32x32x32_bf16 v[64:79], v[108:111], v[40:47], v124
    s_waitcnt lgkmcnt(0)
    v_exp_f32 v50, v50
    v_exp_f32 v51, v51
    v_exp_f32 v52, v52
    v_mfma_f32_32x32x16_bf16 v[32:47], v[100:103], v[24:27], 0
    s_add_u32 s64, s52, 12288
    s_addc_u32 s65, s53, 0
    global_load_dwordx4 a[32:35], v1, s[64:65] offset:-4096
    v_exp_f32 v53, v53
    v_exp_f32 v54, v54
    v_exp_f32 v55, v55
    v_exp_f32 v56, v56
    v_exp_f32 v57, v57
    v_smfmac_f32_32x32x32_bf16 v[80:95], v[104:107], v[48:55], v124
    ds_read_b128 v[96:99], v125 offset:16896
    v_exp_f32 v58, v58
    v_exp_f32 v59, v59
    v_exp_f32 v60, v60
    v_exp_f32 v61, v61
    v_exp_f32 v62, v62
    v_exp_f32 v63, v63
    v_exp_f32 v32, v32
    v_exp_f32 v33, v33
    v_smfmac_f32_32x32x32_bf16 v[80:95], v[108:111], v[56:63], v124
    ds_read_b128 v[104:107], v126 offset:17920
    v_exp_f32 v34, v34
    v_exp_f32 v35, v35
    v_exp_f32 v36, v36
    v_mfma_f32_32x32x16_bf16 v[48:63], v[100:103], v[28:31], 0
    ds_read_b128 v[108:111], v126 offset:18464
    v_exp_f32 v37, v37
    v_exp_f32 v38, v38
    v_exp_f32 v39, v39
    v_exp_f32 v40, v40
    v_exp_f32 v41, v41
    v_smfmac_f32_32x32x32_bf16 v[64:79], v[112:115], v[32:39], v124
    global_load_dwordx4 a[36:39], v1, s[64:65] offset:-3072
    v_exp_f32 v42, v42
    v_exp_f32 v43, v43
    v_exp_f32 v44, v44
    v_exp_f32 v45, v45
    v_exp_f32 v46, v46
    v_exp_f32 v47, v47
    v_exp_f32 v48, v48
    v_exp_f32 v49, v49
    v_smfmac_f32_32x32x32_bf16 v[64:79], v[116:119], v[40:47], v124
    s_waitcnt lgkmcnt(0)
    v_exp_f32 v50, v50
    v_exp_f32 v51, v51
    v_exp_f32 v52, v52
    v_mfma_f32_32x32x16_bf16 v[32:47], v[96:99], v[24:27], 0
    global_load_dwordx4 a[40:43], v1, s[64:65] offset:-2048
    v_exp_f32 v53, v53
    v_exp_f32 v54, v54
    v_exp_f32 v55, v55
    v_exp_f32 v56, v56
    v_exp_f32 v57, v57
    v_smfmac_f32_32x32x32_bf16 v[80:95], v[112:115], v[48:55], v124
    ds_read_b128 v[100:103], v125 offset:19008
    v_exp_f32 v58, v58
    v_exp_f32 v59, v59
    v_exp_f32 v60, v60
    v_exp_f32 v61, v61
    v_exp_f32 v62, v62
    v_exp_f32 v63, v63
    v_exp_f32 v32, v32
    v_exp_f32 v33, v33
    v_smfmac_f32_32x32x32_bf16 v[80:95], v[116:119], v[56:63], v124
    ds_read_b128 v[112:115], v126 offset:20032
    v_exp_f32 v34, v34
    v_exp_f32 v35, v35
    v_exp_f32 v36, v36
    v_mfma_f32_32x32x16_bf16 v[48:63], v[96:99], v[28:31], 0
    ds_read_b128 v[116:119], v126 offset:20576
    v_exp_f32 v37, v37
    v_exp_f32 v38, v38
    v_exp_f32 v39, v39
    v_exp_f32 v40, v40
    v_exp_f32 v41, v41
    v_smfmac_f32_32x32x32_bf16 v[64:79], v[104:107], v[32:39], v124
    global_load_dwordx4 a[44:47], v1, s[64:65] offset:-1024
    v_exp_f32 v42, v42
    v_exp_f32 v43, v43
    v_exp_f32 v44, v44
    v_exp_f32 v45, v45
    v_exp_f32 v46, v46
    v_exp_f32 v47, v47
    v_exp_f32 v48, v48
    v_exp_f32 v49, v49
    v_smfmac_f32_32x32x32_bf16 v[64:79], v[108:111], v[40:47], v124
    s_waitcnt lgkmcnt(0)
    v_exp_f32 v50, v50
    v_exp_f32 v51, v51
    v_exp_f32 v52, v52
    v_mfma_f32_32x32x16_bf16 v[32:47], v[100:103], v[24:27], 0
    global_load_dwordx4 a[48:51], v1, s[64:65] offset:0
    v_exp_f32 v53, v53
    v_exp_f32 v54, v54
    v_exp_f32 v55, v55
    v_exp_f32 v56, v56
    v_exp_f32 v57, v57
    v_smfmac_f32_32x32x32_bf16 v[80:95], v[104:107], v[48:55], v124
    ds_read_b128 v[96:99], v125 offset:21120
    v_exp_f32 v58, v58
    v_exp_f32 v59, v59
    v_exp_f32 v60, v60
    v_exp_f32 v61, v61
    v_exp_f32 v62, v62
    v_exp_f32 v63, v63
    v_exp_f32 v32, v32
    v_exp_f32 v33, v33
    v_smfmac_f32_32x32x32_bf16 v[80:95], v[108:111], v[56:63], v124
    ds_read_b128 v[104:107], v126 offset:22144
    v_exp_f32 v34, v34
    v_exp_f32 v35, v35
    v_exp_f32 v36, v36
    v_mfma_f32_32x32x16_bf16 v[48:63], v[100:103], v[28:31], 0
    ds_read_b128 v[108:111], v126 offset:22688
    v_exp_f32 v37, v37
    v_exp_f32 v38, v38
    v_exp_f32 v39, v39
    v_exp_f32 v40, v40
    v_exp_f32 v41, v41
    v_smfmac_f32_32x32x32_bf16 v[64:79], v[112:115], v[32:39], v124
    global_load_dwordx4 a[52:55], v1, s[64:65] offset:1024
    v_exp_f32 v42, v42
    v_exp_f32 v43, v43
    v_exp_f32 v44, v44
    v_exp_f32 v45, v45
    v_exp_f32 v46, v46
    v_exp_f32 v47, v47
    v_exp_f32 v48, v48
    v_exp_f32 v49, v49
    v_smfmac_f32_32x32x32_bf16 v[64:79], v[116:119], v[40:47], v124
    s_waitcnt lgkmcnt(0)
    v_exp_f32 v50, v50
    v_exp_f32 v51, v51
    v_exp_f32 v52, v52
    v_mfma_f32_32x32x16_bf16 v[32:47], v[96:99], v[24:27], 0
    global_load_dwordx4 a[56:59], v1, s[64:65] offset:2048
    v_exp_f32 v53, v53
    v_exp_f32 v54, v54
    v_exp_f32 v55, v55
    v_exp_f32 v56, v56
    v_exp_f32 v57, v57
    v_smfmac_f32_32x32x32_bf16 v[80:95], v[112:115], v[48:55], v124
    ds_read_b128 v[100:103], v125 offset:23232
    v_exp_f32 v58, v58
    v_exp_f32 v59, v59
    v_exp_f32 v60, v60
    v_exp_f32 v61, v61
    v_exp_f32 v62, v62
    v_exp_f32 v63, v63
    v_exp_f32 v32, v32
    v_exp_f32 v33, v33
    v_smfmac_f32_32x32x32_bf16 v[80:95], v[116:119], v[56:63], v124
    ds_read_b128 v[112:115], v126 offset:24256
    v_exp_f32 v34, v34
    v_exp_f32 v35, v35
    v_exp_f32 v36, v36
    v_mfma_f32_32x32x16_bf16 v[48:63], v[96:99], v[28:31], 0
    ds_read_b128 v[116:119], v126 offset:24800
    v_exp_f32 v37, v37
    v_exp_f32 v38, v38
    v_exp_f32 v39, v39
    v_exp_f32 v40, v40
    v_exp_f32 v41, v41
    v_smfmac_f32_32x32x32_bf16 v[64:79], v[104:107], v[32:39], v124
    s_waitcnt vmcnt(7)
    v_cmp_ne_u32 vcc, s1, v14
    s_nop 4
    s_cbranch_vccnz Lretry_220
Lback_221:
    s_barrier
    global_load_dwordx4 a[60:63], v1, s[64:65] offset:3072
    v_exp_f32 v42, v42
    v_exp_f32 v43, v43
    v_exp_f32 v44, v44
    v_exp_f32 v45, v45
    v_exp_f32 v46, v46
    v_exp_f32 v47, v47
    v_exp_f32 v48, v48
    v_exp_f32 v49, v49
    v_smfmac_f32_32x32x32_bf16 v[64:79], v[108:111], v[40:47], v124
    s_waitcnt lgkmcnt(0)
    v_exp_f32 v50, v50
    v_exp_f32 v51, v51
    v_exp_f32 v52, v52
    v_mfma_f32_32x32x16_bf16 v[32:47], v[100:103], v[24:27], 0
    s_add_u32 m0, s36, 0
    s_add_u32 s66, s56, 202752
    s_addc_u32 s67, s57, 0
    global_load_lds_dwordx4 v1, s[66:67] offset:0
    global_load_lds_dwordx4 v1, s[66:67] offset:1024
    v_exp_f32 v53, v53
    v_exp_f32 v54, v54
    v_exp_f32 v55, v55
    v_exp_f32 v56, v56
    v_exp_f32 v57, v57
    v_smfmac_f32_32x32x32_bf16 v[80:95], v[104:107], v[48:55], v124
    ds_read_b128 v[96:99], v125 offset:25344
    v_exp_f32 v58, v58
    v_exp_f32 v59, v59
    v_exp_f32 v60, v60
    v_exp_f32 v61, v61
    v_exp_f32 v62, v62
    v_exp_f32 v63, v63
    v_exp_f32 v32, v32
    v_exp_f32 v33, v33
    v_smfmac_f32_32x32x32_bf16 v[80:95], v[108:111], v[56:63], v124
    ds_read_b128 v[104:107], v126 offset:26368
    v_exp_f32 v34, v34
    v_exp_f32 v35, v35
    v_exp_f32 v36, v36
    v_mfma_f32_32x32x16_bf16 v[48:63], v[100:103], v[28:31], 0
    ds_read_b128 v[108:111], v126 offset:26912
    v_exp_f32 v37, v37
    v_exp_f32 v38, v38
    v_exp_f32 v39, v39
    v_exp_f32 v40, v40
    v_exp_f32 v41, v41
    v_smfmac_f32_32x32x32_bf16 v[64:79], v[112:115], v[32:39], v124
    global_load_lds_dwordx4 v1, s[66:67] offset:2048
    global_load_lds_dwordx4 v1, s[66:67] offset:3072
    v_exp_f32 v42, v42
    v_exp_f32 v43, v43
    v_exp_f32 v44, v44
    v_exp_f32 v45, v45
    v_exp_f32 v46, v46
    v_exp_f32 v47, v47
    v_exp_f32 v48, v48
    v_exp_f32 v49, v49
    v_smfmac_f32_32x32x32_bf16 v[64:79], v[116:119], v[40:47], v124
    s_waitcnt lgkmcnt(0)
    v_exp_f32 v50, v50
    v_exp_f32 v51, v51
    v_exp_f32 v52, v52
    v_mfma_f32_32x32x16_bf16 v[32:47], v[96:99], v[24:27], 0
    s_add_u32 m0, s36, 16384
    s_add_u32 s66, s56, 219136
    s_addc_u32 s67, s57, 0
    global_load_lds_dwordx4 v1, s[66:67] offset:0
    global_load_lds_dwordx4 v1, s[66:67] offset:1024
    v_exp_f32 v53, v53
    v_exp_f32 v54, v54
    v_exp_f32 v55, v55
    v_exp_f32 v56, v56
    v_exp_f32 v57, v57
    v_smfmac_f32_32x32x32_bf16 v[80:95], v[112:115], v[48:55], v124
    ds_read_b128 v[100:103], v125 offset:27456
    v_exp_f32 v58, v58
    v_exp_f32 v59, v59
    v_exp_f32 v60, v60
    v_exp_f32 v61, v61
    v_exp_f32 v62, v62
    v_exp_f32 v63, v63
    v_exp_f32 v32, v32
    v_exp_f32 v33, v33
    v_smfmac_f32_32x32x32_bf16 v[80:95], v[116:119], v[56:63], v124
    ds_read_b128 v[112:115], v126 offset:28480
    v_exp_f32 v34, v34
    v_exp_f32 v35, v35
    v_exp_f32 v36, v36
    v_mfma_f32_32x32x16_bf16 v[48:63], v[96:99], v[28:31], 0
    ds_read_b128 v[116:119], v126 offset:29024
    v_exp_f32 v37, v37
    v_exp_f32 v38, v38
    v_exp_f32 v39, v39
    v_exp_f32 v40, v40
    v_exp_f32 v41, v41
    v_smfmac_f32_32x32x32_bf16 v[64:79], v[104:107], v[32:39], v124
    global_load_lds_dwordx4 v1, s[66:67] offset:2048
    global_load_lds_dwordx4 v1, s[66:67] offset:3072
    v_exp_f32 v42, v42
    v_exp_f32 v43, v43
    v_exp_f32 v44, v44
    v_exp_f32 v45, v45
    v_exp_f32 v46, v46
    v_exp_f32 v47, v47
    v_exp_f32 v48, v48
    v_exp_f32 v49, v49
    v_smfmac_f32_32x32x32_bf16 v[64:79], v[108:111], v[40:47], v124
    s_waitcnt lgkmcnt(0)
    v_exp_f32 v50, v50
    v_exp_f32 v51, v51
    v_exp_f32 v52, v52
    v_mfma_f32_32x32x16_bf16 v[32:47], v[100:103], v[24:27], 0
    s_add_u32 m0, s36, 32768
    s_add_u32 s66, s56, 235520
    s_addc_u32 s67, s57, 0
    global_load_lds_dwordx4 v1, s[66:67] offset:0
    global_load_lds_dwordx4 v1, s[66:67] offset:1024
    v_exp_f32 v53, v53
    v_exp_f32 v54, v54
    v_exp_f32 v55, v55
    v_exp_f32 v56, v56
    v_exp_f32 v57, v57
    v_smfmac_f32_32x32x32_bf16 v[80:95], v[104:107], v[48:55], v124
    ds_read_b128 v[96:99], v125 offset:29568
    v_exp_f32 v58, v58
    v_exp_f32 v59, v59
    v_exp_f32 v60, v60
    v_exp_f32 v61, v61
    v_exp_f32 v62, v62
    v_exp_f32 v63, v63
    v_exp_f32 v32, v32
    v_exp_f32 v33, v33
    v_smfmac_f32_32x32x32_bf16 v[80:95], v[108:111], v[56:63], v124
    ds_read_b128 v[104:107], v126 offset:30592
    v_exp_f32 v34, v34
    v_exp_f32 v35, v35
    v_exp_f32 v36, v36
    v_mfma_f32_32x32x16_bf16 v[48:63], v[100:103], v[28:31], 0
    ds_read_b128 v[108:111], v126 offset:31136
    v_exp_f32 v37, v37
    v_exp_f32 v38, v38
    v_exp_f32 v39, v39
    v_exp_f32 v40, v40
    v_exp_f32 v41, v41
    v_smfmac_f32_32x32x32_bf16 v[64:79], v[112:115], v[32:39], v124
    global_load_lds_dwordx4 v1, s[66:67] offset:2048
    global_load_lds_dwordx4 v1, s[66:67] offset:3072
    v_exp_f32 v42, v42
    v_exp_f32 v43, v43
    v_exp_f32 v44, v44
    v_exp_f32 v45, v45
    v_exp_f32 v46, v46
    v_exp_f32 v47, v47
    v_exp_f32 v48, v48
    v_exp_f32 v49, v49
    v_smfmac_f32_32x32x32_bf16 v[64:79], v[116:119], v[40:47], v124
    s_waitcnt lgkmcnt(0)
    v_exp_f32 v50, v50
    v_exp_f32 v51, v51
    v_exp_f32 v52, v52
    v_mfma_f32_32x32x16_bf16 v[32:47], v[96:99], v[24:27], 0
    s_add_u32 m0, s36, 49152
    s_add_u32 s66, s56, 251904
    s_addc_u32 s67, s57, 0
    global_load_lds_dwordx4 v1, s[66:67] offset:0
    global_load_lds_dwordx4 v1, s[66:67] offset:1024
    v_exp_f32 v53, v53
    v_exp_f32 v54, v54
    v_exp_f32 v55, v55
    v_exp_f32 v56, v56
    v_exp_f32 v57, v57
    v_smfmac_f32_32x32x32_bf16 v[80:95], v[112:115], v[48:55], v124
    ds_read_b128 v[100:103], v125 offset:31680
    v_exp_f32 v58, v58
    v_exp_f32 v59, v59
    v_exp_f32 v60, v60
    v_exp_f32 v61, v61
    v_exp_f32 v62, v62
    v_exp_f32 v63, v63
    v_exp_f32 v32, v32
    v_exp_f32 v33, v33
    v_smfmac_f32_32x32x32_bf16 v[80:95], v[116:119], v[56:63], v124
    ds_read_b128 v[112:115], v126 offset:32704
    v_exp_f32 v34, v34
    v_exp_f32 v35, v35
    v_exp_f32 v36, v36
    v_mfma_f32_32x32x16_bf16 v[48:63], v[96:99], v[28:31], 0
    ds_read_b128 v[116:119], v126 offset:33248
    v_exp_f32 v37, v37
    v_exp_f32 v38, v38
    v_exp_f32 v39, v39
    v_exp_f32 v40, v40
    v_exp_f32 v41, v41
    v_smfmac_f32_32x32x32_bf16 v[64:79], v[104:107], v[32:39], v124
    global_load_lds_dwordx4 v1, s[66:67] offset:2048
    global_load_lds_dwordx4 v1, s[66:67] offset:3072
    v_exp_f32 v42, v42
    v_exp_f32 v43, v43
    v_exp_f32 v44, v44
    v_exp_f32 v45, v45
    v_exp_f32 v46, v46
    v_exp_f32 v47, v47
    v_exp_f32 v48, v48
    v_exp_f32 v49, v49
    v_smfmac_f32_32x32x32_bf16 v[64:79], v[108:111], v[40:47], v124
    s_waitcnt lgkmcnt(0)
    v_exp_f32 v50, v50
    v_exp_f32 v51, v51
    v_exp_f32 v52, v52
    v_mfma_f32_32x32x16_bf16 v[32:47], v[100:103], v[24:27], 0
    s_add_u32 m0, s37, 65536
    s_add_u32 s66, s58, 268288
    s_addc_u32 s67, s59, 0
    global_load_lds_dwordx4 v1, s[66:67] offset:0
    v_exp_f32 v53, v53
    v_exp_f32 v54, v54
    v_exp_f32 v55, v55
    v_exp_f32 v56, v56
    v_exp_f32 v57, v57
    v_smfmac_f32_32x32x32_bf16 v[80:95], v[104:107], v[48:55], v124
    ds_read_b128 v[96:99], v125 offset:33792
    v_exp_f32 v58, v58
    v_exp_f32 v59, v59
    v_exp_f32 v60, v60
    v_exp_f32 v61, v61
    v_exp_f32 v62, v62
    v_exp_f32 v63, v63
    v_exp_f32 v32, v32
    v_exp_f32 v33, v33
    v_smfmac_f32_32x32x32_bf16 v[80:95], v[108:111], v[56:63], v124
    ds_read_b128 v[104:107], v126 offset:34816
    v_exp_f32 v34, v34
    v_exp_f32 v35, v35
    v_exp_f32 v36, v36
    v_mfma_f32_32x32x16_bf16 v[48:63], v[100:103], v[28:31], 0
    ds_read_b128 v[108:111], v126 offset:35360
    v_exp_f32 v37, v37
    v_exp_f32 v38, v38
    v_exp_f32 v39, v39
    v_exp_f32 v40, v40
    v_exp_f32 v41, v41
    v_smfmac_f32_32x32x32_bf16 v[64:79], v[112:115], v[32:39], v124
    s_add_u32 s64, s52, 20480
    s_addc_u32 s65, s53, 0
    global_load_dwordx4 a[64:67], v1, s[64:65] offset:-4096
    global_load_dwordx4 a[68:71], v1, s[64:65] offset:-3072
    v_exp_f32 v42, v42
    v_exp_f32 v43, v43
    v_exp_f32 v44, v44
    v_exp_f32 v45, v45
    v_exp_f32 v46, v46
    v_exp_f32 v47, v47
    v_exp_f32 v48, v48
    v_exp_f32 v49, v49
    v_smfmac_f32_32x32x32_bf16 v[64:79], v[116:119], v[40:47], v124
    s_waitcnt lgkmcnt(0)
    v_exp_f32 v50, v50
    v_exp_f32 v51, v51
    v_exp_f32 v52, v52
    v_mfma_f32_32x32x16_bf16 v[32:47], v[96:99], v[24:27], 0
    global_load_dwordx4 a[72:75], v1, s[64:65] offset:-2048
    v_exp_f32 v53, v53
    v_exp_f32 v54, v54
    v_exp_f32 v55, v55
    v_exp_f32 v56, v56
    v_exp_f32 v57, v57
    v_smfmac_f32_32x32x32_bf16 v[80:95], v[112:115], v[48:55], v124
    ds_read_b128 v[100:103], v125 offset:35904
    v_exp_f32 v58, v58
    v_exp_f32 v59, v59
    v_exp_f32 v60, v60
    v_exp_f32 v61, v61
    v_exp_f32 v62, v62
    v_exp_f32 v63, v63
    v_exp_f32 v32, v32
    v_exp_f32 v33, v33
    v_smfmac_f32_32x32x32_bf16 v[80:95], v[116:119], v[56:63], v124
    ds_read_b128 v[112:115], v126 offset:36928
    v_exp_f32 v34, v34
    v_exp_f32 v35, v35
    v_exp_f32 v36, v36
    v_mfma_f32_32x32x16_bf16 v[48:63], v[96:99], v[28:31], 0
    ds_read_b128 v[116:119], v126 offset:37472
    v_exp_f32 v37, v37
    v_exp_f32 v38, v38
    v_exp_f32 v39, v39
    v_exp_f32 v40, v40
    v_exp_f32 v41, v41
    v_smfmac_f32_32x32x32_bf16 v[64:79], v[104:107], v[32:39], v124
    global_load_dwordx4 a[76:79], v1, s[64:65] offset:-1024
    global_load_dwordx4 a[80:83], v1, s[64:65] offset:0
    v_exp_f32 v42, v42
    v_exp_f32 v43, v43
    v_exp_f32 v44, v44
    v_exp_f32 v45, v45
    v_exp_f32 v46, v46
    v_exp_f32 v47, v47
    v_exp_f32 v48, v48
    v_exp_f32 v49, v49
    v_smfmac_f32_32x32x32_bf16 v[64:79], v[108:111], v[40:47], v124
    s_waitcnt lgkmcnt(0)
    v_exp_f32 v50, v50
    v_exp_f32 v51, v51
    v_exp_f32 v52, v52
    v_mfma_f32_32x32x16_bf16 v[32:47], v[100:103], v[24:27], 0
    global_load_dwordx4 a[84:87], v1, s[64:65] offset:1024
    v_exp_f32 v53, v53
    v_exp_f32 v54, v54
    v_exp_f32 v55, v55
    v_exp_f32 v56, v56
    v_exp_f32 v57, v57
    v_smfmac_f32_32x32x32_bf16 v[80:95], v[104:107], v[48:55], v124
    ds_read_b128 v[96:99], v125 offset:38016
    v_exp_f32 v58, v58
    v_exp_f32 v59, v59
    v_exp_f32 v60, v60
    v_exp_f32 v61, v61
    v_exp_f32 v62, v62
    v_exp_f32 v63, v63
    v_exp_f32 v32, v32
    v_exp_f32 v33, v33
    v_smfmac_f32_32x32x32_bf16 v[80:95], v[108:111], v[56:63], v124
    ds_read_b128 v[104:107], v126 offset:39040
    v_exp_f32 v34, v34
    v_exp_f32 v35, v35
    v_exp_f32 v36, v36
    v_mfma_f32_32x32x16_bf16 v[48:63], v[100:103], v[28:31], 0
    ds_read_b128 v[108:111], v126 offset:39584
    v_exp_f32 v37, v37
    v_exp_f32 v38, v38
    v_exp_f32 v39, v39
    v_exp_f32 v40, v40
    v_exp_f32 v41, v41
    v_smfmac_f32_32x32x32_bf16 v[64:79], v[112:115], v[32:39], v124
    global_load_dwordx4 a[88:91], v1, s[64:65] offset:2048
    global_load_dwordx4 a[92:95], v1, s[64:65] offset:3072
    v_exp_f32 v42, v42
    v_exp_f32 v43, v43
    v_exp_f32 v44, v44
    v_exp_f32 v45, v45
    v_exp_f32 v46, v46
    v_exp_f32 v47, v47
    v_exp_f32 v48, v48
    v_exp_f32 v49, v49
    v_smfmac_f32_32x32x32_bf16 v[64:79], v[116:119], v[40:47], v124
    s_waitcnt lgkmcnt(0)
    v_exp_f32 v50, v50
    v_exp_f32 v51, v51
    v_exp_f32 v52, v52
    v_mfma_f32_32x32x16_bf16 v[32:47], v[96:99], v[24:27], 0
    s_add_u32 s64, s52, 28672
    s_addc_u32 s65, s53, 0
    global_load_dwordx4 a[96:99], v1, s[64:65] offset:-4096
    v_exp_f32 v53, v53
    v_exp_f32 v54, v54
    v_exp_f32 v55, v55
    v_exp_f32 v56, v56
    v_exp_f32 v57, v57
    v_smfmac_f32_32x32x32_bf16 v[80:95], v[112:115], v[48:55], v124
    ds_read_b128 v[100:103], v125 offset:40128
    v_exp_f32 v58, v58
    v_exp_f32 v59, v59
    v_exp_f32 v60, v60
    v_exp_f32 v61, v61
    v_exp_f32 v62, v62
    v_exp_f32 v63, v63
    v_exp_f32 v32, v32
    v_exp_f32 v33, v33
    v_smfmac_f32_32x32x32_bf16 v[80:95], v[116:119], v[56:63], v124
    ds_read_b128 v[112:115], v126 offset:41152
    v_exp_f32 v34, v34
    v_exp_f32 v35, v35
    v_exp_f32 v36, v36
    v_mfma_f32_32x32x16_bf16 v[48:63], v[96:99], v[28:31], 0
    ds_read_b128 v[116:119], v126 offset:41696
    v_exp_f32 v37, v37
    v_exp_f32 v38, v38
    v_exp_f32 v39, v39
    v_exp_f32 v40, v40
    v_exp_f32 v41, v41
    v_smfmac_f32_32x32x32_bf16 v[64:79], v[104:107], v[32:39], v124
    global_load_dwordx4 a[100:103], v1, s[64:65] offset:-3072
    global_load_dwordx4 a[104:107], v1, s[64:65] offset:-2048
    v_exp_f32 v42, v42
    v_exp_f32 v43, v43
    v_exp_f32 v44, v44
    v_exp_f32 v45, v45
    v_exp_f32 v46, v46
    v_exp_f32 v47, v47
    v_exp_f32 v48, v48
    v_exp_f32 v49, v49
    v_smfmac_f32_32x32x32_bf16 v[64:79], v[108:111], v[40:47], v124
    s_waitcnt lgkmcnt(0)
    v_exp_f32 v50, v50
    v_exp_f32 v51, v51
    v_exp_f32 v52, v52
    v_mfma_f32_32x32x16_bf16 v[32:47], v[100:103], v[24:27], 0
    global_load_dwordx4 a[108:111], v1, s[64:65] offset:-1024
    v_exp_f32 v53, v53
    v_exp_f32 v54, v54
    v_exp_f32 v55, v55
    v_exp_f32 v56, v56
    v_exp_f32 v57, v57
    v_smfmac_f32_32x32x32_bf16 v[80:95], v[104:107], v[48:55], v124
    ds_read_b128 v[96:99], v125 offset:42240
    v_exp_f32 v58, v58
    v_exp_f32 v59, v59
    v_exp_f32 v60, v60
    v_exp_f32 v61, v61
    v_exp_f32 v62, v62
    v_exp_f32 v63, v63
    v_exp_f32 v32, v32
    v_exp_f32 v33, v33
    v_smfmac_f32_32x32x32_bf16 v[80:95], v[108:111], v[56:63], v124
    ds_read_b128 v[104:107], v126 offset:43264
    v_exp_f32 v34, v34
    v_exp_f32 v35, v35
    v_exp_f32 v36, v36
    v_mfma_f32_32x32x16_bf16 v[48:63], v[100:103], v[28:31], 0
    ds_read_b128 v[108:111], v126 offset:43808
    v_exp_f32 v37, v37
    v_exp_f32 v38, v38
    v_exp_f32 v39, v39
    v_exp_f32 v40, v40
    v_exp_f32 v41, v41
    v_smfmac_f32_32x32x32_bf16 v[64:79], v[112:115], v[32:39], v124
    global_load_dwordx4 a[112:115], v1, s[64:65] offset:0
    global_load_dwordx4 a[116:119], v1, s[64:65] offset:1024
    v_exp_f32 v42, v42
    v_exp_f32 v43, v43
    v_exp_f32 v44, v44
    v_exp_f32 v45, v45
    v_exp_f32 v46, v46
    v_exp_f32 v47, v47
    v_exp_f32 v48, v48
    v_exp_f32 v49, v49
    v_smfmac_f32_32x32x32_bf16 v[64:79], v[116:119], v[40:47], v124
    s_waitcnt lgkmcnt(0)
    v_exp_f32 v50, v50
    v_exp_f32 v51, v51
    v_exp_f32 v52, v52
    v_mfma_f32_32x32x16_bf16 v[32:47], v[96:99], v[24:27], 0
    global_load_dwordx4 a[120:123], v1, s[64:65] offset:2048
    v_exp_f32 v53, v53
    v_exp_f32 v54, v54
    v_exp_f32 v55, v55
    v_exp_f32 v56, v56
    v_exp_f32 v57, v57
    v_smfmac_f32_32x32x32_bf16 v[80:95], v[112:115], v[48:55], v124
    ds_read_b128 v[100:103], v125 offset:44352
    v_exp_f32 v58, v58
    v_exp_f32 v59, v59
    v_exp_f32 v60, v60
    v_exp_f32 v61, v61
    v_exp_f32 v62, v62
    v_exp_f32 v63, v63
    v_exp_f32 v32, v32
    v_exp_f32 v33, v33
    v_smfmac_f32_32x32x32_bf16 v[80:95], v[116:119], v[56:63], v124
    ds_read_b128 v[112:115], v126 offset:45376
    v_exp_f32 v34, v34
    v_exp_f32 v35, v35
    v_exp_f32 v36, v36
    v_mfma_f32_32x32x16_bf16 v[48:63], v[96:99], v[28:31], 0
    ds_read_b128 v[116:119], v126 offset:45920
    v_exp_f32 v37, v37
    v_exp_f32 v38, v38
    v_exp_f32 v39, v39
    v_exp_f32 v40, v40
    v_exp_f32 v41, v41
    v_smfmac_f32_32x32x32_bf16 v[64:79], v[104:107], v[32:39], v124
    global_load_dwordx4 a[124:127], v1, s[64:65] offset:3072
    s_add_u32 s64, s54, 0
    buffer_load_dwordx4 a[128:131], v234, s[4:7], s64 offen offset:0
    v_exp_f32 v42, v42
    v_exp_f32 v43, v43
    v_exp_f32 v44, v44
    v_exp_f32 v45, v45
    v_exp_f32 v46, v46
    v_exp_f32 v47, v47
    v_exp_f32 v48, v48
    v_exp_f32 v49, v49
    v_smfmac_f32_32x32x32_bf16 v[64:79], v[108:111], v[40:47], v124
    s_waitcnt lgkmcnt(0)
    v_exp_f32 v50, v50
    v_exp_f32 v51, v51
    v_exp_f32 v52, v52
    v_mfma_f32_32x32x16_bf16 v[32:47], v[100:103], v[24:27], 0
    buffer_load_dwordx4 a[132:135], v234, s[4:7], s64 offen offset:1024
    v_exp_f32 v53, v53
    v_exp_f32 v54, v54
    v_exp_f32 v55, v55
    v_exp_f32 v56, v56
    v_exp_f32 v57, v57
    v_smfmac_f32_32x32x32_bf16 v[80:95], v[104:107], v[48:55], v124
    ds_read_b128 v[96:99], v125 offset:46464
    v_exp_f32 v58, v58
    v_exp_f32 v59, v59
    v_exp_f32 v60, v60
    v_exp_f32 v61, v61
    v_exp_f32 v62, v62
    v_exp_f32 v63, v63
    v_exp_f32 v32, v32
    v_exp_f32 v33, v33
    v_smfmac_f32_32x32x32_bf16 v[80:95], v[108:111], v[56:63], v124
    ds_read_b128 v[104:107], v126 offset:47488
    v_exp_f32 v34, v34
    v_exp_f32 v35, v35
    v_exp_f32 v36, v36
    v_mfma_f32_32x32x16_bf16 v[48:63], v[100:103], v[28:31], 0
    ds_read_b128 v[108:111], v126 offset:48032
    v_exp_f32 v37, v37
    v_exp_f32 v38, v38
    v_exp_f32 v39, v39
    v_exp_f32 v40, v40
    v_exp_f32 v41, v41
    v_smfmac_f32_32x32x32_bf16 v[64:79], v[112:115], v[32:39], v124
    buffer_load_dwordx4 a[136:139], v234, s[4:7], s64 offen offset:2048
    buffer_load_dwordx4 a[140:143], v234, s[4:7], s64 offen offset:3072
    v_exp_f32 v42, v42
    v_exp_f32 v43, v43
    v_exp_f32 v44, v44
    v_exp_f32 v45, v45
    v_exp_f32 v46, v46
    v_exp_f32 v47, v47
    v_exp_f32 v48, v48
    v_exp_f32 v49, v49
    v_smfmac_f32_32x32x32_bf16 v[64:79], v[116:119], v[40:47], v124
    s_waitcnt lgkmcnt(0)
    v_exp_f32 v50, v50
    v_exp_f32 v51, v51
    v_exp_f32 v52, v52
    v_mfma_f32_32x32x16_bf16 v[32:47], v[96:99], v[24:27], 0
    s_add_u32 s64, s54, 4096
    buffer_load_dwordx4 a[144:147], v234, s[4:7], s64 offen offset:0
    v_exp_f32 v53, v53
    v_exp_f32 v54, v54
    v_exp_f32 v55, v55
    v_exp_f32 v56, v56
    v_exp_f32 v57, v57
    v_smfmac_f32_32x32x32_bf16 v[80:95], v[112:115], v[48:55], v124
    ds_read_b128 v[100:103], v125 offset:48576
    v_exp_f32 v58, v58
    v_exp_f32 v59, v59
    v_exp_f32 v60, v60
    v_exp_f32 v61, v61
    v_exp_f32 v62, v62
    v_exp_f32 v63, v63
    v_exp_f32 v32, v32
    v_exp_f32 v33, v33
    v_smfmac_f32_32x32x32_bf16 v[80:95], v[116:119], v[56:63], v124
    ds_read_b128 v[112:115], v126 offset:49600
    v_exp_f32 v34, v34
    v_exp_f32 v35, v35
    v_exp_f32 v36, v36
    v_mfma_f32_32x32x16_bf16 v[48:63], v[96:99], v[28:31], 0
    ds_read_b128 v[116:119], v126 offset:50144
    v_exp_f32 v37, v37
    v_exp_f32 v38, v38
    v_exp_f32 v39, v39
    v_exp_f32 v40, v40
    v_exp_f32 v41, v41
    v_smfmac_f32_32x32x32_bf16 v[64:79], v[104:107], v[32:39], v124
    s_waitcnt vmcnt(21)
    s_barrier
    buffer_load_dwordx4 a[148:151], v234, s[4:7], s64 offen offset:1024
    v_exp_f32 v42, v42
    v_exp_f32 v43, v43
    v_exp_f32 v44, v44
    v_exp_f32 v45, v45
    v_exp_f32 v46, v46
    v_exp_f32 v47, v47
    v_exp_f32 v48, v48
    v_exp_f32 v49, v49
    v_smfmac_f32_32x32x32_bf16 v[64:79], v[108:111], v[40:47], v124
    s_waitcnt lgkmcnt(0)
    v_exp_f32 v50, v50
    v_exp_f32 v51, v51
    v_exp_f32 v52, v52
    v_mfma_f32_32x32x16_bf16 v[32:47], v[100:103], v[24:27], 0
    s_and_b32 s61, s23, 0xffffff00
    s_and_b32 s62, s19, 8192
    s_add_u32 s61, s61, s62
    s_add_u32 s61, s61, 425984
    buffer_store_dwordx4 v[224:227], v1, s[4:7], s61 offen
    v_exp_f32 v53, v53
    v_exp_f32 v54, v54
    v_exp_f32 v55, v55
    v_exp_f32 v56, v56
    v_exp_f32 v57, v57
    v_smfmac_f32_32x32x32_bf16 v[80:95], v[104:107], v[48:55], v124
    ds_read_b128 v[96:99], v125 offset:50688
    v_exp_f32 v58, v58
    v_exp_f32 v59, v59
    v_exp_f32 v60, v60
    v_exp_f32 v61, v61
    v_exp_f32 v62, v62
    v_exp_f32 v63, v63
    v_exp_f32 v32, v32
    v_exp_f32 v33, v33
    v_smfmac_f32_32x32x32_bf16 v[80:95], v[108:111], v[56:63], v124
    ds_read_b128 v[104:107], v126 offset:51712
    v_exp_f32 v34, v34
    v_exp_f32 v35, v35
    v_exp_f32 v36, v36
    v_mfma_f32_32x32x16_bf16 v[48:63], v[100:103], v[28:31], 0
    ds_read_b128 v[108:111], v126 offset:52256
    v_exp_f32 v37, v37
    v_exp_f32 v38, v38
    v_exp_f32 v39, v39
    v_exp_f32 v40, v40
    v_exp_f32 v41, v41
    v_smfmac_f32_32x32x32_bf16 v[64:79], v[112:115], v[32:39], v124
    s_add_u32 s61, s20, 0
    buffer_store_dwordx4 v[224:227], v1, s[4:7], s61 offen offset:0
    v_exp_f32 v42, v42
    v_exp_f32 v43, v43
    v_exp_f32 v44, v44
    v_exp_f32 v45, v45
    v_exp_f32 v46, v46
    v_exp_f32 v47, v47
    v_exp_f32 v48, v48
    v_exp_f32 v49, v49
    v_smfmac_f32_32x32x32_bf16 v[64:79], v[116:119], v[40:47], v124
    s_waitcnt lgkmcnt(0)
    v_exp_f32 v50, v50
    v_exp_f32 v51, v51
    v_exp_f32 v52, v52
    v_mfma_f32_32x32x16_bf16 v[32:47], v[96:99], v[24:27], 0
    s_add_u32 s61, s20, 65536
    buffer_store_dwordx4 v[224:227], v1, s[4:7], s61 offen offset:0
    v_exp_f32 v53, v53
    v_exp_f32 v54, v54
    v_exp_f32 v55, v55
    v_exp_f32 v56, v56
    v_exp_f32 v57, v57
    v_smfmac_f32_32x32x32_bf16 v[80:95], v[112:115], v[48:55], v124
    ds_read_b128 v[100:103], v125 offset:52800
    v_exp_f32 v58, v58
    v_exp_f32 v59, v59
    v_exp_f32 v60, v60
    v_exp_f32 v61, v61
    v_exp_f32 v62, v62
    v_exp_f32 v63, v63
    v_exp_f32 v32, v32
    v_exp_f32 v33, v33
    v_smfmac_f32_32x32x32_bf16 v[80:95], v[116:119], v[56:63], v124
    ds_read_b128 v[112:115], v126 offset:53824
    v_exp_f32 v34, v34
    v_exp_f32 v35, v35
    v_exp_f32 v36, v36
    v_mfma_f32_32x32x16_bf16 v[48:63], v[96:99], v[28:31], 0
    ds_read_b128 v[116:119], v126 offset:54368
    v_exp_f32 v37, v37
    v_exp_f32 v38, v38
    v_exp_f32 v39, v39
    v_exp_f32 v40, v40
    v_exp_f32 v41, v41
    v_smfmac_f32_32x32x32_bf16 v[64:79], v[104:107], v[32:39], v124
    s_add_u32 s61, s24, 0
    buffer_store_dwordx4 v[224:227], v1, s[4:7], s61 offen offset:0
    v_exp_f32 v42, v42
    v_exp_f32 v43, v43
    v_exp_f32 v44, v44
    v_exp_f32 v45, v45
    v_exp_f32 v46, v46
    v_exp_f32 v47, v47
    v_exp_f32 v48, v48
    v_exp_f32 v49, v49
    v_smfmac_f32_32x32x32_bf16 v[64:79], v[108:111], v[40:47], v124
    s_waitcnt lgkmcnt(0)
    v_exp_f32 v50, v50
    v_exp_f32 v51, v51
    v_exp_f32 v52, v52
    v_mfma_f32_32x32x16_bf16 v[32:47], v[100:103], v[24:27], 0
    buffer_store_dwordx4 v[224:227], v1, s[4:7], s61 offen offset:1024
    v_exp_f32 v53, v53
    v_exp_f32 v54, v54
    v_exp_f32 v55, v55
    v_exp_f32 v56, v56
    v_exp_f32 v57, v57
    v_smfmac_f32_32x32x32_bf16 v[80:95], v[104:107], v[48:55], v124
    ds_read_b128 v[96:99], v125 offset:54912
    v_exp_f32 v58, v58
    v_exp_f32 v59, v59
    v_exp_f32 v60, v60
    v_exp_f32 v61, v61
    v_exp_f32 v62, v62
    v_exp_f32 v63, v63
    v_exp_f32 v32, v32
    v_exp_f32 v33, v33
    v_smfmac_f32_32x32x32_bf16 v[80:95], v[108:111], v[56:63], v124
    ds_read_b128 v[104:107], v126 offset:55936
    v_exp_f32 v34, v34
    v_exp_f32 v35, v35
    v_exp_f32 v36, v36
    v_mfma_f32_32x32x16_bf16 v[48:63], v[100:103], v[28:31], 0
    ds_read_b128 v[108:111], v126 offset:56480
    v_exp_f32 v37, v37
    v_exp_f32 v38, v38
    v_exp_f32 v39, v39
    v_exp_f32 v40, v40
    v_exp_f32 v41, v41
    v_smfmac_f32_32x32x32_bf16 v[64:79], v[112:115], v[32:39], v124
    s_add_u32 s61, s25, 0
    buffer_store_dwordx4 v[224:227], v234, s[4:7], s61 offen offset:0
    v_exp_f32 v42, v42
    v_exp_f32 v43, v43
    v_exp_f32 v44, v44
    v_exp_f32 v45, v45
    v_exp_f32 v46, v46
    v_exp_f32 v47, v47
    v_exp_f32 v48, v48
    v_exp_f32 v49, v49
    v_smfmac_f32_32x32x32_bf16 v[64:79], v[116:119], v[40:47], v124
    s_waitcnt lgkmcnt(0)
    v_exp_f32 v50, v50
    v_exp_f32 v51, v51
    v_exp_f32 v52, v52
    v_mfma_f32_32x32x16_bf16 v[32:47], v[96:99], v[24:27], 0
    buffer_store_dwordx4 v[224:227], v234, s[4:7], s61 offen offset:1024
    v_exp_f32 v53, v53
    v_exp_f32 v54, v54
    v_exp_f32 v55, v55
    v_exp_f32 v56, v56
    v_exp_f32 v57, v57
    v_smfmac_f32_32x32x32_bf16 v[80:95], v[112:115], v[48:55], v124
    ds_read_b128 v[100:103], v125 offset:57024
    v_exp_f32 v58, v58
    v_exp_f32 v59, v59
    v_exp_f32 v60, v60
    v_exp_f32 v61, v61
    v_exp_f32 v62, v62
    v_exp_f32 v63, v63
    v_exp_f32 v32, v32
    v_exp_f32 v33, v33
    v_smfmac_f32_32x32x32_bf16 v[80:95], v[116:119], v[56:63], v124
    ds_read_b128 v[112:115], v126 offset:58048
    v_exp_f32 v34, v34
    v_exp_f32 v35, v35
    v_exp_f32 v36, v36
    v_mfma_f32_32x32x16_bf16 v[48:63], v[96:99], v[28:31], 0
    ds_read_b128 v[116:119], v126 offset:58592
    v_exp_f32 v37, v37
    v_exp_f32 v38, v38
    v_exp_f32 v39, v39
    v_exp_f32 v40, v40
    v_exp_f32 v41, v41
    v_smfmac_f32_32x32x32_bf16 v[64:79], v[104:107], v[32:39], v124
    s_add_u32 s61, s20, 32768
    buffer_store_dwordx4 v[224:227], v1, s[4:7], s61 offen offset:0
    v_exp_f32 v42, v42
    v_exp_f32 v43, v43
    v_exp_f32 v44, v44
    v_exp_f32 v45, v45
    v_exp_f32 v46, v46
    v_exp_f32 v47, v47
    v_exp_f32 v48, v48
    v_exp_f32 v49, v49
    v_smfmac_f32_32x32x32_bf16 v[64:79], v[108:111], v[40:47], v124
    s_waitcnt lgkmcnt(0)
    v_exp_f32 v50, v50
    v_exp_f32 v51, v51
    v_exp_f32 v52, v52
    v_mfma_f32_32x32x16_bf16 v[32:47], v[100:103], v[24:27], 0
    s_add_u32 s61, s24, 114688
    buffer_store_dwordx4 v[224:227], v1, s[4:7], s61 offen offset:0
    v_exp_f32 v53, v53
    v_exp_f32 v54, v54
    v_exp_f32 v55, v55
    v_exp_f32 v56, v56
    v_exp_f32 v57, v57
    v_smfmac_f32_32x32x32_bf16 v[80:95], v[104:107], v[48:55], v124
    ds_read_b128 v[96:99], v125 offset:59136
    v_exp_f32 v58, v58
    v_exp_f32 v59, v59
    v_exp_f32 v60, v60
    v_exp_f32 v61, v61
    v_exp_f32 v62, v62
    v_exp_f32 v63, v63
    v_exp_f32 v32, v32
    v_exp_f32 v33, v33
    v_smfmac_f32_32x32x32_bf16 v[80:95], v[108:111], v[56:63], v124
    ds_read_b128 v[104:107], v126 offset:60160
    v_exp_f32 v34, v34
    v_exp_f32 v35, v35
    v_exp_f32 v36, v36
    v_mfma_f32_32x32x16_bf16 v[48:63], v[100:103], v[28:31], 0
    ds_read_b128 v[108:111], v126 offset:60704
    v_exp_f32 v37, v37
    v_exp_f32 v38, v38
    v_exp_f32 v39, v39
    v_exp_f32 v40, v40
    v_exp_f32 v41, v41
    v_smfmac_f32_32x32x32_bf16 v[64:79], v[112:115], v[32:39], v124
    buffer_store_dwordx4 v[224:227], v1, s[4:7], s61 offen offset:1024
    v_exp_f32 v42, v42
    v_exp_f32 v43, v43
    v_exp_f32 v44, v44
    v_exp_f32 v45, v45
    v_exp_f32 v46, v46
    v_exp_f32 v47, v47
    v_exp_f32 v48, v48
    v_exp_f32 v49, v49
    v_smfmac_f32_32x32x32_bf16 v[64:79], v[116:119], v[40:47], v124
    s_waitcnt lgkmcnt(0)
    v_exp_f32 v50, v50
    v_exp_f32 v51, v51
    v_exp_f32 v52, v52
    v_mfma_f32_32x32x16_bf16 v[32:47], v[96:99], v[24:27], 0
    s_add_u32 s61, s25, 114688
    buffer_store_dwordx4 v[224:227], v234, s[4:7], s61 offen offset:0
    v_exp_f32 v53, v53
    v_exp_f32 v54, v54
    v_exp_f32 v55, v55
    v_exp_f32 v56, v56
    v_exp_f32 v57, v57
    v_smfmac_f32_32x32x32_bf16 v[80:95], v[112:115], v[48:55], v124
    ds_read_b128 v[100:103], v125 offset:61248
    v_exp_f32 v58, v58
    v_exp_f32 v59, v59
    v_exp_f32 v60, v60
    v_exp_f32 v61, v61
    v_exp_f32 v62, v62
    v_exp_f32 v63, v63
    v_exp_f32 v32, v32
    v_exp_f32 v33, v33
    v_smfmac_f32_32x32x32_bf16 v[80:95], v[116:119], v[56:63], v124
    ds_read_b128 v[112:115], v126 offset:62272
    v_exp_f32 v34, v34
    v_exp_f32 v35, v35
    v_exp_f32 v36, v36
    v_mfma_f32_32x32x16_bf16 v[48:63], v[96:99], v[28:31], 0
    ds_read_b128 v[116:119], v126 offset:62816
    v_exp_f32 v37, v37
    v_exp_f32 v38, v38
    v_exp_f32 v39, v39
    v_exp_f32 v40, v40
    v_exp_f32 v41, v41
    v_smfmac_f32_32x32x32_bf16 v[64:79], v[104:107], v[32:39], v124
    buffer_store_dwordx4 v[224:227], v234, s[4:7], s61 offen offset:1024
    v_exp_f32 v42, v42
    v_exp_f32 v43, v43
    v_exp_f32 v44, v44
    v_exp_f32 v45, v45
    v_exp_f32 v46, v46
    v_exp_f32 v47, v47
    v_exp_f32 v48, v48
    v_exp_f32 v49, v49
    v_smfmac_f32_32x32x32_bf16 v[64:79], v[108:111], v[40:47], v124
    s_waitcnt lgkmcnt(0)
    v_exp_f32 v50, v50
    v_exp_f32 v51, v51
    v_exp_f32 v52, v52
    v_mfma_f32_32x32x16_bf16 v[32:47], v[100:103], v[24:27], 0
    buffer_load_dwordx4 a[152:155], v234, s[4:7], s64 offen offset:2048
    buffer_load_dwordx4 a[156:159], v234, s[4:7], s64 offen offset:3072
    v_exp_f32 v53, v53
    v_exp_f32 v54, v54
    v_exp_f32 v55, v55
    v_exp_f32 v56, v56
    v_exp_f32 v57, v57
    v_smfmac_f32_32x32x32_bf16 v[80:95], v[104:107], v[48:55], v124
    ds_read_b128 v[96:99], v125 offset:63360
    v_exp_f32 v58, v58
    v_exp_f32 v59, v59
    v_exp_f32 v60, v60
    v_exp_f32 v61, v61
    v_exp_f32 v62, v62
    v_exp_f32 v63, v63
    v_exp_f32 v32, v32
    v_exp_f32 v33, v33
    v_smfmac_f32_32x32x32_bf16 v[80:95], v[108:111], v[56:63], v124
    ds_read_b128 v[104:107], v126 offset:64384
    v_exp_f32 v34, v34
    v_exp_f32 v35, v35
    v_exp_f32 v36, v36
    v_mfma_f32_32x32x16_bf16 v[48:63], v[100:103], v[28:31], 0
    ds_read_b128 v[108:111], v126 offset:64928
    v_exp_f32 v37, v37
    v_exp_f32 v38, v38
    v_exp_f32 v39, v39
    v_exp_f32 v40, v40
    v_exp_f32 v41, v41
    v_smfmac_f32_32x32x32_bf16 v[64:79], v[112:115], v[32:39], v124
    s_add_u32 s64, s54, 8192
    buffer_load_dwordx4 a[160:163], v234, s[4:7], s64 offen offset:0
    buffer_load_dwordx4 a[164:167], v234, s[4:7], s64 offen offset:1024
    v_exp_f32 v42, v42
    v_exp_f32 v43, v43
    v_exp_f32 v44, v44
    v_exp_f32 v45, v45
    v_exp_f32 v46, v46
    v_exp_f32 v47, v47
    v_exp_f32 v48, v48
    v_exp_f32 v49, v49
    v_smfmac_f32_32x32x32_bf16 v[64:79], v[116:119], v[40:47], v124
    s_waitcnt lgkmcnt(0)
    v_exp_f32 v50, v50
    v_exp_f32 v51, v51
    v_exp_f32 v52, v52
    v_mfma_f32_32x32x16_bf16 v[32:47], v[96:99], v[24:27], 0
    buffer_load_dwordx4 a[168:171], v234, s[4:7], s64 offen offset:2048
    buffer_load_dwordx4 a[172:175], v234, s[4:7], s64 offen offset:3072
    v_exp_f32 v53, v53
    v_exp_f32 v54, v54
    v_exp_f32 v55, v55
    v_exp_f32 v56, v56
    v_exp_f32 v57, v57
    v_smfmac_f32_32x32x32_bf16 v[80:95], v[112:115], v[48:55], v124
    ds_read_b128 v[100:103], v125 offset:65472
    v_exp_f32 v58, v58
    v_exp_f32 v59, v59
    v_exp_f32 v60, v60
    v_exp_f32 v61, v61
    v_exp_f32 v62, v62
    v_exp_f32 v63, v63
    v_exp_f32 v32, v32
    v_exp_f32 v33, v33
    v_smfmac_f32_32x32x32_bf16 v[80:95], v[116:119], v[56:63], v124
    v_add_u32 v126, 0xffc0, v126
    ds_read_b128 v[112:115], v126 offset:1024
    v_exp_f32 v34, v34
    v_exp_f32 v35, v35
    v_exp_f32 v36, v36
    v_mfma_f32_32x32x16_bf16 v[48:63], v[96:99], v[28:31], 0
    ds_read_b128 v[116:119], v126 offset:1568
    v_exp_f32 v37, v37
    v_exp_f32 v38, v38
    v_exp_f32 v39, v39
    v_exp_f32 v40, v40
    v_exp_f32 v41, v41
    v_smfmac_f32_32x32x32_bf16 v[64:79], v[104:107], v[32:39], v124
    s_add_u32 s64, s54, 12288
    buffer_load_dwordx4 a[176:179], v234, s[4:7], s64 offen offset:0
    v_exp_f32 v42, v42
    v_exp_f32 v43, v43
    v_exp_f32 v44, v44
    v_exp_f32 v45, v45
    v_exp_f32 v46, v46
    v_exp_f32 v47, v47
    v_exp_f32 v48, v48
    v_exp_f32 v49, v49
    v_smfmac_f32_32x32x32_bf16 v[64:79], v[108:111], v[40:47], v124
    s_waitcnt lgkmcnt(0)
    v_exp_f32 v50, v50
    v_exp_f32 v51, v51
    v_exp_f32 v52, v52
    v_mfma_f32_32x32x16_bf16 v[32:47], v[100:103], v[24:27], 0
    buffer_load_dwordx4 a[180:183], v234, s[4:7], s64 offen offset:1024
    buffer_load_dwordx4 a[184:187], v234, s[4:7], s64 offen offset:2048
    v_exp_f32 v53, v53
    v_exp_f32 v54, v54
    v_exp_f32 v55, v55
    v_exp_f32 v56, v56
    v_exp_f32 v57, v57
    v_smfmac_f32_32x32x32_bf16 v[80:95], v[104:107], v[48:55], v124
    v_add_u32 v125, 0xfffef800, v125
    ds_read_b128 v[96:99], v125 offset:0
    v_exp_f32 v58, v58
    v_exp_f32 v59, v59
    v_exp_f32 v60, v60
    v_exp_f32 v61, v61
    v_exp_f32 v62, v62
    v_exp_f32 v63, v63
    v_exp_f32 v32, v32
    v_exp_f32 v33, v33
    v_smfmac_f32_32x32x32_bf16 v[80:95], v[108:111], v[56:63], v124
    v_add_u32 v126, 0xfffdf840, v126
    ds_read_b128 v[104:107], v126 offset:1024
    v_exp_f32 v34, v34
    v_exp_f32 v35, v35
    v_exp_f32 v36, v36
    v_mfma_f32_32x32x16_bf16 v[48:63], v[100:103], v[28:31], 0
    ds_read_b128 v[108:111], v126 offset:1568
    v_exp_f32 v37, v37
    v_exp_f32 v38, v38
    v_exp_f32 v39, v39
    v_exp_f32 v40, v40
    v_exp_f32 v41, v41
    v_smfmac_f32_32x32x32_bf16 v[64:79], v[112:115], v[32:39], v124
    buffer_load_dwordx4 a[188:191], v234, s[4:7], s64 offen offset:3072
    s_add_u32 s64, s54, 16384
    buffer_load_dwordx4 a[192:195], v234, s[4:7], s64 offen offset:0
    v_exp_f32 v42, v42
    v_exp_f32 v43, v43
    v_exp_f32 v44, v44
    v_exp_f32 v45, v45
    v_exp_f32 v46, v46
    v_exp_f32 v47, v47
    v_exp_f32 v48, v48
    v_exp_f32 v49, v49
    v_smfmac_f32_32x32x32_bf16 v[64:79], v[116:119], v[40:47], v124
    s_waitcnt lgkmcnt(0)
    v_exp_f32 v50, v50
    v_exp_f32 v51, v51
    v_exp_f32 v52, v52
    v_mfma_f32_32x32x16_bf16 v[32:47], v[96:99], v[24:27], 0
    buffer_load_dwordx4 a[196:199], v234, s[4:7], s64 offen offset:1024
    v_exp_f32 v53, v53
    v_exp_f32 v54, v54
    v_exp_f32 v55, v55
    v_exp_f32 v56, v56
    v_exp_f32 v57, v57
    v_smfmac_f32_32x32x32_bf16 v[80:95], v[112:115], v[48:55], v124
    ds_read_b128 v[100:103], v125 offset:2112
    v_exp_f32 v58, v58
    v_exp_f32 v59, v59
    v_exp_f32 v60, v60
    v_exp_f32 v61, v61
    v_exp_f32 v62, v62
    v_exp_f32 v63, v63
    v_exp_f32 v32, v32
    v_exp_f32 v33, v33
    v_smfmac_f32_32x32x32_bf16 v[80:95], v[116:119], v[56:63], v124
    s_waitcnt lgkmcnt(0)
    ds_read_b128 v[112:115], v126 offset:3136
    v_exp_f32 v34, v34
    v_exp_f32 v35, v35
    v_exp_f32 v36, v36
    v_mfma_f32_32x32x16_bf16 v[48:63], v[100:103], v[24:27], 0
    ds_read_b128 v[116:119], v126 offset:3680
    v_exp_f32 v37, v37
    v_exp_f32 v38, v38
    v_exp_f32 v39, v39
    v_exp_f32 v40, v40
    v_exp_f32 v41, v41
    v_smfmac_f32_32x32x32_bf16 v[64:79], v[104:107], v[32:39], v124
    ds_read_b128 v[96:99], v125 offset:4224
    v_exp_f32 v42, v42
    v_exp_f32 v43, v43
    v_exp_f32 v44, v44
    v_exp_f32 v45, v45
    v_exp_f32 v46, v46
    v_exp_f32 v47, v47
    v_exp_f32 v48, v48
    v_exp_f32 v49, v49
    v_smfmac_f32_32x32x32_bf16 v[64:79], v[108:111], v[40:47], v124
    s_waitcnt lgkmcnt(0)
    ds_read_b128 v[104:107], v126 offset:5248
    v_exp_f32 v50, v50
    v_exp_f32 v51, v51
    v_exp_f32 v52, v52
    v_mfma_f32_32x32x16_bf16 v[32:47], v[96:99], v[24:27], 0
    ds_read_b128 v[108:111], v126 offset:5792
    v_exp_f32 v53, v53
    v_exp_f32 v54, v54
    v_exp_f32 v55, v55
    v_exp_f32 v56, v56
    v_exp_f32 v57, v57
    v_smfmac_f32_32x32x32_bf16 v[64:79], v[112:115], v[48:55], v124
    ds_read_b128 v[100:103], v125 offset:6336
    v_exp_f32 v58, v58
    v_exp_f32 v59, v59
    v_exp_f32 v60, v60
    v_exp_f32 v61, v61
    v_exp_f32 v62, v62
    v_exp_f32 v63, v63
    v_exp_f32 v32, v32
    v_exp_f32 v33, v33
    v_smfmac_f32_32x32x32_bf16 v[64:79], v[116:119], v[56:63], v124
    s_waitcnt lgkmcnt(0)
    ds_read_b128 v[112:115], v126 offset:7360
    v_exp_f32 v34, v34
    v_exp_f32 v35, v35
    v_exp_f32 v36, v36
    v_mfma_f32_32x32x16_bf16 v[48:63], v[100:103], v[24:27], 0
    ds_read_b128 v[116:119], v126 offset:7904
    v_exp_f32 v37, v37
    v_exp_f32 v38, v38
    v_exp_f32 v39, v39
    v_exp_f32 v40, v40
    v_exp_f32 v41, v41
    v_smfmac_f32_32x32x32_bf16 v[64:79], v[104:107], v[32:39], v124
    ds_read_b128 v[96:99], v125 offset:8448
    v_exp_f32 v42, v42
    v_exp_f32 v43, v43
    v_exp_f32 v44, v44
    v_exp_f32 v45, v45
    v_exp_f32 v46, v46
    v_exp_f32 v47, v47
    v_exp_f32 v48, v48
    v_exp_f32 v49, v49
    v_smfmac_f32_32x32x32_bf16 v[64:79], v[108:111], v[40:47], v124
    s_waitcnt lgkmcnt(0)
    ds_read_b128 v[104:107], v126 offset:9472
    v_exp_f32 v50, v50
    v_exp_f32 v51, v51
    v_exp_f32 v52, v52
    v_mfma_f32_32x32x16_bf16 v[32:47], v[96:99], v[24:27], 0
    ds_read_b128 v[108:111], v126 offset:10016
    v_exp_f32 v53, v53
    v_exp_f32 v54, v54
    v_exp_f32 v55, v55
    v_exp_f32 v56, v56
    v_exp_f32 v57, v57
    v_smfmac_f32_32x32x32_bf16 v[64:79], v[112:115], v[48:55], v124
    ds_read_b128 v[100:103], v125 offset:10560
    v_exp_f32 v58, v58
    v_exp_f32 v59, v59
    v_exp_f32 v60, v60
    v_exp_f32 v61, v61
    v_exp_f32 v62, v62
    v_exp_f32 v63, v63
    v_exp_f32 v32, v32
    v_exp_f32 v33, v33
    v_smfmac_f32_32x32x32_bf16 v[64:79], v[116:119], v[56:63], v124
    s_waitcnt lgkmcnt(0)
    ds_read_b128 v[112:115], v126 offset:11584
    v_exp_f32 v34, v34
    v_exp_f32 v35, v35
    v_exp_f32 v36, v36
    v_mfma_f32_32x32x16_bf16 v[48:63], v[100:103], v[24:27], 0
    ds_read_b128 v[116:119], v126 offset:12128
    v_exp_f32 v37, v37
    v_exp_f32 v38, v38
    v_exp_f32 v39, v39
    v_exp_f32 v40, v40
    v_exp_f32 v41, v41
    v_smfmac_f32_32x32x32_bf16 v[64:79], v[104:107], v[32:39], v124
    ds_read_b128 v[96:99], v125 offset:12672
    v_exp_f32 v42, v42
    v_exp_f32 v43, v43
    v_exp_f32 v44, v44
    v_exp_f32 v45, v45
    v_exp_f32 v46, v46
    v_exp_f32 v47, v47
    v_exp_f32 v48, v48
    v_exp_f32 v49, v49
    v_smfmac_f32_32x32x32_bf16 v[64:79], v[108:111], v[40:47], v124
    s_waitcnt lgkmcnt(0)
    ds_read_b128 v[104:107], v126 offset:13696
    v_exp_f32 v50, v50
    v_exp_f32 v51, v51
    v_exp_f32 v52, v52
    v_mfma_f32_32x32x16_bf16 v[32:47], v[96:99], v[24:27], 0
    ds_read_b128 v[108:111], v126 offset:14240
    v_exp_f32 v53, v53
    v_exp_f32 v54, v54
    v_exp_f32 v55, v55
    v_exp_f32 v56, v56
    v_exp_f32 v57, v57
    v_smfmac_f32_32x32x32_bf16 v[64:79], v[112:115], v[48:55], v124
    ds_read_b128 v[100:103], v125 offset:14784
    v_exp_f32 v58, v58
    v_exp_f32 v59, v59
    v_exp_f32 v60, v60
    v_exp_f32 v61, v61
    v_exp_f32 v62, v62
    v_exp_f32 v63, v63
    v_exp_f32 v32, v32
    v_exp_f32 v33, v33
    v_smfmac_f32_32x32x32_bf16 v[64:79], v[116:119], v[56:63], v124
    ds_read_b128 v[112:115], v126 offset:15808
    v_exp_f32 v34, v34
    v_exp_f32 v35, v35
    v_exp_f32 v36, v36
    v_mfma_f32_32x32x16_bf16 v[48:63], v[96:99], v[28:31], 0
    ds_read_b128 v[116:119], v126 offset:16352
    v_exp_f32 v37, v37
    v_exp_f32 v38, v38
    v_exp_f32 v39, v39
    v_exp_f32 v40, v40
    v_exp_f32 v41, v41
    s_waitcnt lgkmcnt(4)
    v_smfmac_f32_32x32x32_bf16 v[64:79], v[104:107], v[32:39], v124
    s_barrier
    v_exp_f32 v42, v42
    v_exp_f32 v43, v43
    v_exp_f32 v44, v44
    v_exp_f32 v45, v45
    v_exp_f32 v46, v46
    v_exp_f32 v47, v47
    v_exp_f32 v48, v48
    v_exp_f32 v49, v49
    s_waitcnt lgkmcnt(3)
    v_smfmac_f32_32x32x32_bf16 v[64:79], v[108:111], v[40:47], v124
    s_waitcnt lgkmcnt(0)
    v_exp_f32 v50, v50
    v_exp_f32 v51, v51
    v_exp_f32 v52, v52
    v_mfma_f32_32x32x16_bf16 v[32:47], v[100:103], v[24:27], 0
    s_add_u32 m0, s30, 67584
    s_add_u32 s66, s44, 524288
    s_addc_u32 s67, s45, 0
    global_load_lds_dwordx4 v2, s[66:67] offset:0
    global_load_lds_dwordx4 v2, s[66:67] offset:1024
    v_exp_f32 v53, v53
    v_exp_f32 v54, v54
    v_exp_f32 v55, v55
    v_exp_f32 v56, v56
    v_exp_f32 v57, v57
    v_smfmac_f32_32x32x32_bf16 v[80:95], v[104:107], v[48:55], v124
    ds_read_b128 v[96:99], v125 offset:16896
    v_exp_f32 v58, v58
    v_exp_f32 v59, v59
    v_exp_f32 v60, v60
    v_exp_f32 v61, v61
    v_exp_f32 v62, v62
    v_exp_f32 v63, v63
    v_exp_f32 v32, v32
    v_exp_f32 v33, v33
    v_smfmac_f32_32x32x32_bf16 v[80:95], v[108:111], v[56:63], v124
    ds_read_b128 v[104:107], v126 offset:17920
    v_exp_f32 v34, v34
    v_exp_f32 v35, v35
    v_exp_f32 v36, v36
    v_mfma_f32_32x32x16_bf16 v[48:63], v[100:103], v[28:31], 0
    ds_read_b128 v[108:111], v126 offset:18464
    v_exp_f32 v37, v37
    v_exp_f32 v38, v38
    v_exp_f32 v39, v39
    v_exp_f32 v40, v40
    v_exp_f32 v41, v41
    v_smfmac_f32_32x32x32_bf16 v[64:79], v[112:115], v[32:39], v124
    global_load_lds_dwordx4 v2, s[66:67] offset:2048
    global_load_lds_dwordx4 v2, s[66:67] offset:3072
    v_exp_f32 v42, v42
    v_exp_f32 v43, v43
    v_exp_f32 v44, v44
    v_exp_f32 v45, v45
    v_exp_f32 v46, v46
    v_exp_f32 v47, v47
    v_exp_f32 v48, v48
    v_exp_f32 v49, v49
    v_smfmac_f32_32x32x32_bf16 v[64:79], v[116:119], v[40:47], v124
    s_waitcnt lgkmcnt(0)
    v_exp_f32 v50, v50
    v_exp_f32 v51, v51
    v_exp_f32 v52, v52
    v_mfma_f32_32x32x16_bf16 v[32:47], v[96:99], v[24:27], 0
    s_add_u32 m0, s30, 71680
    s_add_u32 s66, s44, 528384
    s_addc_u32 s67, s45, 0
    global_load_lds_dwordx4 v2, s[66:67] offset:0
    v_exp_f32 v53, v53
    v_exp_f32 v54, v54
    v_exp_f32 v55, v55
    v_exp_f32 v56, v56
    v_exp_f32 v57, v57
    v_smfmac_f32_32x32x32_bf16 v[80:95], v[112:115], v[48:55], v124
    ds_read_b128 v[100:103], v125 offset:19008
    v_exp_f32 v58, v58
    v_exp_f32 v59, v59
    v_exp_f32 v60, v60
    v_exp_f32 v61, v61
    v_exp_f32 v62, v62
    v_exp_f32 v63, v63
    v_exp_f32 v32, v32
    v_exp_f32 v33, v33
    v_smfmac_f32_32x32x32_bf16 v[80:95], v[116:119], v[56:63], v124
    ds_read_b128 v[112:115], v126 offset:20032
    v_exp_f32 v34, v34
    v_exp_f32 v35, v35
    v_exp_f32 v36, v36
    v_mfma_f32_32x32x16_bf16 v[48:63], v[96:99], v[28:31], 0
    ds_read_b128 v[116:119], v126 offset:20576
    v_exp_f32 v37, v37
    v_exp_f32 v38, v38
    v_exp_f32 v39, v39
    v_exp_f32 v40, v40
    v_exp_f32 v41, v41
    v_smfmac_f32_32x32x32_bf16 v[64:79], v[104:107], v[32:39], v124
    global_load_lds_dwordx4 v2, s[66:67] offset:1024
    global_load_lds_dwordx4 v2, s[66:67] offset:2048
    v_exp_f32 v42, v42
    v_exp_f32 v43, v43
    v_exp_f32 v44, v44
    v_exp_f32 v45, v45
    v_exp_f32 v46, v46
    v_exp_f32 v47, v47
    v_exp_f32 v48, v48
    v_exp_f32 v49, v49
    v_smfmac_f32_32x32x32_bf16 v[64:79], v[108:111], v[40:47], v124
    s_waitcnt lgkmcnt(0)
    v_exp_f32 v50, v50
    v_exp_f32 v51, v51
    v_exp_f32 v52, v52
    v_mfma_f32_32x32x16_bf16 v[32:47], v[100:103], v[24:27], 0
    global_load_lds_dwordx4 v2, s[66:67] offset:3072
    s_add_u32 m0, s30, 75776
    s_add_u32 s66, s46, 524288
    s_addc_u32 s67, s47, 0
    global_load_lds_dwordx4 v2, s[66:67] offset:0
    v_exp_f32 v53, v53
    v_exp_f32 v54, v54
    v_exp_f32 v55, v55
    v_exp_f32 v56, v56
    v_exp_f32 v57, v57
    v_smfmac_f32_32x32x32_bf16 v[80:95], v[104:107], v[48:55], v124
    ds_read_b128 v[96:99], v125 offset:21120
    v_exp_f32 v58, v58
    v_exp_f32 v59, v59
    v_exp_f32 v60, v60
    v_exp_f32 v61, v61
    v_exp_f32 v62, v62
    v_exp_f32 v63, v63
    v_exp_f32 v32, v32
    v_exp_f32 v33, v33
    v_smfmac_f32_32x32x32_bf16 v[80:95], v[108:111], v[56:63], v124
    ds_read_b128 v[104:107], v126 offset:22144
    v_exp_f32 v34, v34
    v_exp_f32 v35, v35
    v_exp_f32 v36, v36
    v_mfma_f32_32x32x16_bf16 v[48:63], v[100:103], v[28:31], 0
    ds_read_b128 v[108:111], v126 offset:22688
    v_exp_f32 v37, v37
    v_exp_f32 v38, v38
    v_exp_f32 v39, v39
    v_exp_f32 v40, v40
    v_exp_f32 v41, v41
    v_smfmac_f32_32x32x32_bf16 v[64:79], v[112:115], v[32:39], v124
    global_load_lds_dwordx4 v2, s[66:67] offset:1024
    v_exp_f32 v42, v42
    v_exp_f32 v43, v43
    v_exp_f32 v44, v44
    v_exp_f32 v45, v45
    v_exp_f32 v46, v46
    v_exp_f32 v47, v47
    v_exp_f32 v48, v48
    v_exp_f32 v49, v49
    v_smfmac_f32_32x32x32_bf16 v[64:79], v[116:119], v[40:47], v124
    s_waitcnt lgkmcnt(0)
    v_exp_f32 v50, v50
    v_exp_f32 v51, v51
    v_exp_f32 v52, v52
    v_mfma_f32_32x32x16_bf16 v[32:47], v[96:99], v[24:27], 0
    global_load_lds_dwordx4 v2, s[66:67] offset:2048
    global_load_lds_dwordx4 v2, s[66:67] offset:3072
    v_exp_f32 v53, v53
    v_exp_f32 v54, v54
    v_exp_f32 v55, v55
    v_exp_f32 v56, v56
    v_exp_f32 v57, v57
    v_smfmac_f32_32x32x32_bf16 v[80:95], v[112:115], v[48:55], v124
    ds_read_b128 v[100:103], v125 offset:23232
    v_exp_f32 v58, v58
    v_exp_f32 v59, v59
    v_exp_f32 v60, v60
    v_exp_f32 v61, v61
    v_exp_f32 v62, v62
    v_exp_f32 v63, v63
    v_exp_f32 v32, v32
    v_exp_f32 v33, v33
    v_smfmac_f32_32x32x32_bf16 v[80:95], v[116:119], v[56:63], v124
    ds_read_b128 v[112:115], v126 offset:24256
    v_exp_f32 v34, v34
    v_exp_f32 v35, v35
    v_exp_f32 v36, v36
    v_mfma_f32_32x32x16_bf16 v[48:63], v[96:99], v[28:31], 0
    ds_read_b128 v[116:119], v126 offset:24800
    v_exp_f32 v37, v37
    v_exp_f32 v38, v38
    v_exp_f32 v39, v39
    v_exp_f32 v40, v40
    v_exp_f32 v41, v41
    v_smfmac_f32_32x32x32_bf16 v[64:79], v[104:107], v[32:39], v124
    s_add_u32 m0, s30, 79872
    s_add_u32 s66, s46, 528384
    s_addc_u32 s67, s47, 0
    global_load_lds_dwordx4 v2, s[66:67] offset:0
    global_load_lds_dwordx4 v2, s[66:67] offset:1024
    v_exp_f32 v42, v42
    v_exp_f32 v43, v43
    v_exp_f32 v44, v44
    v_exp_f32 v45, v45
    v_exp_f32 v46, v46
    v_exp_f32 v47, v47
    v_exp_f32 v48, v48
    v_exp_f32 v49, v49
    v_smfmac_f32_32x32x32_bf16 v[64:79], v[108:111], v[40:47], v124
    s_waitcnt lgkmcnt(0)
    v_exp_f32 v50, v50
    v_exp_f32 v51, v51
    v_exp_f32 v52, v52
    v_mfma_f32_32x32x16_bf16 v[32:47], v[100:103], v[24:27], 0
    global_load_lds_dwordx4 v2, s[66:67] offset:2048
    v_exp_f32 v53, v53
    v_exp_f32 v54, v54
    v_exp_f32 v55, v55
    v_exp_f32 v56, v56
    v_exp_f32 v57, v57
    v_smfmac_f32_32x32x32_bf16 v[80:95], v[104:107], v[48:55], v124
    ds_read_b128 v[96:99], v125 offset:25344
    v_exp_f32 v58, v58
    v_exp_f32 v59, v59
    v_exp_f32 v60, v60
    v_exp_f32 v61, v61
    v_exp_f32 v62, v62
    v_exp_f32 v63, v63
    v_exp_f32 v32, v32
    v_exp_f32 v33, v33
    v_smfmac_f32_32x32x32_bf16 v[80:95], v[108:111], v[56:63], v124
    ds_read_b128 v[104:107], v126 offset:26368
    v_exp_f32 v34, v34
    v_exp_f32 v35, v35
    v_exp_f32 v36, v36
    v_mfma_f32_32x32x16_bf16 v[48:63], v[100:103], v[28:31], 0
    ds_read_b128 v[108:111], v126 offset:26912
    v_exp_f32 v37, v37
    v_exp_f32 v38, v38
    v_exp_f32 v39, v39
    v_exp_f32 v40, v40
    v_exp_f32 v41, v41
    v_smfmac_f32_32x32x32_bf16 v[64:79], v[112:115], v[32:39], v124
    global_load_lds_dwordx4 v2, s[66:67] offset:3072
    buffer_load_dwordx4 a[200:203], v234, s[4:7], s64 offen offset:2048
    v_exp_f32 v42, v42
    v_exp_f32 v43, v43
    v_exp_f32 v44, v44
    v_exp_f32 v45, v45
    v_exp_f32 v46, v46
    v_exp_f32 v47, v47
    v_exp_f32 v48, v48
    v_exp_f32 v49, v49
    v_smfmac_f32_32x32x32_bf16 v[64:79], v[116:119], v[40:47], v124
    s_waitcnt lgkmcnt(0)
    v_exp_f32 v50, v50
    v_exp_f32 v51, v51
    v_exp_f32 v52, v52
    v_mfma_f32_32x32x16_bf16 v[32:47], v[96:99], v[24:27], 0
    buffer_load_dwordx4 a[204:207], v234, s[4:7], s64 offen offset:3072
    v_exp_f32 v53, v53
    v_exp_f32 v54, v54
    v_exp_f32 v55, v55
    v_exp_f32 v56, v56
    v_exp_f32 v57, v57
    v_smfmac_f32_32x32x32_bf16 v[80:95], v[112:115], v[48:55], v124
    ds_read_b128 v[100:103], v125 offset:27456
    v_exp_f32 v58, v58
    v_exp_f32 v59, v59
    v_exp_f32 v60, v60
    v_exp_f32 v61, v61
    v_exp_f32 v62, v62
    v_exp_f32 v63, v63
    v_exp_f32 v32, v32
    v_exp_f32 v33, v33
    v_smfmac_f32_32x32x32_bf16 v[80:95], v[116:119], v[56:63], v124
    ds_read_b128 v[112:115], v126 offset:28480
    v_exp_f32 v34, v34
    v_exp_f32 v35, v35
    v_exp_f32 v36, v36
    v_mfma_f32_32x32x16_bf16 v[48:63], v[96:99], v[28:31], 0
    ds_read_b128 v[116:119], v126 offset:29024
    v_exp_f32 v37, v37
    v_exp_f32 v38, v38
    v_exp_f32 v39, v39
    v_exp_f32 v40, v40
    v_exp_f32 v41, v41
    v_smfmac_f32_32x32x32_bf16 v[64:79], v[104:107], v[32:39], v124
    s_add_u32 s64, s54, 20480
    buffer_load_dwordx4 a[208:211], v234, s[4:7], s64 offen offset:0
    buffer_load_dwordx4 a[212:215], v234, s[4:7], s64 offen offset:1024
    v_exp_f32 v42, v42
    v_exp_f32 v43, v43
    v_exp_f32 v44, v44
    v_exp_f32 v45, v45
    v_exp_f32 v46, v46
    v_exp_f32 v47, v47
    v_exp_f32 v48, v48
    v_exp_f32 v49, v49
    v_smfmac_f32_32x32x32_bf16 v[64:79], v[108:111], v[40:47], v124
    s_waitcnt lgkmcnt(0)
    v_exp_f32 v50, v50
    v_exp_f32 v51, v51
    v_exp_f32 v52, v52
    v_mfma_f32_32x32x16_bf16 v[32:47], v[100:103], v[24:27], 0
    buffer_load_dwordx4 a[216:219], v234, s[4:7], s64 offen offset:2048
    buffer_load_dwordx4 a[220:223], v234, s[4:7], s64 offen offset:3072
    v_exp_f32 v53, v53
    v_exp_f32 v54, v54
    v_exp_f32 v55, v55
    v_exp_f32 v56, v56
    v_exp_f32 v57, v57
    v_smfmac_f32_32x32x32_bf16 v[80:95], v[104:107], v[48:55], v124
    ds_read_b128 v[96:99], v125 offset:29568
    v_exp_f32 v58, v58
    v_exp_f32 v59, v59
    v_exp_f32 v60, v60
    v_exp_f32 v61, v61
    v_exp_f32 v62, v62
    v_exp_f32 v63, v63
    v_exp_f32 v32, v32
    v_exp_f32 v33, v33
    v_smfmac_f32_32x32x32_bf16 v[80:95], v[108:111], v[56:63], v124
    ds_read_b128 v[104:107], v126 offset:30592
    v_exp_f32 v34, v34
    v_exp_f32 v35, v35
    v_exp_f32 v36, v36
    v_mfma_f32_32x32x16_bf16 v[48:63], v[100:103], v[28:31], 0
    ds_read_b128 v[108:111], v126 offset:31136
    v_exp_f32 v37, v37
    v_exp_f32 v38, v38
    v_exp_f32 v39, v39
    v_exp_f32 v40, v40
    v_exp_f32 v41, v41
    v_smfmac_f32_32x32x32_bf16 v[64:79], v[112:115], v[32:39], v124
    s_add_u32 s64, s54, 24576
    buffer_load_dwordx4 a[224:227], v234, s[4:7], s64 offen offset:0
    v_exp_f32 v42, v42
    v_exp_f32 v43, v43
    v_exp_f32 v44, v44
    v_exp_f32 v45, v45
    v_exp_f32 v46, v46
    v_exp_f32 v47, v47
    v_exp_f32 v48, v48
    v_exp_f32 v49, v49
    v_smfmac_f32_32x32x32_bf16 v[64:79], v[116:119], v[40:47], v124
    s_waitcnt lgkmcnt(0)
    v_exp_f32 v50, v50
    v_exp_f32 v51, v51
    v_exp_f32 v52, v52
    v_mfma_f32_32x32x16_bf16 v[32:47], v[96:99], v[24:27], 0
    buffer_load_dwordx4 a[228:231], v234, s[4:7], s64 offen offset:1024
    buffer_load_dwordx4 a[232:235], v234, s[4:7], s64 offen offset:2048
    v_exp_f32 v53, v53
    v_exp_f32 v54, v54
    v_exp_f32 v55, v55
    v_exp_f32 v56, v56
    v_exp_f32 v57, v57
    v_smfmac_f32_32x32x32_bf16 v[80:95], v[112:115], v[48:55], v124
    ds_read_b128 v[100:103], v125 offset:31680
    v_exp_f32 v58, v58
    v_exp_f32 v59, v59
    v_exp_f32 v60, v60
    v_exp_f32 v61, v61
    v_exp_f32 v62, v62
    v_exp_f32 v63, v63
    v_exp_f32 v32, v32
    v_exp_f32 v33, v33
    v_smfmac_f32_32x32x32_bf16 v[80:95], v[116:119], v[56:63], v124
    ds_read_b128 v[112:115], v126 offset:32704
    v_exp_f32 v34, v34
    v_exp_f32 v35, v35
    v_exp_f32 v36, v36
    v_mfma_f32_32x32x16_bf16 v[48:63], v[96:99], v[28:31], 0
    ds_read_b128 v[116:119], v126 offset:33248
    v_exp_f32 v37, v37
    v_exp_f32 v38, v38
    v_exp_f32 v39, v39
    v_exp_f32 v40, v40
    v_exp_f32 v41, v41
    v_smfmac_f32_32x32x32_bf16 v[64:79], v[104:107], v[32:39], v124
    buffer_load_dwordx4 a[236:239], v234, s[4:7], s64 offen offset:3072
    s_add_u32 s64, s54, 28672
    buffer_load_dwordx4 a[240:243], v234, s[4:7], s64 offen offset:0
    v_exp_f32 v42, v42
    v_exp_f32 v43, v43
    v_exp_f32 v44, v44
    v_exp_f32 v45, v45
    v_exp_f32 v46, v46
    v_exp_f32 v47, v47
    v_exp_f32 v48, v48
    v_exp_f32 v49, v49
    v_smfmac_f32_32x32x32_bf16 v[64:79], v[108:111], v[40:47], v124
    s_waitcnt lgkmcnt(0)
    v_exp_f32 v50, v50
    v_exp_f32 v51, v51
    v_exp_f32 v52, v52
    v_mfma_f32_32x32x16_bf16 v[32:47], v[100:103], v[24:27], 0
    buffer_load_dwordx4 a[244:247], v234, s[4:7], s64 offen offset:1024
    v_exp_f32 v53, v53
    v_exp_f32 v54, v54
    v_exp_f32 v55, v55
    v_exp_f32 v56, v56
    v_exp_f32 v57, v57
    v_smfmac_f32_32x32x32_bf16 v[80:95], v[104:107], v[48:55], v124
    ds_read_b128 v[96:99], v125 offset:33792
    v_exp_f32 v58, v58
    v_exp_f32 v59, v59
    v_exp_f32 v60, v60
    v_exp_f32 v61, v61
    v_exp_f32 v62, v62
    v_exp_f32 v63, v63
    v_exp_f32 v32, v32
    v_exp_f32 v33, v33
    v_smfmac_f32_32x32x32_bf16 v[80:95], v[108:111], v[56:63], v124
    ds_read_b128 v[104:107], v126 offset:34816
    v_exp_f32 v34, v34
    v_exp_f32 v35, v35
    v_exp_f32 v36, v36
    v_mfma_f32_32x32x16_bf16 v[48:63], v[100:103], v[28:31], 0
    ds_read_b128 v[108:111], v126 offset:35360
    v_exp_f32 v37, v37
    v_exp_f32 v38, v38
    v_exp_f32 v39, v39
    v_exp_f32 v40, v40
    v_exp_f32 v41, v41
    v_smfmac_f32_32x32x32_bf16 v[64:79], v[112:115], v[32:39], v124
    buffer_load_dwordx4 a[248:251], v234, s[4:7], s64 offen offset:2048
    buffer_load_dwordx4 a[252:255], v234, s[4:7], s64 offen offset:3072
    v_exp_f32 v42, v42
    v_exp_f32 v43, v43
    v_exp_f32 v44, v44
    v_exp_f32 v45, v45
    v_exp_f32 v46, v46
    v_exp_f32 v47, v47
    v_exp_f32 v48, v48
    v_exp_f32 v49, v49
    v_smfmac_f32_32x32x32_bf16 v[64:79], v[116:119], v[40:47], v124
    s_waitcnt lgkmcnt(0)
    v_exp_f32 v50, v50
    v_exp_f32 v51, v51
    v_exp_f32 v52, v52
    v_mfma_f32_32x32x16_bf16 v[32:47], v[96:99], v[24:27], 0
    s_add_u32 s64, s48, 4096
    s_addc_u32 s65, s49, 0
    global_load_dwordx4 v[128:131], v2, s[64:65] offset:-4096
    global_load_dwordx4 v[136:139], v2, s[64:65] offset:-3072
    v_exp_f32 v53, v53
    v_exp_f32 v54, v54
    v_exp_f32 v55, v55
    v_exp_f32 v56, v56
    v_exp_f32 v57, v57
    v_smfmac_f32_32x32x32_bf16 v[80:95], v[112:115], v[48:55], v124
    ds_read_b128 v[100:103], v125 offset:35904
    v_exp_f32 v58, v58
    v_exp_f32 v59, v59
    v_exp_f32 v60, v60
    v_exp_f32 v61, v61
    v_exp_f32 v62, v62
    v_exp_f32 v63, v63
    v_exp_f32 v32, v32
    v_exp_f32 v33, v33
    v_smfmac_f32_32x32x32_bf16 v[80:95], v[116:119], v[56:63], v124
    ds_read_b128 v[112:115], v126 offset:36928
    v_exp_f32 v34, v34
    v_exp_f32 v35, v35
    v_exp_f32 v36, v36
    v_mfma_f32_32x32x16_bf16 v[48:63], v[96:99], v[28:31], 0
    ds_read_b128 v[116:119], v126 offset:37472
    v_exp_f32 v37, v37
    v_exp_f32 v38, v38
    v_exp_f32 v39, v39
    v_exp_f32 v40, v40
    v_exp_f32 v41, v41
    v_smfmac_f32_32x32x32_bf16 v[64:79], v[104:107], v[32:39], v124
    global_load_dwordx4 v[144:147], v2, s[64:65] offset:-2048
    s_waitcnt vmcnt(45)
    s_cmp_eq_u32 s12, 0
    s_cbranch_scc1 Lslow_223
    buffer_store_byte v5, off, s[4:7], s21 offset:2176
Lback_224:
    v_exp_f32 v42, v42
    v_exp_f32 v43, v43
    v_exp_f32 v44, v44
    v_exp_f32 v45, v45
    v_exp_f32 v46, v46
    v_exp_f32 v47, v47
    v_exp_f32 v48, v48
    v_exp_f32 v49, v49
    v_smfmac_f32_32x32x32_bf16 v[64:79], v[108:111], v[40:47], v124
    s_waitcnt lgkmcnt(0)
    v_exp_f32 v50, v50
    v_exp_f32 v51, v51
    v_exp_f32 v52, v52
    v_mfma_f32_32x32x16_bf16 v[32:47], v[100:103], v[24:27], 0
    global_load_dwordx4 v[152:155], v2, s[64:65] offset:-1024
    global_load_dwordx4 v[160:163], v2, s[64:65] offset:0
    v_exp_f32 v53, v53
    v_exp_f32 v54, v54
    v_exp_f32 v55, v55
    v_exp_f32 v56, v56
    v_exp_f32 v57, v57
    v_smfmac_f32_32x32x32_bf16 v[80:95], v[104:107], v[48:55], v124
    ds_read_b128 v[96:99], v125 offset:38016
    v_exp_f32 v58, v58
    v_exp_f32 v59, v59
    v_exp_f32 v60, v60
    v_exp_f32 v61, v61
    v_exp_f32 v62, v62
    v_exp_f32 v63, v63
    v_exp_f32 v32, v32
    v_exp_f32 v33, v33
    v_smfmac_f32_32x32x32_bf16 v[80:95], v[108:111], v[56:63], v124
    ds_read_b128 v[104:107], v126 offset:39040
    v_exp_f32 v34, v34
    v_exp_f32 v35, v35
    v_exp_f32 v36, v36
    v_mfma_f32_32x32x16_bf16 v[48:63], v[100:103], v[28:31], 0
    ds_read_b128 v[108:111], v126 offset:39584
    v_exp_f32 v37, v37
    v_exp_f32 v38, v38
    v_exp_f32 v39, v39
    v_exp_f32 v40, v40
    v_exp_f32 v41, v41
    v_smfmac_f32_32x32x32_bf16 v[64:79], v[112:115], v[32:39], v124
    global_load_dwordx4 v[168:171], v2, s[64:65] offset:1024
    v_exp_f32 v42, v42
    v_exp_f32 v43, v43
    v_exp_f32 v44, v44
    v_exp_f32 v45, v45
    v_exp_f32 v46, v46
    v_exp_f32 v47, v47
    v_exp_f32 v48, v48
    v_exp_f32 v49, v49
    v_smfmac_f32_32x32x32_bf16 v[64:79], v[116:119], v[40:47], v124
    s_waitcnt lgkmcnt(0)
    v_exp_f32 v50, v50
    v_exp_f32 v51, v51
    v_exp_f32 v52, v52
    v_mfma_f32_32x32x16_bf16 v[32:47], v[96:99], v[24:27], 0
    global_load_dwordx4 v[176:179], v2, s[64:65] offset:2048
    global_load_dwordx4 v[184:187], v2, s[64:65] offset:3072
    v_exp_f32 v53, v53
    v_exp_f32 v54, v54
    v_exp_f32 v55, v55
    v_exp_f32 v56, v56
    v_exp_f32 v57, v57
    v_smfmac_f32_32x32x32_bf16 v[80:95], v[112:115], v[48:55], v124
    ds_read_b128 v[100:103], v125 offset:40128
    v_exp_f32 v58, v58
    v_exp_f32 v59, v59
    v_exp_f32 v60, v60
    v_exp_f32 v61, v61
    v_exp_f32 v62, v62
    v_exp_f32 v63, v63
    v_exp_f32 v32, v32
    v_exp_f32 v33, v33
    v_smfmac_f32_32x32x32_bf16 v[80:95], v[116:119], v[56:63], v124
    ds_read_b128 v[112:115], v126 offset:41152
    v_exp_f32 v34, v34
    v_exp_f32 v35, v35
    v_exp_f32 v36, v36
    v_mfma_f32_32x32x16_bf16 v[48:63], v[96:99], v[28:31], 0
    ds_read_b128 v[116:119], v126 offset:41696
    v_exp_f32 v37, v37
    v_exp_f32 v38, v38
    v_exp_f32 v39, v39
    v_exp_f32 v40, v40
    v_exp_f32 v41, v41
    v_smfmac_f32_32x32x32_bf16 v[64:79], v[104:107], v[32:39], v124
    s_add_u32 s64, s48, 12288
    s_addc_u32 s65, s49, 0
    global_load_dwordx4 v[192:195], v2, s[64:65] offset:-4096
    global_load_dwordx4 v[200:203], v2, s[64:65] offset:-3072
    v_exp_f32 v42, v42
    v_exp_f32 v43, v43
    v_exp_f32 v44, v44
    v_exp_f32 v45, v45
    v_exp_f32 v46, v46
    v_exp_f32 v47, v47
    v_exp_f32 v48, v48
    v_exp_f32 v49, v49
    v_smfmac_f32_32x32x32_bf16 v[64:79], v[108:111], v[40:47], v124
    s_waitcnt lgkmcnt(0)
    v_exp_f32 v50, v50
    v_exp_f32 v51, v51
    v_exp_f32 v52, v52
    v_mfma_f32_32x32x16_bf16 v[32:47], v[100:103], v[24:27], 0
    global_load_dwordx4 v[208:211], v2, s[64:65] offset:-2048
    v_exp_f32 v53, v53
    v_exp_f32 v54, v54
    v_exp_f32 v55, v55
    v_exp_f32 v56, v56
    v_exp_f32 v57, v57
    v_smfmac_f32_32x32x32_bf16 v[80:95], v[104:107], v[48:55], v124
    ds_read_b128 v[96:99], v125 offset:42240
    v_exp_f32 v58, v58
    v_exp_f32 v59, v59
    v_exp_f32 v60, v60
    v_exp_f32 v61, v61
    v_exp_f32 v62, v62
    v_exp_f32 v63, v63
    v_exp_f32 v32, v32
    v_exp_f32 v33, v33
    v_smfmac_f32_32x32x32_bf16 v[80:95], v[108:111], v[56:63], v124
    ds_read_b128 v[104:107], v126 offset:43264
    v_exp_f32 v34, v34
    v_exp_f32 v35, v35
    v_exp_f32 v36, v36
    v_mfma_f32_32x32x16_bf16 v[48:63], v[100:103], v[28:31], 0
    ds_read_b128 v[108:111], v126 offset:43808
    v_exp_f32 v37, v37
    v_exp_f32 v38, v38
    v_exp_f32 v39, v39
    v_exp_f32 v40, v40
    v_exp_f32 v41, v41
    v_smfmac_f32_32x32x32_bf16 v[64:79], v[112:115], v[32:39], v124
    global_load_dwordx4 v[216:219], v2, s[64:65] offset:-1024
    s_add_u32 s64, s50, 4096
    s_addc_u32 s65, s51, 0
    global_load_dwordx4 v[132:135], v2, s[64:65] offset:-4096
    v_exp_f32 v42, v42
    v_exp_f32 v43, v43
    v_exp_f32 v44, v44
    v_exp_f32 v45, v45
    v_exp_f32 v46, v46
    v_exp_f32 v47, v47
    v_exp_f32 v48, v48
    v_exp_f32 v49, v49
    v_smfmac_f32_32x32x32_bf16 v[64:79], v[116:119], v[40:47], v124
    s_waitcnt lgkmcnt(0)
    v_exp_f32 v50, v50
    v_exp_f32 v51, v51
    v_exp_f32 v52, v52
    v_mfma_f32_32x32x16_bf16 v[32:47], v[96:99], v[24:27], 0
    global_load_dwordx4 v[140:143], v2, s[64:65] offset:-3072
    global_load_dwordx4 v[148:151], v2, s[64:65] offset:-2048
    v_exp_f32 v53, v53
    v_exp_f32 v54, v54
    v_exp_f32 v55, v55
    v_exp_f32 v56, v56
    v_exp_f32 v57, v57
    v_smfmac_f32_32x32x32_bf16 v[80:95], v[112:115], v[48:55], v124
    ds_read_b128 v[100:103], v125 offset:44352
    v_exp_f32 v58, v58
    v_exp_f32 v59, v59
    v_exp_f32 v60, v60
    v_exp_f32 v61, v61
    v_exp_f32 v62, v62
    v_exp_f32 v63, v63
    v_exp_f32 v32, v32
    v_exp_f32 v33, v33
    v_smfmac_f32_32x32x32_bf16 v[80:95], v[116:119], v[56:63], v124
    ds_read_b128 v[112:115], v126 offset:45376
    v_exp_f32 v34, v34
    v_exp_f32 v35, v35
    v_exp_f32 v36, v36
    v_mfma_f32_32x32x16_bf16 v[48:63], v[96:99], v[28:31], 0
    ds_read_b128 v[116:119], v126 offset:45920
    v_exp_f32 v37, v37
    v_exp_f32 v38, v38
    v_exp_f32 v39, v39
    v_exp_f32 v40, v40
    v_exp_f32 v41, v41
    v_smfmac_f32_32x32x32_bf16 v[64:79], v[104:107], v[32:39], v124
    global_load_dwordx4 v[156:159], v2, s[64:65] offset:-1024
    v_exp_f32 v42, v42
    v_exp_f32 v43, v43
    v_exp_f32 v44, v44
    v_exp_f32 v45, v45
    v_exp_f32 v46, v46
    v_exp_f32 v47, v47
    v_exp_f32 v48, v48
    v_exp_f32 v49, v49
    v_smfmac_f32_32x32x32_bf16 v[64:79], v[108:111], v[40:47], v124
    s_waitcnt lgkmcnt(0)
    v_exp_f32 v50, v50
    v_exp_f32 v51, v51
    v_exp_f32 v52, v52
    v_mfma_f32_32x32x16_bf16 v[32:47], v[100:103], v[24:27], 0
    global_load_dwordx4 v[164:167], v2, s[64:65] offset:0
    global_load_dwordx4 v[172:175], v2, s[64:65] offset:1024
    v_exp_f32 v53, v53
    v_exp_f32 v54, v54
    v_exp_f32 v55, v55
    v_exp_f32 v56, v56
    v_exp_f32 v57, v57
    v_smfmac_f32_32x32x32_bf16 v[80:95], v[104:107], v[48:55], v124
    ds_read_b128 v[96:99], v125 offset:46464
    v_exp_f32 v58, v58
    v_exp_f32 v59, v59
    v_exp_f32 v60, v60
    v_exp_f32 v61, v61
    v_exp_f32 v62, v62
    v_exp_f32 v63, v63
    v_exp_f32 v32, v32
    v_exp_f32 v33, v33
    v_smfmac_f32_32x32x32_bf16 v[80:95], v[108:111], v[56:63], v124
    ds_read_b128 v[104:107], v126 offset:47488
    v_exp_f32 v34, v34
    v_exp_f32 v35, v35
    v_exp_f32 v36, v36
    v_mfma_f32_32x32x16_bf16 v[48:63], v[100:103], v[28:31], 0
    ds_read_b128 v[108:111], v126 offset:48032
    v_exp_f32 v37, v37
    v_exp_f32 v38, v38
    v_exp_f32 v39, v39
    v_exp_f32 v40, v40
    v_exp_f32 v41, v41
    v_smfmac_f32_32x32x32_bf16 v[64:79], v[112:115], v[32:39], v124
    global_load_dwordx4 v[180:183], v2, s[64:65] offset:2048
    global_load_dwordx4 v[188:191], v2, s[64:65] offset:3072
    v_exp_f32 v42, v42
    v_exp_f32 v43, v43
    v_exp_f32 v44, v44
    v_exp_f32 v45, v45
    v_exp_f32 v46, v46
    v_exp_f32 v47, v47
    v_exp_f32 v48, v48
    v_exp_f32 v49, v49
    v_smfmac_f32_32x32x32_bf16 v[64:79], v[116:119], v[40:47], v124
    s_waitcnt lgkmcnt(0)
    v_exp_f32 v50, v50
    v_exp_f32 v51, v51
    v_exp_f32 v52, v52
    v_mfma_f32_32x32x16_bf16 v[32:47], v[96:99], v[24:27], 0
    s_add_u32 s64, s50, 12288
    s_addc_u32 s65, s51, 0
    global_load_dwordx4 v[196:199], v2, s[64:65] offset:-4096
    v_exp_f32 v53, v53
    v_exp_f32 v54, v54
    v_exp_f32 v55, v55
    v_exp_f32 v56, v56
    v_exp_f32 v57, v57
    v_smfmac_f32_32x32x32_bf16 v[80:95], v[112:115], v[48:55], v124
    ds_read_b128 v[100:103], v125 offset:48576
    v_exp_f32 v58, v58
    v_exp_f32 v59, v59
    v_exp_f32 v60, v60
    v_exp_f32 v61, v61
    v_exp_f32 v62, v62
    v_exp_f32 v63, v63
    v_exp_f32 v32, v32
    v_exp_f32 v33, v33
    v_smfmac_f32_32x32x32_bf16 v[80:95], v[116:119], v[56:63], v124
    ds_read_b128 v[112:115], v126 offset:49600
    v_exp_f32 v34, v34
    v_exp_f32 v35, v35
    v_exp_f32 v36, v36
    v_mfma_f32_32x32x16_bf16 v[48:63], v[96:99], v[28:31], 0
    ds_read_b128 v[116:119], v126 offset:50144
    v_exp_f32 v37, v37
    v_exp_f32 v38, v38
    v_exp_f32 v39, v39
    v_exp_f32 v40, v40
    v_exp_f32 v41, v41
    v_smfmac_f32_32x32x32_bf16 v[64:79], v[104:107], v[32:39], v124
    global_load_dwordx4 v[204:207], v2, s[64:65] offset:-3072
    global_load_dwordx4 v[212:215], v2, s[64:65] offset:-2048
    v_exp_f32 v42, v42
    v_exp_f32 v43, v43
    v_exp_f32 v44, v44
    v_exp_f32 v45, v45
    v_exp_f32 v46, v46
    v_exp_f32 v47, v47
    v_exp_f32 v48, v48
    v_exp_f32 v49, v49
    v_smfmac_f32_32x32x32_bf16 v[64:79], v[108:111], v[40:47], v124
    s_waitcnt lgkmcnt(0)
    v_exp_f32 v50, v50
    v_exp_f32 v51, v51
    v_exp_f32 v52, v52
    v_mfma_f32_32x32x16_bf16 v[32:47], v[100:103], v[24:27], 0
    global_load_dwordx4 v[220:223], v2, s[64:65] offset:-1024
    v_exp_f32 v53, v53
    v_exp_f32 v54, v54
    v_exp_f32 v55, v55
    v_exp_f32 v56, v56
    v_exp_f32 v57, v57
    v_smfmac_f32_32x32x32_bf16 v[80:95], v[104:107], v[48:55], v124
    ds_read_b128 v[96:99], v125 offset:50688
    v_exp_f32 v58, v58
    v_exp_f32 v59, v59
    v_exp_f32 v60, v60
    v_exp_f32 v61, v61
    v_exp_f32 v62, v62
    v_exp_f32 v63, v63
    v_exp_f32 v32, v32
    v_exp_f32 v33, v33
    v_smfmac_f32_32x32x32_bf16 v[80:95], v[108:111], v[56:63], v124
    ds_read_b128 v[104:107], v126 offset:51712
    v_exp_f32 v34, v34
    v_exp_f32 v35, v35
    v_exp_f32 v36, v36
    v_mfma_f32_32x32x16_bf16 v[48:63], v[100:103], v[28:31], 0
    ds_read_b128 v[108:111], v126 offset:52256
    v_exp_f32 v37, v37
    v_exp_f32 v38, v38
    v_exp_f32 v39, v39
    v_exp_f32 v40, v40
    v_exp_f32 v41, v41
    v_smfmac_f32_32x32x32_bf16 v[64:79], v[112:115], v[32:39], v124
    buffer_load_dwordx2 v[14:15], off, s[4:7], s22 offset:2176 sc1
    v_exp_f32 v42, v42
    v_exp_f32 v43, v43
    v_exp_f32 v44, v44
    v_exp_f32 v45, v45
    v_exp_f32 v46, v46
    v_exp_f32 v47, v47
    v_exp_f32 v48, v48
    v_exp_f32 v49, v49
    v_smfmac_f32_32x32x32_bf16 v[64:79], v[116:119], v[40:47], v124
    s_waitcnt lgkmcnt(0)
    v_exp_f32 v50, v50
    v_exp_f32 v51, v51
    v_exp_f32 v52, v52
    v_mfma_f32_32x32x16_bf16 v[32:47], v[96:99], v[24:27], 0
    s_lshl_b32 s61, s17, 16
    s_lshl_b32 s62, s18, 7
    s_add_u32 s61, s61, s62
    buffer_load_dword v230, v233, s[8:11], s61 offen
    v_exp_f32 v53, v53
    v_exp_f32 v54, v54
    v_exp_f32 v55, v55
    v_exp_f32 v56, v56
    v_exp_f32 v57, v57
    v_smfmac_f32_32x32x32_bf16 v[80:95], v[112:115], v[48:55], v124
    ds_read_b128 v[100:103], v125 offset:52800
    v_exp_f32 v58, v58
    v_exp_f32 v59, v59
    v_exp_f32 v60, v60
    v_exp_f32 v61, v61
    v_exp_f32 v62, v62
    v_exp_f32 v63, v63
    v_exp_f32 v32, v32
    v_exp_f32 v33, v33
    v_smfmac_f32_32x32x32_bf16 v[80:95], v[116:119], v[56:63], v124
    ds_read_b128 v[112:115], v126 offset:53824
    v_exp_f32 v34, v34
    v_exp_f32 v35, v35
    v_exp_f32 v36, v36
    v_mfma_f32_32x32x16_bf16 v[48:63], v[96:99], v[28:31], 0
    ds_read_b128 v[116:119], v126 offset:54368
    v_exp_f32 v37, v37
    v_exp_f32 v38, v38
    v_exp_f32 v39, v39
    v_exp_f32 v40, v40
    v_exp_f32 v41, v41
    v_smfmac_f32_32x32x32_bf16 v[64:79], v[104:107], v[32:39], v124
    s_getpc_b64 s[68:69]
Lpc_222:
    s_lshr_b32 s61, s2, 3
    s_lshl_b32 s61, s61, 2
    s_add_u32 s61, s61, s16
    s_lshl_b32 s61, s61, 8
    s_add_u32 s61, s61, 2048
    s_min_u32 s61, s61, Lend_1-Lpc_222-256
    s_add_u32 s68, s68, s61
    s_addc_u32 s69, s69, 0
    global_load_dword v230, v3, s[68:69]
    v_exp_f32 v42, v42
    v_exp_f32 v43, v43
    v_exp_f32 v44, v44
    v_exp_f32 v45, v45
    v_exp_f32 v46, v46
    v_exp_f32 v47, v47
    v_exp_f32 v48, v48
    v_exp_f32 v49, v49
    v_smfmac_f32_32x32x32_bf16 v[64:79], v[108:111], v[40:47], v124
    s_waitcnt lgkmcnt(0)
    v_exp_f32 v50, v50
    v_exp_f32 v51, v51
    v_exp_f32 v52, v52
    v_mfma_f32_32x32x16_bf16 v[32:47], v[100:103], v[24:27], 0
    v_exp_f32 v53, v53
    v_exp_f32 v54, v54
    v_exp_f32 v55, v55
    v_exp_f32 v56, v56
    v_exp_f32 v57, v57
    v_smfmac_f32_32x32x32_bf16 v[80:95], v[104:107], v[48:55], v124
    ds_read_b128 v[96:99], v125 offset:54912
    v_exp_f32 v58, v58
    v_exp_f32 v59, v59
    v_exp_f32 v60, v60
    v_exp_f32 v61, v61
    v_exp_f32 v62, v62
    v_exp_f32 v63, v63
    v_exp_f32 v32, v32
    v_exp_f32 v33, v33
    v_smfmac_f32_32x32x32_bf16 v[80:95], v[108:111], v[56:63], v124
    ds_read_b128 v[104:107], v126 offset:55936
    v_exp_f32 v34, v34
    v_exp_f32 v35, v35
    v_exp_f32 v36, v36
    v_mfma_f32_32x32x16_bf16 v[48:63], v[100:103], v[28:31], 0
    ds_read_b128 v[108:111], v126 offset:56480
    v_exp_f32 v37, v37
    v_exp_f32 v38, v38
    v_exp_f32 v39, v39
    v_exp_f32 v40, v40
    v_exp_f32 v41, v41
    v_smfmac_f32_32x32x32_bf16 v[64:79], v[112:115], v[32:39], v124
    v_exp_f32 v42, v42
    v_exp_f32 v43, v43
    v_exp_f32 v44, v44
    v_exp_f32 v45, v45
    v_exp_f32 v46, v46
    v_exp_f32 v47, v47
    v_exp_f32 v48, v48
    v_exp_f32 v49, v49
    v_smfmac_f32_32x32x32_bf16 v[64:79], v[116:119], v[40:47], v124
    s_waitcnt lgkmcnt(0)
    v_exp_f32 v50, v50
    v_exp_f32 v51, v51
    v_exp_f32 v52, v52
    v_mfma_f32_32x32x16_bf16 v[32:47], v[96:99], v[24:27], 0
    v_exp_f32 v53, v53
    v_exp_f32 v54, v54
    v_exp_f32 v55, v55
    v_exp_f32 v56, v56
    v_exp_f32 v57, v57
    v_smfmac_f32_32x32x32_bf16 v[80:95], v[112:115], v[48:55], v124
    ds_read_b128 v[100:103], v125 offset:57024
    v_exp_f32 v58, v58
    v_exp_f32 v59, v59
    v_exp_f32 v60, v60
    v_exp_f32 v61, v61
    v_exp_f32 v62, v62
    v_exp_f32 v63, v63
    v_exp_f32 v32, v32
    v_exp_f32 v33, v33
    v_smfmac_f32_32x32x32_bf16 v[80:95], v[116:119], v[56:63], v124
    ds_read_b128 v[112:115], v126 offset:58048
    v_exp_f32 v34, v34
    v_exp_f32 v35, v35
    v_exp_f32 v36, v36
    v_mfma_f32_32x32x16_bf16 v[48:63], v[96:99], v[28:31], 0
    ds_read_b128 v[116:119], v126 offset:58592
    v_exp_f32 v37, v37
    v_exp_f32 v38, v38
    v_exp_f32 v39, v39
    v_exp_f32 v40, v40
    v_exp_f32 v41, v41
    v_smfmac_f32_32x32x32_bf16 v[64:79], v[104:107], v[32:39], v124
    v_exp_f32 v42, v42
    v_exp_f32 v43, v43
    v_exp_f32 v44, v44
    v_exp_f32 v45, v45
    v_exp_f32 v46, v46
    v_exp_f32 v47, v47
    v_exp_f32 v48, v48
    v_exp_f32 v49, v49
    v_smfmac_f32_32x32x32_bf16 v[64:79], v[108:111], v[40:47], v124
    s_waitcnt lgkmcnt(0)
    v_exp_f32 v50, v50
    v_exp_f32 v51, v51
    v_exp_f32 v52, v52
    v_mfma_f32_32x32x16_bf16 v[32:47], v[100:103], v[24:27], 0
    v_exp_f32 v53, v53
    v_exp_f32 v54, v54
    v_exp_f32 v55, v55
    v_exp_f32 v56, v56
    v_exp_f32 v57, v57
    v_smfmac_f32_32x32x32_bf16 v[80:95], v[104:107], v[48:55], v124
    ds_read_b128 v[96:99], v125 offset:59136
    v_exp_f32 v58, v58
    v_exp_f32 v59, v59
    v_exp_f32 v60, v60
    v_exp_f32 v61, v61
    v_exp_f32 v62, v62
    v_exp_f32 v63, v63
    v_exp_f32 v32, v32
    v_exp_f32 v33, v33
    v_smfmac_f32_32x32x32_bf16 v[80:95], v[108:111], v[56:63], v124
    ds_read_b128 v[104:107], v126 offset:60160
    v_exp_f32 v34, v34
    v_exp_f32 v35, v35
    v_exp_f32 v36, v36
    v_mfma_f32_32x32x16_bf16 v[48:63], v[100:103], v[28:31], 0
    ds_read_b128 v[108:111], v126 offset:60704
    v_exp_f32 v37, v37
    v_exp_f32 v38, v38
    v_exp_f32 v39, v39
    v_exp_f32 v40, v40
    v_exp_f32 v41, v41
    v_smfmac_f32_32x32x32_bf16 v[64:79], v[112:115], v[32:39], v124
    v_exp_f32 v42, v42
    v_exp_f32 v43, v43
    v_exp_f32 v44, v44
    v_exp_f32 v45, v45
    v_exp_f32 v46, v46
    v_exp_f32 v47, v47
    v_exp_f32 v48, v48
    v_exp_f32 v49, v49
    v_smfmac_f32_32x32x32_bf16 v[64:79], v[116:119], v[40:47], v124
    s_waitcnt lgkmcnt(0)
    v_exp_f32 v50, v50
    v_exp_f32 v51, v51
    v_exp_f32 v52, v52
    v_mfma_f32_32x32x16_bf16 v[32:47], v[96:99], v[24:27], 0
    v_exp_f32 v53, v53
    v_exp_f32 v54, v54
    v_exp_f32 v55, v55
    v_exp_f32 v56, v56
    v_exp_f32 v57, v57
    v_smfmac_f32_32x32x32_bf16 v[80:95], v[112:115], v[48:55], v124
    ds_read_b128 v[100:103], v125 offset:61248
    v_exp_f32 v58, v58
    v_exp_f32 v59, v59
    v_exp_f32 v60, v60
    v_exp_f32 v61, v61
    v_exp_f32 v62, v62
    v_exp_f32 v63, v63
    v_exp_f32 v32, v32
    v_exp_f32 v33, v33
    v_smfmac_f32_32x32x32_bf16 v[80:95], v[116:119], v[56:63], v124
    ds_read_b128 v[112:115], v126 offset:62272
    v_exp_f32 v34, v34
    v_exp_f32 v35, v35
    v_exp_f32 v36, v36
    v_mfma_f32_32x32x16_bf16 v[48:63], v[96:99], v[28:31], 0
    ds_read_b128 v[116:119], v126 offset:62816
    v_exp_f32 v37, v37
    v_exp_f32 v38, v38
    v_exp_f32 v39, v39
    v_exp_f32 v40, v40
    v_exp_f32 v41, v41
    v_smfmac_f32_32x32x32_bf16 v[64:79], v[104:107], v[32:39], v124
    s_waitcnt vmcnt(2)
    v_and_b32 v14, v14, v15
    s_nop 0
    v_readfirstlane_b32 s60, v14
    s_nop 0
    s_cmp_eq_u32 s60, 0x01010101
    s_cbranch_scc0 Lretry_225
Lback_226:
    v_exp_f32 v42, v42
    v_exp_f32 v43, v43
    v_exp_f32 v44, v44
    v_exp_f32 v45, v45
    v_exp_f32 v46, v46
    v_exp_f32 v47, v47
    v_exp_f32 v48, v48
    v_exp_f32 v49, v49
    v_smfmac_f32_32x32x32_bf16 v[64:79], v[108:111], v[40:47], v124
    s_waitcnt lgkmcnt(0)
    v_exp_f32 v50, v50
    v_exp_f32 v51, v51
    v_exp_f32 v52, v52
    v_mfma_f32_32x32x16_bf16 v[32:47], v[100:103], v[24:27], 0
    v_exp_f32 v53, v53
    v_exp_f32 v54, v54
    v_exp_f32 v55, v55
    v_exp_f32 v56, v56
    v_exp_f32 v57, v57
    v_smfmac_f32_32x32x32_bf16 v[80:95], v[104:107], v[48:55], v124
    ds_read_b128 v[96:99], v125 offset:63360
    v_exp_f32 v58, v58
    v_exp_f32 v59, v59
    v_exp_f32 v60, v60
    v_exp_f32 v61, v61
    v_exp_f32 v62, v62
    v_exp_f32 v63, v63
    v_exp_f32 v32, v32
    v_exp_f32 v33, v33
    v_smfmac_f32_32x32x32_bf16 v[80:95], v[108:111], v[56:63], v124
    ds_read_b128 v[104:107], v126 offset:64384
    v_exp_f32 v34, v34
    v_exp_f32 v35, v35
    v_exp_f32 v36, v36
    v_mfma_f32_32x32x16_bf16 v[48:63], v[100:103], v[28:31], 0
    ds_read_b128 v[108:111], v126 offset:64928
    v_exp_f32 v37, v37
    v_exp_f32 v38, v38
    v_exp_f32 v39, v39
    v_exp_f32 v40, v40
    v_exp_f32 v41, v41
    v_smfmac_f32_32x32x32_bf16 v[64:79], v[112:115], v[32:39], v124
    v_exp_f32 v42, v42
    v_exp_f32 v43, v43
    v_exp_f32 v44, v44
    v_exp_f32 v45, v45
    v_exp_f32 v46, v46
    v_exp_f32 v47, v47
    v_exp_f32 v48, v48
    v_exp_f32 v49, v49
    v_smfmac_f32_32x32x32_bf16 v[64:79], v[116:119], v[40:47], v124
    s_waitcnt lgkmcnt(0)
    v_exp_f32 v50, v50
    v_exp_f32 v51, v51
    v_exp_f32 v52, v52
    v_mfma_f32_32x32x16_bf16 v[32:47], v[96:99], v[24:27], 0
    v_exp_f32 v53, v53
    v_exp_f32 v54, v54
    v_exp_f32 v55, v55
    v_exp_f32 v56, v56
    v_exp_f32 v57, v57
    v_smfmac_f32_32x32x32_bf16 v[80:95], v[112:115], v[48:55], v124
    ds_read_b128 v[100:103], v125 offset:65472
    v_exp_f32 v58, v58
    v_exp_f32 v59, v59
    v_exp_f32 v60, v60
    v_exp_f32 v61, v61
    v_exp_f32 v62, v62
    v_exp_f32 v63, v63
    v_exp_f32 v32, v32
    v_exp_f32 v33, v33
    v_smfmac_f32_32x32x32_bf16 v[80:95], v[116:119], v[56:63], v124
    v_add_u32 v126, 0xffc0, v126
    ds_read_b128 v[112:115], v126 offset:1024
    v_exp_f32 v34, v34
    v_exp_f32 v35, v35
    v_exp_f32 v36, v36
    v_mfma_f32_32x32x16_bf16 v[48:63], v[96:99], v[28:31], 0
    ds_read_b128 v[116:119], v126 offset:1568
    v_exp_f32 v37, v37
    v_exp_f32 v38, v38
    v_exp_f32 v39, v39
    v_exp_f32 v40, v40
    v_exp_f32 v41, v41
    v_smfmac_f32_32x32x32_bf16 v[64:79], v[104:107], v[32:39], v124
    v_exp_f32 v42, v42
    v_exp_f32 v43, v43
    v_exp_f32 v44, v44
    v_exp_f32 v45, v45
    v_exp_f32 v46, v46
    v_exp_f32 v47, v47
    v_exp_f32 v48, v48
    v_exp_f32 v49, v49
    v_smfmac_f32_32x32x32_bf16 v[64:79], v[108:111], v[40:47], v124
    s_waitcnt lgkmcnt(0)
    v_exp_f32 v50, v50
    v_exp_f32 v51, v51
    v_exp_f32 v52, v52
    v_mfma_f32_32x32x16_bf16 v[32:47], v[100:103], v[24:27], 0
    v_exp_f32 v53, v53
    v_exp_f32 v54, v54
    v_exp_f32 v55, v55
    v_exp_f32 v56, v56
    v_exp_f32 v57, v57
    v_smfmac_f32_32x32x32_bf16 v[80:95], v[104:107], v[48:55], v124
    ds_read_b128 v[96:99], v125 offset:0
    v_exp_f32 v58, v58
    v_exp_f32 v59, v59
    v_exp_f32 v60, v60
    v_exp_f32 v61, v61
    v_exp_f32 v62, v62
    v_exp_f32 v63, v63
    v_exp_f32 v32, v32
    v_exp_f32 v33, v33
    v_smfmac_f32_32x32x32_bf16 v[80:95], v[108:111], v[56:63], v124
    v_add_u32 v126, 0xffff0040, v126
    ds_read_b128 v[104:107], v126 offset:1024
    v_exp_f32 v34, v34
    v_exp_f32 v35, v35
    v_exp_f32 v36, v36
    v_mfma_f32_32x32x16_bf16 v[48:63], v[100:103], v[28:31], 0
    ds_read_b128 v[108:111], v126 offset:1568
    v_exp_f32 v37, v37
    v_exp_f32 v38, v38
    v_exp_f32 v39, v39
    v_exp_f32 v40, v40
    v_exp_f32 v41, v41
    v_smfmac_f32_32x32x32_bf16 v[64:79], v[112:115], v[32:39], v124
    v_exp_f32 v42, v42
    v_exp_f32 v43, v43
    v_exp_f32 v44, v44
    v_exp_f32 v45, v45
    v_exp_f32 v46, v46
    v_exp_f32 v47, v47
    v_exp_f32 v48, v48
    v_exp_f32 v49, v49
    v_smfmac_f32_32x32x32_bf16 v[64:79], v[116:119], v[40:47], v124
    s_waitcnt lgkmcnt(0)
    v_exp_f32 v50, v50
    v_exp_f32 v51, v51
    v_exp_f32 v52, v52
    v_mfma_f32_32x32x16_bf16 v[32:47], v[96:99], v[28:31], 0
    v_exp_f32 v53, v53
    v_exp_f32 v54, v54
    v_exp_f32 v55, v55
    v_exp_f32 v56, v56
    v_exp_f32 v57, v57
    v_smfmac_f32_32x32x32_bf16 v[80:95], v[112:115], v[48:55], v124
    ds_read_b128 v[100:103], v125 offset:2112
    v_rcp_f32 v74, v72
    v_subrev_u32 v73, 0x21800000, v72
    v_mul_f32 v64, v74, v64
    v_mul_f32 v65, v74, v65
    v_mul_f32 v66, v74, v66
    v_mul_f32 v67, v74, v67
    v_mul_f32 v68, v74, v68
    v_mul_f32 v69, v74, v69
    v_mul_f32 v70, v74, v70
    v_mul_f32 v71, v74, v71
    v_cmp_lt_u32 vcc, 0x50000000, v73
    v_add_f32 v76, v64, v68
    v_add_f32 v77, v65, v69
    v_add_f32 v78, v66, v70
    v_add_f32 v79, v67, v71
    v_add_f32 v76, v76, v77
    v_add_f32 v78, v78, v79
    s_mov_b32 s61, 0x207
    v_add_f32 v76, v76, v78
    v_cmp_class_f32 s[68:69], v76, s61
    s_add_u32 s61, s20, 0
    s_or_b64 vcc, vcc, s[68:69]
    s_cbranch_vccnz Lfb_227
Lfbback_228:
    v_cvt_pk_bf16_f32 v76, v64, v65
    v_cvt_pk_bf16_f32 v77, v66, v67
    v_cvt_pk_bf16_f32 v78, v68, v69
    v_cvt_pk_bf16_f32 v79, v70, v71
    s_cmp_eq_u32 s12, 0
    s_cbranch_scc1 Lslow_231
    buffer_store_dwordx4 v[76:79], v1, s[4:7], s61 offen
Lback_232:
    v_exp_f32 v58, v58
    v_exp_f32 v59, v59
    v_exp_f32 v60, v60
    v_exp_f32 v61, v61
    v_exp_f32 v62, v62
    v_exp_f32 v63, v63
    v_exp_f32 v32, v32
    v_exp_f32 v33, v33
    v_smfmac_f32_32x32x32_bf16 v[80:95], v[116:119], v[56:63], v124
    s_waitcnt lgkmcnt(0)
    ds_read_b128 v[112:115], v126 offset:3136
    v_exp_f32 v34, v34
    v_exp_f32 v35, v35
    v_exp_f32 v36, v36
    v_mfma_f32_32x32x16_bf16 v[48:63], v[100:103], v[28:31], 0
    ds_read_b128 v[116:119], v126 offset:3680
    v_exp_f32 v37, v37
    v_exp_f32 v38, v38
    v_exp_f32 v39, v39
    v_exp_f32 v40, v40
    v_exp_f32 v41, v41
    v_smfmac_f32_32x32x32_bf16 v[80:95], v[104:107], v[32:39], v124
    ds_read_b128 v[96:99], v125 offset:4224
    v_exp_f32 v42, v42
    v_exp_f32 v43, v43
    v_exp_f32 v44, v44
    v_exp_f32 v45, v45
    v_exp_f32 v46, v46
    v_exp_f32 v47, v47
    v_exp_f32 v48, v48
    v_exp_f32 v49, v49
    v_smfmac_f32_32x32x32_bf16 v[80:95], v[108:111], v[40:47], v124
    s_waitcnt lgkmcnt(0)
    ds_read_b128 v[104:107], v126 offset:5248
    v_exp_f32 v50, v50
    v_exp_f32 v51, v51
    v_exp_f32 v52, v52
    v_mfma_f32_32x32x16_bf16 v[32:47], v[96:99], v[28:31], 0
    ds_read_b128 v[108:111], v126 offset:5792
    v_exp_f32 v53, v53
    v_exp_f32 v54, v54
    v_exp_f32 v55, v55
    v_exp_f32 v56, v56
    v_exp_f32 v57, v57
    v_smfmac_f32_32x32x32_bf16 v[80:95], v[112:115], v[48:55], v124
    ds_read_b128 v[100:103], v125 offset:6336
    v_exp_f32 v58, v58
    v_exp_f32 v59, v59
    v_exp_f32 v60, v60
    v_exp_f32 v61, v61
    v_exp_f32 v62, v62
    v_exp_f32 v63, v63
    v_exp_f32 v32, v32
    v_exp_f32 v33, v33
    v_smfmac_f32_32x32x32_bf16 v[80:95], v[116:119], v[56:63], v124
    s_waitcnt lgkmcnt(0)
    ds_read_b128 v[112:115], v126 offset:7360
    v_exp_f32 v34, v34
    v_exp_f32 v35, v35
    v_exp_f32 v36, v36
    v_mfma_f32_32x32x16_bf16 v[48:63], v[100:103], v[28:31], 0
    ds_read_b128 v[116:119], v126 offset:7904
    v_exp_f32 v37, v37
    v_exp_f32 v38, v38
    v_exp_f32 v39, v39
    v_exp_f32 v40, v40
    v_exp_f32 v41, v41
    v_smfmac_f32_32x32x32_bf16 v[80:95], v[104:107], v[32:39], v124
    ds_read_b128 v[96:99], v125 offset:8448
    v_exp_f32 v42, v42
    v_exp_f32 v43, v43
    v_exp_f32 v44, v44
    v_exp_f32 v45, v45
    v_exp_f32 v46, v46
    v_exp_f32 v47, v47
    v_exp_f32 v48, v48
    v_exp_f32 v49, v49
    v_smfmac_f32_32x32x32_bf16 v[80:95], v[108:111], v[40:47], v124
    s_waitcnt lgkmcnt(0)
    ds_read_b128 v[104:107], v126 offset:9472
    v_exp_f32 v50, v50
    v_exp_f32 v51, v51
    v_exp_f32 v52, v52
    v_mfma_f32_32x32x16_bf16 v[32:47], v[96:99], v[28:31], 0
    ds_read_b128 v[108:111], v126 offset:10016
    v_exp_f32 v53, v53
    v_exp_f32 v54, v54
    v_exp_f32 v55, v55
    v_exp_f32 v56, v56
    v_exp_f32 v57, v57
    v_smfmac_f32_32x32x32_bf16 v[80:95], v[112:115], v[48:55], v124
    ds_read_b128 v[100:103], v125 offset:10560
    s_waitcnt vmcnt(0)
    s_cmp_eq_u32 s12, 0
    s_cbranch_scc1 Lslow_235
    buffer_store_byte v5, off, s[4:7], s21 offset:1024
Lback_236:
    v_exp_f32 v58, v58
    v_exp_f32 v59, v59
    v_exp_f32 v60, v60
    v_exp_f32 v61, v61
    v_exp_f32 v62, v62
    v_exp_f32 v63, v63
    v_exp_f32 v32, v32
    v_exp_f32 v33, v33
    v_smfmac_f32_32x32x32_bf16 v[80:95], v[116:119], v[56:63], v124
    s_waitcnt lgkmcnt(0)
    ds_read_b128 v[112:115], v126 offset:11584
    v_exp_f32 v34, v34
    v_exp_f32 v35, v35
    v_exp_f32 v36, v36
    v_mfma_f32_32x32x16_bf16 v[48:63], v[100:103], v[28:31], 0
    ds_read_b128 v[116:119], v126 offset:12128
    v_exp_f32 v37, v37
    v_exp_f32 v38, v38
    v_exp_f32 v39, v39
    v_exp_f32 v40, v40
    v_exp_f32 v41, v41
    v_smfmac_f32_32x32x32_bf16 v[80:95], v[104:107], v[32:39], v124
    s_cmp_eq_u32 s12, 0
    s_cbranch_scc1 Lgate_237
Lback_238:
    s_add_u32 s64, s38, 4096
    s_addc_u32 s65, s39, 0
    global_load_dwordx4 v[224:227], v1, s[64:65] offset:-4096 sc1
    global_load_dwordx4 v[228:231], v1, s[64:65] offset:-3072 sc1
    v_exp_f32 v42, v42
    v_exp_f32 v43, v43
    v_exp_f32 v44, v44
    v_exp_f32 v45, v45
    v_exp_f32 v46, v46
    v_exp_f32 v47, v47
    v_exp_f32 v48, v48
    v_exp_f32 v49, v49
    v_smfmac_f32_32x32x32_bf16 v[80:95], v[108:111], v[40:47], v124
    global_load_dwordx4 v[232:235], v1, s[64:65] offset:-2048 sc1
    global_load_dwordx4 v[236:239], v1, s[64:65] offset:-1024 sc1
    v_exp_f32 v50, v50
    v_exp_f32 v51, v51
    v_exp_f32 v52, v52
    global_load_dwordx4 v[240:243], v1, s[64:65] offset:0 sc1
    global_load_dwordx4 v[244:247], v1, s[64:65] offset:1024 sc1
    v_exp_f32 v53, v53
    v_exp_f32 v54, v54
    v_exp_f32 v55, v55
    v_exp_f32 v56, v56
    v_exp_f32 v57, v57
    s_waitcnt lgkmcnt(1)
    v_smfmac_f32_32x32x32_bf16 v[80:95], v[112:115], v[48:55], v124
    global_load_dwordx4 v[248:251], v1, s[64:65] offset:2048 sc1
    global_load_dwordx4 v[252:255], v1, s[64:65] offset:3072 sc1
    v_exp_f32 v58, v58
    v_exp_f32 v59, v59
    v_exp_f32 v60, v60
    v_exp_f32 v61, v61
    v_exp_f32 v62, v62
    v_exp_f32 v63, v63
    s_add_u32 s61, s30, 67584
    v_add_u32 v6, s61, v1
    s_waitcnt lgkmcnt(0)
    v_smfmac_f32_32x32x32_bf16 v[80:95], v[116:119], v[56:63], v124
    ds_read_b128 v[96:99], v6 offset:8192
    ds_read_b128 v[100:103], v6 offset:9216
    ds_read_b128 v[104:107], v6 offset:10240
    ds_read_b128 v[108:111], v6 offset:11264
    ds_read_b128 v[112:115], v6 offset:12288
    ds_read_b128 v[116:119], v6 offset:13312
    s_nop 5
    v_rcp_f32 v90, v88
    v_subrev_u32 v89, 0x21800000, v88
    v_mul_f32 v80, v90, v80
    v_mul_f32 v81, v90, v81
    v_mul_f32 v82, v90, v82
    v_mul_f32 v83, v90, v83
    v_mul_f32 v84, v90, v84
    v_mul_f32 v85, v90, v85
    v_mul_f32 v86, v90, v86
    v_mul_f32 v87, v90, v87
    v_cmp_lt_u32 vcc, 0x50000000, v89
    v_add_f32 v92, v80, v84
    v_add_f32 v93, v81, v85
    v_add_f32 v94, v82, v86
    v_add_f32 v95, v83, v87
    v_add_f32 v92, v92, v93
    v_add_f32 v94, v94, v95
    s_mov_b32 s61, 0x207
    v_add_f32 v92, v92, v94
    v_cmp_class_f32 s[68:69], v92, s61
    s_add_u32 s61, s20, 32768
    s_or_b64 vcc, vcc, s[68:69]
    s_cbranch_vccnz Lfb_242
Lfbback_243:
    v_cvt_pk_bf16_f32 v92, v80, v81
    v_cvt_pk_bf16_f32 v93, v82, v83
    v_cvt_pk_bf16_f32 v94, v84, v85
    v_cvt_pk_bf16_f32 v95, v86, v87
    s_cmp_eq_u32 s12, 0
    s_cbranch_scc1 Lslow_246
    buffer_store_dwordx4 v[92:95], v1, s[4:7], s61 offen
Lback_247:
Lopst_250:
    s_waitcnt vmcnt(8)
    s_waitcnt lgkmcnt(5)
    v_mfma_f32_32x32x16_bf16 v[48:63], v[96:99], v[224:227], 0
    ds_read_b128 v[96:99], v6 offset:14336
    v_lshlrev_b32 v32, 16, v16
    v_and_b32 v33, 0xffff0000, v16
    v_lshlrev_b32 v34, 16, v17
    s_waitcnt vmcnt(7)
    s_waitcnt lgkmcnt(5)
    v_mfma_f32_32x32x16_bf16 v[48:63], v[100:103], v[228:231], v[48:63]
    ds_read_b128 v[100:103], v6 offset:15360
    v_and_b32 v35, 0xffff0000, v17
    v_lshlrev_b32 v36, 16, v18
    v_and_b32 v37, 0xffff0000, v18
    s_waitcnt vmcnt(6)
    s_waitcnt lgkmcnt(5)
    v_mfma_f32_32x32x16_bf16 v[48:63], v[104:107], v[232:235], v[48:63]
    ds_read_b128 v[104:107], v6 offset:0
    v_lshlrev_b32 v38, 16, v19
    v_and_b32 v39, 0xffff0000, v19
    v_mov_b32 v40, 0
    s_waitcnt vmcnt(5)
    s_waitcnt lgkmcnt(5)
    v_mfma_f32_32x32x16_bf16 v[48:63], v[108:111], v[236:239], v[48:63]
    ds_read_b128 v[108:111], v6 offset:1024
    v_mov_b32 v41, 0
    v_mov_b32 v42, 0
    v_mov_b32 v43, 0
    s_waitcnt vmcnt(4)
    s_waitcnt lgkmcnt(5)
    v_mfma_f32_32x32x16_bf16 v[48:63], v[112:115], v[240:243], v[48:63]
    ds_read_b128 v[112:115], v6 offset:2048
    v_mov_b32 v44, 0
    v_mov_b32 v45, 0
    v_mov_b32 v46, 0
    s_waitcnt vmcnt(3)
    s_waitcnt lgkmcnt(5)
    v_mfma_f32_32x32x16_bf16 v[48:63], v[116:119], v[244:247], v[48:63]
    ds_read_b128 v[116:119], v6 offset:3072
    v_mov_b32 v47, 0
    v_add_u32 v124, s26, v1
    v_add_u32 v125, s27, v1
    s_waitcnt vmcnt(2)
    s_waitcnt lgkmcnt(5)
    v_mfma_f32_32x32x16_bf16 v[48:63], v[96:99], v[248:251], v[48:63]
    ds_read_b128 v[96:99], v6 offset:4096
    v_add_u32 v126, s28, v1
    v_add_u32 v127, s29, v1
    s_waitcnt vmcnt(1)
    s_waitcnt lgkmcnt(5)
    v_mfma_f32_32x32x16_bf16 v[48:63], v[100:103], v[252:255], v[48:63]
    ds_read_b128 v[100:103], v6 offset:5120
    s_waitcnt lgkmcnt(5)
    v_mfma_f32_32x32x16_bf16 v[32:47], v[104:107], v[224:227], v[32:47]
    ds_read_b128 v[104:107], v6 offset:6144
    s_waitcnt lgkmcnt(5)
    v_mfma_f32_32x32x16_bf16 v[32:47], v[108:111], v[228:231], v[32:47]
    ds_read_b128 v[108:111], v6 offset:7168
    s_waitcnt lgkmcnt(5)
    v_mfma_f32_32x32x16_bf16 v[32:47], v[112:115], v[232:235], v[32:47]
    s_nop 2
    v_cmp_u_f32 vcc, v48, v48
    s_waitcnt lgkmcnt(4)
    v_mfma_f32_32x32x16_bf16 v[32:47], v[116:119], v[236:239], v[32:47]
    s_nop 2
    s_cbranch_vccnz Lredo_251
Lback_252:
    s_waitcnt lgkmcnt(3)
    v_mfma_f32_32x32x16_bf16 v[32:47], v[96:99], v[240:243], v[32:47]
    ds_write_b128 v124, v[48:51] offset:2048
    s_waitcnt lgkmcnt(3)
    v_mfma_f32_32x32x16_bf16 v[32:47], v[100:103], v[244:247], v[32:47]
    ds_write_b128 v124, v[52:55] offset:3072
    s_waitcnt lgkmcnt(3)
    v_mfma_f32_32x32x16_bf16 v[32:47], v[104:107], v[248:251], v[32:47]
    ds_write_b128 v124, v[56:59] offset:4096
    s_waitcnt lgkmcnt(3)
    v_mfma_f32_32x32x16_bf16 v[32:47], v[108:111], v[252:255], v[32:47]
    ds_write_b128 v124, v[60:63] offset:5120
    s_waitcnt vmcnt(0)
    s_cmp_eq_u32 s12, 0
    s_cbranch_scc1 Lslow_256
    buffer_store_byte v5, off, s[4:7], s21 offset:1152
Lback_257:
    s_cmp_eq_u32 s12, 0
    s_cbranch_scc1 Lgate_258
Lback_259:
    s_add_u32 s64, s38, 36864
    s_addc_u32 s65, s39, 0
    global_load_dwordx4 v[224:227], v1, s[64:65] offset:-4096 sc1
    global_load_dwordx4 v[228:231], v1, s[64:65] offset:-3072 sc1
    global_load_dwordx4 v[232:235], v1, s[64:65] offset:-2048 sc1
    ds_write_b128 v124, v[40:43] offset:0
    ds_write_b128 v124, v[44:47] offset:1024
    s_waitcnt lgkmcnt(0)
    s_barrier
    ds_read_b128 v[104:107], v126 offset:2048
    ds_read_b128 v[108:111], v126 offset:3072
    ds_read_b128 v[112:115], v127 offset:4096
    ds_read_b128 v[116:119], v127 offset:5120
    ds_read_b128 v[96:99], v125 offset:0
    ds_read_b128 v[100:103], v125 offset:1024
    global_load_dwordx4 v[236:239], v1, s[64:65] offset:-1024 sc1
    global_load_dwordx4 v[240:243], v1, s[64:65] offset:0 sc1
    s_waitcnt lgkmcnt(5)
    v_pk_add_f32 v[32:33], v[32:33], v[104:105]
    v_pk_add_f32 v[34:35], v[34:35], v[106:107]
    global_load_dwordx4 v[244:247], v1, s[64:65] offset:1024 sc1
    s_waitcnt lgkmcnt(4)
    v_pk_add_f32 v[36:37], v[36:37], v[108:109]
    v_pk_add_f32 v[38:39], v[38:39], v[110:111]
    s_waitcnt lgkmcnt(3)
    v_pk_add_f32 v[32:33], v[32:33], v[112:113]
    v_pk_add_f32 v[34:35], v[34:35], v[114:115]
    s_waitcnt lgkmcnt(2)
    v_pk_add_f32 v[36:37], v[36:37], v[116:117]
    v_pk_add_f32 v[38:39], v[38:39], v[118:119]
    s_waitcnt lgkmcnt(1)
    v_pk_add_f32 v[32:33], v[32:33], v[96:97]
    v_pk_add_f32 v[34:35], v[34:35], v[98:99]
    global_load_dwordx4 v[248:251], v1, s[64:65] offset:2048 sc1
    s_waitcnt lgkmcnt(0)
    v_pk_add_f32 v[36:37], v[36:37], v[100:101]
    v_pk_add_f32 v[38:39], v[38:39], v[102:103]
    ds_read_b128 v[96:99], v6 offset:8192
    ds_read_b128 v[100:103], v6 offset:9216
    ds_read_b128 v[104:107], v6 offset:10240
    ds_read_b128 v[108:111], v6 offset:11264
    ds_read_b128 v[112:115], v6 offset:12288
    ds_read_b128 v[116:119], v6 offset:13312
    s_add_u32 s61, s20, 65536
    s_add_u32 s62, s23, 425984
    v_cvt_pk_bf16_f32 v16, v32, v33
    v_cvt_pk_bf16_f32 v17, v34, v35
    global_load_dwordx4 v[252:255], v1, s[64:65] offset:3072 sc1
    v_cvt_pk_bf16_f32 v18, v36, v37
    v_cvt_pk_bf16_f32 v19, v38, v39
    v_dot2_f32_bf16 v40, v16, v4, 0
    v_dot2_f32_bf16 v41, v16, v16, 0
    v_dot2_f32_bf16 v40, v17, v4, v40
    v_dot2_f32_bf16 v41, v17, v17, v41
    v_dot2_f32_bf16 v40, v18, v4, v40
    v_dot2_f32_bf16 v41, v18, v18, v41
    v_dot2_f32_bf16 v40, v19, v4, v40
    v_dot2_f32_bf16 v41, v19, v19, v41
    s_nop 2
    v_permlane32_swap_b32 v40, v41
    v_add_f32 v40, v40, v41
    s_cmp_eq_u32 s12, 0
    s_cbranch_scc1 Lslow_263
    buffer_store_dwordx4 v[16:19], v1, s[4:7], s61 offen
    buffer_store_dword v40, v1, s[4:7], s62 offen
Lback_264:
Lopst_265:
    s_waitcnt vmcnt(9)
    s_waitcnt lgkmcnt(5)
    v_mfma_f32_32x32x16_bf16 v[80:95], v[96:99], v[224:227], 0
    ds_read_b128 v[96:99], v6 offset:14336
    v_lshlrev_b32 v64, 16, v20
    v_and_b32 v65, 0xffff0000, v20
    v_lshlrev_b32 v66, 16, v21
    s_waitcnt vmcnt(8)
    s_waitcnt lgkmcnt(5)
    v_mfma_f32_32x32x16_bf16 v[80:95], v[100:103], v[228:231], v[80:95]
    ds_read_b128 v[100:103], v6 offset:15360
    v_and_b32 v67, 0xffff0000, v21
    v_lshlrev_b32 v68, 16, v22
    v_and_b32 v69, 0xffff0000, v22
    s_waitcnt vmcnt(7)
    s_waitcnt lgkmcnt(5)
    v_mfma_f32_32x32x16_bf16 v[80:95], v[104:107], v[232:235], v[80:95]
    ds_read_b128 v[104:107], v6 offset:0
    v_lshlrev_b32 v70, 16, v23
    v_and_b32 v71, 0xffff0000, v23
    v_mov_b32 v72, 0
    s_waitcnt vmcnt(6)
    s_waitcnt lgkmcnt(5)
    v_mfma_f32_32x32x16_bf16 v[80:95], v[108:111], v[236:239], v[80:95]
    ds_read_b128 v[108:111], v6 offset:1024
    v_mov_b32 v73, 0
    v_mov_b32 v74, 0
    v_mov_b32 v75, 0
    s_waitcnt vmcnt(5)
    s_waitcnt lgkmcnt(5)
    v_mfma_f32_32x32x16_bf16 v[80:95], v[112:115], v[240:243], v[80:95]
    ds_read_b128 v[112:115], v6 offset:2048
    v_mov_b32 v76, 0
    v_mov_b32 v77, 0
    v_mov_b32 v78, 0
    s_waitcnt vmcnt(4)
    s_waitcnt lgkmcnt(5)
    v_mfma_f32_32x32x16_bf16 v[80:95], v[116:119], v[244:247], v[80:95]
    ds_read_b128 v[116:119], v6 offset:3072
    v_mov_b32 v79, 0
    s_add_u32 s61, s30, 67584
    v_add_u32 v124, s61, v1
    s_add_u32 s61, s31, 67584
    v_add_u32 v125, s61, v1
    s_waitcnt vmcnt(3)
    s_waitcnt lgkmcnt(5)
    v_mfma_f32_32x32x16_bf16 v[80:95], v[96:99], v[248:251], v[80:95]
    ds_read_b128 v[96:99], v6 offset:4096
    s_add_u32 s61, s32, 67584
    v_add_u32 v126, s61, v1
    s_add_u32 s61, s33, 67584
    v_add_u32 v127, s61, v1
    s_waitcnt vmcnt(2)
    s_waitcnt lgkmcnt(5)
    v_mfma_f32_32x32x16_bf16 v[80:95], v[100:103], v[252:255], v[80:95]
    ds_read_b128 v[100:103], v6 offset:5120
    s_waitcnt lgkmcnt(5)
    v_mfma_f32_32x32x16_bf16 v[64:79], v[104:107], v[224:227], v[64:79]
    ds_read_b128 v[104:107], v6 offset:6144
    s_waitcnt lgkmcnt(5)
    v_mfma_f32_32x32x16_bf16 v[64:79], v[108:111], v[228:231], v[64:79]
    ds_read_b128 v[108:111], v6 offset:7168
    s_waitcnt lgkmcnt(5)
    v_mfma_f32_32x32x16_bf16 v[64:79], v[112:115], v[232:235], v[64:79]
    s_nop 2
    v_cmp_u_f32 vcc, v80, v80
    s_waitcnt lgkmcnt(4)
    v_mfma_f32_32x32x16_bf16 v[64:79], v[116:119], v[236:239], v[64:79]
    s_nop 2
    s_cbranch_vccnz Lredo_266
Lback_267:
    s_waitcnt lgkmcnt(3)
    v_mfma_f32_32x32x16_bf16 v[64:79], v[96:99], v[240:243], v[64:79]
    ds_write_b128 v124, v[80:83] offset:2048
    s_cmp_eq_u32 s12, 0
    s_cbranch_scc1 Lgate_271
Lback_272:
    s_add_u32 s66, s40, 430080
    s_addc_u32 s67, s41, 0
    global_load_dwordx4 v[24:27], v1, s[66:67] offset:-4096 sc1
    s_waitcnt lgkmcnt(3)
    v_mfma_f32_32x32x16_bf16 v[64:79], v[100:103], v[244:247], v[64:79]
    ds_write_b128 v124, v[84:87] offset:3072
    global_load_dwordx4 v[28:31], v1, s[66:67] offset:-3072 sc1
    s_waitcnt lgkmcnt(3)
    v_mfma_f32_32x32x16_bf16 v[64:79], v[104:107], v[248:251], v[64:79]
    ds_write_b128 v124, v[88:91] offset:4096
    s_add_u32 m0, s19, 0
    s_add_u32 s66, s38, 65536
    s_addc_u32 s67, s39, 0
    global_load_lds_dwordx4 v1, s[66:67] offset:0 sc1
    s_waitcnt lgkmcnt(3)
    v_mfma_f32_32x32x16_bf16 v[64:79], v[108:111], v[252:255], v[64:79]
    ds_write_b128 v124, v[92:95] offset:5120
    global_load_lds_dwordx4 v1, s[66:67] offset:1024 sc1
    global_load_lds_dwordx4 v1, s[66:67] offset:2048 sc1
    global_load_lds_dwordx4 v1, s[66:67] offset:3072 sc1
    s_waitcnt vmcnt(6)
    s_cmp_eq_u32 s12, 0
    s_cbranch_scc1 Lslow_276
    buffer_store_byte v5, off, s[4:7], s21 offset:1280
Lback_277:
    s_nop 3
    ds_write_b128 v124, v[72:75] offset:0
    ds_write_b128 v124, v[76:79] offset:1024
    s_waitcnt lgkmcnt(0)
    s_barrier
    ds_read_b128 v[104:107], v126 offset:2048
    ds_read_b128 v[108:111], v126 offset:3072
    ds_read_b128 v[112:115], v127 offset:4096
    ds_read_b128 v[116:119], v127 offset:5120
    ds_read_b128 v[96:99], v125 offset:0
    ds_read_b128 v[100:103], v125 offset:1024
    s_add_u32 m0, s19, 4096
    s_add_u32 s66, s38, 69632
    s_addc_u32 s67, s39, 0
    global_load_lds_dwordx4 v1, s[66:67] offset:0 sc1
    global_load_lds_dwordx4 v1, s[66:67] offset:1024 sc1
    s_waitcnt lgkmcnt(5)
    v_pk_add_f32 v[64:65], v[64:65], v[104:105]
    v_pk_add_f32 v[66:67], v[66:67], v[106:107]
    global_load_lds_dwordx4 v1, s[66:67] offset:2048 sc1
    s_waitcnt lgkmcnt(4)
    v_pk_add_f32 v[68:69], v[68:69], v[108:109]
    v_pk_add_f32 v[70:71], v[70:71], v[110:111]
    global_load_lds_dwordx4 v1, s[66:67] offset:3072 sc1
    s_waitcnt lgkmcnt(3)
    v_pk_add_f32 v[64:65], v[64:65], v[112:113]
    v_pk_add_f32 v[66:67], v[66:67], v[114:115]
    s_waitcnt lgkmcnt(2)
    v_pk_add_f32 v[68:69], v[68:69], v[116:117]
    v_pk_add_f32 v[70:71], v[70:71], v[118:119]
    s_waitcnt lgkmcnt(1)
    v_pk_add_f32 v[64:65], v[64:65], v[96:97]
    v_pk_add_f32 v[66:67], v[66:67], v[98:99]
    s_waitcnt lgkmcnt(0)
    v_pk_add_f32 v[68:69], v[68:69], v[100:101]
    v_pk_add_f32 v[70:71], v[70:71], v[102:103]
    s_add_u32 s61, s20, 98304
    s_add_u32 s62, s23, 434176
    v_cvt_pk_bf16_f32 v20, v64, v65
    v_cvt_pk_bf16_f32 v21, v66, v67
    v_cvt_pk_bf16_f32 v22, v68, v69
    v_cvt_pk_bf16_f32 v23, v70, v71
    v_dot2_f32_bf16 v72, v20, v4, 0
    v_dot2_f32_bf16 v73, v20, v20, 0
    v_dot2_f32_bf16 v72, v21, v4, v72
    v_dot2_f32_bf16 v73, v21, v21, v73
    v_dot2_f32_bf16 v72, v22, v4, v72
    v_dot2_f32_bf16 v73, v22, v22, v73
    v_dot2_f32_bf16 v72, v23, v4, v72
    v_dot2_f32_bf16 v73, v23, v23, v73
    s_nop 2
    v_permlane32_swap_b32 v72, v73
    v_add_f32 v72, v72, v73
    s_cmp_eq_u32 s12, 0
    s_cbranch_scc1 Lslow_278
    buffer_store_dwordx4 v[20:23], v1, s[4:7], s61 offen
    buffer_store_dword v72, v1, s[4:7], s62 offen
Lback_279:
Lf1sy_280:
    s_waitcnt vmcnt(11)
    v_add_f32 v24, v24, v28
    v_add_f32 v25, v25, v29
    v_add_f32 v26, v26, v30
    v_add_f32 v27, v27, v31
    v_add_f32 v24, v24, v26
    v_add_f32 v25, v25, v27
    v_add_f32 v24, v24, v25
    v_cmp_u_f32 vcc, v24, v24
    v_add_u32 v25, s26, v3
    ds_write_b32 v25, v24 offset:6144
    s_waitcnt vmcnt(2)
    s_waitcnt lgkmcnt(0)
    s_nop 0
    s_cbranch_vccnz Lredo_281
Lback_282:
    s_barrier
Lf1st_286:
    ds_read_b128 v[96:99], v1 offset:0
    ds_read_b128 v[100:103], v1 offset:1024
    ds_read_b128 v[104:107], v1 offset:2048
    s_waitcnt lgkmcnt(2)
    v_mfma_f32_32x32x16_bf16 v[32:47], a[0:3], v[96:99], 0
    ds_read_b128 v[108:111], v1 offset:3072
    s_waitcnt lgkmcnt(2)
    v_add_u32 v31, 135168, v3
    ds_read_b32 v28, v31 offset:6144
    ds_read_b32 v29, v31 offset:13312
    ds_read_b32 v30, v31 offset:20480
    ds_read_b32 v31, v31 offset:27648
    v_mfma_f32_32x32x16_bf16 v[32:47], a[4:7], v[100:103], v[32:47]
    ds_read_b128 v[96:99], v1 offset:4096
    s_waitcnt lgkmcnt(6)
    v_mfma_f32_32x32x16_bf16 v[32:47], a[8:11], v[104:107], v[32:47]
    ds_read_b128 v[100:103], v1 offset:5120
    s_waitcnt lgkmcnt(6)
    s_waitcnt lgkmcnt(2)
    v_add_f32 v28, v28, v30
    v_add_f32 v29, v29, v31
    v_add_f32 v28, v28, v29
    v_mov_b32 v29, v28
    v_mfma_f32_32x32x16_bf16 v[32:47], a[12:15], v[108:111], v[32:47]
    ds_read_b128 v[104:107], v1 offset:6144
    s_waitcnt lgkmcnt(2)
    v_permlane32_swap_b32 v28, v29
    v_mul_f32 v30, 0x3b000000, v28
    v_mul_f32 v29, 0x3b000000, v29
    v_fma_f32 v29, -v30, v30, v29
    s_waitcnt vmcnt(0)
    s_cmp_eq_u32 s12, 0
    s_cbranch_scc1 Lslow_292
    buffer_store_byte v5, off, s[4:7], s21 offset:1408
Lback_293:
    v_mfma_f32_32x32x16_bf16 v[32:47], a[16:19], v[96:99], v[32:47]
    ds_read_b128 v[108:111], v1 offset:7168
    s_waitcnt lgkmcnt(2)
    v_max_f32 v29, 0, v29
    v_add_f32 v29, 0x3727c5ac, v29
    v_rsq_f32 v6, v29
    s_add_u32 s64, s48, 16384
    s_addc_u32 s65, s49, 0
    global_load_dwordx4 v[224:227], v2, s[64:65] offset:-4096
    v_mfma_f32_32x32x16_bf16 v[32:47], a[20:23], v[100:103], v[32:47]
    ds_read_b128 v[96:99], v1 offset:8192
    s_waitcnt lgkmcnt(2)
    v_mul_f32 v29, 0xbb000000, v28
    v_cvt_pk_bf16_f32 v10, v29, v29
    v_and_b32 v11, 0xffff0000, v10
    v_sub_f32 v29, v29, v11
    v_cvt_pk_bf16_f32 v11, v29, v29
    v_mfma_f32_32x32x16_bf16 v[32:47], a[24:27], v[104:107], v[32:47]
    ds_read_b128 v[100:103], v1 offset:9216
    s_waitcnt lgkmcnt(2)
    v_mul_f32 v124, 0xbfb8aa3b, v6
    v_mov_b32 v125, v124
    global_load_dwordx4 v[232:235], v2, s[64:65] offset:-3072
    v_mfma_f32_32x32x16_bf16 v[32:47], a[28:31], v[108:111], v[32:47]
    ds_read_b128 v[104:107], v1 offset:10240
    s_waitcnt lgkmcnt(2)
    v_mfma_f32_32x32x16_bf16 v[32:47], a[32:35], v[96:99], v[32:47]
    ds_read_b128 v[108:111], v1 offset:11264
    s_waitcnt lgkmcnt(2)
    global_load_dwordx4 v[240:243], v2, s[64:65] offset:-2048
    v_mfma_f32_32x32x16_bf16 v[32:47], a[36:39], v[100:103], v[32:47]
    ds_read_b128 v[96:99], v1 offset:12288
    s_waitcnt lgkmcnt(2)
    v_mfma_f32_32x32x16_bf16 v[32:47], a[40:43], v[104:107], v[32:47]
    ds_read_b128 v[100:103], v1 offset:13312
    s_waitcnt lgkmcnt(2)
    global_load_dwordx4 v[248:251], v2, s[64:65] offset:-1024
    v_mfma_f32_32x32x16_bf16 v[32:47], a[44:47], v[108:111], v[32:47]
    ds_read_b128 v[104:107], v1 offset:14336
    s_waitcnt lgkmcnt(2)
    v_mfma_f32_32x32x16_bf16 v[32:47], a[48:51], v[96:99], v[32:47]
    ds_read_b128 v[108:111], v1 offset:15360
    s_waitcnt lgkmcnt(2)
    buffer_load_dwordx2 v[14:15], off, s[4:7], s22 offset:1408 sc1
    v_mfma_f32_32x32x16_bf16 v[32:47], a[52:55], v[100:103], v[32:47]
    ds_read_b128 v[96:99], v1 offset:16384
    s_waitcnt lgkmcnt(2)
    s_add_u32 s64, s50, 16384
    s_addc_u32 s65, s51, 0
    global_load_dwordx4 v[228:231], v2, s[64:65] offset:-4096
    v_mfma_f32_32x32x16_bf16 v[32:47], a[56:59], v[104:107], v[32:47]
    ds_read_b128 v[100:103], v1 offset:17408
    s_waitcnt lgkmcnt(2)
    v_mfma_f32_32x32x16_bf16 v[32:47], a[60:63], v[108:111], v[32:47]
    ds_read_b128 v[104:107], v1 offset:18432
    s_waitcnt lgkmcnt(2)
    global_load_dwordx4 v[236:239], v2, s[64:65] offset:-3072
    v_mfma_f32_32x32x16_bf16 v[32:47], a[64:67], v[96:99], v[32:47]
    ds_read_b128 v[108:111], v1 offset:19456
    s_waitcnt lgkmcnt(2)
    v_mfma_f32_32x32x16_bf16 v[32:47], a[68:71], v[100:103], v[32:47]
    ds_read_b128 v[96:99], v1 offset:20480
    s_waitcnt lgkmcnt(2)
    global_load_dwordx4 v[244:247], v2, s[64:65] offset:-2048
    v_mfma_f32_32x32x16_bf16 v[32:47], a[72:75], v[104:107], v[32:47]
    ds_read_b128 v[100:103], v1 offset:21504
    s_waitcnt lgkmcnt(2)
    v_mfma_f32_32x32x16_bf16 v[32:47], a[76:79], v[108:111], v[32:47]
    ds_read_b128 v[104:107], v1 offset:22528
    s_waitcnt lgkmcnt(2)
    global_load_dwordx4 v[252:255], v2, s[64:65] offset:-1024
    v_mfma_f32_32x32x16_bf16 v[32:47], a[80:83], v[96:99], v[32:47]
    ds_read_b128 v[108:111], v1 offset:23552
    s_waitcnt lgkmcnt(2)
    v_mfma_f32_32x32x16_bf16 v[32:47], a[84:87], v[100:103], v[32:47]
    ds_read_b128 v[96:99], v1 offset:24576
    s_waitcnt lgkmcnt(2)
    v_mfma_f32_32x32x16_bf16 v[32:47], a[88:91], v[104:107], v[32:47]
    ds_read_b128 v[100:103], v1 offset:25600
    s_waitcnt lgkmcnt(2)
    v_mfma_f32_32x32x16_bf16 v[32:47], a[92:95], v[108:111], v[32:47]
    ds_read_b128 v[104:107], v1 offset:26624
    s_waitcnt lgkmcnt(2)
    s_waitcnt vmcnt(4)
    v_and_b32 v14, v14, v15
    s_nop 0
    v_readfirstlane_b32 s60, v14
    s_nop 0
    s_cmp_eq_u32 s60, 0x01010101
    s_cbranch_scc0 Lretry_294
Lback_295:
    v_mfma_f32_32x32x16_bf16 v[32:47], a[96:99], v[96:99], v[32:47]
    ds_read_b128 v[108:111], v1 offset:27648
    s_waitcnt lgkmcnt(2)
    s_add_u32 s66, s40, 438272
    s_addc_u32 s67, s41, 0
    global_load_dwordx4 v[24:27], v1, s[66:67] offset:-4096 sc1
    v_mfma_f32_32x32x16_bf16 v[32:47], a[100:103], v[100:103], v[32:47]
    ds_read_b128 v[96:99], v1 offset:28672
    s_waitcnt lgkmcnt(2)
    global_load_dwordx4 v[28:31], v1, s[66:67] offset:-3072 sc1
    v_mfma_f32_32x32x16_bf16 v[32:47], a[104:107], v[104:107], v[32:47]
    ds_read_b128 v[100:103], v1 offset:29696
    s_waitcnt lgkmcnt(2)
    v_mfma_f32_32x32x16_bf16 v[32:47], a[108:111], v[108:111], v[32:47]
    ds_read_b128 v[104:107], v1 offset:30720
    s_waitcnt lgkmcnt(2)
    s_add_u32 m0, s19, 32768
    s_add_u32 s66, s38, 98304
    s_addc_u32 s67, s39, 0
    global_load_lds_dwordx4 v1, s[66:67] offset:0 sc1
    v_mfma_f32_32x32x16_bf16 v[32:47], a[112:115], v[96:99], v[32:47]
    ds_read_b128 v[108:111], v1 offset:31744
    s_waitcnt lgkmcnt(2)
    v_mfma_f32_32x32x16_bf16 v[32:47], a[116:119], v[100:103], v[32:47]
    ds_read_b128 v[96:99], v1 offset:0
    s_waitcnt lgkmcnt(2)
    global_load_lds_dwordx4 v1, s[66:67] offset:1024 sc1
    v_mfma_f32_32x32x16_bf16 v[32:47], a[120:123], v[104:107], v[32:47]
    ds_read_b128 v[100:103], v1 offset:1024
    s_waitcnt lgkmcnt(2)
    v_mfma_f32_32x32x16_bf16 v[32:47], a[124:127], v[108:111], v[32:47]
    ds_read_b128 v[104:107], v1 offset:2048
    s_waitcnt lgkmcnt(2)
    v_mfma_f32_32x32x16_bf16 v[32:47], v[120:123], v[10:13], v[32:47]
    global_load_lds_dwordx4 v1, s[66:67] offset:2048 sc1
    v_mfma_f32_32x32x16_bf16 v[48:63], a[128:131], v[96:99], 0
    ds_read_b128 v[108:111], v1 offset:3072
    s_waitcnt lgkmcnt(2)
    v_mfma_f32_32x32x16_bf16 v[48:63], a[132:135], v[100:103], v[48:63]
    ds_read_b128 v[96:99], v1 offset:4096
    s_waitcnt lgkmcnt(2)
    global_load_lds_dwordx4 v1, s[66:67] offset:3072 sc1
    v_mfma_f32_32x32x16_bf16 v[48:63], a[136:139], v[104:107], v[48:63]
    ds_read_b128 v[100:103], v1 offset:5120
    s_waitcnt lgkmcnt(2)
    s_nop 0
    v_cmp_u_f32 vcc, v32, v32
    s_add_u32 m0, s19, 36864
    s_add_u32 s66, s38, 102400
    s_addc_u32 s67, s39, 0
    global_load_lds_dwordx4 v1, s[66:67] offset:0 sc1
    v_mfma_f32_32x32x16_bf16 v[48:63], a[140:143], v[108:111], v[48:63]
    ds_read_b128 v[104:107], v1 offset:6144
    s_waitcnt lgkmcnt(2)
    s_cbranch_vccnz Lredo_287
Lback_288:
    v_mfma_f32_32x32x16_bf16 v[48:63], a[144:147], v[96:99], v[48:63]
    ds_read_b128 v[108:111], v1 offset:7168
    s_waitcnt lgkmcnt(2)
    global_load_lds_dwordx4 v1, s[66:67] offset:1024 sc1
    v_mul_f32 v112, v124, v32
    v_mul_f32 v113, v124, v33
    v_mul_f32 v114, v124, v34
    v_mul_f32 v115, v124, v35
    v_mul_f32 v116, v124, v36
    v_mul_f32 v117, v124, v37
    v_exp_f32 v112, v112
    v_exp_f32 v113, v113
    v_mfma_f32_32x32x16_bf16 v[48:63], a[148:151], v[100:103], v[48:63]
    ds_read_b128 v[96:99], v1 offset:8192
    s_waitcnt lgkmcnt(2)
    v_mul_f32 v118, v124, v38
    v_exp_f32 v114, v114
    v_exp_f32 v115, v115
    v_mfma_f32_32x32x16_bf16 v[48:63], a[152:155], v[104:107], v[48:63]
    ds_read_b128 v[100:103], v1 offset:9216
    s_waitcnt lgkmcnt(2)
    global_load_lds_dwordx4 v1, s[66:67] offset:2048 sc1
    v_mul_f32 v119, v124, v39
    v_exp_f32 v116, v116
    v_exp_f32 v117, v117
    v_mfma_f32_32x32x16_bf16 v[48:63], a[156:159], v[108:111], v[48:63]
    ds_read_b128 v[104:107], v1 offset:10240
    s_waitcnt lgkmcnt(2)
    v_add_f32 v112, 1.0, v112
    v_exp_f32 v118, v118
    v_exp_f32 v119, v119
    v_mfma_f32_32x32x16_bf16 v[48:63], a[160:163], v[96:99], v[48:63]
    ds_read_b128 v[108:111], v1 offset:11264
    s_waitcnt lgkmcnt(2)
    global_load_lds_dwordx4 v1, s[66:67] offset:3072 sc1
    v_add_f32 v113, 1.0, v113
    v_add_f32 v114, 1.0, v114
    v_add_f32 v115, 1.0, v115
    v_rcp_f32 v112, v112
    v_mfma_f32_32x32x16_bf16 v[48:63], a[164:167], v[100:103], v[48:63]
    ds_read_b128 v[96:99], v1 offset:12288
    s_waitcnt lgkmcnt(2)
    v_add_f32 v116, 1.0, v116
    v_rcp_f32 v113, v113
    v_rcp_f32 v114, v114
    v_mfma_f32_32x32x16_bf16 v[48:63], a[168:171], v[104:107], v[48:63]
    ds_read_b128 v[100:103], v1 offset:13312
    s_waitcnt lgkmcnt(2)
    v_add_f32 v117, 1.0, v117
    v_rcp_f32 v115, v115
    v_rcp_f32 v116, v116
    v_mfma_f32_32x32x16_bf16 v[48:63], a[172:175], v[108:111], v[48:63]
    ds_read_b128 v[104:107], v1 offset:14336
    s_waitcnt lgkmcnt(2)
    v_add_f32 v118, 1.0, v118
    v_add_f32 v119, 1.0, v119
    v_mul_f32 v112, v32, v112
    v_rcp_f32 v117, v117
    v_mfma_f32_32x32x16_bf16 v[48:63], a[176:179], v[96:99], v[48:63]
    ds_read_b128 v[108:111], v1 offset:15360
    s_waitcnt lgkmcnt(2)
    v_mul_f32 v113, v33, v113
    v_rcp_f32 v118, v118
    v_rcp_f32 v119, v119
    v_mfma_f32_32x32x16_bf16 v[48:63], a[180:183], v[100:103], v[48:63]
    ds_read_b128 v[96:99], v1 offset:16384
    s_waitcnt lgkmcnt(2)
    v_mul_f32 v114, v34, v114
    v_mul_f32 v115, v35, v115
    v_mul_f32 v116, v36, v116
    v_mul_f32 v117, v37, v117
    v_mul_f32 v118, v38, v118
    v_mfma_f32_32x32x16_bf16 v[48:63], a[184:187], v[104:107], v[48:63]
    ds_read_b128 v[100:103], v1 offset:17408
    s_waitcnt lgkmcnt(2)
    v_mul_f32 v119, v39, v119
    v_cvt_pk_bf16_f32 v32, v112, v113
    v_cvt_pk_bf16_f32 v33, v114, v115
    v_cvt_pk_bf16_f32 v34, v116, v117
    v_cvt_pk_bf16_f32 v35, v118, v119
    v_mfma_f32_32x32x16_bf16 v[48:63], a[188:191], v[108:111], v[48:63]
    ds_read_b128 v[104:107], v1 offset:18432
    s_waitcnt lgkmcnt(2)
    s_add_u32 s61, s24, 0
    s_cmp_eq_u32 s12, 0
    s_cbranch_scc1 Lslow_296
    buffer_store_dwordx4 v[32:35], v1, s[4:7], s61 offen
Lback_297:
    v_mfma_f32_32x32x16_bf16 v[48:63], a[192:195], v[96:99], v[48:63]
    ds_read_b128 v[108:111], v1 offset:19456
    s_waitcnt lgkmcnt(2)
    v_mul_f32 v112, v124, v40
    v_mul_f32 v113, v124, v41
    v_mul_f32 v114, v124, v42
    v_mul_f32 v115, v124, v43
    v_mul_f32 v116, v124, v44
    v_mul_f32 v117, v124, v45
    v_exp_f32 v112, v112
    v_exp_f32 v113, v113
    v_mfma_f32_32x32x16_bf16 v[48:63], a[196:199], v[100:103], v[48:63]
    ds_read_b128 v[96:99], v1 offset:20480
    s_waitcnt lgkmcnt(2)
    v_mul_f32 v118, v124, v46
    v_exp_f32 v114, v114
    v_exp_f32 v115, v115
    v_mfma_f32_32x32x16_bf16 v[48:63], a[200:203], v[104:107], v[48:63]
    ds_read_b128 v[100:103], v1 offset:21504
    s_waitcnt lgkmcnt(2)
    v_mul_f32 v119, v124, v47
    v_exp_f32 v116, v116
    v_exp_f32 v117, v117
    v_mfma_f32_32x32x16_bf16 v[48:63], a[204:207], v[108:111], v[48:63]
    ds_read_b128 v[104:107], v1 offset:22528
    s_waitcnt lgkmcnt(2)
    v_add_f32 v112, 1.0, v112
    v_exp_f32 v118, v118
    v_exp_f32 v119, v119
    v_mfma_f32_32x32x16_bf16 v[48:63], a[208:211], v[96:99], v[48:63]
    ds_read_b128 v[108:111], v1 offset:23552
    s_waitcnt lgkmcnt(2)
    v_add_f32 v113, 1.0, v113
    v_add_f32 v114, 1.0, v114
    v_add_f32 v115, 1.0, v115
    v_rcp_f32 v112, v112
    v_mfma_f32_32x32x16_bf16 v[48:63], a[212:215], v[100:103], v[48:63]
    ds_read_b128 v[96:99], v1 offset:24576
    s_waitcnt lgkmcnt(2)
    v_add_f32 v116, 1.0, v116
    v_rcp_f32 v113, v113
    v_rcp_f32 v114, v114
    v_mfma_f32_32x32x16_bf16 v[48:63], a[216:219], v[104:107], v[48:63]
    ds_read_b128 v[100:103], v1 offset:25600
    s_waitcnt lgkmcnt(2)
    v_add_f32 v117, 1.0, v117
    v_rcp_f32 v115, v115
    v_rcp_f32 v116, v116
    v_mfma_f32_32x32x16_bf16 v[48:63], a[220:223], v[108:111], v[48:63]
    ds_read_b128 v[104:107], v1 offset:26624
    s_waitcnt lgkmcnt(2)
    v_add_f32 v118, 1.0, v118
    v_add_f32 v119, 1.0, v119
    v_mul_f32 v112, v40, v112
    v_rcp_f32 v117, v117
    v_mfma_f32_32x32x16_bf16 v[48:63], a[224:227], v[96:99], v[48:63]
    ds_read_b128 v[108:111], v1 offset:27648
    s_waitcnt lgkmcnt(2)
    v_mul_f32 v113, v41, v113
    v_rcp_f32 v118, v118
    v_rcp_f32 v119, v119
    v_mfma_f32_32x32x16_bf16 v[48:63], a[228:231], v[100:103], v[48:63]
    ds_read_b128 v[96:99], v1 offset:28672
    s_waitcnt lgkmcnt(2)
    v_mul_f32 v114, v42, v114
    v_mul_f32 v115, v43, v115
    v_mul_f32 v116, v44, v116
    v_mul_f32 v117, v45, v117
    v_mul_f32 v118, v46, v118
    v_mfma_f32_32x32x16_bf16 v[48:63], a[232:235], v[104:107], v[48:63]
    ds_read_b128 v[100:103], v1 offset:29696
    s_waitcnt lgkmcnt(2)
    v_mul_f32 v119, v47, v119
    v_cvt_pk_bf16_f32 v40, v112, v113
    v_cvt_pk_bf16_f32 v41, v114, v115
    v_cvt_pk_bf16_f32 v42, v116, v117
    v_cvt_pk_bf16_f32 v43, v118, v119
    v_mfma_f32_32x32x16_bf16 v[48:63], a[236:239], v[108:111], v[48:63]
    ds_read_b128 v[104:107], v1 offset:30720
    s_waitcnt lgkmcnt(2)
    s_add_u32 s61, s24, 1024
    s_cmp_eq_u32 s12, 0
    s_cbranch_scc1 Lslow_298
    buffer_store_dwordx4 v[40:43], v1, s[4:7], s61 offen
Lback_299:
    v_mfma_f32_32x32x16_bf16 v[48:63], a[240:243], v[96:99], v[48:63]
    ds_read_b128 v[108:111], v1 offset:31744
    s_waitcnt lgkmcnt(2)
Lf1sy_300:
    s_waitcnt vmcnt(10)
    v_add_f32 v24, v24, v28
    v_add_f32 v25, v25, v29
    v_add_f32 v26, v26, v30
    v_add_f32 v27, v27, v31
    v_add_f32 v24, v24, v26
    v_add_f32 v25, v25, v27
    v_add_f32 v24, v24, v25
    v_add_u32 v25, s26, v3
    ds_write_b32 v25, v24 offset:6400
    s_waitcnt vmcnt(2)
    s_waitcnt lgkmcnt(0)
    s_barrier
    v_mfma_f32_32x32x16_bf16 v[48:63], a[244:247], v[100:103], v[48:63]
    ds_read_b128 v[96:99], v1 offset:32768
    v_add_u32 v31, 135168, v3
    ds_read_b32 v28, v31 offset:6400
    ds_read_b32 v29, v31 offset:13568
    ds_read_b32 v30, v31 offset:20736
    ds_read_b32 v31, v31 offset:27904
    v_mfma_f32_32x32x16_bf16 v[48:63], a[248:251], v[104:107], v[48:63]
    ds_read_b128 v[100:103], v1 offset:33792
    s_waitcnt lgkmcnt(1)
    v_add_f32 v28, v28, v30
    v_add_f32 v29, v29, v31
    v_add_f32 v28, v28, v29
    v_mov_b32 v29, v28
    v_mfma_f32_32x32x16_bf16 v[48:63], a[252:255], v[108:111], v[48:63]
    ds_read_b128 v[104:107], v1 offset:34816
    v_mfma_f32_32x32x16_bf16 v[48:63], v[120:123], v[8:11], v[48:63]
    v_permlane32_swap_b32 v28, v29
    v_mul_f32 v30, 0x3b000000, v28
    v_mul_f32 v29, 0x3b000000, v29
    v_fma_f32 v29, -v30, v30, v29
    v_mfma_f32_32x32x16_bf16 v[64:79], a[0:3], v[96:99], 0
    ds_read_b128 v[108:111], v1 offset:35840
    s_waitcnt lgkmcnt(2)
    v_max_f32 v29, 0, v29
    v_add_f32 v29, 0x3727c5ac, v29
    v_rsq_f32 v7, v29
    v_mfma_f32_32x32x16_bf16 v[64:79], a[4:7], v[100:103], v[64:79]
    ds_read_b128 v[96:99], v1 offset:36864
    s_waitcnt lgkmcnt(2)
    v_mul_f32 v29, 0xbb000000, v28
    v_cvt_pk_bf16_f32 v10, v29, v29
    v_and_b32 v11, 0xffff0000, v10
    v_sub_f32 v29, v29, v11
    v_cvt_pk_bf16_f32 v11, v29, v29
    v_mul_f32 v126, 0xbfb8aa3b, v7
    v_mov_b32 v127, v126
    v_mfma_f32_32x32x16_bf16 v[64:79], a[8:11], v[104:107], v[64:79]
    ds_read_b128 v[100:103], v1 offset:37888
    s_waitcnt lgkmcnt(2)
    v_mul_f32 v112, v124, v48
    v_mul_f32 v113, v124, v49
    v_mul_f32 v114, v124, v50
    v_mul_f32 v115, v124, v51
    v_mul_f32 v116, v124, v52
    s_add_u32 s64, s48, 20480
    s_addc_u32 s65, s49, 0
    global_load_dwordx4 a[0:3], v2, s[64:65] offset:-4096
    v_mfma_f32_32x32x16_bf16 v[64:79], a[12:15], v[108:111], v[64:79]
    ds_read_b128 v[104:107], v1 offset:38912
    s_waitcnt lgkmcnt(2)
    v_mul_f32 v117, v124, v53
    v_exp_f32 v112, v112
    v_exp_f32 v113, v113
    s_add_u32 s68, s50, 20480
    s_addc_u32 s69, s51, 0
    global_load_dwordx4 a[4:7], v2, s[68:69] offset:-4096
    v_mfma_f32_32x32x16_bf16 v[64:79], a[16:19], v[96:99], v[64:79]
    ds_read_b128 v[108:111], v1 offset:39936
    s_waitcnt lgkmcnt(2)
    v_mul_f32 v118, v124, v54
    v_exp_f32 v114, v114
    v_exp_f32 v115, v115
    v_mfma_f32_32x32x16_bf16 v[64:79], a[20:23], v[100:103], v[64:79]
    ds_read_b128 v[96:99], v1 offset:40960
    s_waitcnt lgkmcnt(2)
    v_mul_f32 v119, v124, v55
    v_exp_f32 v116, v116
    v_exp_f32 v117, v117
    global_load_dwordx4 a[8:11], v2, s[64:65] offset:-3072
    v_mfma_f32_32x32x16_bf16 v[64:79], a[24:27], v[104:107], v[64:79]
    ds_read_b128 v[100:103], v1 offset:41984
    s_waitcnt lgkmcnt(2)
    v_add_f32 v112, 1.0, v112
    v_exp_f32 v118, v118
    v_exp_f32 v119, v119
    v_mfma_f32_32x32x16_bf16 v[64:79], a[28:31], v[108:111], v[64:79]
    ds_read_b128 v[104:107], v1 offset:43008
    s_waitcnt lgkmcnt(2)
    v_add_f32 v113, 1.0, v113
    v_add_f32 v114, 1.0, v114
    v_add_f32 v115, 1.0, v115
    v_rcp_f32 v112, v112
    global_load_dwordx4 a[12:15], v2, s[68:69] offset:-3072
    v_mfma_f32_32x32x16_bf16 v[64:79], a[32:35], v[96:99], v[64:79]
    ds_read_b128 v[108:111], v1 offset:44032
    s_waitcnt lgkmcnt(2)
    v_add_f32 v116, 1.0, v116
    v_rcp_f32 v113, v113
    v_rcp_f32 v114, v114
    global_load_dwordx4 a[16:19], v2, s[64:65] offset:-2048
    v_mfma_f32_32x32x16_bf16 v[64:79], a[36:39], v[100:103], v[64:79]
    ds_read_b128 v[96:99], v1 offset:45056
    s_waitcnt lgkmcnt(2)
    v_add_f32 v117, 1.0, v117
    v_rcp_f32 v115, v115
    v_rcp_f32 v116, v116
    v_mfma_f32_32x32x16_bf16 v[64:79], a[40:43], v[104:107], v[64:79]
    ds_read_b128 v[100:103], v1 offset:46080
    s_waitcnt lgkmcnt(2)
    v_add_f32 v118, 1.0, v118
    v_add_f32 v119, 1.0, v119
    v_mul_f32 v112, v48, v112
    v_rcp_f32 v117, v117
    global_load_dwordx4 a[20:23], v2, s[68:69] offset:-2048
    v_mfma_f32_32x32x16_bf16 v[64:79], a[44:47], v[108:111], v[64:79]
    ds_read_b128 v[104:107], v1 offset:47104
    s_waitcnt lgkmcnt(2)
    v_mul_f32 v113, v49, v113
    v_rcp_f32 v118, v118
    v_rcp_f32 v119, v119
    v_mfma_f32_32x32x16_bf16 v[64:79], a[48:51], v[96:99], v[64:79]
    ds_read_b128 v[108:111], v1 offset:48128
    s_waitcnt lgkmcnt(2)
    v_mul_f32 v114, v50, v114
    v_mul_f32 v115, v51, v115
    v_mul_f32 v116, v52, v116
    v_mul_f32 v117, v53, v117
    v_mul_f32 v118, v54, v118
    global_load_dwordx4 a[24:27], v2, s[64:65] offset:-1024
    v_mfma_f32_32x32x16_bf16 v[64:79], a[52:55], v[100:103], v[64:79]
    ds_read_b128 v[96:99], v1 offset:49152
    s_waitcnt lgkmcnt(2)
    v_mul_f32 v119, v55, v119
    v_cvt_pk_bf16_f32 v48, v112, v113
    v_cvt_pk_bf16_f32 v49, v114, v115
    v_cvt_pk_bf16_f32 v50, v116, v117
    v_cvt_pk_bf16_f32 v51, v118, v119
    global_load_dwordx4 a[28:31], v2, s[68:69] offset:-1024
    v_mfma_f32_32x32x16_bf16 v[64:79], a[56:59], v[104:107], v[64:79]
    ds_read_b128 v[100:103], v1 offset:50176
    s_waitcnt lgkmcnt(2)
    s_add_u32 s61, s25, 0
    v_add_u32 v52, s14, v1
    s_cmp_eq_u32 s12, 0
    s_cbranch_scc1 Lslow_301
    buffer_store_dwordx4 v[48:51], v52, s[4:7], s61 offen
Lback_302:
    v_mfma_f32_32x32x16_bf16 v[64:79], a[60:63], v[108:111], v[64:79]
    ds_read_b128 v[104:107], v1 offset:51200
    s_waitcnt lgkmcnt(2)
    v_mul_f32 v112, v124, v56
    v_mul_f32 v113, v124, v57
    v_mul_f32 v114, v124, v58
    v_mul_f32 v115, v124, v59
    v_mul_f32 v116, v124, v60
    global_load_dwordx4 a[32:35], v2, s[64:65] offset:0
    v_mfma_f32_32x32x16_bf16 v[64:79], a[64:67], v[96:99], v[64:79]
    ds_read_b128 v[108:111], v1 offset:52224
    s_waitcnt lgkmcnt(2)
    v_mul_f32 v117, v124, v61
    v_exp_f32 v112, v112
    v_exp_f32 v113, v113
    v_mfma_f32_32x32x16_bf16 v[64:79], a[68:71], v[100:103], v[64:79]
    ds_read_b128 v[96:99], v1 offset:53248
    s_waitcnt lgkmcnt(2)
    v_mul_f32 v118, v124, v62
    v_exp_f32 v114, v114
    v_exp_f32 v115, v115
    global_load_dwordx4 a[36:39], v2, s[68:69] offset:0
    v_mfma_f32_32x32x16_bf16 v[64:79], a[72:75], v[104:107], v[64:79]
    ds_read_b128 v[100:103], v1 offset:54272
    s_waitcnt lgkmcnt(2)
    v_mul_f32 v119, v124, v63
    v_exp_f32 v116, v116
    v_exp_f32 v117, v117
    global_load_dwordx4 a[40:43], v2, s[64:65] offset:1024
    v_mfma_f32_32x32x16_bf16 v[64:79], a[76:79], v[108:111], v[64:79]
    ds_read_b128 v[104:107], v1 offset:55296
    s_waitcnt lgkmcnt(2)
    v_add_f32 v112, 1.0, v112
    v_exp_f32 v118, v118
    v_exp_f32 v119, v119
    v_mfma_f32_32x32x16_bf16 v[64:79], a[80:83], v[96:99], v[64:79]
    ds_read_b128 v[108:111], v1 offset:56320
    s_waitcnt lgkmcnt(2)
    v_add_f32 v113, 1.0, v113
    v_add_f32 v114, 1.0, v114
    v_add_f32 v115, 1.0, v115
    v_rcp_f32 v112, v112
    global_load_dwordx4 a[44:47], v2, s[68:69] offset:1024
    v_mfma_f32_32x32x16_bf16 v[64:79], a[84:87], v[100:103], v[64:79]
    ds_read_b128 v[96:99], v1 offset:57344
    s_waitcnt lgkmcnt(2)
    v_add_f32 v116, 1.0, v116
    v_rcp_f32 v113, v113
    v_rcp_f32 v114, v114
    v_mfma_f32_32x32x16_bf16 v[64:79], a[88:91], v[104:107], v[64:79]
    ds_read_b128 v[100:103], v1 offset:58368
    s_waitcnt lgkmcnt(2)
    v_add_f32 v117, 1.0, v117
    v_rcp_f32 v115, v115
    v_rcp_f32 v116, v116
    global_load_dwordx4 a[48:51], v2, s[64:65] offset:2048
    v_mfma_f32_32x32x16_bf16 v[64:79], a[92:95], v[108:111], v[64:79]
    ds_read_b128 v[104:107], v1 offset:59392
    s_waitcnt lgkmcnt(2)
    v_add_f32 v118, 1.0, v118
    v_add_f32 v119, 1.0, v119
    v_mul_f32 v112, v56, v112
    v_rcp_f32 v117, v117
    global_load_dwordx4 a[52:55], v2, s[68:69] offset:2048
    v_mfma_f32_32x32x16_bf16 v[64:79], a[96:99], v[96:99], v[64:79]
    ds_read_b128 v[108:111], v1 offset:60416
    s_waitcnt lgkmcnt(2)
    v_mul_f32 v113, v57, v113
    v_rcp_f32 v118, v118
    v_rcp_f32 v119, v119
    v_mfma_f32_32x32x16_bf16 v[64:79], a[100:103], v[100:103], v[64:79]
    ds_read_b128 v[96:99], v1 offset:61440
    s_waitcnt lgkmcnt(2)
    v_mul_f32 v114, v58, v114
    v_mul_f32 v115, v59, v115
    v_mul_f32 v116, v60, v116
    v_mul_f32 v117, v61, v117
    v_mul_f32 v118, v62, v118
    global_load_dwordx4 a[56:59], v2, s[64:65] offset:3072
    v_mfma_f32_32x32x16_bf16 v[64:79], a[104:107], v[104:107], v[64:79]
    ds_read_b128 v[100:103], v1 offset:62464
    s_waitcnt lgkmcnt(2)
    v_mul_f32 v119, v63, v119
    v_cvt_pk_bf16_f32 v56, v112, v113
    v_cvt_pk_bf16_f32 v57, v114, v115
    v_cvt_pk_bf16_f32 v58, v116, v117
    v_cvt_pk_bf16_f32 v59, v118, v119
    v_mfma_f32_32x32x16_bf16 v[64:79], a[108:111], v[108:111], v[64:79]
    ds_read_b128 v[104:107], v1 offset:63488
    s_waitcnt lgkmcnt(2)
    s_add_u32 s61, s25, 1024
    v_add_u32 v60, s14, v1
    s_cmp_eq_u32 s12, 0
    s_cbranch_scc1 Lslow_303
    buffer_store_dwordx4 v[56:59], v60, s[4:7], s61 offen
Lback_304:
    global_load_dwordx4 a[60:63], v2, s[68:69] offset:3072
    v_mfma_f32_32x32x16_bf16 v[64:79], a[112:115], v[96:99], v[64:79]
    ds_read_b128 v[108:111], v1 offset:64512
    s_waitcnt lgkmcnt(2)
    s_add_u32 s64, s48, 28672
    s_addc_u32 s65, s49, 0
    global_load_dwordx4 a[64:67], v2, s[64:65] offset:-4096
    v_mfma_f32_32x32x16_bf16 v[64:79], a[116:119], v[100:103], v[64:79]
    ds_read_b128 v[96:99], v1 offset:32768
    s_waitcnt lgkmcnt(2)
    v_mfma_f32_32x32x16_bf16 v[64:79], a[120:123], v[104:107], v[64:79]
    ds_read_b128 v[100:103], v1 offset:33792
    s_waitcnt lgkmcnt(2)
    s_add_u32 s68, s50, 28672
    s_addc_u32 s69, s51, 0
    global_load_dwordx4 a[68:71], v2, s[68:69] offset:-4096
    v_mfma_f32_32x32x16_bf16 v[64:79], a[124:127], v[108:111], v[64:79]
    ds_read_b128 v[104:107], v1 offset:34816
    s_waitcnt lgkmcnt(2)
    v_mfma_f32_32x32x16_bf16 v[64:79], v[120:123], v[10:13], v[64:79]
    v_mfma_f32_32x32x16_bf16 v[80:95], a[128:131], v[96:99], 0
    ds_read_b128 v[108:111], v1 offset:35840
    s_waitcnt lgkmcnt(2)
    global_load_dwordx4 a[72:75], v2, s[64:65] offset:-3072
    v_mfma_f32_32x32x16_bf16 v[80:95], a[132:135], v[100:103], v[80:95]
    ds_read_b128 v[96:99], v1 offset:36864
    s_waitcnt lgkmcnt(2)
    global_load_dwordx4 a[76:79], v2, s[68:69] offset:-3072
    v_mfma_f32_32x32x16_bf16 v[80:95], a[136:139], v[104:107], v[80:95]
    ds_read_b128 v[100:103], v1 offset:37888
    s_waitcnt lgkmcnt(2)
    s_nop 0
    v_mul_f32 v112, v126, v64
    v_mul_f32 v113, v126, v65
    v_mul_f32 v114, v126, v66
    v_mul_f32 v115, v126, v67
    v_mul_f32 v116, v126, v68
    v_mfma_f32_32x32x16_bf16 v[80:95], a[140:143], v[108:111], v[80:95]
    ds_read_b128 v[104:107], v1 offset:38912
    s_waitcnt lgkmcnt(2)
    global_load_dwordx4 a[80:83], v2, s[64:65] offset:-2048
    v_mul_f32 v117, v126, v69
    v_exp_f32 v112, v112
    v_exp_f32 v113, v113
    v_mfma_f32_32x32x16_bf16 v[80:95], a[144:147], v[96:99], v[80:95]
    ds_read_b128 v[108:111], v1 offset:39936
    s_waitcnt lgkmcnt(2)
    v_mul_f32 v118, v126, v70
    v_exp_f32 v114, v114
    v_exp_f32 v115, v115
    v_mfma_f32_32x32x16_bf16 v[80:95], a[148:151], v[100:103], v[80:95]
    ds_read_b128 v[96:99], v1 offset:40960
    s_waitcnt lgkmcnt(2)
    global_load_dwordx4 a[84:87], v2, s[68:69] offset:-2048
    v_mul_f32 v119, v126, v71
    v_exp_f32 v116, v116
    v_exp_f32 v117, v117
    v_mfma_f32_32x32x16_bf16 v[80:95], a[152:155], v[104:107], v[80:95]
    ds_read_b128 v[100:103], v1 offset:41984
    s_waitcnt lgkmcnt(2)
    global_load_dwordx4 a[88:91], v2, s[64:65] offset:-1024
    v_add_f32 v112, 1.0, v112
    v_exp_f32 v118, v118
    v_exp_f32 v119, v119
    v_mfma_f32_32x32x16_bf16 v[80:95], a[156:159], v[108:111], v[80:95]
    ds_read_b128 v[104:107], v1 offset:43008
    s_waitcnt lgkmcnt(2)
    v_add_f32 v113, 1.0, v113
    v_add_f32 v114, 1.0, v114
    v_add_f32 v115, 1.0, v115
    v_rcp_f32 v112, v112
    v_mfma_f32_32x32x16_bf16 v[80:95], a[160:163], v[96:99], v[80:95]
    ds_read_b128 v[108:111], v1 offset:44032
    s_waitcnt lgkmcnt(2)
    global_load_dwordx4 a[92:95], v2, s[68:69] offset:-1024
    v_add_f32 v116, 1.0, v116
    v_rcp_f32 v113, v113
    v_rcp_f32 v114, v114
    v_mfma_f32_32x32x16_bf16 v[80:95], a[164:167], v[100:103], v[80:95]
    ds_read_b128 v[96:99], v1 offset:45056
    s_waitcnt lgkmcnt(2)
    v_add_f32 v117, 1.0, v117
    v_rcp_f32 v115, v115
    v_rcp_f32 v116, v116
    v_mfma_f32_32x32x16_bf16 v[80:95], a[168:171], v[104:107], v[80:95]
    ds_read_b128 v[100:103], v1 offset:46080
    s_waitcnt lgkmcnt(2)
    v_add_f32 v118, 1.0, v118
    v_add_f32 v119, 1.0, v119
    v_mul_f32 v112, v64, v112
    v_rcp_f32 v117, v117
    s_cmp_eq_u32 s12, 0
    s_cbranch_scc1 Lgate_309
Lback_310:
    s_add_u32 s66, s42, 4096
    s_addc_u32 s67, s43, 0
    global_load_dwordx4 a[96:99], v1, s[66:67] offset:-4096 sc1
    v_mfma_f32_32x32x16_bf16 v[80:95], a[172:175], v[108:111], v[80:95]
    ds_read_b128 v[104:107], v1 offset:47104
    s_waitcnt lgkmcnt(2)
    v_mul_f32 v113, v65, v113
    v_rcp_f32 v118, v118
    v_rcp_f32 v119, v119
    global_load_dwordx4 a[100:103], v1, s[66:67] offset:-3072 sc1
    v_mfma_f32_32x32x16_bf16 v[80:95], a[176:179], v[96:99], v[80:95]
    ds_read_b128 v[108:111], v1 offset:48128
    s_waitcnt lgkmcnt(2)
    v_mul_f32 v114, v66, v114
    v_mul_f32 v115, v67, v115
    v_mul_f32 v116, v68, v116
    v_mul_f32 v117, v69, v117
    v_mul_f32 v118, v70, v118
    v_mfma_f32_32x32x16_bf16 v[80:95], a[180:183], v[100:103], v[80:95]
    ds_read_b128 v[96:99], v1 offset:49152
    s_waitcnt lgkmcnt(2)
    v_mul_f32 v119, v71, v119
    v_cvt_pk_bf16_f32 v64, v112, v113
    v_cvt_pk_bf16_f32 v65, v114, v115
    v_cvt_pk_bf16_f32 v66, v116, v117
    v_cvt_pk_bf16_f32 v67, v118, v119
    global_load_dwordx4 a[104:107], v1, s[66:67] offset:0 sc1
    v_mfma_f32_32x32x16_bf16 v[80:95], a[184:187], v[104:107], v[80:95]
    ds_read_b128 v[100:103], v1 offset:50176
    s_waitcnt lgkmcnt(2)
    s_add_u32 s61, s24, 114688
    s_cmp_eq_u32 s12, 0
    s_cbranch_scc1 Lslow_305
    buffer_store_dwordx4 v[64:67], v1, s[4:7], s61 offen
Lback_306:
    v_mfma_f32_32x32x16_bf16 v[80:95], a[188:191], v[108:111], v[80:95]
    ds_read_b128 v[104:107], v1 offset:51200
    s_waitcnt lgkmcnt(2)
    v_mul_f32 v112, v126, v72
    v_mul_f32 v113, v126, v73
    v_mul_f32 v114, v126, v74
    v_mul_f32 v115, v126, v75
    v_mul_f32 v116, v126, v76
    global_load_dwordx4 a[108:111], v1, s[66:67] offset:1024 sc1
    v_mfma_f32_32x32x16_bf16 v[80:95], a[192:195], v[96:99], v[80:95]
    ds_read_b128 v[108:111], v1 offset:52224
    s_waitcnt lgkmcnt(2)
    v_mul_f32 v117, v126, v77
    v_exp_f32 v112, v112
    v_exp_f32 v113, v113
    v_mfma_f32_32x32x16_bf16 v[80:95], a[196:199], v[100:103], v[80:95]
    ds_read_b128 v[96:99], v1 offset:53248
    s_waitcnt lgkmcnt(2)
    v_mul_f32 v118, v126, v78
    v_exp_f32 v114, v114
    v_exp_f32 v115, v115
    s_add_u32 s66, s42, 12288
    s_addc_u32 s67, s43, 0
    global_load_dwordx4 a[112:115], v1, s[66:67] offset:-4096 sc1
    v_mfma_f32_32x32x16_bf16 v[80:95], a[200:203], v[104:107], v[80:95]
    ds_read_b128 v[100:103], v1 offset:54272
    s_waitcnt lgkmcnt(2)
    v_mul_f32 v119, v126, v79
    v_exp_f32 v116, v116
    v_exp_f32 v117, v117
    v_mfma_f32_32x32x16_bf16 v[80:95], a[204:207], v[108:111], v[80:95]
    ds_read_b128 v[104:107], v1 offset:55296
    s_waitcnt lgkmcnt(2)
    v_add_f32 v112, 1.0, v112
    v_exp_f32 v118, v118
    v_exp_f32 v119, v119
    global_load_dwordx4 a[116:119], v1, s[66:67] offset:-3072 sc1
    v_mfma_f32_32x32x16_bf16 v[80:95], a[208:211], v[96:99], v[80:95]
    ds_read_b128 v[108:111], v1 offset:56320
    s_waitcnt lgkmcnt(2)
    v_add_f32 v113, 1.0, v113
    v_add_f32 v114, 1.0, v114
    v_add_f32 v115, 1.0, v115
    v_rcp_f32 v112, v112
    v_mfma_f32_32x32x16_bf16 v[80:95], a[212:215], v[100:103], v[80:95]
    ds_read_b128 v[96:99], v1 offset:57344
    s_waitcnt lgkmcnt(2)
    v_add_f32 v116, 1.0, v116
    v_rcp_f32 v113, v113
    v_rcp_f32 v114, v114
    global_load_dwordx4 a[120:123], v1, s[66:67] offset:0 sc1
    v_mfma_f32_32x32x16_bf16 v[80:95], a[216:219], v[104:107], v[80:95]
    ds_read_b128 v[100:103], v1 offset:58368
    s_waitcnt lgkmcnt(2)
    v_add_f32 v117, 1.0, v117
    v_rcp_f32 v115, v115
    v_rcp_f32 v116, v116
    global_load_dwordx4 a[124:127], v1, s[66:67] offset:1024 sc1
    v_mfma_f32_32x32x16_bf16 v[80:95], a[220:223], v[108:111], v[80:95]
    ds_read_b128 v[104:107], v1 offset:59392
    s_waitcnt lgkmcnt(2)
    v_add_f32 v118, 1.0, v118
    v_add_f32 v119, 1.0, v119
    v_mul_f32 v112, v72, v112
    v_rcp_f32 v117, v117
    v_mfma_f32_32x32x16_bf16 v[80:95], a[224:227], v[96:99], v[80:95]
    ds_read_b128 v[108:111], v1 offset:60416
    s_waitcnt lgkmcnt(2)
    v_mul_f32 v113, v73, v113
    v_rcp_f32 v118, v118
    v_rcp_f32 v119, v119
    global_load_dwordx4 a[128:131], v1, s[66:67] offset:2048 sc1
    v_mfma_f32_32x32x16_bf16 v[80:95], a[228:231], v[100:103], v[80:95]
    ds_read_b128 v[96:99], v1 offset:61440
    s_waitcnt lgkmcnt(2)
    v_mul_f32 v114, v74, v114
    v_mul_f32 v115, v75, v115
    v_mul_f32 v116, v76, v116
    v_mul_f32 v117, v77, v117
    v_mul_f32 v118, v78, v118
    v_mfma_f32_32x32x16_bf16 v[80:95], a[232:235], v[104:107], v[80:95]
    ds_read_b128 v[100:103], v1 offset:62464
    s_waitcnt lgkmcnt(2)
    v_mul_f32 v119, v79, v119
    v_cvt_pk_bf16_f32 v72, v112, v113
    v_cvt_pk_bf16_f32 v73, v114, v115
    v_cvt_pk_bf16_f32 v74, v116, v117
    v_cvt_pk_bf16_f32 v75, v118, v119
    global_load_dwordx4 a[132:135], v1, s[66:67] offset:3072 sc1
    v_mfma_f32_32x32x16_bf16 v[80:95], a[236:239], v[108:111], v[80:95]
    ds_read_b128 v[104:107], v1 offset:63488
    s_waitcnt lgkmcnt(2)
    s_add_u32 s61, s24, 115712
    s_cmp_eq_u32 s12, 0
    s_cbranch_scc1 Lslow_307
    buffer_store_dwordx4 v[72:75], v1, s[4:7], s61 offen
Lback_308:
    v_mfma_f32_32x32x16_bf16 v[80:95], a[240:243], v[96:99], v[80:95]
    ds_read_b128 v[108:111], v1 offset:64512
    s_waitcnt lgkmcnt(2)
    s_add_u32 s66, s42, 22528
    s_addc_u32 s67, s43, 0
    global_load_dwordx4 a[136:139], v1, s[66:67] offset:-4096 sc1
    v_mfma_f32_32x32x16_bf16 v[80:95], a[244:247], v[100:103], v[80:95]
    s_waitcnt lgkmcnt(1)
    v_mfma_f32_32x32x16_bf16 v[80:95], a[248:251], v[104:107], v[80:95]
    s_waitcnt lgkmcnt(0)
    global_load_dwordx4 a[140:143], v1, s[66:67] offset:-3072 sc1
    v_mfma_f32_32x32x16_bf16 v[80:95], a[252:255], v[108:111], v[80:95]
    v_mfma_f32_32x32x16_bf16 v[80:95], v[120:123], v[8:11], v[80:95]
    s_waitcnt vmcnt(13)
    v_mfma_f32_32x32x16_bf16 v[48:63], v[132:135], a[96:99], 0
    s_add_u32 s66, s42, 26624
    s_addc_u32 s67, s43, 0
    global_load_dwordx4 a[144:147], v1, s[66:67] offset:-4096 sc1
    v_mfma_f32_32x32x16_bf16 v[32:47], v[128:131], a[96:99], 0
    global_load_dwordx4 a[148:151], v1, s[66:67] offset:-3072 sc1
    s_nop 4
    v_mul_f32 v112, v126, v80
    v_mul_f32 v113, v126, v81
    v_mul_f32 v114, v126, v82
    v_mul_f32 v115, v126, v83
    v_mul_f32 v116, v126, v84
    s_waitcnt vmcnt(14)
    v_mfma_f32_32x32x16_bf16 v[48:63], v[140:143], a[100:103], v[48:63]
    v_mul_f32 v117, v126, v85
    v_exp_f32 v112, v112
    v_exp_f32 v113, v113
    v_mfma_f32_32x32x16_bf16 v[32:47], v[136:139], a[100:103], v[32:47]
    global_load_dwordx4 a[152:155], v1, s[66:67] offset:0 sc1
    s_waitcnt vmcnt(14)
    v_mfma_f32_32x32x16_bf16 v[48:63], v[148:151], a[104:107], v[48:63]
    global_load_dwordx4 a[156:159], v1, s[66:67] offset:1024 sc1
    v_mul_f32 v118, v126, v86
    v_exp_f32 v114, v114
    v_exp_f32 v115, v115
    v_mfma_f32_32x32x16_bf16 v[32:47], v[144:147], a[104:107], v[32:47]
    v_mul_f32 v119, v126, v87
    v_exp_f32 v116, v116
    v_exp_f32 v117, v117
    s_waitcnt vmcnt(13)
    v_mfma_f32_32x32x16_bf16 v[48:63], v[156:159], a[108:111], v[48:63]
    s_add_u32 s66, s42, 6144
    s_addc_u32 s67, s43, 0
    global_load_dwordx4 a[96:99], v1, s[66:67] offset:-4096 sc1
    v_mfma_f32_32x32x16_bf16 v[32:47], v[152:155], a[108:111], v[32:47]
    global_load_dwordx4 a[100:103], v1, s[66:67] offset:-3072 sc1
    v_add_f32 v112, 1.0, v112
    v_exp_f32 v118, v118
    v_exp_f32 v119, v119
    s_waitcnt vmcnt(14)
    v_mfma_f32_32x32x16_bf16 v[48:63], v[164:167], a[112:115], v[48:63]
    v_add_f32 v113, 1.0, v113
    v_add_f32 v114, 1.0, v114
    v_add_f32 v115, 1.0, v115
    v_rcp_f32 v112, v112
    v_mfma_f32_32x32x16_bf16 v[32:47], v[160:163], a[112:115], v[32:47]
    global_load_dwordx4 a[104:107], v1, s[66:67] offset:0 sc1
    s_waitcnt vmcnt(14)
    v_mfma_f32_32x32x16_bf16 v[48:63], v[172:175], a[116:119], v[48:63]
    global_load_dwordx4 a[108:111], v1, s[66:67] offset:1024 sc1
    v_add_f32 v116, 1.0, v116
    v_rcp_f32 v113, v113
    v_rcp_f32 v114, v114
    v_mfma_f32_32x32x16_bf16 v[32:47], v[168:171], a[116:119], v[32:47]
    v_add_f32 v117, 1.0, v117
    v_rcp_f32 v115, v115
    v_rcp_f32 v116, v116
    s_waitcnt vmcnt(14)
    v_mfma_f32_32x32x16_bf16 v[48:63], v[180:183], a[120:123], v[48:63]
    s_add_u32 s66, s42, 14336
    s_addc_u32 s67, s43, 0
    global_load_dwordx4 a[112:115], v1, s[66:67] offset:-4096 sc1
    v_mfma_f32_32x32x16_bf16 v[32:47], v[176:179], a[120:123], v[32:47]
    global_load_dwordx4 a[116:119], v1, s[66:67] offset:-3072 sc1
    v_add_f32 v118, 1.0, v118
    v_add_f32 v119, 1.0, v119
    v_mul_f32 v112, v80, v112
    v_rcp_f32 v117, v117
    s_waitcnt vmcnt(15)
    v_mfma_f32_32x32x16_bf16 v[48:63], v[188:191], a[124:127], v[48:63]
    v_mul_f32 v113, v81, v113
    v_rcp_f32 v118, v118
    v_rcp_f32 v119, v119
    v_mfma_f32_32x32x16_bf16 v[32:47], v[184:187], a[124:127], v[32:47]
    global_load_dwordx4 a[120:123], v1, s[66:67] offset:2048 sc1
    s_waitcnt vmcnt(15)
    v_mfma_f32_32x32x16_bf16 v[48:63], v[196:199], a[128:131], v[48:63]
    global_load_dwordx4 a[124:127], v1, s[66:67] offset:3072 sc1
    v_mul_f32 v114, v82, v114
    v_mul_f32 v115, v83, v115
    v_mul_f32 v116, v84, v116
    v_mul_f32 v117, v85, v117
    v_mul_f32 v118, v86, v118
    v_mfma_f32_32x32x16_bf16 v[32:47], v[192:195], a[128:131], v[32:47]
    v_mul_f32 v119, v87, v119
    v_cvt_pk_bf16_f32 v80, v112, v113
    v_cvt_pk_bf16_f32 v81, v114, v115
    v_cvt_pk_bf16_f32 v82, v116, v117
    v_cvt_pk_bf16_f32 v83, v118, v119
    s_waitcnt vmcnt(15)
    v_mfma_f32_32x32x16_bf16 v[48:63], v[204:207], a[132:135], v[48:63]
    s_add_u32 s66, s42, 24576
    s_addc_u32 s67, s43, 0
    global_load_dwordx4 a[128:131], v1, s[66:67] offset:-4096 sc1
    v_mfma_f32_32x32x16_bf16 v[32:47], v[200:203], a[132:135], v[32:47]
    global_load_dwordx4 a[132:135], v1, s[66:67] offset:-3072 sc1
    s_add_u32 s61, s25, 114688
    v_add_u32 v84, s14, v1
    s_cmp_eq_u32 s12, 0
    s_cbranch_scc1 Lslow_315
    buffer_store_dwordx4 v[80:83], v84, s[4:7], s61 offen
Lback_316:
    s_waitcnt vmcnt(16)
    v_mfma_f32_32x32x16_bf16 v[48:63], v[212:215], a[136:139], v[48:63]
    v_mul_f32 v112, v126, v88
    v_mul_f32 v113, v126, v89
    v_mul_f32 v114, v126, v90
    v_mul_f32 v115, v126, v91
    v_mul_f32 v116, v126, v92
    v_mfma_f32_32x32x16_bf16 v[32:47], v[208:211], a[136:139], v[32:47]
    global_load_dwordx4 a[136:139], v1, s[66:67] offset:0 sc1
    s_waitcnt vmcnt(16)
    v_mfma_f32_32x32x16_bf16 v[48:63], v[220:223], a[140:143], v[48:63]
    v_mul_f32 v117, v126, v93
    v_exp_f32 v112, v112
    v_exp_f32 v113, v113
    v_mfma_f32_32x32x16_bf16 v[32:47], v[216:219], a[140:143], v[32:47]
    global_load_dwordx4 a[140:143], v1, s[66:67] offset:1024 sc1
    v_mul_f32 v118, v126, v94
    v_exp_f32 v114, v114
    v_exp_f32 v115, v115
    s_waitcnt vmcnt(16)
    v_mfma_f32_32x32x16_bf16 v[48:63], v[228:231], a[144:147], v[48:63]
    v_mfma_f32_32x32x16_bf16 v[32:47], v[224:227], a[144:147], v[32:47]
    v_mul_f32 v119, v126, v95
    v_exp_f32 v116, v116
    v_exp_f32 v117, v117
    s_add_u32 s66, s42, 118784
    s_addc_u32 s67, s43, 0
    global_load_dwordx4 a[144:147], v1, s[66:67] offset:-4096 sc1
    s_waitcnt vmcnt(16)
    v_mfma_f32_32x32x16_bf16 v[48:63], v[236:239], a[148:151], v[48:63]
    v_add_f32 v112, 1.0, v112
    v_exp_f32 v118, v118
    v_exp_f32 v119, v119
    v_mfma_f32_32x32x16_bf16 v[32:47], v[232:235], a[148:151], v[32:47]
    global_load_dwordx4 a[148:151], v1, s[66:67] offset:-3072 sc1
    s_waitcnt vmcnt(16)
    v_mfma_f32_32x32x16_bf16 v[48:63], v[244:247], a[152:155], v[48:63]
    v_add_f32 v113, 1.0, v113
    v_add_f32 v114, 1.0, v114
    v_add_f32 v115, 1.0, v115
    v_rcp_f32 v112, v112
    v_mfma_f32_32x32x16_bf16 v[32:47], v[240:243], a[152:155], v[32:47]
    v_add_f32 v116, 1.0, v116
    v_rcp_f32 v113, v113
    v_rcp_f32 v114, v114
    global_load_dwordx4 a[152:155], v1, s[66:67] offset:0 sc1
    s_waitcnt vmcnt(16)
    v_mfma_f32_32x32x16_bf16 v[48:63], v[252:255], a[156:159], v[48:63]
    v_mfma_f32_32x32x16_bf16 v[32:47], v[248:251], a[156:159], v[32:47]
    v_add_f32 v117, 1.0, v117
    v_rcp_f32 v115, v115
    v_rcp_f32 v116, v116
    global_load_dwordx4 a[156:159], v1, s[66:67] offset:1024 sc1
    s_waitcnt vmcnt(16)
    v_mfma_f32_32x32x16_bf16 v[48:63], a[4:7], a[96:99], v[48:63]
    v_add_f32 v118, 1.0, v118
    v_add_f32 v119, 1.0, v119
    v_mul_f32 v112, v88, v112
    v_rcp_f32 v117, v117
    v_mfma_f32_32x32x16_bf16 v[32:47], a[0:3], a[96:99], v[32:47]
    s_add_u32 s66, s42, 126976
    s_addc_u32 s67, s43, 0
    global_load_dwordx4 a[96:99], v1, s[66:67] offset:-4096 sc1
    s_waitcnt vmcnt(16)
    v_mfma_f32_32x32x16_bf16 v[48:63], a[12:15], a[100:103], v[48:63]
    v_mul_f32 v113, v89, v113
    v_rcp_f32 v118, v118
    v_rcp_f32 v119, v119
    v_mfma_f32_32x32x16_bf16 v[32:47], a[8:11], a[100:103], v[32:47]
    v_mul_f32 v114, v90, v114
    v_mul_f32 v115, v91, v115
    v_mul_f32 v116, v92, v116
    v_mul_f32 v117, v93, v117
    v_mul_f32 v118, v94, v118
    global_load_dwordx4 a[100:103], v1, s[66:67] offset:-3072 sc1
    s_waitcnt vmcnt(16)
    v_mfma_f32_32x32x16_bf16 v[48:63], a[20:23], a[104:107], v[48:63]
    v_mfma_f32_32x32x16_bf16 v[32:47], a[16:19], a[104:107], v[32:47]
    v_mul_f32 v119, v95, v119
    v_cvt_pk_bf16_f32 v88, v112, v113
    v_cvt_pk_bf16_f32 v89, v114, v115
    v_cvt_pk_bf16_f32 v90, v116, v117
    v_cvt_pk_bf16_f32 v91, v118, v119
    global_load_dwordx4 a[104:107], v1, s[66:67] offset:0 sc1
    s_waitcnt vmcnt(16)
    v_mfma_f32_32x32x16_bf16 v[48:63], a[28:31], a[108:111], v[48:63]
    s_add_u32 s61, s25, 115712
    v_add_u32 v92, s14, v1
    s_cmp_eq_u32 s12, 0
    s_cbranch_scc1 Lslow_317
    buffer_store_dwordx4 v[88:91], v92, s[4:7], s61 offen
Lback_318:
    v_mfma_f32_32x32x16_bf16 v[32:47], a[24:27], a[108:111], v[32:47]
    global_load_dwordx4 a[108:111], v1, s[66:67] offset:1024 sc1
    s_waitcnt vmcnt(17)
    v_mfma_f32_32x32x16_bf16 v[48:63], a[36:39], a[112:115], v[48:63]
    v_mfma_f32_32x32x16_bf16 v[32:47], a[32:35], a[112:115], v[32:47]
    global_load_dwordx4 a[112:115], v1, s[66:67] offset:2048 sc1
    s_waitcnt vmcnt(17)
    v_mfma_f32_32x32x16_bf16 v[48:63], a[44:47], a[116:119], v[48:63]
    s_cmp_eq_u32 s12, 0
    s_cbranch_scc1 Lslow_319
    buffer_store_byte v5, off, s[4:7], s21 offset:1536
Lback_320:
    v_mfma_f32_32x32x16_bf16 v[32:47], a[40:43], a[116:119], v[32:47]
    global_load_dwordx4 a[116:119], v1, s[66:67] offset:3072 sc1
    s_waitcnt vmcnt(18)
    v_mfma_f32_32x32x16_bf16 v[48:63], a[52:55], a[120:123], v[48:63]
    s_cmp_eq_u32 s12, 0
    s_cbranch_scc1 Lgate_321
Lback_322:
    s_waitcnt vmcnt(17)
    v_mfma_f32_32x32x16_bf16 v[48:63], a[60:63], a[124:127], v[48:63]
    s_waitcnt vmcnt(16)
    v_mfma_f32_32x32x16_bf16 v[48:63], a[68:71], a[128:131], v[48:63]
    s_waitcnt vmcnt(15)
    v_mfma_f32_32x32x16_bf16 v[48:63], a[76:79], a[132:135], v[48:63]
    s_waitcnt vmcnt(13)
    v_mfma_f32_32x32x16_bf16 v[48:63], a[84:87], a[136:139], v[48:63]
    v_add_u32 v124, s26, v1
    v_add_u32 v125, s27, v1
    v_add_u32 v126, s28, v1
    v_add_u32 v127, s29, v1
    s_waitcnt vmcnt(12)
    v_mfma_f32_32x32x16_bf16 v[48:63], a[92:95], a[140:143], v[48:63]
    v_mfma_f32_32x32x16_bf16 v[32:47], a[48:51], a[120:123], v[32:47]
    v_mfma_f32_32x32x16_bf16 v[32:47], a[56:59], a[124:127], v[32:47]
    v_mfma_f32_32x32x16_bf16 v[32:47], a[64:67], a[128:131], v[32:47]
    s_nop 8
    v_cmp_u_f32 vcc, v48, v48
    v_mfma_f32_32x32x16_bf16 v[32:47], a[72:75], a[132:135], v[32:47]
    s_nop 3
    s_cbranch_vccnz Lredo_326
Lback_327:
Lf2st_314:
    ds_write_b128 v124, v[48:51] offset:2048
    v_mfma_f32_32x32x16_bf16 v[32:47], a[80:83], a[136:139], v[32:47]
    ds_write_b128 v124, v[52:55] offset:3072
    v_mfma_f32_32x32x16_bf16 v[32:47], a[88:91], a[140:143], v[32:47]
    ds_write_b128 v124, v[56:59] offset:4096
    ds_write_b128 v124, v[60:63] offset:5120
    s_add_u32 s66, s42, 137216
    s_addc_u32 s67, s43, 0
    global_load_dwordx4 a[120:123], v1, s[66:67] offset:-4096 sc1
    global_load_dwordx4 a[124:127], v1, s[66:67] offset:-3072 sc1
    s_nop 5
    ds_write_b128 v124, v[40:43] offset:0
    ds_write_b128 v124, v[44:47] offset:1024
    s_waitcnt lgkmcnt(0)
    s_barrier
    ds_read_b128 v[104:107], v126 offset:2048
    ds_read_b128 v[108:111], v126 offset:3072
    ds_read_b128 v[112:115], v127 offset:4096
    ds_read_b128 v[116:119], v127 offset:5120
    ds_read_b128 v[96:99], v125 offset:0
    ds_read_b128 v[100:103], v125 offset:1024
    s_add_u32 s66, s42, 141312
    s_addc_u32 s67, s43, 0
    global_load_dwordx4 a[128:131], v1, s[66:67] offset:-4096 sc1
    global_load_dwordx4 a[132:135], v1, s[66:67] offset:-3072 sc1
    global_load_dwordx4 a[136:139], v1, s[66:67] offset:0 sc1
    global_load_dwordx4 a[140:143], v1, s[66:67] offset:1024 sc1
    v_lshlrev_b32 v40, 16, v16
    v_and_b32 v41, 0xffff0000, v16
    v_lshlrev_b32 v42, 16, v17
    v_and_b32 v43, 0xffff0000, v17
    v_lshlrev_b32 v44, 16, v18
    v_and_b32 v45, 0xffff0000, v18
    v_lshlrev_b32 v46, 16, v19
    v_and_b32 v47, 0xffff0000, v19
    s_waitcnt lgkmcnt(5)
    v_pk_add_f32 v[32:33], v[32:33], v[104:105]
    v_pk_add_f32 v[34:35], v[34:35], v[106:107]
    s_waitcnt lgkmcnt(4)
    v_pk_add_f32 v[36:37], v[36:37], v[108:109]
    v_pk_add_f32 v[38:39], v[38:39], v[110:111]
    s_waitcnt lgkmcnt(3)
    v_pk_add_f32 v[32:33], v[32:33], v[112:113]
    v_pk_add_f32 v[34:35], v[34:35], v[114:115]
    s_waitcnt lgkmcnt(2)
    v_pk_add_f32 v[36:37], v[36:37], v[116:117]
    v_pk_add_f32 v[38:39], v[38:39], v[118:119]
    s_waitcnt lgkmcnt(1)
    v_pk_add_f32 v[32:33], v[32:33], v[96:97]
    v_pk_add_f32 v[34:35], v[34:35], v[98:99]
    s_waitcnt lgkmcnt(0)
    v_pk_add_f32 v[36:37], v[36:37], v[100:101]
    v_pk_add_f32 v[38:39], v[38:39], v[102:103]
    v_fma_f32 v32, v6, v32, v40
    v_fma_f32 v33, v6, v33, v41
    v_fma_f32 v34, v6, v34, v42
    v_fma_f32 v35, v6, v35, v43
    v_fma_f32 v36, v6, v36, v44
    v_fma_f32 v37, v6, v37, v45
    v_fma_f32 v38, v6, v38, v46
    v_fma_f32 v39, v6, v39, v47
    v_cvt_pk_bf16_f32 v16, v32, v33
    v_cvt_pk_bf16_f32 v17, v34, v35
    v_cvt_pk_bf16_f32 v18, v36, v37
    v_cvt_pk_bf16_f32 v19, v38, v39
    v_and_b32 v32, 31, v0
    v_lshlrev_b32 v32, 10, v32
    v_lshrrev_b32 v33, 5, v0
    v_lshl_add_u32 v32, v33, 4, v32
    v_permlane32_swap_b32 v16, v18
    v_permlane32_swap_b32 v17, v19
    s_lshl_b32 s61, s18, 2
    s_add_u32 s61, s61, s16
    s_lshl_b32 s61, s61, 5
    s_lshl_b32 s62, s17, 16
    s_add_u32 s61, s61, s62
    s_add_u32 s61, s61, 0
    buffer_store_dwordx4 v[16:19], v32, s[8:11], s61 offen
Lf2st_331:
    s_waitcnt vmcnt(18)
    v_mfma_f32_32x32x16_bf16 v[80:95], v[132:135], a[144:147], 0
    v_mfma_f32_32x32x16_bf16 v[64:79], v[128:131], a[144:147], 0
    s_add_u32 s66, s42, 120832
    s_addc_u32 s67, s43, 0
    global_load_dwordx4 a[144:147], v1, s[66:67] offset:-4096 sc1
    s_waitcnt vmcnt(18)
    v_mfma_f32_32x32x16_bf16 v[80:95], v[140:143], a[148:151], v[80:95]
    s_waitcnt vmcnt(12)
    s_cmp_eq_u32 s12, 0
    s_cbranch_scc1 Lslow_332
    buffer_store_byte v5, off, s[4:7], s21 offset:1664
Lback_333:
    v_mfma_f32_32x32x16_bf16 v[64:79], v[136:139], a[148:151], v[64:79]
    global_load_dwordx4 a[148:151], v1, s[66:67] offset:-3072 sc1
    v_mfma_f32_32x32x16_bf16 v[80:95], v[148:151], a[152:155], v[80:95]
    v_mfma_f32_32x32x16_bf16 v[64:79], v[144:147], a[152:155], v[64:79]
    global_load_dwordx4 a[152:155], v1, s[66:67] offset:0 sc1
    v_mfma_f32_32x32x16_bf16 v[80:95], v[156:159], a[156:159], v[80:95]
    v_mfma_f32_32x32x16_bf16 v[64:79], v[152:155], a[156:159], v[64:79]
    global_load_dwordx4 a[156:159], v1, s[66:67] offset:1024 sc1
    v_mfma_f32_32x32x16_bf16 v[80:95], v[164:167], a[96:99], v[80:95]
    v_mfma_f32_32x32x16_bf16 v[64:79], v[160:163], a[96:99], v[64:79]
    s_add_u32 s66, s42, 129024
    s_addc_u32 s67, s43, 0
    global_load_dwordx4 a[96:99], v1, s[66:67] offset:-4096 sc1
    v_mfma_f32_32x32x16_bf16 v[80:95], v[172:175], a[100:103], v[80:95]
    v_mfma_f32_32x32x16_bf16 v[64:79], v[168:171], a[100:103], v[64:79]
    global_load_dwordx4 a[100:103], v1, s[66:67] offset:-3072 sc1
    v_mfma_f32_32x32x16_bf16 v[80:95], v[180:183], a[104:107], v[80:95]
    v_mfma_f32_32x32x16_bf16 v[64:79], v[176:179], a[104:107], v[64:79]
    global_load_dwordx4 a[104:107], v1, s[66:67] offset:2048 sc1
    s_waitcnt vmcnt(18)
    v_mfma_f32_32x32x16_bf16 v[80:95], v[188:191], a[108:111], v[80:95]
    v_mfma_f32_32x32x16_bf16 v[64:79], v[184:187], a[108:111], v[64:79]
    global_load_dwordx4 a[108:111], v1, s[66:67] offset:3072 sc1
    s_waitcnt vmcnt(18)
    v_mfma_f32_32x32x16_bf16 v[80:95], v[196:199], a[112:115], v[80:95]
    v_mfma_f32_32x32x16_bf16 v[64:79], v[192:195], a[112:115], v[64:79]
    s_add_u32 s66, s42, 139264
    s_addc_u32 s67, s43, 0
    global_load_dwordx4 a[112:115], v1, s[66:67] offset:-4096 sc1
    s_waitcnt vmcnt(17)
    v_mfma_f32_32x32x16_bf16 v[80:95], v[204:207], a[116:119], v[80:95]
    v_mfma_f32_32x32x16_bf16 v[64:79], v[200:203], a[116:119], v[64:79]
    global_load_dwordx4 a[116:119], v1, s[66:67] offset:-3072 sc1
    s_waitcnt vmcnt(17)
    v_mfma_f32_32x32x16_bf16 v[80:95], v[212:215], a[120:123], v[80:95]
    v_mfma_f32_32x32x16_bf16 v[64:79], v[208:211], a[120:123], v[64:79]
    global_load_dwordx4 a[120:123], v1, s[66:67] offset:0 sc1
    s_waitcnt vmcnt(17)
    v_mfma_f32_32x32x16_bf16 v[80:95], v[220:223], a[124:127], v[80:95]
    v_mfma_f32_32x32x16_bf16 v[64:79], v[216:219], a[124:127], v[64:79]
    global_load_dwordx4 a[124:127], v1, s[66:67] offset:1024 sc1
    s_waitcnt vmcnt(17)
    v_mfma_f32_32x32x16_bf16 v[80:95], v[228:231], a[128:131], v[80:95]
    v_mfma_f32_32x32x16_bf16 v[64:79], v[224:227], a[128:131], v[64:79]
    s_waitcnt vmcnt(16)
    v_mfma_f32_32x32x16_bf16 v[80:95], v[236:239], a[132:135], v[80:95]
    v_mfma_f32_32x32x16_bf16 v[64:79], v[232:235], a[132:135], v[64:79]
    s_waitcnt vmcnt(15)
    v_mfma_f32_32x32x16_bf16 v[80:95], v[244:247], a[136:139], v[80:95]
    v_mfma_f32_32x32x16_bf16 v[64:79], v[240:243], a[136:139], v[64:79]
    s_waitcnt vmcnt(14)
    v_mfma_f32_32x32x16_bf16 v[80:95], v[252:255], a[140:143], v[80:95]
    v_mfma_f32_32x32x16_bf16 v[64:79], v[248:251], a[140:143], v[64:79]
    s_waitcnt vmcnt(12)
    v_mfma_f32_32x32x16_bf16 v[80:95], a[4:7], a[144:147], v[80:95]
    v_mfma_f32_32x32x16_bf16 v[64:79], a[0:3], a[144:147], v[64:79]
    s_waitcnt vmcnt(10)
    v_mfma_f32_32x32x16_bf16 v[80:95], a[12:15], a[148:151], v[80:95]
    v_mfma_f32_32x32x16_bf16 v[64:79], a[8:11], a[148:151], v[64:79]
    s_waitcnt vmcnt(9)
    v_mfma_f32_32x32x16_bf16 v[80:95], a[20:23], a[152:155], v[80:95]
    v_mfma_f32_32x32x16_bf16 v[64:79], a[16:19], a[152:155], v[64:79]
    s_waitcnt vmcnt(8)
    v_mfma_f32_32x32x16_bf16 v[80:95], a[28:31], a[156:159], v[80:95]
    v_mfma_f32_32x32x16_bf16 v[64:79], a[24:27], a[156:159], v[64:79]
    s_waitcnt vmcnt(7)
    v_mfma_f32_32x32x16_bf16 v[80:95], a[36:39], a[96:99], v[80:95]
    v_mfma_f32_32x32x16_bf16 v[64:79], a[32:35], a[96:99], v[64:79]
    s_waitcnt vmcnt(6)
    v_mfma_f32_32x32x16_bf16 v[80:95], a[44:47], a[100:103], v[80:95]
    v_mfma_f32_32x32x16_bf16 v[64:79], a[40:43], a[100:103], v[64:79]
    s_waitcnt vmcnt(5)
    v_mfma_f32_32x32x16_bf16 v[80:95], a[52:55], a[104:107], v[80:95]
    s_waitcnt vmcnt(4)
    v_mfma_f32_32x32x16_bf16 v[80:95], a[60:63], a[108:111], v[80:95]
    s_waitcnt vmcnt(3)
    v_mfma_f32_32x32x16_bf16 v[80:95], a[68:71], a[112:115], v[80:95]
    s_waitcnt vmcnt(2)
    v_mfma_f32_32x32x16_bf16 v[80:95], a[76:79], a[116:119], v[80:95]
    s_waitcnt vmcnt(1)
    v_mfma_f32_32x32x16_bf16 v[80:95], a[84:87], a[120:123], v[80:95]
    v_add_u32 v124, s30, v1
    v_add_u32 v125, s31, v1
    v_add_u32 v126, s32, v1
    v_add_u32 v127, s33, v1
    s_waitcnt vmcnt(0)
    v_mfma_f32_32x32x16_bf16 v[80:95], a[92:95], a[124:127], v[80:95]
    v_mfma_f32_32x32x16_bf16 v[64:79], a[48:51], a[104:107], v[64:79]
    v_mfma_f32_32x32x16_bf16 v[64:79], a[56:59], a[108:111], v[64:79]
    v_mfma_f32_32x32x16_bf16 v[64:79], a[64:67], a[112:115], v[64:79]
    s_nop 8
    v_cmp_u_f32 vcc, v80, v80
    v_mfma_f32_32x32x16_bf16 v[64:79], a[72:75], a[116:119], v[64:79]
    s_nop 3
    s_cbranch_vccnz Lredo_334
Lback_335:
    ds_write_b128 v124, v[80:83] offset:2048
    v_mfma_f32_32x32x16_bf16 v[64:79], a[80:83], a[120:123], v[64:79]
    ds_write_b128 v124, v[84:87] offset:3072
    v_mfma_f32_32x32x16_bf16 v[64:79], a[88:91], a[124:127], v[64:79]
    ds_write_b128 v124, v[88:91] offset:4096
    ds_write_b128 v124, v[92:95] offset:5120
    s_nop 9
    ds_write_b128 v124, v[72:75] offset:0
    ds_write_b128 v124, v[76:79] offset:1024
    s_waitcnt lgkmcnt(0)
    s_barrier
    ds_read_b128 v[104:107], v126 offset:2048
    ds_read_b128 v[108:111], v126 offset:3072
    ds_read_b128 v[112:115], v127 offset:4096
    ds_read_b128 v[116:119], v127 offset:5120
    ds_read_b128 v[96:99], v125 offset:0
    ds_read_b128 v[100:103], v125 offset:1024
    v_lshlrev_b32 v72, 16, v20
    v_and_b32 v73, 0xffff0000, v20
    v_lshlrev_b32 v74, 16, v21
    v_and_b32 v75, 0xffff0000, v21
    v_lshlrev_b32 v76, 16, v22
    v_and_b32 v77, 0xffff0000, v22
    v_lshlrev_b32 v78, 16, v23
    v_and_b32 v79, 0xffff0000, v23
    s_waitcnt lgkmcnt(5)
    v_pk_add_f32 v[64:65], v[64:65], v[104:105]
    v_pk_add_f32 v[66:67], v[66:67], v[106:107]
    s_waitcnt lgkmcnt(4)
    v_pk_add_f32 v[68:69], v[68:69], v[108:109]
    v_pk_add_f32 v[70:71], v[70:71], v[110:111]
    s_waitcnt lgkmcnt(3)
    v_pk_add_f32 v[64:65], v[64:65], v[112:113]
    v_pk_add_f32 v[66:67], v[66:67], v[114:115]
    s_waitcnt lgkmcnt(2)
    v_pk_add_f32 v[68:69], v[68:69], v[116:117]
    v_pk_add_f32 v[70:71], v[70:71], v[118:119]
    s_waitcnt lgkmcnt(1)
    v_pk_add_f32 v[64:65], v[64:65], v[96:97]
    v_pk_add_f32 v[66:67], v[66:67], v[98:99]
    s_waitcnt lgkmcnt(0)
    v_pk_add_f32 v[68:69], v[68:69], v[100:101]
    v_pk_add_f32 v[70:71], v[70:71], v[102:103]
    v_fma_f32 v64, v7, v64, v72
    v_fma_f32 v65, v7, v65, v73
    v_fma_f32 v66, v7, v66, v74
    v_fma_f32 v67, v7, v67, v75
    v_fma_f32 v68, v7, v68, v76
    v_fma_f32 v69, v7, v69, v77
    v_fma_f32 v70, v7, v70, v78
    v_fma_f32 v71, v7, v71, v79
    v_cvt_pk_bf16_f32 v20, v64, v65
    v_cvt_pk_bf16_f32 v21, v66, v67
    v_cvt_pk_bf16_f32 v22, v68, v69
    v_cvt_pk_bf16_f32 v23, v70, v71
    v_and_b32 v64, 31, v0
    v_lshlrev_b32 v64, 10, v64
    v_lshrrev_b32 v65, 5, v0
    v_lshl_add_u32 v64, v65, 4, v64
    v_permlane32_swap_b32 v20, v22
    v_permlane32_swap_b32 v21, v23
    s_lshl_b32 s61, s18, 2
    s_add_u32 s61, s61, s16
    s_lshl_b32 s61, s61, 5
    s_lshl_b32 s62, s17, 16
    s_add_u32 s61, s61, s62
    s_add_u32 s61, s61, 32768
    buffer_store_dwordx4 v[20:23], v64, s[8:11], s61 offen
    s_endpgm
Lnr_9:
    s_sub_u32 s13, s13, 1
    s_cmp_lt_i32 s13, 0
    s_cbranch_scc1 Lnw_8
    global_load_dword v14, v15, s[66:67] sc1
    s_waitcnt vmcnt(0)
    v_readfirstlane_b32 s1, v14
    s_nop 0
    s_cmp_lg_u32 s1, 0
    s_nop 1
    s_cbranch_scc1 Lnw_8
    s_branch Lnr_9
Lretry_23:
    s_sub_u32 s13, s13, 1
    s_cmp_lt_i32 s13, 0
    s_cbranch_scc1 Lback_24
    s_mov_b64 exec, 0xffff
    buffer_load_dword v14, v15, s[4:7], s63 offen sc1
    s_mov_b64 exec, -1
    s_waitcnt vmcnt(0)
    v_cmp_ne_u32 vcc, s1, v14
    s_nop 4
    s_cbranch_vccz Lback_24
    s_branch Lretry_23
Lretry_39:
    s_sub_u32 s13, s13, 1
    s_cmp_lt_i32 s13, 0
    s_nop 0
    s_cbranch_scc1 Lback_40
    s_mov_b64 exec, 0xffff
    buffer_load_dword v14, v15, s[4:7], s63 offen sc1
    s_mov_b64 exec, -1
    s_waitcnt vmcnt(0)
    v_cmp_ne_u32 vcc, s1, v14
    s_nop 4
    s_cbranch_vccz Lback_40
    s_branch Lretry_39
Lretry_41:
    s_sub_u32 s13, s13, 1
    s_cmp_lt_i32 s13, 0
    s_cbranch_scc1 Lback_42
    buffer_load_dword v14, v15, s[4:7], s63 offen sc1
    s_waitcnt vmcnt(0)
    v_xor_b32 v14, s1, v14
    v_cmp_lt_u32 vcc, 15, v14
    s_nop 4
    s_cbranch_vccz Lback_42
    s_branch Lretry_41
Lslow_44:
    s_mov_b64 exec, 1
    buffer_store_byte v5, off, s[4:7], s21 offset:2048 sc1
    s_mov_b64 exec, -1
    s_nop 0
    s_branch Lback_45
Lretry_46:
    s_sub_u32 s13, s13, 1
    s_cmp_lt_i32 s13, 0
    s_nop 1
    s_cbranch_scc1 Lback_47
    buffer_load_dwordx2 v[14:15], off, s[4:7], s22 offset:2048 sc1
    s_waitcnt vmcnt(0)
    v_and_b32 v14, v14, v15
    s_nop 0
    v_readfirstlane_b32 s60, v14
    s_nop 0
    s_cmp_eq_u32 s60, 0x01010101
    s_nop 1
    s_cbranch_scc1 Lback_47
    s_branch Lretry_46
Lslow_52:
    buffer_store_dwordx4 v[76:79], v1, s[4:7], s61 offen sc1
    s_nop 0
    s_branch Lback_53
Lfb_48:
    v_mov_b32 v252, 0xff800000
    s_mov_b32 s68, 4849664
    s_mov_b32 s69, 64
Lp1_50:
    buffer_load_dwordx4 v[240:243], v1, s[4:7], s68 offen sc1
    s_waitcnt vmcnt(0)
    v_mfma_f32_32x32x16_bf16 v[224:239], v[240:243], v[24:27], 0
    s_nop 11
    v_max_f32 v252, v252, v224
    v_max_f32 v252, v252, v225
    v_max_f32 v252, v252, v226
    v_max_f32 v252, v252, v227
    v_max_f32 v252, v252, v228
    v_max_f32 v252, v252, v229
    v_max_f32 v252, v252, v230
    v_max_f32 v252, v252, v231
    v_max_f32 v252, v252, v232
    v_max_f32 v252, v252, v233
    v_max_f32 v252, v252, v234
    v_max_f32 v252, v252, v235
    v_max_f32 v252, v252, v236
    v_max_f32 v252, v252, v237
    v_max_f32 v252, v252, v238
    v_max_f32 v252, v252, v239
    s_add_u32 s68, s68, 2112
    s_sub_u32 s69, s69, 1
    s_cmp_lg_u32 s69, 0
    s_nop 0
    s_cbranch_scc1 Lp1_50
    v_mov_b32 v253, v252
    s_nop 1
    v_permlane32_swap_b32 v252, v253
    v_max_f32 v252, v252, v253
    v_and_b32 v253, 31, v0
    v_min_u32 v253, 16, v253
    v_lshlrev_b32 v253, 4, v253
    v_lshrrev_b32 v254, 5, v0
    v_mul_u32_u24 v254, 272, v254
    v_add_u32 v253, v253, v254
    v_mov_b32 v64, 0
    v_mov_b32 v65, 0
    v_mov_b32 v66, 0
    v_mov_b32 v67, 0
    v_mov_b32 v68, 0
    v_mov_b32 v69, 0
    v_mov_b32 v70, 0
    v_mov_b32 v71, 0
    v_mov_b32 v72, 0
    v_mov_b32 v73, 0
    v_mov_b32 v74, 0
    v_mov_b32 v75, 0
    v_mov_b32 v76, 0
    v_mov_b32 v77, 0
    v_mov_b32 v78, 0
    v_mov_b32 v79, 0
    s_mov_b32 s68, 4849664
    s_mov_b32 s69, 64
Lp2_51:
    buffer_load_dwordx4 v[240:243], v1, s[4:7], s68 offen sc1
    buffer_load_dwordx4 v[244:247], v253, s[4:7], s68 offen offset:1024 sc1
    buffer_load_dwordx4 v[248:251], v253, s[4:7], s68 offen offset:1568 sc1
    s_waitcnt vmcnt(0)
    v_mfma_f32_32x32x16_bf16 v[224:239], v[240:243], v[24:27], 0
    s_nop 11
    v_sub_f32 v224, v224, v252
    v_sub_f32 v225, v225, v252
    v_sub_f32 v226, v226, v252
    v_sub_f32 v227, v227, v252
    v_sub_f32 v228, v228, v252
    v_sub_f32 v229, v229, v252
    v_sub_f32 v230, v230, v252
    v_sub_f32 v231, v231, v252
    v_sub_f32 v232, v232, v252
    v_sub_f32 v233, v233, v252
    v_sub_f32 v234, v234, v252
    v_sub_f32 v235, v235, v252
    v_sub_f32 v236, v236, v252
    v_sub_f32 v237, v237, v252
    v_sub_f32 v238, v238, v252
    v_sub_f32 v239, v239, v252
    v_exp_f32 v224, v224
    v_exp_f32 v225, v225
    v_exp_f32 v226, v226
    v_exp_f32 v227, v227
    v_exp_f32 v228, v228
    v_exp_f32 v229, v229
    v_exp_f32 v230, v230
    v_exp_f32 v231, v231
    v_exp_f32 v232, v232
    v_exp_f32 v233, v233
    v_exp_f32 v234, v234
    v_exp_f32 v235, v235
    v_exp_f32 v236, v236
    v_exp_f32 v237, v237
    v_exp_f32 v238, v238
    v_exp_f32 v239, v239
    v_smfmac_f32_32x32x32_bf16 v[64:79], v[244:247], v[224:231], v124
    s_nop 0
    v_smfmac_f32_32x32x32_bf16 v[64:79], v[248:251], v[232:239], v124
    s_add_u32 s68, s68, 2112
    s_sub_u32 s69, s69, 1
    s_cmp_lg_u32 s69, 0
    s_nop 7
    s_cbranch_scc1 Lp2_51
    v_rcp_f32 v74, v72
    v_subrev_u32 v73, 0x21800000, v72
    v_mul_f32 v64, v74, v64
    v_mul_f32 v65, v74, v65
    v_mul_f32 v66, v74, v66
    v_mul_f32 v67, v74, v67
    v_mul_f32 v68, v74, v68
    v_mul_f32 v69, v74, v69
    v_mul_f32 v70, v74, v70
    v_mul_f32 v71, v74, v71
    s_nop 3
    s_branch Lfbback_49
Lslow_54:
    s_mov_b64 exec, 1
    buffer_store_byte v5, off, s[4:7], s21 offset:0 sc1
    s_mov_b64 exec, -1
    s_nop 3
    s_branch Lback_55
Lgate_56:
    s_waitcnt vmcnt(0)
    s_cmp_eq_u32 s12, 0
    s_cbranch_scc1 Lblkp_60
    buffer_store_byte v5, off, s[4:7], s21 offset:0
    s_branch Lblk_58
Lblkp_60:
    s_mov_b64 exec, 1
    buffer_store_byte v5, off, s[4:7], s21 offset:0 sc1
    s_mov_b64 exec, -1
Lblk_58:
    s_sub_u32 s13, s13, 1
    s_cmp_lt_i32 s13, 0
    s_cbranch_scc1 Lblke_59
    buffer_load_dwordx2 v[14:15], off, s[4:7], s22 offset:0 sc1
    s_waitcnt vmcnt(0)
    v_and_b32 v14, v14, v15
    s_nop 0
    v_readfirstlane_b32 s60, v14
    s_nop 0
    s_cmp_eq_u32 s60, 0x01010101
    s_nop 1
    s_cbranch_scc0 Lblk_58
Lblke_59:
    s_waitcnt vmcnt(0)
    s_branch Lback_57
Lslow_65:
    buffer_store_dwordx4 v[92:95], v1, s[4:7], s61 offen sc1
    s_nop 0
    s_branch Lback_66
Lfb_61:
    v_mov_b32 v60, 0xff800000
    s_mov_b32 s68, 4849664
    s_mov_b32 s69, 64
Lp1_63:
    buffer_load_dwordx4 v[48:51], v1, s[4:7], s68 offen sc1
    s_waitcnt vmcnt(0)
    v_mfma_f32_32x32x16_bf16 v[32:47], v[48:51], v[28:31], 0
    s_nop 11
    v_max_f32 v60, v60, v32
    v_max_f32 v60, v60, v33
    v_max_f32 v60, v60, v34
    v_max_f32 v60, v60, v35
    v_max_f32 v60, v60, v36
    v_max_f32 v60, v60, v37
    v_max_f32 v60, v60, v38
    v_max_f32 v60, v60, v39
    v_max_f32 v60, v60, v40
    v_max_f32 v60, v60, v41
    v_max_f32 v60, v60, v42
    v_max_f32 v60, v60, v43
    v_max_f32 v60, v60, v44
    v_max_f32 v60, v60, v45
    v_max_f32 v60, v60, v46
    v_max_f32 v60, v60, v47
    s_add_u32 s68, s68, 2112
    s_sub_u32 s69, s69, 1
    s_cmp_lg_u32 s69, 0
    s_nop 0
    s_cbranch_scc1 Lp1_63
    v_mov_b32 v61, v60
    s_nop 1
    v_permlane32_swap_b32 v60, v61
    v_max_f32 v60, v60, v61
    v_and_b32 v61, 31, v0
    v_min_u32 v61, 16, v61
    v_lshlrev_b32 v61, 4, v61
    v_lshrrev_b32 v62, 5, v0
    v_mul_u32_u24 v62, 272, v62
    v_add_u32 v61, v61, v62
    v_mov_b32 v80, 0
    v_mov_b32 v81, 0
    v_mov_b32 v82, 0
    v_mov_b32 v83, 0
    v_mov_b32 v84, 0
    v_mov_b32 v85, 0
    v_mov_b32 v86, 0
    v_mov_b32 v87, 0
    v_mov_b32 v88, 0
    v_mov_b32 v89, 0
    v_mov_b32 v90, 0
    v_mov_b32 v91, 0
    v_mov_b32 v92, 0
    v_mov_b32 v93, 0
    v_mov_b32 v94, 0
    v_mov_b32 v95, 0
    s_mov_b32 s68, 4849664
    s_mov_b32 s69, 64
Lp2_64:
    buffer_load_dwordx4 v[48:51], v1, s[4:7], s68 offen sc1
    buffer_load_dwordx4 v[52:55], v61, s[4:7], s68 offen offset:1024 sc1
    buffer_load_dwordx4 v[56:59], v61, s[4:7], s68 offen offset:1568 sc1
    s_waitcnt vmcnt(0)
    v_mfma_f32_32x32x16_bf16 v[32:47], v[48:51], v[28:31], 0
    s_nop 11
    v_sub_f32 v32, v32, v60
    v_sub_f32 v33, v33, v60
    v_sub_f32 v34, v34, v60
    v_sub_f32 v35, v35, v60
    v_sub_f32 v36, v36, v60
    v_sub_f32 v37, v37, v60
    v_sub_f32 v38, v38, v60
    v_sub_f32 v39, v39, v60
    v_sub_f32 v40, v40, v60
    v_sub_f32 v41, v41, v60
    v_sub_f32 v42, v42, v60
    v_sub_f32 v43, v43, v60
    v_sub_f32 v44, v44, v60
    v_sub_f32 v45, v45, v60
    v_sub_f32 v46, v46, v60
    v_sub_f32 v47, v47, v60
    v_exp_f32 v32, v32
    v_exp_f32 v33, v33
    v_exp_f32 v34, v34
    v_exp_f32 v35, v35
    v_exp_f32 v36, v36
    v_exp_f32 v37, v37
    v_exp_f32 v38, v38
    v_exp_f32 v39, v39
    v_exp_f32 v40, v40
    v_exp_f32 v41, v41
    v_exp_f32 v42, v42
    v_exp_f32 v43, v43
    v_exp_f32 v44, v44
    v_exp_f32 v45, v45
    v_exp_f32 v46, v46
    v_exp_f32 v47, v47
    v_smfmac_f32_32x32x32_bf16 v[80:95], v[52:55], v[32:39], v124
    s_nop 0
    v_smfmac_f32_32x32x32_bf16 v[80:95], v[56:59], v[40:47], v124
    s_add_u32 s68, s68, 2112
    s_sub_u32 s69, s69, 1
    s_cmp_lg_u32 s69, 0
    s_nop 7
    s_cbranch_scc1 Lp2_64
    v_rcp_f32 v90, v88
    v_subrev_u32 v89, 0x21800000, v88
    v_mul_f32 v80, v90, v80
    v_mul_f32 v81, v90, v81
    v_mul_f32 v82, v90, v82
    v_mul_f32 v83, v90, v83
    v_mul_f32 v84, v90, v84
    v_mul_f32 v85, v90, v85
    v_mul_f32 v86, v90, v86
    v_mul_f32 v87, v90, v87
    s_nop 3
    s_branch Lfbback_62
Lredo_68:
    s_cmp_eq_u32 s3, 1
    s_nop 5
    s_cbranch_scc1 Lback_69
    s_mov_b32 s3, 1
    s_waitcnt vmcnt(0)
    s_cmp_eq_u32 s12, 0
    s_cbranch_scc1 Lblkp_72
    buffer_store_byte v5, off, s[4:7], s21 offset:0
    s_branch Lblk_70
Lblkp_72:
    s_mov_b64 exec, 1
    buffer_store_byte v5, off, s[4:7], s21 offset:0 sc1
    s_mov_b64 exec, -1
Lblk_70:
    s_sub_u32 s13, s13, 1
    s_cmp_lt_i32 s13, 0
    s_cbranch_scc1 Lblke_71
    buffer_load_dwordx2 v[14:15], off, s[4:7], s22 offset:0 sc1
    s_waitcnt vmcnt(0)
    v_and_b32 v14, v14, v15
    s_nop 0
    v_readfirstlane_b32 s60, v14
    s_nop 0
    s_cmp_eq_u32 s60, 0x01010101
    s_nop 1
    s_cbranch_scc0 Lblk_70
Lblke_71:
    s_add_u32 s64, s38, 4096
    s_addc_u32 s65, s39, 0
    global_load_dwordx4 v[224:227], v1, s[64:65] offset:-4096 sc1
    global_load_dwordx4 v[228:231], v1, s[64:65] offset:-3072 sc1
    global_load_dwordx4 v[232:235], v1, s[64:65] offset:-2048 sc1
    global_load_dwordx4 v[236:239], v1, s[64:65] offset:-1024 sc1
    global_load_dwordx4 v[240:243], v1, s[64:65] offset:0 sc1
    global_load_dwordx4 v[244:247], v1, s[64:65] offset:1024 sc1
    global_load_dwordx4 v[248:251], v1, s[64:65] offset:2048 sc1
    global_load_dwordx4 v[252:255], v1, s[64:65] offset:3072 sc1
    ds_read_b128 v[96:99], v6 offset:8192
    ds_read_b128 v[100:103], v6 offset:9216
    ds_read_b128 v[104:107], v6 offset:10240
    ds_read_b128 v[108:111], v6 offset:11264
    ds_read_b128 v[112:115], v6 offset:12288
    ds_read_b128 v[116:119], v6 offset:13312
    s_waitcnt vmcnt(0) lgkmcnt(0)
    s_branch Lopst_67
Lslow_73:
    s_mov_b64 exec, 1
    buffer_store_byte v5, off, s[4:7], s21 offset:128 sc1
    s_mov_b64 exec, -1
    s_nop 3
    s_branch Lback_74
Lgate_75:
    s_waitcnt vmcnt(0)
    s_cmp_eq_u32 s12, 0
    s_cbranch_scc1 Lblkp_79
    buffer_store_byte v5, off, s[4:7], s21 offset:128
    s_branch Lblk_77
Lblkp_79:
    s_mov_b64 exec, 1
    buffer_store_byte v5, off, s[4:7], s21 offset:128 sc1
    s_mov_b64 exec, -1
Lblk_77:
    s_sub_u32 s13, s13, 1
    s_cmp_lt_i32 s13, 0
    s_cbranch_scc1 Lblke_78
    buffer_load_dwordx2 v[14:15], off, s[4:7], s22 offset:128 sc1
    s_waitcnt vmcnt(0)
    v_and_b32 v14, v14, v15
    s_nop 0
    v_readfirstlane_b32 s60, v14
    s_nop 0
    s_cmp_eq_u32 s60, 0x01010101
    s_nop 1
    s_cbranch_scc0 Lblk_77
Lblke_78:
    s_waitcnt vmcnt(0)
    s_branch Lback_76
Lslow_80:
    buffer_store_dwordx4 v[16:19], v1, s[4:7], s61 offen sc1
    buffer_store_dword v40, v1, s[4:7], s62 offen sc1
    s_branch Lback_81
Lredo_83:
    s_cmp_eq_u32 s3, 2
    s_nop 5
    s_cbranch_scc1 Lback_84
    s_mov_b32 s3, 2
    s_waitcnt vmcnt(0)
    s_cmp_eq_u32 s12, 0
    s_cbranch_scc1 Lblkp_87
    buffer_store_byte v5, off, s[4:7], s21 offset:128
    s_branch Lblk_85
Lblkp_87:
    s_mov_b64 exec, 1
    buffer_store_byte v5, off, s[4:7], s21 offset:128 sc1
    s_mov_b64 exec, -1
Lblk_85:
    s_sub_u32 s13, s13, 1
    s_cmp_lt_i32 s13, 0
    s_cbranch_scc1 Lblke_86
    buffer_load_dwordx2 v[14:15], off, s[4:7], s22 offset:128 sc1
    s_waitcnt vmcnt(0)
    v_and_b32 v14, v14, v15
    s_nop 0
    v_readfirstlane_b32 s60, v14
    s_nop 0
    s_cmp_eq_u32 s60, 0x01010101
    s_nop 1
    s_cbranch_scc0 Lblk_85
Lblke_86:
    s_add_u32 s64, s38, 36864
    s_addc_u32 s65, s39, 0
    global_load_dwordx4 v[224:227], v1, s[64:65] offset:-4096 sc1
    global_load_dwordx4 v[228:231], v1, s[64:65] offset:-3072 sc1
    global_load_dwordx4 v[232:235], v1, s[64:65] offset:-2048 sc1
    global_load_dwordx4 v[236:239], v1, s[64:65] offset:-1024 sc1
    global_load_dwordx4 v[240:243], v1, s[64:65] offset:0 sc1
    global_load_dwordx4 v[244:247], v1, s[64:65] offset:1024 sc1
    global_load_dwordx4 v[248:251], v1, s[64:65] offset:2048 sc1
    global_load_dwordx4 v[252:255], v1, s[64:65] offset:3072 sc1
    ds_read_b128 v[96:99], v6 offset:8192
    ds_read_b128 v[100:103], v6 offset:9216
    ds_read_b128 v[104:107], v6 offset:10240
    ds_read_b128 v[108:111], v6 offset:11264
    ds_read_b128 v[112:115], v6 offset:12288
    ds_read_b128 v[116:119], v6 offset:13312
    s_waitcnt vmcnt(0) lgkmcnt(0)
    s_branch Lopst_82
Lgate_88:
    s_waitcnt vmcnt(0)
    s_cmp_eq_u32 s12, 0
    s_cbranch_scc1 Lblkp_92
    buffer_store_byte v5, off, s[4:7], s21 offset:256
    s_branch Lblk_90
Lblkp_92:
    s_mov_b64 exec, 1
    buffer_store_byte v5, off, s[4:7], s21 offset:256 sc1
    s_mov_b64 exec, -1
Lblk_90:
    s_sub_u32 s13, s13, 1
    s_cmp_lt_i32 s13, 0
    s_cbranch_scc1 Lblke_91
    buffer_load_dwordx2 v[14:15], off, s[4:7], s22 offset:256 sc1
    s_waitcnt vmcnt(0)
    v_and_b32 v14, v14, v15
    s_nop 0
    v_readfirstlane_b32 s60, v14
    s_nop 0
    s_cmp_eq_u32 s60, 0x01010101
    s_nop 1
    s_cbranch_scc0 Lblk_90
Lblke_91:
    s_waitcnt vmcnt(0)
    s_branch Lback_89
Lslow_93:
    s_mov_b64 exec, 1
    buffer_store_byte v5, off, s[4:7], s21 offset:256 sc1
    s_mov_b64 exec, -1
    s_nop 0
    s_branch Lback_94
Lslow_95:
    buffer_store_dwordx4 v[20:23], v1, s[4:7], s61 offen sc1
    buffer_store_dword v72, v1, s[4:7], s62 offen sc1
    s_branch Lback_96
Lredo_98:
    s_cmp_eq_u32 s3, 3
    s_cbranch_scc1 Lback_99
    s_mov_b32 s3, 3
    s_waitcnt vmcnt(0)
    s_cmp_eq_u32 s12, 0
    s_cbranch_scc1 Lblkp_102
    buffer_store_byte v5, off, s[4:7], s21 offset:256
    s_branch Lblk_100
Lblkp_102:
    s_mov_b64 exec, 1
    buffer_store_byte v5, off, s[4:7], s21 offset:256 sc1
    s_mov_b64 exec, -1
Lblk_100:
    s_sub_u32 s13, s13, 1
    s_cmp_lt_i32 s13, 0
    s_cbranch_scc1 Lblke_101
    buffer_load_dwordx2 v[14:15], off, s[4:7], s22 offset:256 sc1
    s_waitcnt vmcnt(0)
    v_and_b32 v14, v14, v15
    s_nop 0
    v_readfirstlane_b32 s60, v14
    s_nop 0
    s_cmp_eq_u32 s60, 0x01010101
    s_nop 1
    s_cbranch_scc0 Lblk_100
Lblke_101:
    s_add_u32 s66, s40, 430080
    s_addc_u32 s67, s41, 0
    global_load_dwordx4 v[24:27], v1, s[66:67] offset:-4096 sc1
    global_load_dwordx4 v[28:31], v1, s[66:67] offset:-3072 sc1
    s_add_u32 m0, s19, 0
    s_add_u32 s66, s38, 65536
    s_addc_u32 s67, s39, 0
    global_load_lds_dwordx4 v1, s[66:67] offset:0 sc1
    global_load_lds_dwordx4 v1, s[66:67] offset:1024 sc1
    global_load_lds_dwordx4 v1, s[66:67] offset:2048 sc1
    global_load_lds_dwordx4 v1, s[66:67] offset:3072 sc1
    s_add_u32 m0, s19, 4096
    s_add_u32 s66, s38, 69632
    s_addc_u32 s67, s39, 0
    global_load_lds_dwordx4 v1, s[66:67] offset:0 sc1
    global_load_lds_dwordx4 v1, s[66:67] offset:1024 sc1
    global_load_lds_dwordx4 v1, s[66:67] offset:2048 sc1
    global_load_lds_dwordx4 v1, s[66:67] offset:3072 sc1
    s_waitcnt vmcnt(0) lgkmcnt(0)
    s_branch Lf1sy_97
Lredo_104:
    s_cmp_eq_u32 s3, 20
    s_nop 6
    s_cbranch_scc1 Lback_105
    s_mov_b32 s3, 20
    s_waitcnt vmcnt(0)
    s_cmp_eq_u32 s12, 0
    s_cbranch_scc1 Lblkp_108
    buffer_store_byte v5, off, s[4:7], s21 offset:256
    s_branch Lblk_106
Lblkp_108:
    s_mov_b64 exec, 1
    buffer_store_byte v5, off, s[4:7], s21 offset:256 sc1
    s_mov_b64 exec, -1
Lblk_106:
    s_sub_u32 s13, s13, 1
    s_cmp_lt_i32 s13, 0
    s_cbranch_scc1 Lblke_107
    s_and_b32 s60, s22, 0xffffffe0
    v_and_b32 v15, 28, v3
    buffer_load_dword v14, v15, s[4:7], s60 offen offset:256 sc1
    s_waitcnt vmcnt(0)
    v_cmp_ne_u32 vcc, 0x01010101, v14
    s_nop 4
    s_cbranch_vccnz Lblk_106
Lblke_107:
    s_sub_u32 s68, s38, s19
    s_subb_u32 s69, s39, 0
    s_mov_b32 s61, 0
    s_add_u32 m0, s61, 0
    s_add_u32 s66, s68, 65536
    s_addc_u32 s67, s69, 0
    global_load_lds_dwordx4 v1, s[66:67] offset:0 sc1
    global_load_lds_dwordx4 v1, s[66:67] offset:1024 sc1
    global_load_lds_dwordx4 v1, s[66:67] offset:2048 sc1
    global_load_lds_dwordx4 v1, s[66:67] offset:3072 sc1
    s_add_u32 m0, s61, 4096
    s_add_u32 s66, s68, 69632
    s_addc_u32 s67, s69, 0
    global_load_lds_dwordx4 v1, s[66:67] offset:0 sc1
    global_load_lds_dwordx4 v1, s[66:67] offset:1024 sc1
    global_load_lds_dwordx4 v1, s[66:67] offset:2048 sc1
    global_load_lds_dwordx4 v1, s[66:67] offset:3072 sc1
    s_add_u32 m0, s61, 8192
    s_add_u32 s66, s68, 73728
    s_addc_u32 s67, s69, 0
    global_load_lds_dwordx4 v1, s[66:67] offset:0 sc1
    global_load_lds_dwordx4 v1, s[66:67] offset:1024 sc1
    global_load_lds_dwordx4 v1, s[66:67] offset:2048 sc1
    global_load_lds_dwordx4 v1, s[66:67] offset:3072 sc1
    s_add_u32 m0, s61, 12288
    s_add_u32 s66, s68, 77824
    s_addc_u32 s67, s69, 0
    global_load_lds_dwordx4 v1, s[66:67] offset:0 sc1
    global_load_lds_dwordx4 v1, s[66:67] offset:1024 sc1
    global_load_lds_dwordx4 v1, s[66:67] offset:2048 sc1
    global_load_lds_dwordx4 v1, s[66:67] offset:3072 sc1
    s_add_u32 m0, s61, 16384
    s_add_u32 s66, s68, 81920
    s_addc_u32 s67, s69, 0
    global_load_lds_dwordx4 v1, s[66:67] offset:0 sc1
    global_load_lds_dwordx4 v1, s[66:67] offset:1024 sc1
    global_load_lds_dwordx4 v1, s[66:67] offset:2048 sc1
    global_load_lds_dwordx4 v1, s[66:67] offset:3072 sc1
    s_add_u32 m0, s61, 20480
    s_add_u32 s66, s68, 86016
    s_addc_u32 s67, s69, 0
    global_load_lds_dwordx4 v1, s[66:67] offset:0 sc1
    global_load_lds_dwordx4 v1, s[66:67] offset:1024 sc1
    global_load_lds_dwordx4 v1, s[66:67] offset:2048 sc1
    global_load_lds_dwordx4 v1, s[66:67] offset:3072 sc1
    s_add_u32 m0, s61, 24576
    s_add_u32 s66, s68, 90112
    s_addc_u32 s67, s69, 0
    global_load_lds_dwordx4 v1, s[66:67] offset:0 sc1
    global_load_lds_dwordx4 v1, s[66:67] offset:1024 sc1
    global_load_lds_dwordx4 v1, s[66:67] offset:2048 sc1
    global_load_lds_dwordx4 v1, s[66:67] offset:3072 sc1
    s_add_u32 m0, s61, 28672
    s_add_u32 s66, s68, 94208
    s_addc_u32 s67, s69, 0
    global_load_lds_dwordx4 v1, s[66:67] offset:0 sc1
    global_load_lds_dwordx4 v1, s[66:67] offset:1024 sc1
    global_load_lds_dwordx4 v1, s[66:67] offset:2048 sc1
    global_load_lds_dwordx4 v1, s[66:67] offset:3072 sc1
    s_waitcnt vmcnt(0) lgkmcnt(0)
    s_branch Lf1st_103
Lslow_109:
    s_mov_b64 exec, 1
    buffer_store_byte v5, off, s[4:7], s21 offset:384 sc1
    s_mov_b64 exec, -1
    s_branch Lback_110
Lretry_111:
    s_sub_u32 s13, s13, 1
    s_cmp_lt_i32 s13, 0
    s_cbranch_scc1 Lback_112
    buffer_load_dwordx2 v[14:15], off, s[4:7], s22 offset:384 sc1
    s_waitcnt vmcnt(0)
    v_and_b32 v14, v14, v15
    s_nop 0
    v_readfirstlane_b32 s60, v14
    s_nop 0
    s_cmp_eq_u32 s60, 0x01010101
    s_nop 1
    s_cbranch_scc1 Lback_112
    s_branch Lretry_111
Lslow_113:
    buffer_store_dwordx4 v[32:35], v1, s[4:7], s61 offen sc1
    s_nop 4
    s_branch Lback_114
Lslow_115:
    buffer_store_dwordx4 v[40:43], v1, s[4:7], s61 offen sc1
    s_nop 4
    s_branch Lback_116
Lslow_118:
    buffer_store_dwordx4 v[48:51], v52, s[4:7], s61 offen sc1
    s_nop 3
    s_branch Lback_119
Lslow_120:
    buffer_store_dwordx4 v[56:59], v60, s[4:7], s61 offen sc1
    s_nop 3
    s_branch Lback_121
Lslow_122:
    buffer_store_dwordx4 v[64:67], v1, s[4:7], s61 offen sc1
    s_nop 4
    s_branch Lback_123
Lslow_124:
    buffer_store_dwordx4 v[72:75], v1, s[4:7], s61 offen sc1
    s_nop 4
    s_branch Lback_125
Lgate_126:
    s_waitcnt vmcnt(0)
    s_cmp_eq_u32 s12, 0
    s_cbranch_scc1 Lblkp_130
    buffer_store_byte v5, off, s[4:7], s21 offset:512
    s_branch Lblk_128
Lblkp_130:
    s_mov_b64 exec, 1
    buffer_store_byte v5, off, s[4:7], s21 offset:512 sc1
    s_mov_b64 exec, -1
Lblk_128:
    s_sub_u32 s13, s13, 1
    s_cmp_lt_i32 s13, 0
    s_cbranch_scc1 Lblke_129
    buffer_load_dwordx2 v[14:15], off, s[4:7], s22 offset:512 sc1
    s_waitcnt vmcnt(0)
    v_and_b32 v14, v14, v15
    s_nop 0
    v_readfirstlane_b32 s60, v14
    s_nop 0
    s_cmp_eq_u32 s60, 0x01010101
    s_nop 1
    s_cbranch_scc0 Lblk_128
Lblke_129:
    s_waitcnt vmcnt(0)
    s_branch Lback_127
Lslow_132:
    buffer_store_dwordx4 v[80:83], v84, s[4:7], s61 offen sc1
    s_nop 4
    s_branch Lback_133
Lslow_134:
    buffer_store_dwordx4 v[88:91], v92, s[4:7], s61 offen sc1
    s_nop 5
    s_branch Lback_135
Lslow_136:
    s_mov_b64 exec, 1
    buffer_store_byte v5, off, s[4:7], s21 offset:512 sc1
    s_mov_b64 exec, -1
    s_nop 5
    s_branch Lback_137
Lgate_138:
    s_waitcnt vmcnt(0)
    s_cmp_eq_u32 s12, 0
    s_cbranch_scc1 Lblkp_142
    buffer_store_byte v5, off, s[4:7], s21 offset:640
    s_branch Lblk_140
Lblkp_142:
    s_mov_b64 exec, 1
    buffer_store_byte v5, off, s[4:7], s21 offset:640 sc1
    s_mov_b64 exec, -1
Lblk_140:
    s_sub_u32 s13, s13, 1
    s_cmp_lt_i32 s13, 0
    s_cbranch_scc1 Lblke_141
    buffer_load_dwordx2 v[14:15], off, s[4:7], s22 offset:640 sc1
    s_waitcnt vmcnt(0)
    v_and_b32 v14, v14, v15
    s_nop 0
    v_readfirstlane_b32 s60, v14
    s_nop 0
    s_cmp_eq_u32 s60, 0x01010101
    s_nop 1
    s_cbranch_scc0 Lblk_140
Lblke_141:
    s_add_u32 s66, s42, 118784
    s_addc_u32 s67, s43, 0
    global_load_dwordx4 a[144:147], v1, s[66:67] offset:-4096 sc1
    global_load_dwordx4 a[148:151], v1, s[66:67] offset:-3072 sc1
    global_load_dwordx4 a[152:155], v1, s[66:67] offset:0 sc1
    global_load_dwordx4 a[156:159], v1, s[66:67] offset:1024 sc1
    s_add_u32 s66, s42, 126976
    s_addc_u32 s67, s43, 0
    global_load_dwordx4 a[96:99], v1, s[66:67] offset:-4096 sc1
    global_load_dwordx4 a[100:103], v1, s[66:67] offset:-3072 sc1
    global_load_dwordx4 a[104:107], v1, s[66:67] offset:0 sc1
    global_load_dwordx4 a[108:111], v1, s[66:67] offset:1024 sc1
    global_load_dwordx4 a[112:115], v1, s[66:67] offset:2048 sc1
    global_load_dwordx4 a[116:119], v1, s[66:67] offset:3072 sc1
    s_waitcnt vmcnt(0)
    s_branch Lback_139
Lredo_143:
    s_cmp_eq_u32 s3, 5
    s_nop 4
    s_cbranch_scc1 Lback_144
    s_mov_b32 s3, 5
    s_waitcnt vmcnt(0)
    s_cmp_eq_u32 s12, 0
    s_cbranch_scc1 Lblkp_147
    buffer_store_byte v5, off, s[4:7], s21 offset:512
    s_branch Lblk_145
Lblkp_147:
    s_mov_b64 exec, 1
    buffer_store_byte v5, off, s[4:7], s21 offset:512 sc1
    s_mov_b64 exec, -1
Lblk_145:
    s_sub_u32 s13, s13, 1
    s_cmp_lt_i32 s13, 0
    s_cbranch_scc1 Lblke_146
    buffer_load_dwordx2 v[14:15], off, s[4:7], s22 offset:512 sc1
    s_waitcnt vmcnt(0)
    v_and_b32 v14, v14, v15
    s_nop 0
    v_readfirstlane_b32 s60, v14
    s_nop 0
    s_cmp_eq_u32 s60, 0x01010101
    s_nop 1
    s_cbranch_scc0 Lblk_145
Lblke_146:
    s_add_u32 s66, s42, 4096
    s_addc_u32 s67, s43, 0
    global_load_dwordx4 a[96:99], v1, s[66:67] offset:-4096 sc1
    global_load_dwordx4 a[100:103], v1, s[66:67] offset:-3072 sc1
    global_load_dwordx4 a[104:107], v1, s[66:67] offset:0 sc1
    global_load_dwordx4 a[108:111], v1, s[66:67] offset:1024 sc1
    s_add_u32 s66, s42, 12288
    s_addc_u32 s67, s43, 0
    global_load_dwordx4 a[112:115], v1, s[66:67] offset:-4096 sc1
    global_load_dwordx4 a[116:119], v1, s[66:67] offset:-3072 sc1
    global_load_dwordx4 a[120:123], v1, s[66:67] offset:0 sc1
    global_load_dwordx4 a[124:127], v1, s[66:67] offset:1024 sc1
    global_load_dwordx4 a[128:131], v1, s[66:67] offset:2048 sc1
    global_load_dwordx4 a[132:135], v1, s[66:67] offset:3072 sc1
    s_add_u32 s66, s42, 22528
    s_addc_u32 s67, s43, 0
    global_load_dwordx4 a[136:139], v1, s[66:67] offset:-4096 sc1
    global_load_dwordx4 a[140:143], v1, s[66:67] offset:-3072 sc1
    s_add_u32 s66, s42, 26624
    s_addc_u32 s67, s43, 0
    global_load_dwordx4 a[144:147], v1, s[66:67] offset:-4096 sc1
    global_load_dwordx4 a[148:151], v1, s[66:67] offset:-3072 sc1
    global_load_dwordx4 a[152:155], v1, s[66:67] offset:0 sc1
    global_load_dwordx4 a[156:159], v1, s[66:67] offset:1024 sc1
    s_waitcnt vmcnt(0)
    v_mfma_f32_32x32x16_bf16 v[48:63], v[132:135], a[96:99], 0
    v_mfma_f32_32x32x16_bf16 v[32:47], v[128:131], a[96:99], 0
    v_mfma_f32_32x32x16_bf16 v[48:63], v[140:143], a[100:103], v[48:63]
    v_mfma_f32_32x32x16_bf16 v[32:47], v[136:139], a[100:103], v[32:47]
    v_mfma_f32_32x32x16_bf16 v[48:63], v[148:151], a[104:107], v[48:63]
    v_mfma_f32_32x32x16_bf16 v[32:47], v[144:147], a[104:107], v[32:47]
    v_mfma_f32_32x32x16_bf16 v[48:63], v[156:159], a[108:111], v[48:63]
    v_mfma_f32_32x32x16_bf16 v[32:47], v[152:155], a[108:111], v[32:47]
    v_mfma_f32_32x32x16_bf16 v[48:63], v[164:167], a[112:115], v[48:63]
    v_mfma_f32_32x32x16_bf16 v[32:47], v[160:163], a[112:115], v[32:47]
    v_mfma_f32_32x32x16_bf16 v[48:63], v[172:175], a[116:119], v[48:63]
    v_mfma_f32_32x32x16_bf16 v[32:47], v[168:171], a[116:119], v[32:47]
    v_mfma_f32_32x32x16_bf16 v[48:63], v[180:183], a[120:123], v[48:63]
    v_mfma_f32_32x32x16_bf16 v[32:47], v[176:179], a[120:123], v[32:47]
    v_mfma_f32_32x32x16_bf16 v[48:63], v[188:191], a[124:127], v[48:63]
    v_mfma_f32_32x32x16_bf16 v[32:47], v[184:187], a[124:127], v[32:47]
    v_mfma_f32_32x32x16_bf16 v[48:63], v[196:199], a[128:131], v[48:63]
    v_mfma_f32_32x32x16_bf16 v[32:47], v[192:195], a[128:131], v[32:47]
    v_mfma_f32_32x32x16_bf16 v[48:63], v[204:207], a[132:135], v[48:63]
    v_mfma_f32_32x32x16_bf16 v[32:47], v[200:203], a[132:135], v[32:47]
    v_mfma_f32_32x32x16_bf16 v[48:63], v[212:215], a[136:139], v[48:63]
    v_mfma_f32_32x32x16_bf16 v[32:47], v[208:211], a[136:139], v[32:47]
    v_mfma_f32_32x32x16_bf16 v[48:63], v[220:223], a[140:143], v[48:63]
    v_mfma_f32_32x32x16_bf16 v[32:47], v[216:219], a[140:143], v[32:47]
    v_mfma_f32_32x32x16_bf16 v[48:63], v[228:231], a[144:147], v[48:63]
    v_mfma_f32_32x32x16_bf16 v[32:47], v[224:227], a[144:147], v[32:47]
    v_mfma_f32_32x32x16_bf16 v[48:63], v[236:239], a[148:151], v[48:63]
    v_mfma_f32_32x32x16_bf16 v[32:47], v[232:235], a[148:151], v[32:47]
    v_mfma_f32_32x32x16_bf16 v[48:63], v[244:247], a[152:155], v[48:63]
    v_mfma_f32_32x32x16_bf16 v[32:47], v[240:243], a[152:155], v[32:47]
    v_mfma_f32_32x32x16_bf16 v[48:63], v[252:255], a[156:159], v[48:63]
    v_mfma_f32_32x32x16_bf16 v[32:47], v[248:251], a[156:159], v[32:47]
    s_add_u32 s66, s42, 6144
    s_addc_u32 s67, s43, 0
    global_load_dwordx4 a[96:99], v1, s[66:67] offset:-4096 sc1
    global_load_dwordx4 a[100:103], v1, s[66:67] offset:-3072 sc1
    global_load_dwordx4 a[104:107], v1, s[66:67] offset:0 sc1
    global_load_dwordx4 a[108:111], v1, s[66:67] offset:1024 sc1
    s_add_u32 s66, s42, 14336
    s_addc_u32 s67, s43, 0
    global_load_dwordx4 a[112:115], v1, s[66:67] offset:-4096 sc1
    global_load_dwordx4 a[116:119], v1, s[66:67] offset:-3072 sc1
    global_load_dwordx4 a[120:123], v1, s[66:67] offset:2048 sc1
    global_load_dwordx4 a[124:127], v1, s[66:67] offset:3072 sc1
    s_add_u32 s66, s42, 24576
    s_addc_u32 s67, s43, 0
    global_load_dwordx4 a[128:131], v1, s[66:67] offset:-4096 sc1
    global_load_dwordx4 a[132:135], v1, s[66:67] offset:-3072 sc1
    global_load_dwordx4 a[136:139], v1, s[66:67] offset:0 sc1
    global_load_dwordx4 a[140:143], v1, s[66:67] offset:1024 sc1
    s_waitcnt vmcnt(0)
    v_mfma_f32_32x32x16_bf16 v[48:63], a[4:7], a[96:99], v[48:63]
    v_mfma_f32_32x32x16_bf16 v[32:47], a[0:3], a[96:99], v[32:47]
    v_mfma_f32_32x32x16_bf16 v[48:63], a[12:15], a[100:103], v[48:63]
    v_mfma_f32_32x32x16_bf16 v[32:47], a[8:11], a[100:103], v[32:47]
    v_mfma_f32_32x32x16_bf16 v[48:63], a[20:23], a[104:107], v[48:63]
    v_mfma_f32_32x32x16_bf16 v[32:47], a[16:19], a[104:107], v[32:47]
    v_mfma_f32_32x32x16_bf16 v[48:63], a[28:31], a[108:111], v[48:63]
    v_mfma_f32_32x32x16_bf16 v[32:47], a[24:27], a[108:111], v[32:47]
    v_mfma_f32_32x32x16_bf16 v[48:63], a[36:39], a[112:115], v[48:63]
    v_mfma_f32_32x32x16_bf16 v[32:47], a[32:35], a[112:115], v[32:47]
    v_mfma_f32_32x32x16_bf16 v[48:63], a[44:47], a[116:119], v[48:63]
    v_mfma_f32_32x32x16_bf16 v[32:47], a[40:43], a[116:119], v[32:47]
    v_mfma_f32_32x32x16_bf16 v[48:63], a[52:55], a[120:123], v[48:63]
    v_mfma_f32_32x32x16_bf16 v[48:63], a[60:63], a[124:127], v[48:63]
    v_mfma_f32_32x32x16_bf16 v[48:63], a[68:71], a[128:131], v[48:63]
    v_mfma_f32_32x32x16_bf16 v[48:63], a[76:79], a[132:135], v[48:63]
    v_mfma_f32_32x32x16_bf16 v[48:63], a[84:87], a[136:139], v[48:63]
    v_mfma_f32_32x32x16_bf16 v[48:63], a[92:95], a[140:143], v[48:63]
    v_mfma_f32_32x32x16_bf16 v[32:47], a[48:51], a[120:123], v[32:47]
    v_mfma_f32_32x32x16_bf16 v[32:47], a[56:59], a[124:127], v[32:47]
    v_mfma_f32_32x32x16_bf16 v[32:47], a[64:67], a[128:131], v[32:47]
    v_mfma_f32_32x32x16_bf16 v[32:47], a[72:75], a[132:135], v[32:47]
    s_add_u32 s66, s42, 118784
    s_addc_u32 s67, s43, 0
    global_load_dwordx4 a[144:147], v1, s[66:67] offset:-4096 sc1
    global_load_dwordx4 a[148:151], v1, s[66:67] offset:-3072 sc1
    global_load_dwordx4 a[152:155], v1, s[66:67] offset:0 sc1
    global_load_dwordx4 a[156:159], v1, s[66:67] offset:1024 sc1
    s_add_u32 s66, s42, 126976
    s_addc_u32 s67, s43, 0
    global_load_dwordx4 a[96:99], v1, s[66:67] offset:-4096 sc1
    global_load_dwordx4 a[100:103], v1, s[66:67] offset:-3072 sc1
    global_load_dwordx4 a[104:107], v1, s[66:67] offset:0 sc1
    global_load_dwordx4 a[108:111], v1, s[66:67] offset:1024 sc1
    global_load_dwordx4 a[112:115], v1, s[66:67] offset:2048 sc1
    global_load_dwordx4 a[116:119], v1, s[66:67] offset:3072 sc1
    s_waitcnt vmcnt(0) lgkmcnt(0)
    s_branch Lf2st_131
Lslow_148:
    buffer_store_dwordx4 v[16:19], v1, s[4:7], s61 offen sc1
    buffer_store_dword v40, v1, s[4:7], s62 offen sc1
    s_branch Lback_149
Lslow_151:
    s_mov_b64 exec, 1
    buffer_store_byte v5, off, s[4:7], s21 offset:640 sc1
    s_mov_b64 exec, -1
    s_nop 4
    s_branch Lback_152
Lgate_154:
    s_waitcnt vmcnt(0)
    s_cmp_eq_u32 s12, 0
    s_cbranch_scc1 Lblkp_158
    buffer_store_byte v5, off, s[4:7], s21 offset:768
    s_branch Lblk_156
Lblkp_158:
    s_mov_b64 exec, 1
    buffer_store_byte v5, off, s[4:7], s21 offset:768 sc1
    s_mov_b64 exec, -1
Lblk_156:
    s_sub_u32 s13, s13, 1
    s_cmp_lt_i32 s13, 0
    s_cbranch_scc1 Lblke_157
    buffer_load_dwordx2 v[14:15], off, s[4:7], s22 offset:768 sc1
    s_waitcnt vmcnt(0)
    v_and_b32 v14, v14, v15
    s_nop 0
    v_readfirstlane_b32 s60, v14
    s_nop 0
    s_cmp_eq_u32 s60, 0x01010101
    s_nop 1
    s_cbranch_scc0 Lblk_156
Lblke_157:
    s_waitcnt vmcnt(0)
    s_branch Lback_155
Lslow_159:
    s_mov_b64 exec, 1
    buffer_store_byte v5, off, s[4:7], s21 offset:768 sc1
    s_mov_b64 exec, -1
    s_nop 4
    s_branch Lback_160
Lredo_161:
    s_cmp_eq_u32 s3, 6
    s_nop 4
    s_cbranch_scc1 Lback_162
    s_mov_b32 s3, 6
    s_waitcnt vmcnt(0)
    s_cmp_eq_u32 s12, 0
    s_cbranch_scc1 Lblkp_165
    buffer_store_byte v5, off, s[4:7], s21 offset:640
    s_branch Lblk_163
Lblkp_165:
    s_mov_b64 exec, 1
    buffer_store_byte v5, off, s[4:7], s21 offset:640 sc1
    s_mov_b64 exec, -1
Lblk_163:
    s_sub_u32 s13, s13, 1
    s_cmp_lt_i32 s13, 0
    s_cbranch_scc1 Lblke_164
    buffer_load_dwordx2 v[14:15], off, s[4:7], s22 offset:640 sc1
    s_waitcnt vmcnt(0)
    v_and_b32 v14, v14, v15
    s_nop 0
    v_readfirstlane_b32 s60, v14
    s_nop 0
    s_cmp_eq_u32 s60, 0x01010101
    s_nop 1
    s_cbranch_scc0 Lblk_163
Lblke_164:
    s_add_u32 s66, s42, 118784
    s_addc_u32 s67, s43, 0
    global_load_dwordx4 a[144:147], v1, s[66:67] offset:-4096 sc1
    global_load_dwordx4 a[148:151], v1, s[66:67] offset:-3072 sc1
    global_load_dwordx4 a[152:155], v1, s[66:67] offset:0 sc1
    global_load_dwordx4 a[156:159], v1, s[66:67] offset:1024 sc1
    s_add_u32 s66, s42, 126976
    s_addc_u32 s67, s43, 0
    global_load_dwordx4 a[96:99], v1, s[66:67] offset:-4096 sc1
    global_load_dwordx4 a[100:103], v1, s[66:67] offset:-3072 sc1
    global_load_dwordx4 a[104:107], v1, s[66:67] offset:0 sc1
    global_load_dwordx4 a[108:111], v1, s[66:67] offset:1024 sc1
    global_load_dwordx4 a[112:115], v1, s[66:67] offset:2048 sc1
    global_load_dwordx4 a[116:119], v1, s[66:67] offset:3072 sc1
    s_add_u32 s66, s42, 137216
    s_addc_u32 s67, s43, 0
    global_load_dwordx4 a[120:123], v1, s[66:67] offset:-4096 sc1
    global_load_dwordx4 a[124:127], v1, s[66:67] offset:-3072 sc1
    s_add_u32 s66, s42, 141312
    s_addc_u32 s67, s43, 0
    global_load_dwordx4 a[128:131], v1, s[66:67] offset:-4096 sc1
    global_load_dwordx4 a[132:135], v1, s[66:67] offset:-3072 sc1
    global_load_dwordx4 a[136:139], v1, s[66:67] offset:0 sc1
    global_load_dwordx4 a[140:143], v1, s[66:67] offset:1024 sc1
    s_waitcnt vmcnt(0) lgkmcnt(0)
    s_branch Lf2st_150
Lslow_166:
    buffer_store_dwordx4 v[20:23], v1, s[4:7], s61 offen sc1
    buffer_store_dword v72, v1, s[4:7], s62 offen sc1
    s_branch Lback_167
Lredo_169:
    s_cmp_eq_u32 s3, 7
    s_nop 1
    s_cbranch_scc1 Lback_170
    s_mov_b32 s3, 7
    s_waitcnt vmcnt(0)
    s_cmp_eq_u32 s12, 0
    s_cbranch_scc1 Lblkp_173
    buffer_store_byte v5, off, s[4:7], s21 offset:768
    s_branch Lblk_171
Lblkp_173:
    s_mov_b64 exec, 1
    buffer_store_byte v5, off, s[4:7], s21 offset:768 sc1
    s_mov_b64 exec, -1
Lblk_171:
    s_sub_u32 s13, s13, 1
    s_cmp_lt_i32 s13, 0
    s_cbranch_scc1 Lblke_172
    buffer_load_dwordx2 v[14:15], off, s[4:7], s22 offset:768 sc1
    s_waitcnt vmcnt(0)
    v_and_b32 v14, v14, v15
    s_nop 0
    v_readfirstlane_b32 s60, v14
    s_nop 0
    s_cmp_eq_u32 s60, 0x01010101
    s_nop 1
    s_cbranch_scc0 Lblk_171
Lblke_172:
    s_add_u32 s64, s40, 446464
    s_addc_u32 s65, s41, 0
    global_load_dwordx4 v[24:27], v1, s[64:65] offset:-4096 sc1
    global_load_dwordx4 v[28:31], v1, s[64:65] offset:-3072 sc1
    s_add_u32 s64, s38, 135168
    s_addc_u32 s65, s39, 0
    global_load_dwordx4 v[32:35], v1, s[64:65] offset:-4096 sc1
    global_load_dwordx4 v[36:39], v1, s[64:65] offset:-3072 sc1
    global_load_dwordx4 v[40:43], v1, s[64:65] offset:-2048 sc1
    global_load_dwordx4 v[44:47], v1, s[64:65] offset:-1024 sc1
    global_load_dwordx4 v[48:51], v1, s[64:65] offset:0 sc1
    global_load_dwordx4 v[52:55], v1, s[64:65] offset:1024 sc1
    global_load_dwordx4 v[56:59], v1, s[64:65] offset:2048 sc1
    global_load_dwordx4 v[60:63], v1, s[64:65] offset:3072 sc1
    s_waitcnt vmcnt(0) lgkmcnt(0)
    s_branch Lqst_168
Lredo_177:
    s_cmp_eq_u32 s3, 7
    s_cbranch_scc1 Lback_178
    s_mov_b32 s3, 7
    s_waitcnt vmcnt(0)
    s_cmp_eq_u32 s12, 0
    s_cbranch_scc1 Lblkp_181
    buffer_store_byte v5, off, s[4:7], s21 offset:768
    s_branch Lblk_179
Lblkp_181:
    s_mov_b64 exec, 1
    buffer_store_byte v5, off, s[4:7], s21 offset:768 sc1
    s_mov_b64 exec, -1
Lblk_179:
    s_sub_u32 s13, s13, 1
    s_cmp_lt_i32 s13, 0
    s_cbranch_scc1 Lblke_180
    buffer_load_dwordx2 v[14:15], off, s[4:7], s22 offset:768 sc1
    s_waitcnt vmcnt(0)
    v_and_b32 v14, v14, v15
    s_nop 0
    v_readfirstlane_b32 s60, v14
    s_nop 0
    s_cmp_eq_u32 s60, 0x01010101
    s_nop 1
    s_cbranch_scc0 Lblk_179
Lblke_180:
    s_add_u32 s64, s40, 446464
    s_addc_u32 s65, s41, 0
    global_load_dwordx4 v[24:27], v1, s[64:65] offset:-4096 sc1
    global_load_dwordx4 v[28:31], v1, s[64:65] offset:-3072 sc1
    s_add_u32 s64, s38, 135168
    s_addc_u32 s65, s39, 0
    global_load_dwordx4 v[32:35], v1, s[64:65] offset:-4096 sc1
    global_load_dwordx4 v[36:39], v1, s[64:65] offset:-3072 sc1
    global_load_dwordx4 v[40:43], v1, s[64:65] offset:-2048 sc1
    global_load_dwordx4 v[44:47], v1, s[64:65] offset:-1024 sc1
    global_load_dwordx4 v[48:51], v1, s[64:65] offset:0 sc1
    global_load_dwordx4 v[52:55], v1, s[64:65] offset:1024 sc1
    global_load_dwordx4 v[56:59], v1, s[64:65] offset:2048 sc1
    global_load_dwordx4 v[60:63], v1, s[64:65] offset:3072 sc1
    s_waitcnt vmcnt(0) lgkmcnt(0)
    s_branch Lqst_168
Lredo_183:
    s_cmp_eq_u32 s3, 7
    s_nop 4
    s_cbranch_scc1 Lback_184
    s_mov_b32 s3, 7
    s_waitcnt vmcnt(0)
    s_cmp_eq_u32 s12, 0
    s_cbranch_scc1 Lblkp_187
    buffer_store_byte v5, off, s[4:7], s21 offset:768
    s_branch Lblk_185
Lblkp_187:
    s_mov_b64 exec, 1
    buffer_store_byte v5, off, s[4:7], s21 offset:768 sc1
    s_mov_b64 exec, -1
Lblk_185:
    s_sub_u32 s13, s13, 1
    s_cmp_lt_i32 s13, 0
    s_cbranch_scc1 Lblke_186
    buffer_load_dwordx2 v[14:15], off, s[4:7], s22 offset:768 sc1
    s_waitcnt vmcnt(0)
    v_and_b32 v14, v14, v15
    s_nop 0
    v_readfirstlane_b32 s60, v14
    s_nop 0
    s_cmp_eq_u32 s60, 0x01010101
    s_nop 1
    s_cbranch_scc0 Lblk_185
Lblke_186:
    s_add_u32 s64, s40, 446464
    s_addc_u32 s65, s41, 0
    global_load_dwordx4 v[24:27], v1, s[64:65] offset:-4096 sc1
    global_load_dwordx4 v[28:31], v1, s[64:65] offset:-3072 sc1
    s_add_u32 s64, s38, 135168
    s_addc_u32 s65, s39, 0
    global_load_dwordx4 v[32:35], v1, s[64:65] offset:-4096 sc1
    global_load_dwordx4 v[36:39], v1, s[64:65] offset:-3072 sc1
    global_load_dwordx4 v[40:43], v1, s[64:65] offset:-2048 sc1
    global_load_dwordx4 v[44:47], v1, s[64:65] offset:-1024 sc1
    global_load_dwordx4 v[48:51], v1, s[64:65] offset:0 sc1
    global_load_dwordx4 v[52:55], v1, s[64:65] offset:1024 sc1
    global_load_dwordx4 v[56:59], v1, s[64:65] offset:2048 sc1
    global_load_dwordx4 v[60:63], v1, s[64:65] offset:3072 sc1
    s_waitcnt vmcnt(0) lgkmcnt(0)
    s_branch Lqst_168
Lgate_189:
    s_waitcnt vmcnt(0)
    s_cmp_eq_u32 s12, 0
    s_cbranch_scc1 Lblkp_193
    buffer_store_byte v5, off, s[4:7], s21 offset:896
    s_branch Lblk_191
Lblkp_193:
    s_mov_b64 exec, 1
    buffer_store_byte v5, off, s[4:7], s21 offset:896 sc1
    s_mov_b64 exec, -1
Lblk_191:
    s_sub_u32 s13, s13, 1
    s_cmp_lt_i32 s13, 0
    s_cbranch_scc1 Lblke_192
    buffer_load_dwordx2 v[14:15], off, s[4:7], s22 offset:896 sc1
    s_waitcnt vmcnt(0)
    v_and_b32 v14, v14, v15
    s_nop 0
    v_readfirstlane_b32 s60, v14
    s_nop 0
    s_cmp_eq_u32 s60, 0x01010101
    s_nop 1
    s_cbranch_scc0 Lblk_191
Lblke_192:
    s_waitcnt vmcnt(0)
    s_branch Lback_190
Lslow_195:
    s_mov_b64 exec, 1
    buffer_store_byte v5, off, s[4:7], s21 offset:896 sc1
    s_mov_b64 exec, -1
    s_branch Lback_196
Lredo_197:
    s_cmp_eq_u32 s3, 8
    s_nop 1
    s_cbranch_scc1 Lback_198
    s_mov_b32 s3, 8
    s_waitcnt vmcnt(0)
    s_cmp_eq_u32 s12, 0
    s_cbranch_scc1 Lblkp_201
    buffer_store_byte v5, off, s[4:7], s21 offset:896
    s_branch Lblk_199
Lblkp_201:
    s_mov_b64 exec, 1
    buffer_store_byte v5, off, s[4:7], s21 offset:896 sc1
    s_mov_b64 exec, -1
Lblk_199:
    s_sub_u32 s13, s13, 1
    s_cmp_lt_i32 s13, 0
    s_cbranch_scc1 Lblke_200
    buffer_load_dwordx2 v[14:15], off, s[4:7], s22 offset:896 sc1
    s_waitcnt vmcnt(0)
    v_and_b32 v14, v14, v15
    s_nop 0
    v_readfirstlane_b32 s60, v14
    s_nop 0
    s_cmp_eq_u32 s60, 0x01010101
    s_nop 1
    s_cbranch_scc0 Lblk_199
Lblke_200:
    s_add_u32 s64, s40, 454656
    s_addc_u32 s65, s41, 0
    global_load_dwordx4 v[200:203], v1, s[64:65] offset:-4096 sc1
    global_load_dwordx4 v[204:207], v1, s[64:65] offset:-3072 sc1
    s_add_u32 s64, s38, 167936
    s_addc_u32 s65, s39, 0
    global_load_dwordx4 v[160:163], v1, s[64:65] offset:-4096 sc1
    global_load_dwordx4 v[164:167], v1, s[64:65] offset:-3072 sc1
    global_load_dwordx4 v[168:171], v1, s[64:65] offset:-2048 sc1
    global_load_dwordx4 v[172:175], v1, s[64:65] offset:-1024 sc1
    global_load_dwordx4 v[176:179], v1, s[64:65] offset:0 sc1
    global_load_dwordx4 v[180:183], v1, s[64:65] offset:1024 sc1
    global_load_dwordx4 v[184:187], v1, s[64:65] offset:2048 sc1
    global_load_dwordx4 v[188:191], v1, s[64:65] offset:3072 sc1
    s_waitcnt vmcnt(0) lgkmcnt(0)
    s_branch Lqst_194
Lredo_205:
    s_cmp_eq_u32 s3, 8
    s_cbranch_scc1 Lback_206
    s_mov_b32 s3, 8
    s_waitcnt vmcnt(0)
    s_cmp_eq_u32 s12, 0
    s_cbranch_scc1 Lblkp_209
    buffer_store_byte v5, off, s[4:7], s21 offset:896
    s_branch Lblk_207
Lblkp_209:
    s_mov_b64 exec, 1
    buffer_store_byte v5, off, s[4:7], s21 offset:896 sc1
    s_mov_b64 exec, -1
Lblk_207:
    s_sub_u32 s13, s13, 1
    s_cmp_lt_i32 s13, 0
    s_cbranch_scc1 Lblke_208
    buffer_load_dwordx2 v[14:15], off, s[4:7], s22 offset:896 sc1
    s_waitcnt vmcnt(0)
    v_and_b32 v14, v14, v15
    s_nop 0
    v_readfirstlane_b32 s60, v14
    s_nop 0
    s_cmp_eq_u32 s60, 0x01010101
    s_nop 1
    s_cbranch_scc0 Lblk_207
Lblke_208:
    s_add_u32 s64, s40, 454656
    s_addc_u32 s65, s41, 0
    global_load_dwordx4 v[200:203], v1, s[64:65] offset:-4096 sc1
    global_load_dwordx4 v[204:207], v1, s[64:65] offset:-3072 sc1
    s_add_u32 s64, s38, 167936
    s_addc_u32 s65, s39, 0
    global_load_dwordx4 v[160:163], v1, s[64:65] offset:-4096 sc1
    global_load_dwordx4 v[164:167], v1, s[64:65] offset:-3072 sc1
    global_load_dwordx4 v[168:171], v1, s[64:65] offset:-2048 sc1
    global_load_dwordx4 v[172:175], v1, s[64:65] offset:-1024 sc1
    global_load_dwordx4 v[176:179], v1, s[64:65] offset:0 sc1
    global_load_dwordx4 v[180:183], v1, s[64:65] offset:1024 sc1
    global_load_dwordx4 v[184:187], v1, s[64:65] offset:2048 sc1
    global_load_dwordx4 v[188:191], v1, s[64:65] offset:3072 sc1
    s_waitcnt vmcnt(0) lgkmcnt(0)
    s_branch Lqst_194
Lredo_211:
    s_cmp_eq_u32 s3, 8
    s_nop 4
    s_cbranch_scc1 Lback_212
    s_mov_b32 s3, 8
    s_waitcnt vmcnt(0)
    s_cmp_eq_u32 s12, 0
    s_cbranch_scc1 Lblkp_215
    buffer_store_byte v5, off, s[4:7], s21 offset:896
    s_branch Lblk_213
Lblkp_215:
    s_mov_b64 exec, 1
    buffer_store_byte v5, off, s[4:7], s21 offset:896 sc1
    s_mov_b64 exec, -1
Lblk_213:
    s_sub_u32 s13, s13, 1
    s_cmp_lt_i32 s13, 0
    s_cbranch_scc1 Lblke_214
    buffer_load_dwordx2 v[14:15], off, s[4:7], s22 offset:896 sc1
    s_waitcnt vmcnt(0)
    v_and_b32 v14, v14, v15
    s_nop 0
    v_readfirstlane_b32 s60, v14
    s_nop 0
    s_cmp_eq_u32 s60, 0x01010101
    s_nop 1
    s_cbranch_scc0 Lblk_213
Lblke_214:
    s_add_u32 s64, s40, 454656
    s_addc_u32 s65, s41, 0
    global_load_dwordx4 v[200:203], v1, s[64:65] offset:-4096 sc1
    global_load_dwordx4 v[204:207], v1, s[64:65] offset:-3072 sc1
    s_add_u32 s64, s38, 167936
    s_addc_u32 s65, s39, 0
    global_load_dwordx4 v[160:163], v1, s[64:65] offset:-4096 sc1
    global_load_dwordx4 v[164:167], v1, s[64:65] offset:-3072 sc1
    global_load_dwordx4 v[168:171], v1, s[64:65] offset:-2048 sc1
    global_load_dwordx4 v[172:175], v1, s[64:65] offset:-1024 sc1
    global_load_dwordx4 v[176:179], v1, s[64:65] offset:0 sc1
    global_load_dwordx4 v[180:183], v1, s[64:65] offset:1024 sc1
    global_load_dwordx4 v[184:187], v1, s[64:65] offset:2048 sc1
    global_load_dwordx4 v[188:191], v1, s[64:65] offset:3072 sc1
    s_waitcnt vmcnt(0) lgkmcnt(0)
    s_branch Lqst_194
Lretry_217:
    s_sub_u32 s13, s13, 1
    s_cmp_lt_i32 s13, 0
    s_cbranch_scc1 Lback_218
    s_mov_b64 exec, 0xffff
    buffer_load_dword v14, v15, s[4:7], s63 offen sc1
    s_mov_b64 exec, -1
    s_waitcnt vmcnt(0)
    v_cmp_ne_u32 vcc, s1, v14
    s_nop 4
    s_cbranch_vccz Lback_218
    s_branch Lretry_217
Lretry_220:
    s_sub_u32 s13, s13, 1
    s_cmp_lt_i32 s13, 0
    s_nop 0
    s_cbranch_scc1 Lback_221
    s_mov_b64 exec, 0xffff
    buffer_load_dword v14, v15, s[4:7], s63 offen sc1
    s_mov_b64 exec, -1
    s_waitcnt vmcnt(0)
    v_cmp_ne_u32 vcc, s1, v14
    s_nop 4
    s_cbranch_vccz Lback_221
    s_branch Lretry_220
Lslow_223:
    s_mov_b64 exec, 1
    buffer_store_byte v5, off, s[4:7], s21 offset:2176 sc1
    s_mov_b64 exec, -1
    s_nop 3
    s_branch Lback_224
Lretry_225:
    s_sub_u32 s13, s13, 1
    s_cmp_lt_i32 s13, 0
    s_nop 1
    s_cbranch_scc1 Lback_226
    buffer_load_dwordx2 v[14:15], off, s[4:7], s22 offset:2176 sc1
    s_waitcnt vmcnt(0)
    v_and_b32 v14, v14, v15
    s_nop 0
    v_readfirstlane_b32 s60, v14
    s_nop 0
    s_cmp_eq_u32 s60, 0x01010101
    s_nop 1
    s_cbranch_scc1 Lback_226
    s_branch Lretry_225
Lslow_231:
    buffer_store_dwordx4 v[76:79], v1, s[4:7], s61 offen sc1
    s_nop 0
    s_branch Lback_232
Lfb_227:
    v_lshlrev_b32 v253, 7, v0
    s_mov_b32 s68, 5136384
    s_mov_b32 s69, 5144576
Lfq_233:
    s_sub_u32 s13, s13, 1
    s_cmp_lt_i32 s13, 0
    s_cbranch_scc1 Lfr_234
    buffer_load_dword v240, v253, s[4:7], s68 offen offset:4 sc1
    buffer_load_dword v241, v253, s[4:7], s69 offen offset:4 sc1
    s_waitcnt vmcnt(0)
    v_xor_b32 v240, s1, v240
    v_xor_b32 v241, s1, v241
    v_or_b32 v240, v240, v241
    v_cmp_ne_u32 vcc, 0, v240
    s_nop 4
    s_cbranch_vccnz Lfq_233
Lfr_234:
    v_mov_b32 v252, 0xff800000
    s_mov_b32 s68, 4984832
    s_mov_b32 s69, 64
Lp1_229:
    buffer_load_dwordx4 v[240:243], v1, s[4:7], s68 offen sc1
    s_waitcnt vmcnt(0)
    v_mfma_f32_32x32x16_bf16 v[224:239], v[240:243], v[24:27], 0
    s_nop 11
    v_max_f32 v252, v252, v224
    v_max_f32 v252, v252, v225
    v_max_f32 v252, v252, v226
    v_max_f32 v252, v252, v227
    v_max_f32 v252, v252, v228
    v_max_f32 v252, v252, v229
    v_max_f32 v252, v252, v230
    v_max_f32 v252, v252, v231
    v_max_f32 v252, v252, v232
    v_max_f32 v252, v252, v233
    v_max_f32 v252, v252, v234
    v_max_f32 v252, v252, v235
    v_max_f32 v252, v252, v236
    v_max_f32 v252, v252, v237
    v_max_f32 v252, v252, v238
    v_max_f32 v252, v252, v239
    s_add_u32 s68, s68, 2112
    s_sub_u32 s69, s69, 1
    s_cmp_lg_u32 s69, 0
    s_nop 0
    s_cbranch_scc1 Lp1_229
    v_mov_b32 v253, v252
    s_nop 1
    v_permlane32_swap_b32 v252, v253
    v_max_f32 v252, v252, v253
    v_and_b32 v253, 31, v0
    v_min_u32 v253, 16, v253
    v_lshlrev_b32 v253, 4, v253
    v_lshrrev_b32 v254, 5, v0
    v_mul_u32_u24 v254, 272, v254
    v_add_u32 v253, v253, v254
    v_mov_b32 v64, 0
    v_mov_b32 v65, 0
    v_mov_b32 v66, 0
    v_mov_b32 v67, 0
    v_mov_b32 v68, 0
    v_mov_b32 v69, 0
    v_mov_b32 v70, 0
    v_mov_b32 v71, 0
    v_mov_b32 v72, 0
    v_mov_b32 v73, 0
    v_mov_b32 v74, 0
    v_mov_b32 v75, 0
    v_mov_b32 v76, 0
    v_mov_b32 v77, 0
    v_mov_b32 v78, 0
    v_mov_b32 v79, 0
    s_mov_b32 s68, 4984832
    s_mov_b32 s69, 64
Lp2_230:
    buffer_load_dwordx4 v[240:243], v1, s[4:7], s68 offen sc1
    buffer_load_dwordx4 v[244:247], v253, s[4:7], s68 offen offset:1024 sc1
    buffer_load_dwordx4 v[248:251], v253, s[4:7], s68 offen offset:1568 sc1
    s_waitcnt vmcnt(0)
    v_mfma_f32_32x32x16_bf16 v[224:239], v[240:243], v[24:27], 0
    s_nop 11
    v_sub_f32 v224, v224, v252
    v_sub_f32 v225, v225, v252
    v_sub_f32 v226, v226, v252
    v_sub_f32 v227, v227, v252
    v_sub_f32 v228, v228, v252
    v_sub_f32 v229, v229, v252
    v_sub_f32 v230, v230, v252
    v_sub_f32 v231, v231, v252
    v_sub_f32 v232, v232, v252
    v_sub_f32 v233, v233, v252
    v_sub_f32 v234, v234, v252
    v_sub_f32 v235, v235, v252
    v_sub_f32 v236, v236, v252
    v_sub_f32 v237, v237, v252
    v_sub_f32 v238, v238, v252
    v_sub_f32 v239, v239, v252
    v_exp_f32 v224, v224
    v_exp_f32 v225, v225
    v_exp_f32 v226, v226
    v_exp_f32 v227, v227
    v_exp_f32 v228, v228
    v_exp_f32 v229, v229
    v_exp_f32 v230, v230
    v_exp_f32 v231, v231
    v_exp_f32 v232, v232
    v_exp_f32 v233, v233
    v_exp_f32 v234, v234
    v_exp_f32 v235, v235
    v_exp_f32 v236, v236
    v_exp_f32 v237, v237
    v_exp_f32 v238, v238
    v_exp_f32 v239, v239
    v_smfmac_f32_32x32x32_bf16 v[64:79], v[244:247], v[224:231], v124
    s_nop 0
    v_smfmac_f32_32x32x32_bf16 v[64:79], v[248:251], v[232:239], v124
    s_add_u32 s68, s68, 2112
    s_sub_u32 s69, s69, 1
    s_cmp_lg_u32 s69, 0
    s_nop 7
    s_cbranch_scc1 Lp2_230
    v_rcp_f32 v74, v72
    v_subrev_u32 v73, 0x21800000, v72
    v_mul_f32 v64, v74, v64
    v_mul_f32 v65, v74, v65
    v_mul_f32 v66, v74, v66
    v_mul_f32 v67, v74, v67
    v_mul_f32 v68, v74, v68
    v_mul_f32 v69, v74, v69
    v_mul_f32 v70, v74, v70
    v_mul_f32 v71, v74, v71
    s_nop 3
    s_branch Lfbback_228
Lslow_235:
    s_mov_b64 exec, 1
    buffer_store_byte v5, off, s[4:7], s21 offset:1024 sc1
    s_mov_b64 exec, -1
    s_nop 3
    s_branch Lback_236
Lgate_237:
    s_waitcnt vmcnt(0)
    s_cmp_eq_u32 s12, 0
    s_cbranch_scc1 Lblkp_241
    buffer_store_byte v5, off, s[4:7], s21 offset:1024
    s_branch Lblk_239
Lblkp_241:
    s_mov_b64 exec, 1
    buffer_store_byte v5, off, s[4:7], s21 offset:1024 sc1
    s_mov_b64 exec, -1
Lblk_239:
    s_sub_u32 s13, s13, 1
    s_cmp_lt_i32 s13, 0
    s_cbranch_scc1 Lblke_240
    buffer_load_dwordx2 v[14:15], off, s[4:7], s22 offset:1024 sc1
    s_waitcnt vmcnt(0)
    v_and_b32 v14, v14, v15
    s_nop 0
    v_readfirstlane_b32 s60, v14
    s_nop 0
    s_cmp_eq_u32 s60, 0x01010101
    s_nop 1
    s_cbranch_scc0 Lblk_239
Lblke_240:
    s_waitcnt vmcnt(0)
    s_branch Lback_238
Lslow_246:
    buffer_store_dwordx4 v[92:95], v1, s[4:7], s61 offen sc1
    s_nop 0
    s_branch Lback_247
Lfb_242:
    v_lshlrev_b32 v61, 7, v0
    s_mov_b32 s68, 5136384
    s_mov_b32 s69, 5144576
Lfq_248:
    s_sub_u32 s13, s13, 1
    s_cmp_lt_i32 s13, 0
    s_cbranch_scc1 Lfr_249
    buffer_load_dword v48, v61, s[4:7], s68 offen offset:4 sc1
    buffer_load_dword v49, v61, s[4:7], s69 offen offset:4 sc1
    s_waitcnt vmcnt(0)
    v_xor_b32 v48, s1, v48
    v_xor_b32 v49, s1, v49
    v_or_b32 v48, v48, v49
    v_cmp_ne_u32 vcc, 0, v48
    s_nop 4
    s_cbranch_vccnz Lfq_248
Lfr_249:
    v_mov_b32 v60, 0xff800000
    s_mov_b32 s68, 4984832
    s_mov_b32 s69, 64
Lp1_244:
    buffer_load_dwordx4 v[48:51], v1, s[4:7], s68 offen sc1
    s_waitcnt vmcnt(0)
    v_mfma_f32_32x32x16_bf16 v[32:47], v[48:51], v[28:31], 0
    s_nop 11
    v_max_f32 v60, v60, v32
    v_max_f32 v60, v60, v33
    v_max_f32 v60, v60, v34
    v_max_f32 v60, v60, v35
    v_max_f32 v60, v60, v36
    v_max_f32 v60, v60, v37
    v_max_f32 v60, v60, v38
    v_max_f32 v60, v60, v39
    v_max_f32 v60, v60, v40
    v_max_f32 v60, v60, v41
    v_max_f32 v60, v60, v42
    v_max_f32 v60, v60, v43
    v_max_f32 v60, v60, v44
    v_max_f32 v60, v60, v45
    v_max_f32 v60, v60, v46
    v_max_f32 v60, v60, v47
    s_add_u32 s68, s68, 2112
    s_sub_u32 s69, s69, 1
    s_cmp_lg_u32 s69, 0
    s_nop 0
    s_cbranch_scc1 Lp1_244
    v_mov_b32 v61, v60
    s_nop 1
    v_permlane32_swap_b32 v60, v61
    v_max_f32 v60, v60, v61
    v_and_b32 v61, 31, v0
    v_min_u32 v61, 16, v61
    v_lshlrev_b32 v61, 4, v61
    v_lshrrev_b32 v62, 5, v0
    v_mul_u32_u24 v62, 272, v62
    v_add_u32 v61, v61, v62
    v_mov_b32 v80, 0
    v_mov_b32 v81, 0
    v_mov_b32 v82, 0
    v_mov_b32 v83, 0
    v_mov_b32 v84, 0
    v_mov_b32 v85, 0
    v_mov_b32 v86, 0
    v_mov_b32 v87, 0
    v_mov_b32 v88, 0
    v_mov_b32 v89, 0
    v_mov_b32 v90, 0
    v_mov_b32 v91, 0
    v_mov_b32 v92, 0
    v_mov_b32 v93, 0
    v_mov_b32 v94, 0
    v_mov_b32 v95, 0
    s_mov_b32 s68, 4984832
    s_mov_b32 s69, 64
Lp2_245:
    buffer_load_dwordx4 v[48:51], v1, s[4:7], s68 offen sc1
    buffer_load_dwordx4 v[52:55], v61, s[4:7], s68 offen offset:1024 sc1
    buffer_load_dwordx4 v[56:59], v61, s[4:7], s68 offen offset:1568 sc1
    s_waitcnt vmcnt(0)
    v_mfma_f32_32x32x16_bf16 v[32:47], v[48:51], v[28:31], 0
    s_nop 11
    v_sub_f32 v32, v32, v60
    v_sub_f32 v33, v33, v60
    v_sub_f32 v34, v34, v60
    v_sub_f32 v35, v35, v60
    v_sub_f32 v36, v36, v60
    v_sub_f32 v37, v37, v60
    v_sub_f32 v38, v38, v60
    v_sub_f32 v39, v39, v60
    v_sub_f32 v40, v40, v60
    v_sub_f32 v41, v41, v60
    v_sub_f32 v42, v42, v60
    v_sub_f32 v43, v43, v60
    v_sub_f32 v44, v44, v60
    v_sub_f32 v45, v45, v60
    v_sub_f32 v46, v46, v60
    v_sub_f32 v47, v47, v60
    v_exp_f32 v32, v32
    v_exp_f32 v33, v33
    v_exp_f32 v34, v34
    v_exp_f32 v35, v35
    v_exp_f32 v36, v36
    v_exp_f32 v37, v37
    v_exp_f32 v38, v38
    v_exp_f32 v39, v39
    v_exp_f32 v40, v40
    v_exp_f32 v41, v41
    v_exp_f32 v42, v42
    v_exp_f32 v43, v43
    v_exp_f32 v44, v44
    v_exp_f32 v45, v45
    v_exp_f32 v46, v46
    v_exp_f32 v47, v47
    v_smfmac_f32_32x32x32_bf16 v[80:95], v[52:55], v[32:39], v124
    s_nop 0
    v_smfmac_f32_32x32x32_bf16 v[80:95], v[56:59], v[40:47], v124
    s_add_u32 s68, s68, 2112
    s_sub_u32 s69, s69, 1
    s_cmp_lg_u32 s69, 0
    s_nop 7
    s_cbranch_scc1 Lp2_245
    v_rcp_f32 v90, v88
    v_subrev_u32 v89, 0x21800000, v88
    v_mul_f32 v80, v90, v80
    v_mul_f32 v81, v90, v81
    v_mul_f32 v82, v90, v82
    v_mul_f32 v83, v90, v83
    v_mul_f32 v84, v90, v84
    v_mul_f32 v85, v90, v85
    v_mul_f32 v86, v90, v86
    v_mul_f32 v87, v90, v87
    s_nop 3
    s_branch Lfbback_243
Lredo_251:
    s_cmp_eq_u32 s3, 9
    s_nop 5
    s_cbranch_scc1 Lback_252
    s_mov_b32 s3, 9
    s_waitcnt vmcnt(0)
    s_cmp_eq_u32 s12, 0
    s_cbranch_scc1 Lblkp_255
    buffer_store_byte v5, off, s[4:7], s21 offset:1024
    s_branch Lblk_253
Lblkp_255:
    s_mov_b64 exec, 1
    buffer_store_byte v5, off, s[4:7], s21 offset:1024 sc1
    s_mov_b64 exec, -1
Lblk_253:
    s_sub_u32 s13, s13, 1
    s_cmp_lt_i32 s13, 0
    s_cbranch_scc1 Lblke_254
    buffer_load_dwordx2 v[14:15], off, s[4:7], s22 offset:1024 sc1
    s_waitcnt vmcnt(0)
    v_and_b32 v14, v14, v15
    s_nop 0
    v_readfirstlane_b32 s60, v14
    s_nop 0
    s_cmp_eq_u32 s60, 0x01010101
    s_nop 1
    s_cbranch_scc0 Lblk_253
Lblke_254:
    s_add_u32 s64, s38, 4096
    s_addc_u32 s65, s39, 0
    global_load_dwordx4 v[224:227], v1, s[64:65] offset:-4096 sc1
    global_load_dwordx4 v[228:231], v1, s[64:65] offset:-3072 sc1
    global_load_dwordx4 v[232:235], v1, s[64:65] offset:-2048 sc1
    global_load_dwordx4 v[236:239], v1, s[64:65] offset:-1024 sc1
    global_load_dwordx4 v[240:243], v1, s[64:65] offset:0 sc1
    global_load_dwordx4 v[244:247], v1, s[64:65] offset:1024 sc1
    global_load_dwordx4 v[248:251], v1, s[64:65] offset:2048 sc1
    global_load_dwordx4 v[252:255], v1, s[64:65] offset:3072 sc1
    ds_read_b128 v[96:99], v6 offset:8192
    ds_read_b128 v[100:103], v6 offset:9216
    ds_read_b128 v[104:107], v6 offset:10240
    ds_read_b128 v[108:111], v6 offset:11264
    ds_read_b128 v[112:115], v6 offset:12288
    ds_read_b128 v[116:119], v6 offset:13312
    s_waitcnt vmcnt(0) lgkmcnt(0)
    s_branch Lopst_250
Lslow_256:
    s_mov_b64 exec, 1
    buffer_store_byte v5, off, s[4:7], s21 offset:1152 sc1
    s_mov_b64 exec, -1
    s_nop 3
    s_branch Lback_257
Lgate_258:
    s_waitcnt vmcnt(0)
    s_cmp_eq_u32 s12, 0
    s_cbranch_scc1 Lblkp_262
    buffer_store_byte v5, off, s[4:7], s21 offset:1152
    s_branch Lblk_260
Lblkp_262:
    s_mov_b64 exec, 1
    buffer_store_byte v5, off, s[4:7], s21 offset:1152 sc1
    s_mov_b64 exec, -1
Lblk_260:
    s_sub_u32 s13, s13, 1
    s_cmp_lt_i32 s13, 0
    s_cbranch_scc1 Lblke_261
    buffer_load_dwordx2 v[14:15], off, s[4:7], s22 offset:1152 sc1
    s_waitcnt vmcnt(0)
    v_and_b32 v14, v14, v15
    s_nop 0
    v_readfirstlane_b32 s60, v14
    s_nop 0
    s_cmp_eq_u32 s60, 0x01010101
    s_nop 1
    s_cbranch_scc0 Lblk_260
Lblke_261:
    s_waitcnt vmcnt(0)
    s_branch Lback_259
Lslow_263:
    buffer_store_dwordx4 v[16:19], v1, s[4:7], s61 offen sc1
    buffer_store_dword v40, v1, s[4:7], s62 offen sc1
    s_branch Lback_264
Lredo_266:
    s_cmp_eq_u32 s3, 10
    s_nop 5
    s_cbranch_scc1 Lback_267
    s_mov_b32 s3, 10
    s_waitcnt vmcnt(0)
    s_cmp_eq_u32 s12, 0
    s_cbranch_scc1 Lblkp_270
    buffer_store_byte v5, off, s[4:7], s21 offset:1152
    s_branch Lblk_268
Lblkp_270:
    s_mov_b64 exec, 1
    buffer_store_byte v5, off, s[4:7], s21 offset:1152 sc1
    s_mov_b64 exec, -1
Lblk_268:
    s_sub_u32 s13, s13, 1
    s_cmp_lt_i32 s13, 0
    s_cbranch_scc1 Lblke_269
    buffer_load_dwordx2 v[14:15], off, s[4:7], s22 offset:1152 sc1
    s_waitcnt vmcnt(0)
    v_and_b32 v14, v14, v15
    s_nop 0
    v_readfirstlane_b32 s60, v14
    s_nop 0
    s_cmp_eq_u32 s60, 0x01010101
    s_nop 1
    s_cbranch_scc0 Lblk_268
Lblke_269:
    s_add_u32 s64, s38, 36864
    s_addc_u32 s65, s39, 0
    global_load_dwordx4 v[224:227], v1, s[64:65] offset:-4096 sc1
    global_load_dwordx4 v[228:231], v1, s[64:65] offset:-3072 sc1
    global_load_dwordx4 v[232:235], v1, s[64:65] offset:-2048 sc1
    global_load_dwordx4 v[236:239], v1, s[64:65] offset:-1024 sc1
    global_load_dwordx4 v[240:243], v1, s[64:65] offset:0 sc1
    global_load_dwordx4 v[244:247], v1, s[64:65] offset:1024 sc1
    global_load_dwordx4 v[248:251], v1, s[64:65] offset:2048 sc1
    global_load_dwordx4 v[252:255], v1, s[64:65] offset:3072 sc1
    ds_read_b128 v[96:99], v6 offset:8192
    ds_read_b128 v[100:103], v6 offset:9216
    ds_read_b128 v[104:107], v6 offset:10240
    ds_read_b128 v[108:111], v6 offset:11264
    ds_read_b128 v[112:115], v6 offset:12288
    ds_read_b128 v[116:119], v6 offset:13312
    s_waitcnt vmcnt(0) lgkmcnt(0)
    s_branch Lopst_265
Lgate_271:
    s_waitcnt vmcnt(0)
    s_cmp_eq_u32 s12, 0
    s_cbranch_scc1 Lblkp_275
    buffer_store_byte v5, off, s[4:7], s21 offset:1280
    s_branch Lblk_273
Lblkp_275:
    s_mov_b64 exec, 1
    buffer_store_byte v5, off, s[4:7], s21 offset:1280 sc1
    s_mov_b64 exec, -1
Lblk_273:
    s_sub_u32 s13, s13, 1
    s_cmp_lt_i32 s13, 0
    s_cbranch_scc1 Lblke_274
    buffer_load_dwordx2 v[14:15], off, s[4:7], s22 offset:1280 sc1
    s_waitcnt vmcnt(0)
    v_and_b32 v14, v14, v15
    s_nop 0
    v_readfirstlane_b32 s60, v14
    s_nop 0
    s_cmp_eq_u32 s60, 0x01010101
    s_nop 1
    s_cbranch_scc0 Lblk_273
Lblke_274:
    s_waitcnt vmcnt(0)
    s_branch Lback_272
Lslow_276:
    s_mov_b64 exec, 1
    buffer_store_byte v5, off, s[4:7], s21 offset:1280 sc1
    s_mov_b64 exec, -1
    s_nop 0
    s_branch Lback_277
Lslow_278:
    buffer_store_dwordx4 v[20:23], v1, s[4:7], s61 offen sc1
    buffer_store_dword v72, v1, s[4:7], s62 offen sc1
    s_branch Lback_279
Lredo_281:
    s_cmp_eq_u32 s3, 11
    s_cbranch_scc1 Lback_282
    s_mov_b32 s3, 11
    s_waitcnt vmcnt(0)
    s_cmp_eq_u32 s12, 0
    s_cbranch_scc1 Lblkp_285
    buffer_store_byte v5, off, s[4:7], s21 offset:1280
    s_branch Lblk_283
Lblkp_285:
    s_mov_b64 exec, 1
    buffer_store_byte v5, off, s[4:7], s21 offset:1280 sc1
    s_mov_b64 exec, -1
Lblk_283:
    s_sub_u32 s13, s13, 1
    s_cmp_lt_i32 s13, 0
    s_cbranch_scc1 Lblke_284
    buffer_load_dwordx2 v[14:15], off, s[4:7], s22 offset:1280 sc1
    s_waitcnt vmcnt(0)
    v_and_b32 v14, v14, v15
    s_nop 0
    v_readfirstlane_b32 s60, v14
    s_nop 0
    s_cmp_eq_u32 s60, 0x01010101
    s_nop 1
    s_cbranch_scc0 Lblk_283
Lblke_284:
    s_add_u32 s66, s40, 430080
    s_addc_u32 s67, s41, 0
    global_load_dwordx4 v[24:27], v1, s[66:67] offset:-4096 sc1
    global_load_dwordx4 v[28:31], v1, s[66:67] offset:-3072 sc1
    s_add_u32 m0, s19, 0
    s_add_u32 s66, s38, 65536
    s_addc_u32 s67, s39, 0
    global_load_lds_dwordx4 v1, s[66:67] offset:0 sc1
    global_load_lds_dwordx4 v1, s[66:67] offset:1024 sc1
    global_load_lds_dwordx4 v1, s[66:67] offset:2048 sc1
    global_load_lds_dwordx4 v1, s[66:67] offset:3072 sc1
    s_add_u32 m0, s19, 4096
    s_add_u32 s66, s38, 69632
    s_addc_u32 s67, s39, 0
    global_load_lds_dwordx4 v1, s[66:67] offset:0 sc1
    global_load_lds_dwordx4 v1, s[66:67] offset:1024 sc1
    global_load_lds_dwordx4 v1, s[66:67] offset:2048 sc1
    global_load_lds_dwordx4 v1, s[66:67] offset:3072 sc1
    s_waitcnt vmcnt(0) lgkmcnt(0)
    s_branch Lf1sy_280
Lredo_287:
    s_cmp_eq_u32 s3, 21
    s_nop 6
    s_cbranch_scc1 Lback_288
    s_mov_b32 s3, 21
    s_waitcnt vmcnt(0)
    s_cmp_eq_u32 s12, 0
    s_cbranch_scc1 Lblkp_291
    buffer_store_byte v5, off, s[4:7], s21 offset:1280
    s_branch Lblk_289
Lblkp_291:
    s_mov_b64 exec, 1
    buffer_store_byte v5, off, s[4:7], s21 offset:1280 sc1
    s_mov_b64 exec, -1
Lblk_289:
    s_sub_u32 s13, s13, 1
    s_cmp_lt_i32 s13, 0
    s_cbranch_scc1 Lblke_290
    s_and_b32 s60, s22, 0xffffffe0
    v_and_b32 v15, 28, v3
    buffer_load_dword v14, v15, s[4:7], s60 offen offset:1280 sc1
    s_waitcnt vmcnt(0)
    v_cmp_ne_u32 vcc, 0x01010101, v14
    s_nop 4
    s_cbranch_vccnz Lblk_289
Lblke_290:
    s_sub_u32 s68, s38, s19
    s_subb_u32 s69, s39, 0
    s_mov_b32 s61, 0
    s_add_u32 m0, s61, 0
    s_add_u32 s66, s68, 65536
    s_addc_u32 s67, s69, 0
    global_load_lds_dwordx4 v1, s[66:67] offset:0 sc1
    global_load_lds_dwordx4 v1, s[66:67] offset:1024 sc1
    global_load_lds_dwordx4 v1, s[66:67] offset:2048 sc1
    global_load_lds_dwordx4 v1, s[66:67] offset:3072 sc1
    s_add_u32 m0, s61, 4096
    s_add_u32 s66, s68, 69632
    s_addc_u32 s67, s69, 0
    global_load_lds_dwordx4 v1, s[66:67] offset:0 sc1
    global_load_lds_dwordx4 v1, s[66:67] offset:1024 sc1
    global_load_lds_dwordx4 v1, s[66:67] offset:2048 sc1
    global_load_lds_dwordx4 v1, s[66:67] offset:3072 sc1
    s_add_u32 m0, s61, 8192
    s_add_u32 s66, s68, 73728
    s_addc_u32 s67, s69, 0
    global_load_lds_dwordx4 v1, s[66:67] offset:0 sc1
    global_load_lds_dwordx4 v1, s[66:67] offset:1024 sc1
    global_load_lds_dwordx4 v1, s[66:67] offset:2048 sc1
    global_load_lds_dwordx4 v1, s[66:67] offset:3072 sc1
    s_add_u32 m0, s61, 12288
    s_add_u32 s66, s68, 77824
    s_addc_u32 s67, s69, 0
    global_load_lds_dwordx4 v1, s[66:67] offset:0 sc1
    global_load_lds_dwordx4 v1, s[66:67] offset:1024 sc1
    global_load_lds_dwordx4 v1, s[66:67] offset:2048 sc1
    global_load_lds_dwordx4 v1, s[66:67] offset:3072 sc1
    s_add_u32 m0, s61, 16384
    s_add_u32 s66, s68, 81920
    s_addc_u32 s67, s69, 0
    global_load_lds_dwordx4 v1, s[66:67] offset:0 sc1
    global_load_lds_dwordx4 v1, s[66:67] offset:1024 sc1
    global_load_lds_dwordx4 v1, s[66:67] offset:2048 sc1
    global_load_lds_dwordx4 v1, s[66:67] offset:3072 sc1
    s_add_u32 m0, s61, 20480
    s_add_u32 s66, s68, 86016
    s_addc_u32 s67, s69, 0
    global_load_lds_dwordx4 v1, s[66:67] offset:0 sc1
    global_load_lds_dwordx4 v1, s[66:67] offset:1024 sc1
    global_load_lds_dwordx4 v1, s[66:67] offset:2048 sc1
    global_load_lds_dwordx4 v1, s[66:67] offset:3072 sc1
    s_add_u32 m0, s61, 24576
    s_add_u32 s66, s68, 90112
    s_addc_u32 s67, s69, 0
    global_load_lds_dwordx4 v1, s[66:67] offset:0 sc1
    global_load_lds_dwordx4 v1, s[66:67] offset:1024 sc1
    global_load_lds_dwordx4 v1, s[66:67] offset:2048 sc1
    global_load_lds_dwordx4 v1, s[66:67] offset:3072 sc1
    s_add_u32 m0, s61, 28672
    s_add_u32 s66, s68, 94208
    s_addc_u32 s67, s69, 0
    global_load_lds_dwordx4 v1, s[66:67] offset:0 sc1
    global_load_lds_dwordx4 v1, s[66:67] offset:1024 sc1
    global_load_lds_dwordx4 v1, s[66:67] offset:2048 sc1
    global_load_lds_dwordx4 v1, s[66:67] offset:3072 sc1
    s_waitcnt vmcnt(0) lgkmcnt(0)
    s_branch Lf1st_286
Lslow_292:
    s_mov_b64 exec, 1
    buffer_store_byte v5, off, s[4:7], s21 offset:1408 sc1
    s_mov_b64 exec, -1
    s_branch Lback_293
Lretry_294:
    s_sub_u32 s13, s13, 1
    s_cmp_lt_i32 s13, 0
    s_cbranch_scc1 Lback_295
    buffer_load_dwordx2 v[14:15], off, s[4:7], s22 offset:1408 sc1
    s_waitcnt vmcnt(0)
    v_and_b32 v14, v14, v15
    s_nop 0
    v_readfirstlane_b32 s60, v14
    s_nop 0
    s_cmp_eq_u32 s60, 0x01010101
    s_nop 1
    s_cbranch_scc1 Lback_295
    s_branch Lretry_294
Lslow_296:
    buffer_store_dwordx4 v[32:35], v1, s[4:7], s61 offen sc1
    s_nop 4
    s_branch Lback_297
Lslow_298:
    buffer_store_dwordx4 v[40:43], v1, s[4:7], s61 offen sc1
    s_nop 4
    s_branch Lback_299
Lslow_301:
    buffer_store_dwordx4 v[48:51], v52, s[4:7], s61 offen sc1
    s_nop 3
    s_branch Lback_302
Lslow_303:
    buffer_store_dwordx4 v[56:59], v60, s[4:7], s61 offen sc1
    s_nop 3
    s_branch Lback_304
Lslow_305:
    buffer_store_dwordx4 v[64:67], v1, s[4:7], s61 offen sc1
    s_nop 4
    s_branch Lback_306
Lslow_307:
    buffer_store_dwordx4 v[72:75], v1, s[4:7], s61 offen sc1
    s_nop 4
    s_branch Lback_308
Lgate_309:
    s_waitcnt vmcnt(0)
    s_cmp_eq_u32 s12, 0
    s_cbranch_scc1 Lblkp_313
    buffer_store_byte v5, off, s[4:7], s21 offset:1536
    s_branch Lblk_311
Lblkp_313:
    s_mov_b64 exec, 1
    buffer_store_byte v5, off, s[4:7], s21 offset:1536 sc1
    s_mov_b64 exec, -1
Lblk_311:
    s_sub_u32 s13, s13, 1
    s_cmp_lt_i32 s13, 0
    s_cbranch_scc1 Lblke_312
    buffer_load_dwordx2 v[14:15], off, s[4:7], s22 offset:1536 sc1
    s_waitcnt vmcnt(0)
    v_and_b32 v14, v14, v15
    s_nop 0
    v_readfirstlane_b32 s60, v14
    s_nop 0
    s_cmp_eq_u32 s60, 0x01010101
    s_nop 1
    s_cbranch_scc0 Lblk_311
Lblke_312:
    s_waitcnt vmcnt(0)
    s_branch Lback_310
Lslow_315:
    buffer_store_dwordx4 v[80:83], v84, s[4:7], s61 offen sc1
    s_nop 4
    s_branch Lback_316
Lslow_317:
    buffer_store_dwordx4 v[88:91], v92, s[4:7], s61 offen sc1
    s_nop 5
    s_branch Lback_318
Lslow_319:
    s_mov_b64 exec, 1
    buffer_store_byte v5, off, s[4:7], s21 offset:1536 sc1
    s_mov_b64 exec, -1
    s_nop 5
    s_branch Lback_320
Lgate_321:
    s_waitcnt vmcnt(0)
    s_cmp_eq_u32 s12, 0
    s_cbranch_scc1 Lblkp_325
    buffer_store_byte v5, off, s[4:7], s21 offset:1664
    s_branch Lblk_323
Lblkp_325:
    s_mov_b64 exec, 1
    buffer_store_byte v5, off, s[4:7], s21 offset:1664 sc1
    s_mov_b64 exec, -1
Lblk_323:
    s_sub_u32 s13, s13, 1
    s_cmp_lt_i32 s13, 0
    s_cbranch_scc1 Lblke_324
    buffer_load_dwordx2 v[14:15], off, s[4:7], s22 offset:1664 sc1
    s_waitcnt vmcnt(0)
    v_and_b32 v14, v14, v15
    s_nop 0
    v_readfirstlane_b32 s60, v14
    s_nop 0
    s_cmp_eq_u32 s60, 0x01010101
    s_nop 1
    s_cbranch_scc0 Lblk_323
Lblke_324:
    s_add_u32 s66, s42, 118784
    s_addc_u32 s67, s43, 0
    global_load_dwordx4 a[144:147], v1, s[66:67] offset:-4096 sc1
    global_load_dwordx4 a[148:151], v1, s[66:67] offset:-3072 sc1
    global_load_dwordx4 a[152:155], v1, s[66:67] offset:0 sc1
    global_load_dwordx4 a[156:159], v1, s[66:67] offset:1024 sc1
    s_add_u32 s66, s42, 126976
    s_addc_u32 s67, s43, 0
    global_load_dwordx4 a[96:99], v1, s[66:67] offset:-4096 sc1
    global_load_dwordx4 a[100:103], v1, s[66:67] offset:-3072 sc1
    global_load_dwordx4 a[104:107], v1, s[66:67] offset:0 sc1
    global_load_dwordx4 a[108:111], v1, s[66:67] offset:1024 sc1
    global_load_dwordx4 a[112:115], v1, s[66:67] offset:2048 sc1
    global_load_dwordx4 a[116:119], v1, s[66:67] offset:3072 sc1
    s_waitcnt vmcnt(0)
    s_branch Lback_322
Lredo_326:
    s_cmp_eq_u32 s3, 13
    s_nop 4
    s_cbranch_scc1 Lback_327
    s_mov_b32 s3, 13
    s_waitcnt vmcnt(0)
    s_cmp_eq_u32 s12, 0
    s_cbranch_scc1 Lblkp_330
    buffer_store_byte v5, off, s[4:7], s21 offset:1536
    s_branch Lblk_328
Lblkp_330:
    s_mov_b64 exec, 1
    buffer_store_byte v5, off, s[4:7], s21 offset:1536 sc1
    s_mov_b64 exec, -1
Lblk_328:
    s_sub_u32 s13, s13, 1
    s_cmp_lt_i32 s13, 0
    s_cbranch_scc1 Lblke_329
    buffer_load_dwordx2 v[14:15], off, s[4:7], s22 offset:1536 sc1
    s_waitcnt vmcnt(0)
    v_and_b32 v14, v14, v15
    s_nop 0
    v_readfirstlane_b32 s60, v14
    s_nop 0
    s_cmp_eq_u32 s60, 0x01010101
    s_nop 1
    s_cbranch_scc0 Lblk_328
Lblke_329:
    s_add_u32 s66, s42, 4096
    s_addc_u32 s67, s43, 0
    global_load_dwordx4 a[96:99], v1, s[66:67] offset:-4096 sc1
    global_load_dwordx4 a[100:103], v1, s[66:67] offset:-3072 sc1
    global_load_dwordx4 a[104:107], v1, s[66:67] offset:0 sc1
    global_load_dwordx4 a[108:111], v1, s[66:67] offset:1024 sc1
    s_add_u32 s66, s42, 12288
    s_addc_u32 s67, s43, 0
    global_load_dwordx4 a[112:115], v1, s[66:67] offset:-4096 sc1
    global_load_dwordx4 a[116:119], v1, s[66:67] offset:-3072 sc1
    global_load_dwordx4 a[120:123], v1, s[66:67] offset:0 sc1
    global_load_dwordx4 a[124:127], v1, s[66:67] offset:1024 sc1
    global_load_dwordx4 a[128:131], v1, s[66:67] offset:2048 sc1
    global_load_dwordx4 a[132:135], v1, s[66:67] offset:3072 sc1
    s_add_u32 s66, s42, 22528
    s_addc_u32 s67, s43, 0
    global_load_dwordx4 a[136:139], v1, s[66:67] offset:-4096 sc1
    global_load_dwordx4 a[140:143], v1, s[66:67] offset:-3072 sc1
    s_add_u32 s66, s42, 26624
    s_addc_u32 s67, s43, 0
    global_load_dwordx4 a[144:147], v1, s[66:67] offset:-4096 sc1
    global_load_dwordx4 a[148:151], v1, s[66:67] offset:-3072 sc1
    global_load_dwordx4 a[152:155], v1, s[66:67] offset:0 sc1
    global_load_dwordx4 a[156:159], v1, s[66:67] offset:1024 sc1
    s_waitcnt vmcnt(0)
    v_mfma_f32_32x32x16_bf16 v[48:63], v[132:135], a[96:99], 0
    v_mfma_f32_32x32x16_bf16 v[32:47], v[128:131], a[96:99], 0
    v_mfma_f32_32x32x16_bf16 v[48:63], v[140:143], a[100:103], v[48:63]
    v_mfma_f32_32x32x16_bf16 v[32:47], v[136:139], a[100:103], v[32:47]
    v_mfma_f32_32x32x16_bf16 v[48:63], v[148:151], a[104:107], v[48:63]
    v_mfma_f32_32x32x16_bf16 v[32:47], v[144:147], a[104:107], v[32:47]
    v_mfma_f32_32x32x16_bf16 v[48:63], v[156:159], a[108:111], v[48:63]
    v_mfma_f32_32x32x16_bf16 v[32:47], v[152:155], a[108:111], v[32:47]
    v_mfma_f32_32x32x16_bf16 v[48:63], v[164:167], a[112:115], v[48:63]
    v_mfma_f32_32x32x16_bf16 v[32:47], v[160:163], a[112:115], v[32:47]
    v_mfma_f32_32x32x16_bf16 v[48:63], v[172:175], a[116:119], v[48:63]
    v_mfma_f32_32x32x16_bf16 v[32:47], v[168:171], a[116:119], v[32:47]
    v_mfma_f32_32x32x16_bf16 v[48:63], v[180:183], a[120:123], v[48:63]
    v_mfma_f32_32x32x16_bf16 v[32:47], v[176:179], a[120:123], v[32:47]
    v_mfma_f32_32x32x16_bf16 v[48:63], v[188:191], a[124:127], v[48:63]
    v_mfma_f32_32x32x16_bf16 v[32:47], v[184:187], a[124:127], v[32:47]
    v_mfma_f32_32x32x16_bf16 v[48:63], v[196:199], a[128:131], v[48:63]
    v_mfma_f32_32x32x16_bf16 v[32:47], v[192:195], a[128:131], v[32:47]
    v_mfma_f32_32x32x16_bf16 v[48:63], v[204:207], a[132:135], v[48:63]
    v_mfma_f32_32x32x16_bf16 v[32:47], v[200:203], a[132:135], v[32:47]
    v_mfma_f32_32x32x16_bf16 v[48:63], v[212:215], a[136:139], v[48:63]
    v_mfma_f32_32x32x16_bf16 v[32:47], v[208:211], a[136:139], v[32:47]
    v_mfma_f32_32x32x16_bf16 v[48:63], v[220:223], a[140:143], v[48:63]
    v_mfma_f32_32x32x16_bf16 v[32:47], v[216:219], a[140:143], v[32:47]
    v_mfma_f32_32x32x16_bf16 v[48:63], v[228:231], a[144:147], v[48:63]
    v_mfma_f32_32x32x16_bf16 v[32:47], v[224:227], a[144:147], v[32:47]
    v_mfma_f32_32x32x16_bf16 v[48:63], v[236:239], a[148:151], v[48:63]
    v_mfma_f32_32x32x16_bf16 v[32:47], v[232:235], a[148:151], v[32:47]
    v_mfma_f32_32x32x16_bf16 v[48:63], v[244:247], a[152:155], v[48:63]
    v_mfma_f32_32x32x16_bf16 v[32:47], v[240:243], a[152:155], v[32:47]
    v_mfma_f32_32x32x16_bf16 v[48:63], v[252:255], a[156:159], v[48:63]
    v_mfma_f32_32x32x16_bf16 v[32:47], v[248:251], a[156:159], v[32:47]
    s_add_u32 s66, s42, 6144
    s_addc_u32 s67, s43, 0
    global_load_dwordx4 a[96:99], v1, s[66:67] offset:-4096 sc1
    global_load_dwordx4 a[100:103], v1, s[66:67] offset:-3072 sc1
    global_load_dwordx4 a[104:107], v1, s[66:67] offset:0 sc1
    global_load_dwordx4 a[108:111], v1, s[66:67] offset:1024 sc1
    s_add_u32 s66, s42, 14336
    s_addc_u32 s67, s43, 0
    global_load_dwordx4 a[112:115], v1, s[66:67] offset:-4096 sc1
    global_load_dwordx4 a[116:119], v1, s[66:67] offset:-3072 sc1
    global_load_dwordx4 a[120:123], v1, s[66:67] offset:2048 sc1
    global_load_dwordx4 a[124:127], v1, s[66:67] offset:3072 sc1
    s_add_u32 s66, s42, 24576
    s_addc_u32 s67, s43, 0
    global_load_dwordx4 a[128:131], v1, s[66:67] offset:-4096 sc1
    global_load_dwordx4 a[132:135], v1, s[66:67] offset:-3072 sc1
    global_load_dwordx4 a[136:139], v1, s[66:67] offset:0 sc1
    global_load_dwordx4 a[140:143], v1, s[66:67] offset:1024 sc1
    s_waitcnt vmcnt(0)
    v_mfma_f32_32x32x16_bf16 v[48:63], a[4:7], a[96:99], v[48:63]
    v_mfma_f32_32x32x16_bf16 v[32:47], a[0:3], a[96:99], v[32:47]
    v_mfma_f32_32x32x16_bf16 v[48:63], a[12:15], a[100:103], v[48:63]
    v_mfma_f32_32x32x16_bf16 v[32:47], a[8:11], a[100:103], v[32:47]
    v_mfma_f32_32x32x16_bf16 v[48:63], a[20:23], a[104:107], v[48:63]
    v_mfma_f32_32x32x16_bf16 v[32:47], a[16:19], a[104:107], v[32:47]
    v_mfma_f32_32x32x16_bf16 v[48:63], a[28:31], a[108:111], v[48:63]
    v_mfma_f32_32x32x16_bf16 v[32:47], a[24:27], a[108:111], v[32:47]
    v_mfma_f32_32x32x16_bf16 v[48:63], a[36:39], a[112:115], v[48:63]
    v_mfma_f32_32x32x16_bf16 v[32:47], a[32:35], a[112:115], v[32:47]
    v_mfma_f32_32x32x16_bf16 v[48:63], a[44:47], a[116:119], v[48:63]
    v_mfma_f32_32x32x16_bf16 v[32:47], a[40:43], a[116:119], v[32:47]
    v_mfma_f32_32x32x16_bf16 v[48:63], a[52:55], a[120:123], v[48:63]
    v_mfma_f32_32x32x16_bf16 v[48:63], a[60:63], a[124:127], v[48:63]
    v_mfma_f32_32x32x16_bf16 v[48:63], a[68:71], a[128:131], v[48:63]
    v_mfma_f32_32x32x16_bf16 v[48:63], a[76:79], a[132:135], v[48:63]
    v_mfma_f32_32x32x16_bf16 v[48:63], a[84:87], a[136:139], v[48:63]
    v_mfma_f32_32x32x16_bf16 v[48:63], a[92:95], a[140:143], v[48:63]
    v_mfma_f32_32x32x16_bf16 v[32:47], a[48:51], a[120:123], v[32:47]
    v_mfma_f32_32x32x16_bf16 v[32:47], a[56:59], a[124:127], v[32:47]
    v_mfma_f32_32x32x16_bf16 v[32:47], a[64:67], a[128:131], v[32:47]
    v_mfma_f32_32x32x16_bf16 v[32:47], a[72:75], a[132:135], v[32:47]
    s_add_u32 s66, s42, 118784
    s_addc_u32 s67, s43, 0
    global_load_dwordx4 a[144:147], v1, s[66:67] offset:-4096 sc1
    global_load_dwordx4 a[148:151], v1, s[66:67] offset:-3072 sc1
    global_load_dwordx4 a[152:155], v1, s[66:67] offset:0 sc1
    global_load_dwordx4 a[156:159], v1, s[66:67] offset:1024 sc1
    s_add_u32 s66, s42, 126976
    s_addc_u32 s67, s43, 0
    global_load_dwordx4 a[96:99], v1, s[66:67] offset:-4096 sc1
    global_load_dwordx4 a[100:103], v1, s[66:67] offset:-3072 sc1
    global_load_dwordx4 a[104:107], v1, s[66:67] offset:0 sc1
    global_load_dwordx4 a[108:111], v1, s[66:67] offset:1024 sc1
    global_load_dwordx4 a[112:115], v1, s[66:67] offset:2048 sc1
    global_load_dwordx4 a[116:119], v1, s[66:67] offset:3072 sc1
    s_waitcnt vmcnt(0) lgkmcnt(0)
    s_branch Lf2st_314
Lslow_332:
    s_mov_b64 exec, 1
    buffer_store_byte v5, off, s[4:7], s21 offset:1664 sc1
    s_mov_b64 exec, -1
    s_nop 4
    s_branch Lback_333
Lredo_334:
    s_cmp_eq_u32 s3, 14
    s_nop 4
    s_cbranch_scc1 Lback_335
    s_mov_b32 s3, 14
    s_waitcnt vmcnt(0)
    s_cmp_eq_u32 s12, 0
    s_cbranch_scc1 Lblkp_338
    buffer_store_byte v5, off, s[4:7], s21 offset:1664
    s_branch Lblk_336
Lblkp_338:
    s_mov_b64 exec, 1
    buffer_store_byte v5, off, s[4:7], s21 offset:1664 sc1
    s_mov_b64 exec, -1
Lblk_336:
    s_sub_u32 s13, s13, 1
    s_cmp_lt_i32 s13, 0
    s_cbranch_scc1 Lblke_337
    buffer_load_dwordx2 v[14:15], off, s[4:7], s22 offset:1664 sc1
    s_waitcnt vmcnt(0)
    v_and_b32 v14, v14, v15
    s_nop 0
    v_readfirstlane_b32 s60, v14
    s_nop 0
    s_cmp_eq_u32 s60, 0x01010101
    s_nop 1
    s_cbranch_scc0 Lblk_336
Lblke_337:
    s_add_u32 s66, s42, 118784
    s_addc_u32 s67, s43, 0
    global_load_dwordx4 a[144:147], v1, s[66:67] offset:-4096 sc1
    global_load_dwordx4 a[148:151], v1, s[66:67] offset:-3072 sc1
    global_load_dwordx4 a[152:155], v1, s[66:67] offset:0 sc1
    global_load_dwordx4 a[156:159], v1, s[66:67] offset:1024 sc1
    s_add_u32 s66, s42, 126976
    s_addc_u32 s67, s43, 0
    global_load_dwordx4 a[96:99], v1, s[66:67] offset:-4096 sc1
    global_load_dwordx4 a[100:103], v1, s[66:67] offset:-3072 sc1
    global_load_dwordx4 a[104:107], v1, s[66:67] offset:0 sc1
    global_load_dwordx4 a[108:111], v1, s[66:67] offset:1024 sc1
    global_load_dwordx4 a[112:115], v1, s[66:67] offset:2048 sc1
    global_load_dwordx4 a[116:119], v1, s[66:67] offset:3072 sc1
    s_add_u32 s66, s42, 137216
    s_addc_u32 s67, s43, 0
    global_load_dwordx4 a[120:123], v1, s[66:67] offset:-4096 sc1
    global_load_dwordx4 a[124:127], v1, s[66:67] offset:-3072 sc1
    s_add_u32 s66, s42, 141312
    s_addc_u32 s67, s43, 0
    global_load_dwordx4 a[128:131], v1, s[66:67] offset:-4096 sc1
    global_load_dwordx4 a[132:135], v1, s[66:67] offset:-3072 sc1
    global_load_dwordx4 a[136:139], v1, s[66:67] offset:0 sc1
    global_load_dwordx4 a[140:143], v1, s[66:67] offset:1024 sc1
    s_waitcnt vmcnt(0) lgkmcnt(0)
    s_branch Lf2st_331
Lend_1:
    s_endpgm
.section .rodata,"a"
.p2align 6
.amdhsa_kernel interleave_layers__grouped_kv_mqa__dense_activation_silu__prompt_kernel
  .amdhsa_next_free_vgpr 512
  .amdhsa_next_free_sgpr 102
  .amdhsa_accum_offset 256
  .amdhsa_group_segment_fixed_size 0
  .amdhsa_kernarg_size 88
  .amdhsa_user_sgpr_count 2
  .amdhsa_user_sgpr_kernarg_segment_ptr 1
  .amdhsa_system_sgpr_workgroup_id_x 1
.end_amdhsa_kernel
```
